```python
import torch

def _softmax(x, axis=-1):
    return torch.softmax(x, dim=axis)

def _gelu(x):
    return torch.nn.functional.gelu(x, approximate='tanh')

def _silu(x):
    return torch.nn.functional.silu(x)

def _sigmoid(x):
    return torch.sigmoid(x)

def _layernorm(x, axis=-1, eps=1e-05):
    m = x.mean(dim=axis, keepdim=True)
    v = x.var(dim=axis, keepdim=True, unbiased=False)
    return (x - m) / torch.sqrt(v + eps)

def _scatter_add(tgt, idx, src, axis=0):
    return tgt.clone().index_add_(axis, idx, src)

def _segment_sum(src, seg, n):
    out = torch.zeros((n,) + src.shape[1:], dtype=src.dtype)
    return out.index_add_(0, seg, src)

def _pad(x, pw):
    flat = tuple((v for pair in reversed(pw) for v in pair))
    return torch.nn.functional.pad(x, flat)
kernel_name = 'sequential_preLN__sliding_block__mixer_gmlp__prompt'

def setup_inputs():

    _w = lambda a: (lambda t: t.to(torch.bfloat16) if t.is_floating_point() else t)(torch.as_tensor(a))

    def _A_setup():
        B, S, D = (1, 2048, 576)
        return {'x': _w((lambda *s: torch.randn(*s, dtype=torch.bfloat16) * 0.05)(B, S, D)), 'wqkv': _w((lambda *s: torch.randn(*s, dtype=torch.bfloat16) * 0.05)(D, 3 * D)), 'wo': _w((lambda *s: torch.randn(*s, dtype=torch.bfloat16) * 0.05)(D, D))}
    _A_in = _A_setup()

    def _B_setup():
        B, S, D, F = (1, 2048, 576, 4608)
        Fh = F // 2
        return {'x': _w((lambda *s: torch.randn(*s, dtype=torch.bfloat16) * 0.05)(B, S, D)), 'w_in': _w((lambda *s: torch.randn(*s, dtype=torch.bfloat16) * 0.8)(D, 2 * Fh)), 'w_sp': _w(0.01 * (lambda *s: torch.randn(*s, dtype=torch.bfloat16) * 0.8)(S, S)), 'b_sp': _w(1.0 + 0.01 * (lambda *s: torch.randn(*s, dtype=torch.bfloat16) * 0.05)(S)), 'w_out': _w((lambda *s: torch.randn(*s, dtype=torch.bfloat16) * 0.05)(Fh, D))}
    _B_in = _B_setup()
    return {'A_x': _A_in['x'], 'A_wqkv': _A_in['wqkv'], 'A_wo': _A_in['wo'], 'B_x': _B_in['x'], 'B_w_in': _B_in['w_in'], 'B_w_sp': _B_in['w_sp'], 'B_b_sp': _B_in['b_sp'], 'B_w_out': _B_in['w_out']}

def reference(A_x, A_wqkv, A_wo, B_x, B_w_in, B_w_sp, B_b_sp, B_w_out):

    def _A_ref(x, wqkv, wo):
        B, S, D = x.shape
        H = 32
        Dh = D // H
        W = 256
        qkv = (lambda x, *d: x.permute(*d))((x @ wqkv).reshape(B, S, 3, H, Dh), 2, 0, 3, 1, 4)
        q, k, v = (qkv[0], qkv[1], qkv[2])
        scores = torch.einsum('bhqd,bhkd->bhqk', q, k) * Dh ** (-0.5)
        idx = torch.arange(S)
        mask = (idx[:, None] - idx[None, :] >= 0) & (idx[:, None] - idx[None, :] < W)
        scores = torch.where(mask[None, None], scores, -1000000000.0)
        p = _softmax(scores, axis=-1)
        o = torch.einsum('bhqk,bhkd->bhqd', p, v)
        return (lambda x, *d: x.permute(*d))(o, 0, 2, 1, 3).reshape(B, S, D) @ wo

    def _B_ref(x, w_in, w_sp, b_sp, w_out):
        B, S, D = x.shape
        F = w_in.shape[-1]
        Fh = F // 2
        z = _gelu(torch.einsum('bsd,df->bsf', x, w_in))
        z1 = z[..., :Fh].clone()
        z2 = _layernorm(z[..., Fh:], axis=-1)
        g = torch.einsum('ts,bsf->btf', w_sp, z2) + b_sp[None, :, None]
        return torch.einsum('bsf,fd->bsd', z1 * g, w_out)
    x = A_x
    h = x + _A_ref(_layernorm(x, axis=-1), A_wqkv, A_wo)
    h2 = h + _B_ref(_layernorm(h, axis=-1), B_w_in, B_w_sp, B_b_sp, B_w_out)
    return h2
```

```asm
; @launch grid=(256,1,1) block=(512,1,1) lds=163840
.amdgcn_target "amdgcn-amd-amdhsa--gfx950"
.text
.globl sequential_preLN__sliding_block__mixer_gmlp__prompt_kernel
.p2align 8
.type sequential_preLN__sliding_block__mixer_gmlp__prompt_kernel,@function
sequential_preLN__sliding_block__mixer_gmlp__prompt_kernel:
    s_cmp_ge_u32 s2, 256
    s_cbranch_scc1 sequential_preLN__sliding_block__mixer_gmlp__prompt_kernel_end
    s_load_dwordx4 s[4:7], s[0:1], 40
    s_load_dwordx2 s[40:41], s[0:1], 80
    s_load_dwordx2 s[8:9], s[0:1], 0
    s_load_dwordx2 s[12:13], s[0:1], 56
    s_load_dwordx4 s[24:27], s[0:1], 0
    s_load_dwordx2 s[48:49], s[0:1], 32
    s_load_dwordx2 s[50:51], s[0:1], 16
    s_load_dwordx2 s[44:45], s[0:1], 72
    v_lshrrev_b32 v2, 6, v0
    v_and_b32 v1, 63, v0
    v_readfirstlane_b32 s20, v2
    s_nop 0
    s_and_b32 s23, s20, 3
    v_mov_b32 v8, 0
    v_lshlrev_b32 v9, 2, v1
    v_add_u32 v9, 147456, v9
    ds_write_b32 v9, v8
    s_and_b32 s38, s2, 7
    s_lshr_b32 s39, s2, 3
    s_cmp_lt_u32 s39, 8
    s_cbranch_scc1 sequential_preLN__sliding_block__mixer_gmlp__prompt_kernel_side
    s_sub_u32 s39, s39, 8
    s_and_b32 s21, s38, 3
    s_lshl_b32 s21, s21, 2
    s_and_b32 s42, s39, 3
    s_add_u32 s21, s21, s42
    s_lshr_b32 s38, s38, 2
    s_mul_i32 s38, s38, 6
    s_lshr_b32 s43, s39, 2
    s_add_u32 s22, s43, s38
    s_cmp_lt_u32 s20, 4
    s_cbranch_scc1 sequential_preLN__sliding_block__mixer_gmlp__prompt_kernel_c1
    v_lshlrev_b32 v3, 4, v1
    v_lshrrev_b32_e64 v11, 3, v1
    v_mul_u32_u24 v12, 1152, v11
    v_and_b32 v13, 7, v1
    v_lshrrev_b32 v14, 4, v1
    v_xor_b32_e64 v13, v13, v14
    v_lshl_add_u32 v4, v13, 4, v12
    v_xor_b32_e64 v13, 4, v13
    v_lshl_add_u32 v5, v13, 4, v12
    v_add_u32 v5, 9216, v5
    s_mul_i32 s42, s42, 2
    s_mul_i32 s43, s43, 3
    s_lshr_b32 s43, s43, 0
    s_add_u32 s33, s42, s43
    s_mul_i32 s38, s33, 29
    s_lshr_b32 s38, s38, 8
    s_mul_i32 s38, s38, 9
    s_sub_u32 s33, s33, s38
    s_mul_i32 s53, s21, 147456
    s_mul_i32 s39, s23, 36864
    s_add_u32 s53, s53, s39
    s_lshl_b32 s39, s33, 7
    s_add_u32 s53, s53, s39
    s_add_u32 s54, s53, 18432
    s_mul_i32 s55, s22, 288
    s_mul_i32 s39, s33, 221184
    s_add_u32 s55, s55, s39
    s_lshl_b32 s14, s23, 12
    s_add_u32 s15, s14, 65536
    s_and_b32 s39, s23, 1
    s_lshl_b32 s39, s39, 10
    s_add_u32 s32, s39, 81920
    s_cmp_lt_u32 s23, 2
    s_cselect_b64 s[34:35], -1, 0
    s_cselect_b64 s[36:37], 0, -1
    s_waitcnt lgkmcnt(0)
    s_mov_b32 s28, s26
    s_mov_b32 s29, s27
    s_mov_b32 s30, 1990656
    s_mov_b32 s31, 0x20000
    s_mov_b32 s26, 2359296
    s_mov_b32 s27, 0x20000
    s_add_u32 m0, s14, 0
    s_nop 0
    buffer_load_dwordx4 v4, s[24:27], s53 offen lds
    s_add_u32 m0, s14, 1024
    s_nop 0
    buffer_load_dwordx4 v5, s[24:27], s53 offen lds
    s_add_u32 m0, s14, 2048
    s_nop 0
    buffer_load_dwordx4 v4, s[24:27], s54 offen lds
    s_add_u32 m0, s14, 3072
    s_nop 0
    buffer_load_dwordx4 v5, s[24:27], s54 offen lds
    s_mul_i32 s38, s23, 256
    s_add_u32 s38, s38, 0
    v_add_u32 v11, s38, v1
    v_mul_u32_u24 v12, 911, v11
    v_lshrrev_b32 v12, 14, v12
    v_mul_u32_u24 v13, 18, v12
    v_sub_u32_e64 v13, v11, v13
    v_bfe_u32 v14, v12, 0, 2
    v_mul_u32_u24 v16, 3456, v14
    v_bfe_u32 v14, v12, 2, 2
    s_mov_b32 s39, 27648
    v_mad_u32_u24 v16, v14, s39, v16
    v_bfe_u32 v14, v12, 4, 1
    s_mov_b32 s39, 13824
    v_mad_u32_u24 v16, v14, s39, v16
    v_bfe_u32 v14, v12, 5, 1
    s_mov_b32 s39, 110592
    v_mad_u32_u24 v16, v14, s39, v16
    v_lshl_add_u32 v16, v13, 4, v16
    s_mul_i32 s38, s23, 256
    s_add_u32 s38, s38, 64
    v_add_u32 v11, s38, v1
    v_mul_u32_u24 v12, 911, v11
    v_lshrrev_b32 v12, 14, v12
    v_mul_u32_u24 v13, 18, v12
    v_sub_u32_e64 v13, v11, v13
    v_bfe_u32 v14, v12, 0, 2
    v_mul_u32_u24 v17, 3456, v14
    v_bfe_u32 v14, v12, 2, 2
    s_mov_b32 s39, 27648
    v_mad_u32_u24 v17, v14, s39, v17
    v_bfe_u32 v14, v12, 4, 1
    s_mov_b32 s39, 13824
    v_mad_u32_u24 v17, v14, s39, v17
    v_bfe_u32 v14, v12, 5, 1
    s_mov_b32 s39, 110592
    v_mad_u32_u24 v17, v14, s39, v17
    v_lshl_add_u32 v17, v13, 4, v17
    s_mul_i32 s38, s23, 256
    s_add_u32 s38, s38, 128
    v_add_u32_e64 v11, s38, v1
    v_mul_u32_u24 v12, 911, v11
    v_lshrrev_b32 v12, 14, v12
    v_mul_u32_u24 v13, 18, v12
    v_sub_u32_e64 v13, v11, v13
    v_bfe_u32 v14, v12, 0, 2
    v_mul_u32_u24 v18, 3456, v14
    v_bfe_u32 v14, v12, 2, 2
    s_mov_b32 s39, 27648
    v_mad_u32_u24 v18, v14, s39, v18
    v_bfe_u32 v14, v12, 4, 1
    s_mov_b32 s39, 13824
    v_mad_u32_u24 v18, v14, s39, v18
    v_bfe_u32 v14, v12, 5, 1
    s_mov_b32 s39, 110592
    v_mad_u32_u24 v18, v14, s39, v18
    v_lshl_add_u32 v18, v13, 4, v18
    s_mul_i32 s38, s23, 256
    s_add_u32 s38, s38, 192
    v_add_u32_e64 v11, s38, v1
    v_mul_u32_u24 v12, 911, v11
    v_lshrrev_b32 v12, 14, v12
    v_mul_u32_u24 v13, 18, v12
    v_sub_u32_e64 v13, v11, v13
    v_bfe_u32 v14, v12, 0, 2
    v_mul_u32_u24 v19, 3456, v14
    v_bfe_u32 v14, v12, 2, 2
    s_mov_b32 s39, 27648
    v_mad_u32_u24 v19, v14, s39, v19
    v_bfe_u32 v14, v12, 4, 1
    s_mov_b32 s39, 13824
    v_mad_u32_u24 v19, v14, s39, v19
    v_bfe_u32 v14, v12, 5, 1
    s_mov_b32 s39, 110592
    v_mad_u32_u24 v19, v14, s39, v19
    v_lshl_add_u32 v19, v13, 4, v19
    s_and_b32 s38, s23, 1
    s_lshl_b32 s38, s38, 6
    s_add_u32 s38, s38, 1024
    v_add_u32_e64 v11, s38, v1
    v_mul_u32_u24 v12, 911, v11
    v_lshrrev_b32 v12, 14, v12
    v_mul_u32_u24 v13, 18, v12
    v_sub_u32_e64 v13, v11, v13
    v_bfe_u32 v14, v12, 0, 2
    v_mul_u32_u24 v20, 3456, v14
    v_bfe_u32 v14, v12, 2, 2
    s_mov_b32 s39, 27648
    v_mad_u32_u24 v20, v14, s39, v20
    v_bfe_u32 v14, v12, 4, 1
    s_mov_b32 s39, 13824
    v_mad_u32_u24 v20, v14, s39, v20
    v_bfe_u32 v14, v12, 5, 1
    s_mov_b32 s39, 110592
    v_mad_u32_u24 v20, v14, s39, v20
    v_lshl_add_u32 v20, v13, 4, v20
    s_add_u32 m0, s15, 0
    s_nop 0
    buffer_load_dwordx4 v16, s[28:31], s55 offen lds
    s_add_u32 m0, s15, 1024
    s_nop 0
    buffer_load_dwordx4 v17, s[28:31], s55 offen lds
    s_add_u32 m0, s15, 2048
    s_nop 0
    buffer_load_dwordx4 v18, s[28:31], s55 offen lds
    s_add_u32 m0, s15, 3072
    s_nop 0
    buffer_load_dwordx4 v19, s[28:31], s55 offen lds
    s_add_u32 m0, s32, 0
    s_mov_b64 exec, s[34:35]
    buffer_load_dwordx4 v20, s[28:31], s55 offen lds
    s_mov_b64 exec, -1
    s_add_u32 s33, s33, 1
    s_cmp_eq_u32 s33, 9
    s_movk_i32 s38, 128
    s_cselect_b32 s38, 4294966272, s38
    s_mov_b32 s39, 221184
    s_cselect_b32 s39, 4293197824, s39
    s_add_u32 s53, s53, s38
    s_add_u32 s54, s54, s38
    s_add_u32 s55, s55, s39
    s_add_u32 m0, s14, 16384
    s_nop 0
    buffer_load_dwordx4 v4, s[24:27], s53 offen lds
    s_add_u32 m0, s14, 17408
    s_nop 0
    buffer_load_dwordx4 v5, s[24:27], s53 offen lds
    s_add_u32 m0, s14, 18432
    s_nop 0
    buffer_load_dwordx4 v4, s[24:27], s54 offen lds
    s_add_u32 m0, s14, 19456
    s_nop 0
    buffer_load_dwordx4 v5, s[24:27], s54 offen lds
    s_add_u32 m0, s15, 18432
    s_nop 0
    buffer_load_dwordx4 v16, s[28:31], s55 offen lds
    s_add_u32 m0, s15, 19456
    s_nop 0
    buffer_load_dwordx4 v17, s[28:31], s55 offen lds
    s_add_u32 m0, s15, 20480
    s_nop 0
    buffer_load_dwordx4 v18, s[28:31], s55 offen lds
    s_add_u32 m0, s15, 21504
    s_nop 0
    buffer_load_dwordx4 v19, s[28:31], s55 offen lds
    s_add_u32 m0, s32, 18432
    s_mov_b64 exec, s[36:37]
    buffer_load_dwordx4 v20, s[28:31], s55 offen lds
    s_mov_b64 exec, -1
    s_add_u32 s33, s33, 1
    s_cmp_eq_u32 s33, 9
    s_movk_i32 s38, 128
    s_cselect_b32 s38, 4294966272, s38
    s_mov_b32 s39, 221184
    s_cselect_b32 s39, 4293197824, s39
    s_add_u32 s53, s53, s38
    s_add_u32 s54, s54, s38
    s_add_u32 s55, s55, s39
    s_mov_b32 s16, s40
    s_mov_b32 s17, s41
    s_mov_b32 s18, 268435456
    s_mov_b32 s19, 0x20000
    s_mov_b32 s46, 256
    s_mov_b32 s47, 0x20000
    v_mov_b32 v8, 128
    s_waitcnt vmcnt(8)
    s_barrier
    s_add_u32 m0, s14, 32768
    s_nop 0
    buffer_load_dwordx4 v4, s[24:27], s53 offen lds
    s_add_u32 m0, s14, 33792
    s_nop 0
    buffer_load_dwordx4 v5, s[24:27], s53 offen lds
    s_add_u32 m0, s14, 34816
    s_nop 0
    buffer_load_dwordx4 v4, s[24:27], s54 offen lds
    s_add_u32 m0, s14, 35840
    s_nop 0
    buffer_load_dwordx4 v5, s[24:27], s54 offen lds
    s_add_u32 m0, s15, 36864
    s_nop 0
    buffer_load_dwordx4 v16, s[28:31], s55 offen lds
    s_add_u32 m0, s15, 37888
    s_nop 0
    buffer_load_dwordx4 v17, s[28:31], s55 offen lds
    s_add_u32 m0, s15, 38912
    s_nop 0
    buffer_load_dwordx4 v18, s[28:31], s55 offen lds
    s_add_u32 m0, s15, 39936
    s_nop 0
    buffer_load_dwordx4 v19, s[28:31], s55 offen lds
    s_add_u32 m0, s32, 36864
    s_mov_b64 exec, s[34:35]
    buffer_load_dwordx4 v20, s[28:31], s55 offen lds
    s_mov_b64 exec, -1
    s_add_u32 s33, s33, 1
    s_cmp_eq_u32 s33, 9
    s_movk_i32 s38, 128
    s_cselect_b32 s38, 4294966272, s38
    s_mov_b32 s39, 221184
    s_cselect_b32 s39, 4293197824, s39
    s_add_u32 s53, s53, s38
    s_add_u32 s54, s54, s38
    s_add_u32 s55, s55, s39
    s_waitcnt vmcnt(8)
    s_barrier
    s_add_u32 m0, s14, 49152
    s_nop 0
    buffer_load_dwordx4 v4, s[24:27], s53 offen lds
    s_add_u32 m0, s14, 50176
    s_nop 0
    buffer_load_dwordx4 v5, s[24:27], s53 offen lds
    s_add_u32 m0, s14, 51200
    s_nop 0
    buffer_load_dwordx4 v4, s[24:27], s54 offen lds
    s_add_u32 m0, s14, 52224
    s_nop 0
    buffer_load_dwordx4 v5, s[24:27], s54 offen lds
    s_add_u32 m0, s15, 55296
    s_nop 0
    buffer_load_dwordx4 v16, s[28:31], s55 offen lds
    s_add_u32 m0, s15, 56320
    s_nop 0
    buffer_load_dwordx4 v17, s[28:31], s55 offen lds
    s_add_u32 m0, s15, 57344
    s_nop 0
    buffer_load_dwordx4 v18, s[28:31], s55 offen lds
    s_add_u32 m0, s15, 58368
    s_nop 0
    buffer_load_dwordx4 v19, s[28:31], s55 offen lds
    s_add_u32 m0, s32, 55296
    s_mov_b64 exec, s[36:37]
    buffer_load_dwordx4 v20, s[28:31], s55 offen lds
    s_mov_b64 exec, -1
    s_add_u32 s33, s33, 1
    s_cmp_eq_u32 s33, 9
    s_movk_i32 s38, 128
    s_cselect_b32 s38, 4294966272, s38
    s_mov_b32 s39, 221184
    s_cselect_b32 s39, 4293197824, s39
    s_add_u32 s53, s53, s38
    s_add_u32 s54, s54, s38
    s_add_u32 s55, s55, s39
    s_waitcnt vmcnt(8)
    s_barrier
    s_add_u32 m0, s14, 0
    s_nop 0
    buffer_load_dwordx4 v4, s[24:27], s53 offen lds
    s_add_u32 m0, s14, 1024
    s_nop 0
    buffer_load_dwordx4 v5, s[24:27], s53 offen lds
    s_add_u32 m0, s14, 2048
    s_nop 0
    buffer_load_dwordx4 v4, s[24:27], s54 offen lds
    s_add_u32 m0, s14, 3072
    s_nop 0
    buffer_load_dwordx4 v5, s[24:27], s54 offen lds
    s_add_u32 m0, s15, 0
    s_nop 0
    buffer_load_dwordx4 v16, s[28:31], s55 offen lds
    s_add_u32 m0, s15, 1024
    s_nop 0
    buffer_load_dwordx4 v17, s[28:31], s55 offen lds
    s_add_u32 m0, s15, 2048
    s_nop 0
    buffer_load_dwordx4 v18, s[28:31], s55 offen lds
    s_add_u32 m0, s15, 3072
    s_nop 0
    buffer_load_dwordx4 v19, s[28:31], s55 offen lds
    s_add_u32 m0, s32, 0
    s_mov_b64 exec, s[34:35]
    buffer_load_dwordx4 v20, s[28:31], s55 offen lds
    s_mov_b64 exec, -1
    s_add_u32 s33, s33, 1
    s_cmp_eq_u32 s33, 9
    s_movk_i32 s38, 128
    s_cselect_b32 s38, 4294966272, s38
    s_mov_b32 s39, 221184
    s_cselect_b32 s39, 4293197824, s39
    s_add_u32 s53, s53, s38
    s_add_u32 s54, s54, s38
    s_add_u32 s55, s55, s39
    s_waitcnt vmcnt(8)
    s_barrier
    s_add_u32 m0, s14, 16384
    s_nop 0
    buffer_load_dwordx4 v4, s[24:27], s53 offen lds
    s_add_u32 m0, s14, 17408
    s_nop 0
    buffer_load_dwordx4 v5, s[24:27], s53 offen lds
    s_add_u32 m0, s14, 18432
    s_nop 0
    buffer_load_dwordx4 v4, s[24:27], s54 offen lds
    s_add_u32 m0, s14, 19456
    s_nop 0
    buffer_load_dwordx4 v5, s[24:27], s54 offen lds
    s_add_u32 m0, s15, 18432
    s_nop 0
    buffer_load_dwordx4 v16, s[28:31], s55 offen lds
    s_add_u32 m0, s15, 19456
    s_nop 0
    buffer_load_dwordx4 v17, s[28:31], s55 offen lds
    s_add_u32 m0, s15, 20480
    s_nop 0
    buffer_load_dwordx4 v18, s[28:31], s55 offen lds
    s_add_u32 m0, s15, 21504
    s_nop 0
    buffer_load_dwordx4 v19, s[28:31], s55 offen lds
    s_add_u32 m0, s32, 18432
    s_mov_b64 exec, s[36:37]
    buffer_load_dwordx4 v20, s[28:31], s55 offen lds
    s_mov_b64 exec, -1
    s_add_u32 s33, s33, 1
    s_cmp_eq_u32 s33, 9
    s_movk_i32 s38, 128
    s_cselect_b32 s38, 4294966272, s38
    s_mov_b32 s39, 221184
    s_cselect_b32 s39, 4293197824, s39
    s_add_u32 s53, s53, s38
    s_add_u32 s54, s54, s38
    s_add_u32 s55, s55, s39
    s_waitcnt vmcnt(8)
    s_barrier
    s_add_u32 m0, s14, 32768
    s_nop 0
    buffer_load_dwordx4 v4, s[24:27], s53 offen lds
    s_add_u32 m0, s14, 33792
    s_nop 0
    buffer_load_dwordx4 v5, s[24:27], s53 offen lds
    s_add_u32 m0, s14, 34816
    s_nop 0
    buffer_load_dwordx4 v4, s[24:27], s54 offen lds
    s_add_u32 m0, s14, 35840
    s_nop 0
    buffer_load_dwordx4 v5, s[24:27], s54 offen lds
    s_add_u32 m0, s15, 36864
    s_nop 0
    buffer_load_dwordx4 v16, s[28:31], s55 offen lds
    s_add_u32 m0, s15, 37888
    s_nop 0
    buffer_load_dwordx4 v17, s[28:31], s55 offen lds
    s_add_u32 m0, s15, 38912
    s_nop 0
    buffer_load_dwordx4 v18, s[28:31], s55 offen lds
    s_add_u32 m0, s15, 39936
    s_nop 0
    buffer_load_dwordx4 v19, s[28:31], s55 offen lds
    s_add_u32 m0, s32, 36864
    s_mov_b64 exec, s[34:35]
    buffer_load_dwordx4 v20, s[28:31], s55 offen lds
    s_mov_b64 exec, -1
    s_add_u32 s33, s33, 1
    s_cmp_eq_u32 s33, 9
    s_movk_i32 s38, 128
    s_cselect_b32 s38, 4294966272, s38
    s_mov_b32 s39, 221184
    s_cselect_b32 s39, 4293197824, s39
    s_add_u32 s53, s53, s38
    s_add_u32 s54, s54, s38
    s_add_u32 s55, s55, s39
    s_waitcnt vmcnt(8)
    s_barrier
    s_add_u32 m0, s14, 49152
    s_nop 0
    buffer_load_dwordx4 v4, s[24:27], s53 offen lds
    s_add_u32 m0, s14, 50176
    s_nop 0
    buffer_load_dwordx4 v5, s[24:27], s53 offen lds
    s_add_u32 m0, s14, 51200
    s_nop 0
    buffer_load_dwordx4 v4, s[24:27], s54 offen lds
    s_add_u32 m0, s14, 52224
    s_nop 0
    buffer_load_dwordx4 v5, s[24:27], s54 offen lds
    s_add_u32 m0, s15, 55296
    s_nop 0
    buffer_load_dwordx4 v16, s[28:31], s55 offen lds
    s_add_u32 m0, s15, 56320
    s_nop 0
    buffer_load_dwordx4 v17, s[28:31], s55 offen lds
    s_add_u32 m0, s15, 57344
    s_nop 0
    buffer_load_dwordx4 v18, s[28:31], s55 offen lds
    s_add_u32 m0, s15, 58368
    s_nop 0
    buffer_load_dwordx4 v19, s[28:31], s55 offen lds
    s_add_u32 m0, s32, 55296
    s_mov_b64 exec, s[36:37]
    buffer_load_dwordx4 v20, s[28:31], s55 offen lds
    s_mov_b64 exec, -1
    s_add_u32 s33, s33, 1
    s_cmp_eq_u32 s33, 9
    s_movk_i32 s38, 128
    s_cselect_b32 s38, 4294966272, s38
    s_mov_b32 s39, 221184
    s_cselect_b32 s39, 4293197824, s39
    s_add_u32 s53, s53, s38
    s_add_u32 s54, s54, s38
    s_add_u32 s55, s55, s39
    s_waitcnt vmcnt(8)
    s_barrier
    s_add_u32 m0, s14, 0
    s_nop 0
    buffer_load_dwordx4 v4, s[24:27], s53 offen lds
    s_add_u32 m0, s14, 1024
    s_nop 0
    buffer_load_dwordx4 v5, s[24:27], s53 offen lds
    s_add_u32 m0, s14, 2048
    s_nop 0
    buffer_load_dwordx4 v4, s[24:27], s54 offen lds
    s_add_u32 m0, s14, 3072
    s_nop 0
    buffer_load_dwordx4 v5, s[24:27], s54 offen lds
    s_add_u32 m0, s15, 0
    s_nop 0
    buffer_load_dwordx4 v16, s[28:31], s55 offen lds
    s_add_u32 m0, s15, 1024
    s_nop 0
    buffer_load_dwordx4 v17, s[28:31], s55 offen lds
    s_add_u32 m0, s15, 2048
    s_nop 0
    buffer_load_dwordx4 v18, s[28:31], s55 offen lds
    s_add_u32 m0, s15, 3072
    s_nop 0
    buffer_load_dwordx4 v19, s[28:31], s55 offen lds
    s_add_u32 m0, s32, 0
    s_mov_b64 exec, s[34:35]
    buffer_load_dwordx4 v20, s[28:31], s55 offen lds
    s_mov_b64 exec, -1
    s_add_u32 s33, s33, 1
    s_cmp_eq_u32 s33, 9
    s_movk_i32 s38, 128
    s_cselect_b32 s38, 4294966272, s38
    s_mov_b32 s39, 221184
    s_cselect_b32 s39, 4293197824, s39
    s_add_u32 s53, s53, s38
    s_add_u32 s54, s54, s38
    s_add_u32 s55, s55, s39
    s_waitcnt vmcnt(8)
    s_barrier
    buffer_load_dword v10, v8, s[44:47], 0 offen sc1
    s_waitcnt vmcnt(1)
    s_barrier
    s_waitcnt vmcnt(0)
    v_cmp_gt_u32 vcc, 1, v10
    s_mov_b32 s52, 0x10000
    v_mov_b32 v9, 147468
    s_nop 2
    s_cbranch_vccnz sequential_preLN__sliding_block__mixer_gmlp__prompt_kernel_c1poll
sequential_preLN__sliding_block__mixer_gmlp__prompt_kernel_c1poll_ok:
    v_mov_b32_e64 v10, 1
    ds_write_b32 v9, v10
    s_waitcnt lgkmcnt(0)
    s_barrier
    s_setprio 0
    s_branch sequential_preLN__sliding_block__mixer_gmlp__prompt_kernel_p1done
sequential_preLN__sliding_block__mixer_gmlp__prompt_kernel_c1:
    v_and_b32 v11, 15, v1
    v_lshrrev_b32 v12, 4, v1
    v_lshrrev_b32 v13, 1, v11
    v_xor_b32 v12, v12, v13
    v_lshlrev_b32_e64 v12, 4, v12
    v_lshl_add_u32 v12, v11, 7, v12
    s_lshl_b32 s38, s20, 12
    v_add_u32 v4, s38, v12
    v_xor_b32 v5, 64, v4
    v_lshrrev_b32 v11, 2, v1
    v_mul_u32_u24 v11, 288, v11
    v_add_u32 v11, 65536, v11
    v_and_b32_e64 v12, 3, v1
    v_lshl_add_u32 v6, v12, 3, v11
    v_add_u32 v7, 55296, v6
    v_mul_u32_u24 v8, 72, v12
    v_add3_u32 v8, v8, v11, 32
    v_add_u32 v9, 55296, v8
    s_waitcnt lgkmcnt(0)
    s_mov_b32 s16, s40
    s_mov_b32 s17, s41
    s_mov_b32 s18, 268435456
    s_mov_b32 s19, 0x20000
    s_add_u32 s24, s40, 4718592
    s_addc_u32 s25, s41, 0
    s_mov_b32 s26, 2359296
    s_mov_b32 s27, 0x20000
    s_cmp_lt_u32 s22, 8
    s_cselect_b32 s33, 72, 64
    s_add_u32 s38, s20, 0
    s_and_b32 s50, s38, 3
    s_mul_i32 s38, s50, s33
    v_add_u32 v218, s38, v6
    v_add_u32 v219, s38, v7
    s_add_u32 s38, s20, 1
    s_and_b32 s51, s38, 3
    s_mul_i32 s38, s51, s33
    v_add_u32 v220, s38, v6
    v_add_u32 v221, s38, v7
    s_add_u32 s38, s20, 2
    s_and_b32 s52, s38, 3
    s_mul_i32 s38, s52, s33
    v_add_u32 v222, s38, v6
    v_add_u32 v223, s38, v7
    s_add_u32 s38, s20, 3
    s_and_b32 s53, s38, 3
    s_mul_i32 s38, s53, s33
    v_add_u32 v224, s38, v6
    v_add_u32 v225, s38, v7
    s_lshl_b32 s44, s21, 2
    s_add_u32 s44, s44, s20
    s_lshl_b32 s43, s21, 4
    s_add_u32 s43, s43, s22
    s_lshl_b32 s43, s43, 7
    s_add_u32 s43, s43, 15663104
    v_and_b32 v11, 15, v1
    v_lshrrev_b32_e64 v12, 4, v1
    s_lshl_b32 s45, s20, 8
    s_add_u32 s45, s45, 139264
    v_lshlrev_b32_e64 v3, 4, v1
    v_mov_b32 v192, 0x3f803f80
    v_mov_b32 v193, 0x3f803f80
    v_mov_b32 v194, 0x3f803f80
    v_mov_b32 v195, 0x3f803f80
    v_lshrrev_b32 v13, 2, v11
    v_and_b32 v14, 3, v1
    v_lshl_add_u32 v212, v11, 2, s45
    v_cmp_eq_u32_e64 vcc, v12, v13
    v_mov_b32 v2, 141312
    s_nop 0
    v_cndmask_b32 v212, v2, v212, vcc
    v_cmp_eq_u32 s[30:31], 1, v14
    v_cmp_eq_u32 s[34:35], 2, v14
    v_cmp_eq_u32 s[36:37], 3, v14
    s_mov_b32 s28, 987991609
    s_mov_b32 s32, 925353388
    s_cmp_lt_u32 s22, 4
    s_cselect_b32 s29, 1051597459, 1.0
    s_lshl_b32 s38, s20, 7
    s_add_u32 s38, s38, 140288
    v_lshl_add_u32 v246, v11, 2, s38
    v_lshlrev_b32_e64 v247, 2, v11
    v_add_u32 v247, 140800, v247
    s_cmp_ge_u32 s22, 8
    s_cbranch_scc1 sequential_preLN__sliding_block__mixer_gmlp__prompt_kernel_v1
    v_lshl_add_u32 v13, v11, 2, s45
    v_lshlrev_b32_e64 v14, 4, v12
    v_add_u32 v14, 140288, v14
    s_and_b32 s46, s22, 3
    s_lshl_b32 s47, s46, 19
    s_lshl_b32 s48, s44, 10
    s_add_u32 s47, s47, s48
    s_cmp_lt_u32 s22, 4
    s_mov_b32 s48, 0
    s_cselect_b32 s48, s48, 2097152
    s_mov_b32 s49, 4194304
    s_cselect_b32 s49, s49, 4456448
    s_add_u32 s47, s47, s48
    s_lshl_b32 s38, s50, 7
    v_add_u32 v238, s38, v14
    s_lshl_b32 s50, s50, 17
    s_add_u32 s50, s50, s47
    s_lshl_b32 s38, s51, 7
    v_add_u32 v239, s38, v14
    s_lshl_b32 s51, s51, 17
    s_add_u32 s51, s51, s47
    s_lshl_b32 s38, s52, 7
    v_add_u32 v240, s38, v14
    s_lshl_b32 s52, s52, 17
    s_add_u32 s52, s52, s47
    s_lshl_b32 s38, s53, 7
    v_add_u32 v241, s38, v14
    s_lshl_b32 s53, s53, 17
    s_add_u32 s53, s53, s47
    s_lshl_b32 s46, s46, 16
    s_add_u32 s49, s49, s46
    s_lshl_b32 s46, s44, 7
    s_add_u32 s49, s49, s46
    v_and_b32 v10, 31, v1
    v_lshlrev_b32 v10, 2, v10
    v_lshrrev_b32 v15, 5, v1
    v_lshl_add_u32 v10, v15, 15, v10
    s_barrier
    ds_read_b128 v[88:91], v4 offset:0
    ds_read_b128 v[92:95], v4 offset:2048
    ds_read_b64_tr_b16 v[96:97], v218 offset:0
    ds_read_b64_tr_b16 v[98:99], v218 offset:4608
    ds_read_b64_tr_b16 v[100:101], v218 offset:40
    ds_read_b64_tr_b16 v[102:103], v218 offset:4648
    ds_read_b64_tr_b16 v[104:105], v220 offset:0
    ds_read_b64_tr_b16 v[106:107], v220 offset:4608
    ds_read_b64_tr_b16 v[108:109], v220 offset:40
    ds_read_b64_tr_b16 v[110:111], v220 offset:4648
    ds_read_b64_tr_b16 v[112:113], v222 offset:0
    ds_read_b64_tr_b16 v[114:115], v222 offset:4608
    ds_read_b64_tr_b16 v[116:117], v222 offset:40
    ds_read_b64_tr_b16 v[118:119], v222 offset:4648
    ds_read_b64_tr_b16 v[120:121], v224 offset:0
    ds_read_b64_tr_b16 v[122:123], v224 offset:4608
    ds_read_b64_tr_b16 v[124:125], v224 offset:40
    ds_read_b64_tr_b16 v[126:127], v224 offset:4648
    ds_read_b64_tr_b16 v[128:129], v8 offset:0
    ds_read_b64_tr_b16 v[130:131], v8 offset:4608
    s_waitcnt lgkmcnt(0)
    v_mfma_f32_16x16x32_bf16 v[196:199], v[192:195], v[88:91], 0
    ds_read_b128 v[132:135], v5 offset:0
    v_mfma_f32_16x16x32_bf16 v[204:207], v[88:91], v[88:91], 0
    ds_read_b128 v[136:139], v5 offset:2048
    v_mfma_f32_16x16x32_bf16 v[200:203], v[192:195], v[92:95], 0
    ds_read_b64_tr_b16 v[140:141], v218 offset:9216
    v_mfma_f32_16x16x32_bf16 v[208:211], v[92:95], v[92:95], 0
    ds_read_b64_tr_b16 v[142:143], v218 offset:13824
    v_mfma_f32_16x16x32_bf16 v[226:229], v[192:195], v[96:99], 0
    ds_read_b64_tr_b16 v[144:145], v218 offset:9256
    v_mfma_f32_16x16x32_bf16 v[230:233], v[192:195], v[100:103], 0
    ds_read_b64_tr_b16 v[146:147], v218 offset:13864
    v_mfma_f32_16x16x32_bf16 v[234:237], v[192:195], v[128:131], 0
    ds_read_b64_tr_b16 v[148:149], v220 offset:9216
    v_mfma_f32_16x16x32_bf16 v[16:19], v[96:99], v[88:91], 0
    ds_read_b64_tr_b16 v[150:151], v220 offset:13824
    v_mfma_f32_16x16x32_bf16 v[52:55], v[96:99], v[92:95], 0
    ds_read_b64_tr_b16 v[152:153], v220 offset:9256
    v_mfma_f32_16x16x32_bf16 v[20:23], v[100:103], v[88:91], 0
    ds_read_b64_tr_b16 v[154:155], v220 offset:13864
    v_mfma_f32_16x16x32_bf16 v[56:59], v[100:103], v[92:95], 0
    ds_read_b64_tr_b16 v[156:157], v222 offset:9216
    v_mfma_f32_16x16x32_bf16 v[24:27], v[104:107], v[88:91], 0
    ds_read_b64_tr_b16 v[158:159], v222 offset:13824
    v_mfma_f32_16x16x32_bf16 v[60:63], v[104:107], v[92:95], 0
    ds_read_b64_tr_b16 v[160:161], v222 offset:9256
    v_mfma_f32_16x16x32_bf16 v[28:31], v[108:111], v[88:91], 0
    ds_read_b64_tr_b16 v[162:163], v222 offset:13864
    v_mfma_f32_16x16x32_bf16 v[64:67], v[108:111], v[92:95], 0
    ds_read_b64_tr_b16 v[164:165], v224 offset:9216
    v_mfma_f32_16x16x32_bf16 v[32:35], v[112:115], v[88:91], 0
    ds_read_b64_tr_b16 v[166:167], v224 offset:13824
    v_mfma_f32_16x16x32_bf16 v[68:71], v[112:115], v[92:95], 0
    ds_read_b64_tr_b16 v[168:169], v224 offset:9256
    v_mfma_f32_16x16x32_bf16 v[36:39], v[116:119], v[88:91], 0
    ds_read_b64_tr_b16 v[170:171], v224 offset:13864
    v_mfma_f32_16x16x32_bf16 v[72:75], v[116:119], v[92:95], 0
    ds_read_b64_tr_b16 v[172:173], v8 offset:9216
    v_mfma_f32_16x16x32_bf16 v[40:43], v[120:123], v[88:91], 0
    ds_read_b64_tr_b16 v[174:175], v8 offset:13824
    v_mfma_f32_16x16x32_bf16 v[76:79], v[120:123], v[92:95], 0
    v_mfma_f32_16x16x32_bf16 v[44:47], v[124:127], v[88:91], 0
    v_mfma_f32_16x16x32_bf16 v[80:83], v[124:127], v[92:95], 0
    v_mfma_f32_16x16x32_bf16 v[48:51], v[128:131], v[88:91], 0
    v_mfma_f32_16x16x32_bf16 v[84:87], v[128:131], v[92:95], 0
    s_waitcnt lgkmcnt(0)
    s_barrier
    v_mfma_f32_16x16x32_bf16 v[196:199], v[192:195], v[132:135], v[196:199]
    ds_read_b128 v[88:91], v4 offset:16384
    v_mfma_f32_16x16x32_bf16 v[204:207], v[132:135], v[132:135], v[204:207]
    ds_read_b128 v[92:95], v4 offset:18432
    v_mfma_f32_16x16x32_bf16 v[200:203], v[192:195], v[136:139], v[200:203]
    ds_read_b64_tr_b16 v[96:97], v218 offset:18432
    v_mfma_f32_16x16x32_bf16 v[208:211], v[136:139], v[136:139], v[208:211]
    ds_read_b64_tr_b16 v[98:99], v218 offset:23040
    v_mfma_f32_16x16x32_bf16 v[226:229], v[192:195], v[140:143], v[226:229]
    ds_read_b64_tr_b16 v[100:101], v218 offset:18472
    v_mfma_f32_16x16x32_bf16 v[230:233], v[192:195], v[144:147], v[230:233]
    ds_read_b64_tr_b16 v[102:103], v218 offset:23080
    v_mfma_f32_16x16x32_bf16 v[234:237], v[192:195], v[172:175], v[234:237]
    ds_read_b64_tr_b16 v[104:105], v220 offset:18432
    v_mfma_f32_16x16x32_bf16 v[16:19], v[140:143], v[132:135], v[16:19]
    ds_read_b64_tr_b16 v[106:107], v220 offset:23040
    v_mfma_f32_16x16x32_bf16 v[52:55], v[140:143], v[136:139], v[52:55]
    ds_read_b64_tr_b16 v[108:109], v220 offset:18472
    v_mfma_f32_16x16x32_bf16 v[20:23], v[144:147], v[132:135], v[20:23]
    ds_read_b64_tr_b16 v[110:111], v220 offset:23080
    v_mfma_f32_16x16x32_bf16 v[56:59], v[144:147], v[136:139], v[56:59]
    ds_read_b64_tr_b16 v[112:113], v222 offset:18432
    v_mfma_f32_16x16x32_bf16 v[24:27], v[148:151], v[132:135], v[24:27]
    ds_read_b64_tr_b16 v[114:115], v222 offset:23040
    v_mfma_f32_16x16x32_bf16 v[60:63], v[148:151], v[136:139], v[60:63]
    ds_read_b64_tr_b16 v[116:117], v222 offset:18472
    v_mfma_f32_16x16x32_bf16 v[28:31], v[152:155], v[132:135], v[28:31]
    ds_read_b64_tr_b16 v[118:119], v222 offset:23080
    v_mfma_f32_16x16x32_bf16 v[64:67], v[152:155], v[136:139], v[64:67]
    ds_read_b64_tr_b16 v[120:121], v224 offset:18432
    v_mfma_f32_16x16x32_bf16 v[32:35], v[156:159], v[132:135], v[32:35]
    ds_read_b64_tr_b16 v[122:123], v224 offset:23040
    v_mfma_f32_16x16x32_bf16 v[68:71], v[156:159], v[136:139], v[68:71]
    ds_read_b64_tr_b16 v[124:125], v224 offset:18472
    v_mfma_f32_16x16x32_bf16 v[36:39], v[160:163], v[132:135], v[36:39]
    ds_read_b64_tr_b16 v[126:127], v224 offset:23080
    v_mfma_f32_16x16x32_bf16 v[72:75], v[160:163], v[136:139], v[72:75]
    ds_read_b64_tr_b16 v[128:129], v8 offset:18432
    v_mfma_f32_16x16x32_bf16 v[40:43], v[164:167], v[132:135], v[40:43]
    ds_read_b64_tr_b16 v[130:131], v8 offset:23040
    v_mfma_f32_16x16x32_bf16 v[76:79], v[164:167], v[136:139], v[76:79]
    v_mfma_f32_16x16x32_bf16 v[44:47], v[168:171], v[132:135], v[44:47]
    v_mfma_f32_16x16x32_bf16 v[80:83], v[168:171], v[136:139], v[80:83]
    v_mfma_f32_16x16x32_bf16 v[48:51], v[172:175], v[132:135], v[48:51]
    v_mfma_f32_16x16x32_bf16 v[84:87], v[172:175], v[136:139], v[84:87]
    s_waitcnt lgkmcnt(0)
    v_mfma_f32_16x16x32_bf16 v[196:199], v[192:195], v[88:91], v[196:199]
    ds_read_b128 v[132:135], v5 offset:16384
    v_mfma_f32_16x16x32_bf16 v[204:207], v[88:91], v[88:91], v[204:207]
    ds_read_b128 v[136:139], v5 offset:18432
    v_mfma_f32_16x16x32_bf16 v[200:203], v[192:195], v[92:95], v[200:203]
    ds_read_b64_tr_b16 v[140:141], v218 offset:27648
    v_mfma_f32_16x16x32_bf16 v[208:211], v[92:95], v[92:95], v[208:211]
    ds_read_b64_tr_b16 v[142:143], v218 offset:32256
    v_mfma_f32_16x16x32_bf16 v[226:229], v[192:195], v[96:99], v[226:229]
    ds_read_b64_tr_b16 v[144:145], v218 offset:27688
    v_mfma_f32_16x16x32_bf16 v[230:233], v[192:195], v[100:103], v[230:233]
    ds_read_b64_tr_b16 v[146:147], v218 offset:32296
    v_mfma_f32_16x16x32_bf16 v[234:237], v[192:195], v[128:131], v[234:237]
    ds_read_b64_tr_b16 v[148:149], v220 offset:27648
    v_mfma_f32_16x16x32_bf16 v[16:19], v[96:99], v[88:91], v[16:19]
    ds_read_b64_tr_b16 v[150:151], v220 offset:32256
    v_mfma_f32_16x16x32_bf16 v[52:55], v[96:99], v[92:95], v[52:55]
    ds_read_b64_tr_b16 v[152:153], v220 offset:27688
    v_mfma_f32_16x16x32_bf16 v[20:23], v[100:103], v[88:91], v[20:23]
    ds_read_b64_tr_b16 v[154:155], v220 offset:32296
    v_mfma_f32_16x16x32_bf16 v[56:59], v[100:103], v[92:95], v[56:59]
    ds_read_b64_tr_b16 v[156:157], v222 offset:27648
    v_mfma_f32_16x16x32_bf16 v[24:27], v[104:107], v[88:91], v[24:27]
    ds_read_b64_tr_b16 v[158:159], v222 offset:32256
    v_mfma_f32_16x16x32_bf16 v[60:63], v[104:107], v[92:95], v[60:63]
    ds_read_b64_tr_b16 v[160:161], v222 offset:27688
    v_mfma_f32_16x16x32_bf16 v[28:31], v[108:111], v[88:91], v[28:31]
    ds_read_b64_tr_b16 v[162:163], v222 offset:32296
    v_mfma_f32_16x16x32_bf16 v[64:67], v[108:111], v[92:95], v[64:67]
    ds_read_b64_tr_b16 v[164:165], v224 offset:27648
    v_mfma_f32_16x16x32_bf16 v[32:35], v[112:115], v[88:91], v[32:35]
    ds_read_b64_tr_b16 v[166:167], v224 offset:32256
    v_mfma_f32_16x16x32_bf16 v[68:71], v[112:115], v[92:95], v[68:71]
    ds_read_b64_tr_b16 v[168:169], v224 offset:27688
    v_mfma_f32_16x16x32_bf16 v[36:39], v[116:119], v[88:91], v[36:39]
    ds_read_b64_tr_b16 v[170:171], v224 offset:32296
    v_mfma_f32_16x16x32_bf16 v[72:75], v[116:119], v[92:95], v[72:75]
    ds_read_b64_tr_b16 v[172:173], v8 offset:27648
    v_mfma_f32_16x16x32_bf16 v[40:43], v[120:123], v[88:91], v[40:43]
    ds_read_b64_tr_b16 v[174:175], v8 offset:32256
    v_mfma_f32_16x16x32_bf16 v[76:79], v[120:123], v[92:95], v[76:79]
    v_mfma_f32_16x16x32_bf16 v[44:47], v[124:127], v[88:91], v[44:47]
    v_mfma_f32_16x16x32_bf16 v[80:83], v[124:127], v[92:95], v[80:83]
    v_mfma_f32_16x16x32_bf16 v[48:51], v[128:131], v[88:91], v[48:51]
    v_mfma_f32_16x16x32_bf16 v[84:87], v[128:131], v[92:95], v[84:87]
    s_waitcnt lgkmcnt(0)
    s_barrier
    v_mfma_f32_16x16x32_bf16 v[196:199], v[192:195], v[132:135], v[196:199]
    ds_read_b128 v[88:91], v4 offset:32768
    v_mfma_f32_16x16x32_bf16 v[204:207], v[132:135], v[132:135], v[204:207]
    ds_read_b128 v[92:95], v4 offset:34816
    v_mfma_f32_16x16x32_bf16 v[200:203], v[192:195], v[136:139], v[200:203]
    ds_read_b64_tr_b16 v[96:97], v218 offset:36864
    v_mfma_f32_16x16x32_bf16 v[208:211], v[136:139], v[136:139], v[208:211]
    ds_read_b64_tr_b16 v[98:99], v218 offset:41472
    v_mfma_f32_16x16x32_bf16 v[226:229], v[192:195], v[140:143], v[226:229]
    ds_read_b64_tr_b16 v[100:101], v218 offset:36904
    v_mfma_f32_16x16x32_bf16 v[230:233], v[192:195], v[144:147], v[230:233]
    ds_read_b64_tr_b16 v[102:103], v218 offset:41512
    v_mfma_f32_16x16x32_bf16 v[234:237], v[192:195], v[172:175], v[234:237]
    ds_read_b64_tr_b16 v[104:105], v220 offset:36864
    v_mfma_f32_16x16x32_bf16 v[16:19], v[140:143], v[132:135], v[16:19]
    ds_read_b64_tr_b16 v[106:107], v220 offset:41472
    v_mfma_f32_16x16x32_bf16 v[52:55], v[140:143], v[136:139], v[52:55]
    ds_read_b64_tr_b16 v[108:109], v220 offset:36904
    v_mfma_f32_16x16x32_bf16 v[20:23], v[144:147], v[132:135], v[20:23]
    ds_read_b64_tr_b16 v[110:111], v220 offset:41512
    v_mfma_f32_16x16x32_bf16 v[56:59], v[144:147], v[136:139], v[56:59]
    ds_read_b64_tr_b16 v[112:113], v222 offset:36864
    v_mfma_f32_16x16x32_bf16 v[24:27], v[148:151], v[132:135], v[24:27]
    ds_read_b64_tr_b16 v[114:115], v222 offset:41472
    v_mfma_f32_16x16x32_bf16 v[60:63], v[148:151], v[136:139], v[60:63]
    ds_read_b64_tr_b16 v[116:117], v222 offset:36904
    v_mfma_f32_16x16x32_bf16 v[28:31], v[152:155], v[132:135], v[28:31]
    ds_read_b64_tr_b16 v[118:119], v222 offset:41512
    v_mfma_f32_16x16x32_bf16 v[64:67], v[152:155], v[136:139], v[64:67]
    ds_read_b64_tr_b16 v[120:121], v224 offset:36864
    v_mfma_f32_16x16x32_bf16 v[32:35], v[156:159], v[132:135], v[32:35]
    ds_read_b64_tr_b16 v[122:123], v224 offset:41472
    v_mfma_f32_16x16x32_bf16 v[68:71], v[156:159], v[136:139], v[68:71]
    ds_read_b64_tr_b16 v[124:125], v224 offset:36904
    v_mfma_f32_16x16x32_bf16 v[36:39], v[160:163], v[132:135], v[36:39]
    ds_read_b64_tr_b16 v[126:127], v224 offset:41512
    v_mfma_f32_16x16x32_bf16 v[72:75], v[160:163], v[136:139], v[72:75]
    ds_read_b64_tr_b16 v[128:129], v8 offset:36864
    v_mfma_f32_16x16x32_bf16 v[40:43], v[164:167], v[132:135], v[40:43]
    ds_read_b64_tr_b16 v[130:131], v8 offset:41472
    v_mfma_f32_16x16x32_bf16 v[76:79], v[164:167], v[136:139], v[76:79]
    v_mfma_f32_16x16x32_bf16 v[44:47], v[168:171], v[132:135], v[44:47]
    v_mfma_f32_16x16x32_bf16 v[80:83], v[168:171], v[136:139], v[80:83]
    v_mfma_f32_16x16x32_bf16 v[48:51], v[172:175], v[132:135], v[48:51]
    v_mfma_f32_16x16x32_bf16 v[84:87], v[172:175], v[136:139], v[84:87]
    s_waitcnt lgkmcnt(0)
    v_mfma_f32_16x16x32_bf16 v[196:199], v[192:195], v[88:91], v[196:199]
    ds_read_b128 v[132:135], v5 offset:32768
    v_mfma_f32_16x16x32_bf16 v[204:207], v[88:91], v[88:91], v[204:207]
    ds_read_b128 v[136:139], v5 offset:34816
    v_mfma_f32_16x16x32_bf16 v[200:203], v[192:195], v[92:95], v[200:203]
    ds_read_b64_tr_b16 v[140:141], v218 offset:46080
    v_mfma_f32_16x16x32_bf16 v[208:211], v[92:95], v[92:95], v[208:211]
    ds_read_b64_tr_b16 v[142:143], v218 offset:50688
    v_mfma_f32_16x16x32_bf16 v[226:229], v[192:195], v[96:99], v[226:229]
    ds_read_b64_tr_b16 v[144:145], v218 offset:46120
    v_mfma_f32_16x16x32_bf16 v[230:233], v[192:195], v[100:103], v[230:233]
    ds_read_b64_tr_b16 v[146:147], v218 offset:50728
    v_mfma_f32_16x16x32_bf16 v[234:237], v[192:195], v[128:131], v[234:237]
    ds_read_b64_tr_b16 v[148:149], v220 offset:46080
    v_mfma_f32_16x16x32_bf16 v[16:19], v[96:99], v[88:91], v[16:19]
    ds_read_b64_tr_b16 v[150:151], v220 offset:50688
    v_mfma_f32_16x16x32_bf16 v[52:55], v[96:99], v[92:95], v[52:55]
    ds_read_b64_tr_b16 v[152:153], v220 offset:46120
    v_mfma_f32_16x16x32_bf16 v[20:23], v[100:103], v[88:91], v[20:23]
    ds_read_b64_tr_b16 v[154:155], v220 offset:50728
    v_mfma_f32_16x16x32_bf16 v[56:59], v[100:103], v[92:95], v[56:59]
    ds_read_b64_tr_b16 v[156:157], v222 offset:46080
    v_mfma_f32_16x16x32_bf16 v[24:27], v[104:107], v[88:91], v[24:27]
    ds_read_b64_tr_b16 v[158:159], v222 offset:50688
    v_mfma_f32_16x16x32_bf16 v[60:63], v[104:107], v[92:95], v[60:63]
    ds_read_b64_tr_b16 v[160:161], v222 offset:46120
    v_mfma_f32_16x16x32_bf16 v[28:31], v[108:111], v[88:91], v[28:31]
    ds_read_b64_tr_b16 v[162:163], v222 offset:50728
    v_mfma_f32_16x16x32_bf16 v[64:67], v[108:111], v[92:95], v[64:67]
    ds_read_b64_tr_b16 v[164:165], v224 offset:46080
    v_mfma_f32_16x16x32_bf16 v[32:35], v[112:115], v[88:91], v[32:35]
    ds_read_b64_tr_b16 v[166:167], v224 offset:50688
    v_mfma_f32_16x16x32_bf16 v[68:71], v[112:115], v[92:95], v[68:71]
    ds_read_b64_tr_b16 v[168:169], v224 offset:46120
    v_mfma_f32_16x16x32_bf16 v[36:39], v[116:119], v[88:91], v[36:39]
    ds_read_b64_tr_b16 v[170:171], v224 offset:50728
    v_mfma_f32_16x16x32_bf16 v[72:75], v[116:119], v[92:95], v[72:75]
    ds_read_b64_tr_b16 v[172:173], v8 offset:46080
    v_mfma_f32_16x16x32_bf16 v[40:43], v[120:123], v[88:91], v[40:43]
    ds_read_b64_tr_b16 v[174:175], v8 offset:50688
    v_mfma_f32_16x16x32_bf16 v[76:79], v[120:123], v[92:95], v[76:79]
    v_mfma_f32_16x16x32_bf16 v[44:47], v[124:127], v[88:91], v[44:47]
    v_mfma_f32_16x16x32_bf16 v[80:83], v[124:127], v[92:95], v[80:83]
    v_mfma_f32_16x16x32_bf16 v[48:51], v[128:131], v[88:91], v[48:51]
    v_mfma_f32_16x16x32_bf16 v[84:87], v[128:131], v[92:95], v[84:87]
    s_waitcnt lgkmcnt(0)
    s_barrier
    v_mfma_f32_16x16x32_bf16 v[196:199], v[192:195], v[132:135], v[196:199]
    ds_read_b128 v[88:91], v4 offset:49152
    v_mfma_f32_16x16x32_bf16 v[204:207], v[132:135], v[132:135], v[204:207]
    ds_read_b128 v[92:95], v4 offset:51200
    v_mfma_f32_16x16x32_bf16 v[200:203], v[192:195], v[136:139], v[200:203]
    ds_read_b64_tr_b16 v[96:97], v219 offset:0
    v_mfma_f32_16x16x32_bf16 v[208:211], v[136:139], v[136:139], v[208:211]
    ds_read_b64_tr_b16 v[98:99], v219 offset:4608
    v_mfma_f32_16x16x32_bf16 v[226:229], v[192:195], v[140:143], v[226:229]
    ds_read_b64_tr_b16 v[100:101], v219 offset:40
    v_mfma_f32_16x16x32_bf16 v[230:233], v[192:195], v[144:147], v[230:233]
    ds_read_b64_tr_b16 v[102:103], v219 offset:4648
    v_mfma_f32_16x16x32_bf16 v[234:237], v[192:195], v[172:175], v[234:237]
    ds_read_b64_tr_b16 v[104:105], v221 offset:0
    v_mfma_f32_16x16x32_bf16 v[16:19], v[140:143], v[132:135], v[16:19]
    ds_read_b64_tr_b16 v[106:107], v221 offset:4608
    v_mfma_f32_16x16x32_bf16 v[52:55], v[140:143], v[136:139], v[52:55]
    ds_read_b64_tr_b16 v[108:109], v221 offset:40
    v_mfma_f32_16x16x32_bf16 v[20:23], v[144:147], v[132:135], v[20:23]
    ds_read_b64_tr_b16 v[110:111], v221 offset:4648
    v_mfma_f32_16x16x32_bf16 v[56:59], v[144:147], v[136:139], v[56:59]
    ds_read_b64_tr_b16 v[112:113], v223 offset:0
    v_mfma_f32_16x16x32_bf16 v[24:27], v[148:151], v[132:135], v[24:27]
    ds_read_b64_tr_b16 v[114:115], v223 offset:4608
    v_mfma_f32_16x16x32_bf16 v[60:63], v[148:151], v[136:139], v[60:63]
    ds_read_b64_tr_b16 v[116:117], v223 offset:40
    v_mfma_f32_16x16x32_bf16 v[28:31], v[152:155], v[132:135], v[28:31]
    ds_read_b64_tr_b16 v[118:119], v223 offset:4648
    v_mfma_f32_16x16x32_bf16 v[64:67], v[152:155], v[136:139], v[64:67]
    ds_read_b64_tr_b16 v[120:121], v225 offset:0
    v_mfma_f32_16x16x32_bf16 v[32:35], v[156:159], v[132:135], v[32:35]
    ds_read_b64_tr_b16 v[122:123], v225 offset:4608
    v_mfma_f32_16x16x32_bf16 v[68:71], v[156:159], v[136:139], v[68:71]
    ds_read_b64_tr_b16 v[124:125], v225 offset:40
    v_mfma_f32_16x16x32_bf16 v[36:39], v[160:163], v[132:135], v[36:39]
    ds_read_b64_tr_b16 v[126:127], v225 offset:4648
    v_mfma_f32_16x16x32_bf16 v[72:75], v[160:163], v[136:139], v[72:75]
    ds_read_b64_tr_b16 v[128:129], v9 offset:0
    v_mfma_f32_16x16x32_bf16 v[40:43], v[164:167], v[132:135], v[40:43]
    ds_read_b64_tr_b16 v[130:131], v9 offset:4608
    v_mfma_f32_16x16x32_bf16 v[76:79], v[164:167], v[136:139], v[76:79]
    v_mfma_f32_16x16x32_bf16 v[44:47], v[168:171], v[132:135], v[44:47]
    v_mfma_f32_16x16x32_bf16 v[80:83], v[168:171], v[136:139], v[80:83]
    v_mfma_f32_16x16x32_bf16 v[48:51], v[172:175], v[132:135], v[48:51]
    v_mfma_f32_16x16x32_bf16 v[84:87], v[172:175], v[136:139], v[84:87]
    s_waitcnt lgkmcnt(0)
    v_mfma_f32_16x16x32_bf16 v[196:199], v[192:195], v[88:91], v[196:199]
    ds_read_b128 v[132:135], v5 offset:49152
    v_mfma_f32_16x16x32_bf16 v[204:207], v[88:91], v[88:91], v[204:207]
    ds_read_b128 v[136:139], v5 offset:51200
    v_mfma_f32_16x16x32_bf16 v[200:203], v[192:195], v[92:95], v[200:203]
    ds_read_b64_tr_b16 v[140:141], v219 offset:9216
    v_mfma_f32_16x16x32_bf16 v[208:211], v[92:95], v[92:95], v[208:211]
    ds_read_b64_tr_b16 v[142:143], v219 offset:13824
    v_mfma_f32_16x16x32_bf16 v[226:229], v[192:195], v[96:99], v[226:229]
    ds_read_b64_tr_b16 v[144:145], v219 offset:9256
    v_mfma_f32_16x16x32_bf16 v[230:233], v[192:195], v[100:103], v[230:233]
    ds_read_b64_tr_b16 v[146:147], v219 offset:13864
    v_mfma_f32_16x16x32_bf16 v[234:237], v[192:195], v[128:131], v[234:237]
    ds_read_b64_tr_b16 v[148:149], v221 offset:9216
    v_mfma_f32_16x16x32_bf16 v[16:19], v[96:99], v[88:91], v[16:19]
    ds_read_b64_tr_b16 v[150:151], v221 offset:13824
    v_mfma_f32_16x16x32_bf16 v[52:55], v[96:99], v[92:95], v[52:55]
    ds_read_b64_tr_b16 v[152:153], v221 offset:9256
    v_mfma_f32_16x16x32_bf16 v[20:23], v[100:103], v[88:91], v[20:23]
    ds_read_b64_tr_b16 v[154:155], v221 offset:13864
    v_mfma_f32_16x16x32_bf16 v[56:59], v[100:103], v[92:95], v[56:59]
    ds_read_b64_tr_b16 v[156:157], v223 offset:9216
    v_mfma_f32_16x16x32_bf16 v[24:27], v[104:107], v[88:91], v[24:27]
    ds_read_b64_tr_b16 v[158:159], v223 offset:13824
    v_mfma_f32_16x16x32_bf16 v[60:63], v[104:107], v[92:95], v[60:63]
    ds_read_b64_tr_b16 v[160:161], v223 offset:9256
    v_mfma_f32_16x16x32_bf16 v[28:31], v[108:111], v[88:91], v[28:31]
    ds_read_b64_tr_b16 v[162:163], v223 offset:13864
    v_mfma_f32_16x16x32_bf16 v[64:67], v[108:111], v[92:95], v[64:67]
    ds_read_b64_tr_b16 v[164:165], v225 offset:9216
    v_mfma_f32_16x16x32_bf16 v[32:35], v[112:115], v[88:91], v[32:35]
    ds_read_b64_tr_b16 v[166:167], v225 offset:13824
    v_mfma_f32_16x16x32_bf16 v[68:71], v[112:115], v[92:95], v[68:71]
    ds_read_b64_tr_b16 v[168:169], v225 offset:9256
    v_mfma_f32_16x16x32_bf16 v[36:39], v[116:119], v[88:91], v[36:39]
    ds_read_b64_tr_b16 v[170:171], v225 offset:13864
    v_mfma_f32_16x16x32_bf16 v[72:75], v[116:119], v[92:95], v[72:75]
    ds_read_b64_tr_b16 v[172:173], v9 offset:9216
    v_mfma_f32_16x16x32_bf16 v[40:43], v[120:123], v[88:91], v[40:43]
    ds_read_b64_tr_b16 v[174:175], v9 offset:13824
    v_mfma_f32_16x16x32_bf16 v[76:79], v[120:123], v[92:95], v[76:79]
    v_mfma_f32_16x16x32_bf16 v[44:47], v[124:127], v[88:91], v[44:47]
    v_mfma_f32_16x16x32_bf16 v[80:83], v[124:127], v[92:95], v[80:83]
    v_mfma_f32_16x16x32_bf16 v[48:51], v[128:131], v[88:91], v[48:51]
    v_mfma_f32_16x16x32_bf16 v[84:87], v[128:131], v[92:95], v[84:87]
    s_waitcnt lgkmcnt(0)
    s_barrier
    v_mfma_f32_16x16x32_bf16 v[196:199], v[192:195], v[132:135], v[196:199]
    ds_read_b128 v[88:91], v4 offset:0
    v_mfma_f32_16x16x32_bf16 v[204:207], v[132:135], v[132:135], v[204:207]
    ds_read_b128 v[92:95], v4 offset:2048
    v_mfma_f32_16x16x32_bf16 v[200:203], v[192:195], v[136:139], v[200:203]
    ds_read_b64_tr_b16 v[96:97], v218 offset:0
    v_mfma_f32_16x16x32_bf16 v[208:211], v[136:139], v[136:139], v[208:211]
    ds_read_b64_tr_b16 v[98:99], v218 offset:4608
    v_mfma_f32_16x16x32_bf16 v[226:229], v[192:195], v[140:143], v[226:229]
    ds_read_b64_tr_b16 v[100:101], v218 offset:40
    v_mfma_f32_16x16x32_bf16 v[230:233], v[192:195], v[144:147], v[230:233]
    ds_read_b64_tr_b16 v[102:103], v218 offset:4648
    v_mfma_f32_16x16x32_bf16 v[234:237], v[192:195], v[172:175], v[234:237]
    ds_read_b64_tr_b16 v[104:105], v220 offset:0
    v_mfma_f32_16x16x32_bf16 v[16:19], v[140:143], v[132:135], v[16:19]
    ds_read_b64_tr_b16 v[106:107], v220 offset:4608
    v_mfma_f32_16x16x32_bf16 v[52:55], v[140:143], v[136:139], v[52:55]
    ds_read_b64_tr_b16 v[108:109], v220 offset:40
    v_mfma_f32_16x16x32_bf16 v[20:23], v[144:147], v[132:135], v[20:23]
    ds_read_b64_tr_b16 v[110:111], v220 offset:4648
    v_mfma_f32_16x16x32_bf16 v[56:59], v[144:147], v[136:139], v[56:59]
    ds_read_b64_tr_b16 v[112:113], v222 offset:0
    v_mfma_f32_16x16x32_bf16 v[24:27], v[148:151], v[132:135], v[24:27]
    ds_read_b64_tr_b16 v[114:115], v222 offset:4608
    v_mfma_f32_16x16x32_bf16 v[60:63], v[148:151], v[136:139], v[60:63]
    ds_read_b64_tr_b16 v[116:117], v222 offset:40
    v_mfma_f32_16x16x32_bf16 v[28:31], v[152:155], v[132:135], v[28:31]
    ds_read_b64_tr_b16 v[118:119], v222 offset:4648
    v_mfma_f32_16x16x32_bf16 v[64:67], v[152:155], v[136:139], v[64:67]
    ds_read_b64_tr_b16 v[120:121], v224 offset:0
    v_mfma_f32_16x16x32_bf16 v[32:35], v[156:159], v[132:135], v[32:35]
    ds_read_b64_tr_b16 v[122:123], v224 offset:4608
    v_mfma_f32_16x16x32_bf16 v[68:71], v[156:159], v[136:139], v[68:71]
    ds_read_b64_tr_b16 v[124:125], v224 offset:40
    v_mfma_f32_16x16x32_bf16 v[36:39], v[160:163], v[132:135], v[36:39]
    ds_read_b64_tr_b16 v[126:127], v224 offset:4648
    v_mfma_f32_16x16x32_bf16 v[72:75], v[160:163], v[136:139], v[72:75]
    ds_read_b64_tr_b16 v[128:129], v8 offset:0
    v_mfma_f32_16x16x32_bf16 v[40:43], v[164:167], v[132:135], v[40:43]
    ds_read_b64_tr_b16 v[130:131], v8 offset:4608
    v_mfma_f32_16x16x32_bf16 v[76:79], v[164:167], v[136:139], v[76:79]
    v_mfma_f32_16x16x32_bf16 v[44:47], v[168:171], v[132:135], v[44:47]
    v_mfma_f32_16x16x32_bf16 v[80:83], v[168:171], v[136:139], v[80:83]
    v_mfma_f32_16x16x32_bf16 v[48:51], v[172:175], v[132:135], v[48:51]
    v_mfma_f32_16x16x32_bf16 v[84:87], v[172:175], v[136:139], v[84:87]
    s_waitcnt lgkmcnt(0)
    v_mfma_f32_16x16x32_bf16 v[196:199], v[192:195], v[88:91], v[196:199]
    ds_read_b128 v[132:135], v5 offset:0
    v_mfma_f32_16x16x32_bf16 v[204:207], v[88:91], v[88:91], v[204:207]
    ds_read_b128 v[136:139], v5 offset:2048
    v_mfma_f32_16x16x32_bf16 v[200:203], v[192:195], v[92:95], v[200:203]
    ds_read_b64_tr_b16 v[140:141], v218 offset:9216
    v_mfma_f32_16x16x32_bf16 v[208:211], v[92:95], v[92:95], v[208:211]
    ds_read_b64_tr_b16 v[142:143], v218 offset:13824
    v_mfma_f32_16x16x32_bf16 v[226:229], v[192:195], v[96:99], v[226:229]
    ds_read_b64_tr_b16 v[144:145], v218 offset:9256
    v_mfma_f32_16x16x32_bf16 v[230:233], v[192:195], v[100:103], v[230:233]
    ds_read_b64_tr_b16 v[146:147], v218 offset:13864
    v_mfma_f32_16x16x32_bf16 v[234:237], v[192:195], v[128:131], v[234:237]
    ds_read_b64_tr_b16 v[148:149], v220 offset:9216
    v_mfma_f32_16x16x32_bf16 v[16:19], v[96:99], v[88:91], v[16:19]
    ds_read_b64_tr_b16 v[150:151], v220 offset:13824
    v_mfma_f32_16x16x32_bf16 v[52:55], v[96:99], v[92:95], v[52:55]
    ds_read_b64_tr_b16 v[152:153], v220 offset:9256
    v_mfma_f32_16x16x32_bf16 v[20:23], v[100:103], v[88:91], v[20:23]
    ds_read_b64_tr_b16 v[154:155], v220 offset:13864
    v_mfma_f32_16x16x32_bf16 v[56:59], v[100:103], v[92:95], v[56:59]
    ds_read_b64_tr_b16 v[156:157], v222 offset:9216
    v_mfma_f32_16x16x32_bf16 v[24:27], v[104:107], v[88:91], v[24:27]
    ds_read_b64_tr_b16 v[158:159], v222 offset:13824
    v_mfma_f32_16x16x32_bf16 v[60:63], v[104:107], v[92:95], v[60:63]
    ds_read_b64_tr_b16 v[160:161], v222 offset:9256
    v_mfma_f32_16x16x32_bf16 v[28:31], v[108:111], v[88:91], v[28:31]
    ds_read_b64_tr_b16 v[162:163], v222 offset:13864
    v_mfma_f32_16x16x32_bf16 v[64:67], v[108:111], v[92:95], v[64:67]
    ds_read_b64_tr_b16 v[164:165], v224 offset:9216
    v_mfma_f32_16x16x32_bf16 v[32:35], v[112:115], v[88:91], v[32:35]
    ds_read_b64_tr_b16 v[166:167], v224 offset:13824
    v_mfma_f32_16x16x32_bf16 v[68:71], v[112:115], v[92:95], v[68:71]
    ds_read_b64_tr_b16 v[168:169], v224 offset:9256
    v_mfma_f32_16x16x32_bf16 v[36:39], v[116:119], v[88:91], v[36:39]
    ds_read_b64_tr_b16 v[170:171], v224 offset:13864
    v_mfma_f32_16x16x32_bf16 v[72:75], v[116:119], v[92:95], v[72:75]
    ds_read_b64_tr_b16 v[172:173], v8 offset:9216
    v_mfma_f32_16x16x32_bf16 v[40:43], v[120:123], v[88:91], v[40:43]
    ds_read_b64_tr_b16 v[174:175], v8 offset:13824
    v_mfma_f32_16x16x32_bf16 v[76:79], v[120:123], v[92:95], v[76:79]
    v_mfma_f32_16x16x32_bf16 v[44:47], v[124:127], v[88:91], v[44:47]
    v_mfma_f32_16x16x32_bf16 v[80:83], v[124:127], v[92:95], v[80:83]
    v_mfma_f32_16x16x32_bf16 v[48:51], v[128:131], v[88:91], v[48:51]
    v_mfma_f32_16x16x32_bf16 v[84:87], v[128:131], v[92:95], v[84:87]
    s_waitcnt lgkmcnt(0)
    s_barrier
    v_mfma_f32_16x16x32_bf16 v[196:199], v[192:195], v[132:135], v[196:199]
    ds_read_b128 v[88:91], v4 offset:16384
    v_mfma_f32_16x16x32_bf16 v[204:207], v[132:135], v[132:135], v[204:207]
    ds_read_b128 v[92:95], v4 offset:18432
    v_mfma_f32_16x16x32_bf16 v[200:203], v[192:195], v[136:139], v[200:203]
    ds_read_b64_tr_b16 v[96:97], v218 offset:18432
    v_mfma_f32_16x16x32_bf16 v[208:211], v[136:139], v[136:139], v[208:211]
    ds_read_b64_tr_b16 v[98:99], v218 offset:23040
    v_mfma_f32_16x16x32_bf16 v[226:229], v[192:195], v[140:143], v[226:229]
    ds_read_b64_tr_b16 v[100:101], v218 offset:18472
    v_mfma_f32_16x16x32_bf16 v[230:233], v[192:195], v[144:147], v[230:233]
    ds_read_b64_tr_b16 v[102:103], v218 offset:23080
    v_mfma_f32_16x16x32_bf16 v[234:237], v[192:195], v[172:175], v[234:237]
    ds_read_b64_tr_b16 v[104:105], v220 offset:18432
    v_mfma_f32_16x16x32_bf16 v[16:19], v[140:143], v[132:135], v[16:19]
    ds_read_b64_tr_b16 v[106:107], v220 offset:23040
    v_mfma_f32_16x16x32_bf16 v[52:55], v[140:143], v[136:139], v[52:55]
    ds_read_b64_tr_b16 v[108:109], v220 offset:18472
    v_mfma_f32_16x16x32_bf16 v[20:23], v[144:147], v[132:135], v[20:23]
    ds_read_b64_tr_b16 v[110:111], v220 offset:23080
    v_mfma_f32_16x16x32_bf16 v[56:59], v[144:147], v[136:139], v[56:59]
    ds_read_b64_tr_b16 v[112:113], v222 offset:18432
    v_mfma_f32_16x16x32_bf16 v[24:27], v[148:151], v[132:135], v[24:27]
    ds_read_b64_tr_b16 v[114:115], v222 offset:23040
    v_mfma_f32_16x16x32_bf16 v[60:63], v[148:151], v[136:139], v[60:63]
    ds_read_b64_tr_b16 v[116:117], v222 offset:18472
    v_mfma_f32_16x16x32_bf16 v[28:31], v[152:155], v[132:135], v[28:31]
    ds_read_b64_tr_b16 v[118:119], v222 offset:23080
    v_mfma_f32_16x16x32_bf16 v[64:67], v[152:155], v[136:139], v[64:67]
    ds_read_b64_tr_b16 v[120:121], v224 offset:18432
    v_mfma_f32_16x16x32_bf16 v[32:35], v[156:159], v[132:135], v[32:35]
    ds_read_b64_tr_b16 v[122:123], v224 offset:23040
    v_mfma_f32_16x16x32_bf16 v[68:71], v[156:159], v[136:139], v[68:71]
    ds_read_b64_tr_b16 v[124:125], v224 offset:18472
    v_mfma_f32_16x16x32_bf16 v[36:39], v[160:163], v[132:135], v[36:39]
    ds_read_b64_tr_b16 v[126:127], v224 offset:23080
    v_mfma_f32_16x16x32_bf16 v[72:75], v[160:163], v[136:139], v[72:75]
    ds_read_b64_tr_b16 v[128:129], v8 offset:18432
    v_mfma_f32_16x16x32_bf16 v[40:43], v[164:167], v[132:135], v[40:43]
    ds_read_b64_tr_b16 v[130:131], v8 offset:23040
    v_mfma_f32_16x16x32_bf16 v[76:79], v[164:167], v[136:139], v[76:79]
    v_mfma_f32_16x16x32_bf16 v[44:47], v[168:171], v[132:135], v[44:47]
    v_mfma_f32_16x16x32_bf16 v[80:83], v[168:171], v[136:139], v[80:83]
    v_mfma_f32_16x16x32_bf16 v[48:51], v[172:175], v[132:135], v[48:51]
    v_mfma_f32_16x16x32_bf16 v[84:87], v[172:175], v[136:139], v[84:87]
    s_waitcnt lgkmcnt(0)
    v_mfma_f32_16x16x32_bf16 v[196:199], v[192:195], v[88:91], v[196:199]
    ds_read_b128 v[132:135], v5 offset:16384
    v_mfma_f32_16x16x32_bf16 v[204:207], v[88:91], v[88:91], v[204:207]
    ds_read_b128 v[136:139], v5 offset:18432
    v_mfma_f32_16x16x32_bf16 v[200:203], v[192:195], v[92:95], v[200:203]
    ds_read_b64_tr_b16 v[140:141], v218 offset:27648
    v_mfma_f32_16x16x32_bf16 v[208:211], v[92:95], v[92:95], v[208:211]
    ds_read_b64_tr_b16 v[142:143], v218 offset:32256
    v_mfma_f32_16x16x32_bf16 v[226:229], v[192:195], v[96:99], v[226:229]
    ds_read_b64_tr_b16 v[144:145], v218 offset:27688
    v_mfma_f32_16x16x32_bf16 v[230:233], v[192:195], v[100:103], v[230:233]
    ds_read_b64_tr_b16 v[146:147], v218 offset:32296
    v_mfma_f32_16x16x32_bf16 v[234:237], v[192:195], v[128:131], v[234:237]
    ds_read_b64_tr_b16 v[148:149], v220 offset:27648
    v_mfma_f32_16x16x32_bf16 v[16:19], v[96:99], v[88:91], v[16:19]
    ds_read_b64_tr_b16 v[150:151], v220 offset:32256
    v_mfma_f32_16x16x32_bf16 v[52:55], v[96:99], v[92:95], v[52:55]
    ds_read_b64_tr_b16 v[152:153], v220 offset:27688
    v_mfma_f32_16x16x32_bf16 v[20:23], v[100:103], v[88:91], v[20:23]
    ds_read_b64_tr_b16 v[154:155], v220 offset:32296
    v_mfma_f32_16x16x32_bf16 v[56:59], v[100:103], v[92:95], v[56:59]
    ds_read_b64_tr_b16 v[156:157], v222 offset:27648
    v_mfma_f32_16x16x32_bf16 v[24:27], v[104:107], v[88:91], v[24:27]
    ds_read_b64_tr_b16 v[158:159], v222 offset:32256
    v_mfma_f32_16x16x32_bf16 v[60:63], v[104:107], v[92:95], v[60:63]
    ds_read_b64_tr_b16 v[160:161], v222 offset:27688
    v_mfma_f32_16x16x32_bf16 v[28:31], v[108:111], v[88:91], v[28:31]
    ds_read_b64_tr_b16 v[162:163], v222 offset:32296
    v_mfma_f32_16x16x32_bf16 v[64:67], v[108:111], v[92:95], v[64:67]
    ds_read_b64_tr_b16 v[164:165], v224 offset:27648
    v_mfma_f32_16x16x32_bf16 v[32:35], v[112:115], v[88:91], v[32:35]
    ds_read_b64_tr_b16 v[166:167], v224 offset:32256
    v_mfma_f32_16x16x32_bf16 v[68:71], v[112:115], v[92:95], v[68:71]
    ds_read_b64_tr_b16 v[168:169], v224 offset:27688
    v_mfma_f32_16x16x32_bf16 v[36:39], v[116:119], v[88:91], v[36:39]
    ds_read_b64_tr_b16 v[170:171], v224 offset:32296
    v_mfma_f32_16x16x32_bf16 v[72:75], v[116:119], v[92:95], v[72:75]
    ds_read_b64_tr_b16 v[172:173], v8 offset:27648
    v_mfma_f32_16x16x32_bf16 v[40:43], v[120:123], v[88:91], v[40:43]
    ds_read_b64_tr_b16 v[174:175], v8 offset:32256
    v_mfma_f32_16x16x32_bf16 v[76:79], v[120:123], v[92:95], v[76:79]
    v_mfma_f32_16x16x32_bf16 v[44:47], v[124:127], v[88:91], v[44:47]
    v_mfma_f32_16x16x32_bf16 v[80:83], v[124:127], v[92:95], v[80:83]
    v_mfma_f32_16x16x32_bf16 v[48:51], v[128:131], v[88:91], v[48:51]
    v_mfma_f32_16x16x32_bf16 v[84:87], v[128:131], v[92:95], v[84:87]
    s_waitcnt lgkmcnt(0)
    s_barrier
    v_mfma_f32_16x16x32_bf16 v[196:199], v[192:195], v[132:135], v[196:199]
    ds_read_b128 v[88:91], v4 offset:32768
    v_mfma_f32_16x16x32_bf16 v[204:207], v[132:135], v[132:135], v[204:207]
    ds_read_b128 v[92:95], v4 offset:34816
    v_mfma_f32_16x16x32_bf16 v[200:203], v[192:195], v[136:139], v[200:203]
    ds_read_b64_tr_b16 v[96:97], v218 offset:36864
    v_mfma_f32_16x16x32_bf16 v[208:211], v[136:139], v[136:139], v[208:211]
    ds_read_b64_tr_b16 v[98:99], v218 offset:41472
    v_mfma_f32_16x16x32_bf16 v[226:229], v[192:195], v[140:143], v[226:229]
    ds_read_b64_tr_b16 v[100:101], v218 offset:36904
    v_mfma_f32_16x16x32_bf16 v[230:233], v[192:195], v[144:147], v[230:233]
    ds_read_b64_tr_b16 v[102:103], v218 offset:41512
    v_mfma_f32_16x16x32_bf16 v[234:237], v[192:195], v[172:175], v[234:237]
    ds_read_b64_tr_b16 v[104:105], v220 offset:36864
    v_mfma_f32_16x16x32_bf16 v[16:19], v[140:143], v[132:135], v[16:19]
    ds_read_b64_tr_b16 v[106:107], v220 offset:41472
    v_mfma_f32_16x16x32_bf16 v[52:55], v[140:143], v[136:139], v[52:55]
    ds_read_b64_tr_b16 v[108:109], v220 offset:36904
    v_mfma_f32_16x16x32_bf16 v[20:23], v[144:147], v[132:135], v[20:23]
    ds_read_b64_tr_b16 v[110:111], v220 offset:41512
    v_mfma_f32_16x16x32_bf16 v[56:59], v[144:147], v[136:139], v[56:59]
    ds_read_b64_tr_b16 v[112:113], v222 offset:36864
    v_mfma_f32_16x16x32_bf16 v[24:27], v[148:151], v[132:135], v[24:27]
    ds_read_b64_tr_b16 v[114:115], v222 offset:41472
    v_mfma_f32_16x16x32_bf16 v[60:63], v[148:151], v[136:139], v[60:63]
    ds_read_b64_tr_b16 v[116:117], v222 offset:36904
    v_mfma_f32_16x16x32_bf16 v[28:31], v[152:155], v[132:135], v[28:31]
    ds_read_b64_tr_b16 v[118:119], v222 offset:41512
    v_mfma_f32_16x16x32_bf16 v[64:67], v[152:155], v[136:139], v[64:67]
    ds_read_b64_tr_b16 v[120:121], v224 offset:36864
    v_mfma_f32_16x16x32_bf16 v[32:35], v[156:159], v[132:135], v[32:35]
    ds_read_b64_tr_b16 v[122:123], v224 offset:41472
    v_mfma_f32_16x16x32_bf16 v[68:71], v[156:159], v[136:139], v[68:71]
    ds_read_b64_tr_b16 v[124:125], v224 offset:36904
    v_mfma_f32_16x16x32_bf16 v[36:39], v[160:163], v[132:135], v[36:39]
    ds_read_b64_tr_b16 v[126:127], v224 offset:41512
    v_mfma_f32_16x16x32_bf16 v[72:75], v[160:163], v[136:139], v[72:75]
    ds_read_b64_tr_b16 v[128:129], v8 offset:36864
    v_mfma_f32_16x16x32_bf16 v[40:43], v[164:167], v[132:135], v[40:43]
    ds_read_b64_tr_b16 v[130:131], v8 offset:41472
    v_mfma_f32_16x16x32_bf16 v[76:79], v[164:167], v[136:139], v[76:79]
    v_mfma_f32_16x16x32_bf16 v[44:47], v[168:171], v[132:135], v[44:47]
    v_mfma_f32_16x16x32_bf16 v[80:83], v[168:171], v[136:139], v[80:83]
    v_mfma_f32_16x16x32_bf16 v[48:51], v[172:175], v[132:135], v[48:51]
    v_mfma_f32_16x16x32_bf16 v[84:87], v[172:175], v[136:139], v[84:87]
    s_waitcnt lgkmcnt(0)
    v_mfma_f32_16x16x32_bf16 v[196:199], v[192:195], v[88:91], v[196:199]
    ds_read_b128 v[132:135], v5 offset:32768
    v_mfma_f32_16x16x32_bf16 v[204:207], v[88:91], v[88:91], v[204:207]
    ds_read_b128 v[136:139], v5 offset:34816
    v_mfma_f32_16x16x32_bf16 v[200:203], v[192:195], v[92:95], v[200:203]
    ds_read_b64_tr_b16 v[140:141], v218 offset:46080
    v_mfma_f32_16x16x32_bf16 v[208:211], v[92:95], v[92:95], v[208:211]
    ds_read_b64_tr_b16 v[142:143], v218 offset:50688
    v_mfma_f32_16x16x32_bf16 v[226:229], v[192:195], v[96:99], v[226:229]
    ds_read_b64_tr_b16 v[144:145], v218 offset:46120
    v_mfma_f32_16x16x32_bf16 v[230:233], v[192:195], v[100:103], v[230:233]
    ds_read_b64_tr_b16 v[146:147], v218 offset:50728
    v_mfma_f32_16x16x32_bf16 v[234:237], v[192:195], v[128:131], v[234:237]
    ds_read_b64_tr_b16 v[148:149], v220 offset:46080
    v_mfma_f32_16x16x32_bf16 v[16:19], v[96:99], v[88:91], v[16:19]
    ds_read_b64_tr_b16 v[150:151], v220 offset:50688
    v_mfma_f32_16x16x32_bf16 v[52:55], v[96:99], v[92:95], v[52:55]
    ds_read_b64_tr_b16 v[152:153], v220 offset:46120
    v_mfma_f32_16x16x32_bf16 v[20:23], v[100:103], v[88:91], v[20:23]
    ds_read_b64_tr_b16 v[154:155], v220 offset:50728
    v_mfma_f32_16x16x32_bf16 v[56:59], v[100:103], v[92:95], v[56:59]
    ds_read_b64_tr_b16 v[156:157], v222 offset:46080
    v_mfma_f32_16x16x32_bf16 v[24:27], v[104:107], v[88:91], v[24:27]
    ds_read_b64_tr_b16 v[158:159], v222 offset:50688
    v_mfma_f32_16x16x32_bf16 v[60:63], v[104:107], v[92:95], v[60:63]
    ds_read_b64_tr_b16 v[160:161], v222 offset:46120
    v_mfma_f32_16x16x32_bf16 v[28:31], v[108:111], v[88:91], v[28:31]
    ds_read_b64_tr_b16 v[162:163], v222 offset:50728
    v_mfma_f32_16x16x32_bf16 v[64:67], v[108:111], v[92:95], v[64:67]
    ds_read_b64_tr_b16 v[164:165], v224 offset:46080
    v_mfma_f32_16x16x32_bf16 v[32:35], v[112:115], v[88:91], v[32:35]
    ds_read_b64_tr_b16 v[166:167], v224 offset:50688
    v_mfma_f32_16x16x32_bf16 v[68:71], v[112:115], v[92:95], v[68:71]
    ds_read_b64_tr_b16 v[168:169], v224 offset:46120
    v_mfma_f32_16x16x32_bf16 v[36:39], v[116:119], v[88:91], v[36:39]
    ds_read_b64_tr_b16 v[170:171], v224 offset:50728
    v_mfma_f32_16x16x32_bf16 v[72:75], v[116:119], v[92:95], v[72:75]
    ds_read_b64_tr_b16 v[172:173], v8 offset:46080
    v_mfma_f32_16x16x32_bf16 v[40:43], v[120:123], v[88:91], v[40:43]
    ds_read_b64_tr_b16 v[174:175], v8 offset:50688
    v_mfma_f32_16x16x32_bf16 v[76:79], v[120:123], v[92:95], v[76:79]
    v_mfma_f32_16x16x32_bf16 v[44:47], v[124:127], v[88:91], v[44:47]
    v_mfma_f32_16x16x32_bf16 v[80:83], v[124:127], v[92:95], v[80:83]
    v_mfma_f32_16x16x32_bf16 v[48:51], v[128:131], v[88:91], v[48:51]
    v_mfma_f32_16x16x32_bf16 v[84:87], v[128:131], v[92:95], v[84:87]
    s_waitcnt lgkmcnt(0)
    s_barrier
    v_mfma_f32_16x16x32_bf16 v[196:199], v[192:195], v[132:135], v[196:199]
    ds_read_b128 v[88:91], v4 offset:49152
    v_mfma_f32_16x16x32_bf16 v[204:207], v[132:135], v[132:135], v[204:207]
    ds_read_b128 v[92:95], v4 offset:51200
    v_mfma_f32_16x16x32_bf16 v[200:203], v[192:195], v[136:139], v[200:203]
    ds_read_b64_tr_b16 v[96:97], v219 offset:0
    v_mfma_f32_16x16x32_bf16 v[208:211], v[136:139], v[136:139], v[208:211]
    ds_read_b64_tr_b16 v[98:99], v219 offset:4608
    v_mfma_f32_16x16x32_bf16 v[226:229], v[192:195], v[140:143], v[226:229]
    ds_read_b64_tr_b16 v[100:101], v219 offset:40
    v_mfma_f32_16x16x32_bf16 v[230:233], v[192:195], v[144:147], v[230:233]
    ds_read_b64_tr_b16 v[102:103], v219 offset:4648
    v_mfma_f32_16x16x32_bf16 v[234:237], v[192:195], v[172:175], v[234:237]
    ds_read_b64_tr_b16 v[104:105], v221 offset:0
    v_mfma_f32_16x16x32_bf16 v[16:19], v[140:143], v[132:135], v[16:19]
    ds_read_b64_tr_b16 v[106:107], v221 offset:4608
    v_mfma_f32_16x16x32_bf16 v[52:55], v[140:143], v[136:139], v[52:55]
    ds_read_b64_tr_b16 v[108:109], v221 offset:40
    v_mfma_f32_16x16x32_bf16 v[20:23], v[144:147], v[132:135], v[20:23]
    ds_read_b64_tr_b16 v[110:111], v221 offset:4648
    v_mfma_f32_16x16x32_bf16 v[56:59], v[144:147], v[136:139], v[56:59]
    ds_read_b64_tr_b16 v[112:113], v223 offset:0
    v_mfma_f32_16x16x32_bf16 v[24:27], v[148:151], v[132:135], v[24:27]
    ds_read_b64_tr_b16 v[114:115], v223 offset:4608
    v_mfma_f32_16x16x32_bf16 v[60:63], v[148:151], v[136:139], v[60:63]
    ds_read_b64_tr_b16 v[116:117], v223 offset:40
    v_mfma_f32_16x16x32_bf16 v[28:31], v[152:155], v[132:135], v[28:31]
    ds_read_b64_tr_b16 v[118:119], v223 offset:4648
    v_mfma_f32_16x16x32_bf16 v[64:67], v[152:155], v[136:139], v[64:67]
    ds_read_b64_tr_b16 v[120:121], v225 offset:0
    v_mfma_f32_16x16x32_bf16 v[32:35], v[156:159], v[132:135], v[32:35]
    ds_read_b64_tr_b16 v[122:123], v225 offset:4608
    v_mfma_f32_16x16x32_bf16 v[68:71], v[156:159], v[136:139], v[68:71]
    ds_read_b64_tr_b16 v[124:125], v225 offset:40
    v_mfma_f32_16x16x32_bf16 v[36:39], v[160:163], v[132:135], v[36:39]
    ds_read_b64_tr_b16 v[126:127], v225 offset:4648
    v_mfma_f32_16x16x32_bf16 v[72:75], v[160:163], v[136:139], v[72:75]
    ds_read_b64_tr_b16 v[128:129], v9 offset:0
    v_mfma_f32_16x16x32_bf16 v[40:43], v[164:167], v[132:135], v[40:43]
    ds_read_b64_tr_b16 v[130:131], v9 offset:4608
    v_mfma_f32_16x16x32_bf16 v[76:79], v[164:167], v[136:139], v[76:79]
    v_mfma_f32_16x16x32_bf16 v[44:47], v[168:171], v[132:135], v[44:47]
    v_mfma_f32_16x16x32_bf16 v[80:83], v[168:171], v[136:139], v[80:83]
    v_mfma_f32_16x16x32_bf16 v[48:51], v[172:175], v[132:135], v[48:51]
    v_mfma_f32_16x16x32_bf16 v[84:87], v[172:175], v[136:139], v[84:87]
    s_waitcnt lgkmcnt(0)
    v_mfma_f32_16x16x32_bf16 v[196:199], v[192:195], v[88:91], v[196:199]
    ds_read_b128 v[132:135], v5 offset:49152
    v_mfma_f32_16x16x32_bf16 v[204:207], v[88:91], v[88:91], v[204:207]
    ds_read_b128 v[136:139], v5 offset:51200
    v_mfma_f32_16x16x32_bf16 v[200:203], v[192:195], v[92:95], v[200:203]
    ds_read_b64_tr_b16 v[140:141], v219 offset:9216
    v_mfma_f32_16x16x32_bf16 v[208:211], v[92:95], v[92:95], v[208:211]
    ds_read_b64_tr_b16 v[142:143], v219 offset:13824
    v_mfma_f32_16x16x32_bf16 v[226:229], v[192:195], v[96:99], v[226:229]
    ds_read_b64_tr_b16 v[144:145], v219 offset:9256
    v_mfma_f32_16x16x32_bf16 v[230:233], v[192:195], v[100:103], v[230:233]
    ds_read_b64_tr_b16 v[146:147], v219 offset:13864
    v_mfma_f32_16x16x32_bf16 v[234:237], v[192:195], v[128:131], v[234:237]
    ds_read_b64_tr_b16 v[148:149], v221 offset:9216
    v_mfma_f32_16x16x32_bf16 v[16:19], v[96:99], v[88:91], v[16:19]
    ds_read_b64_tr_b16 v[150:151], v221 offset:13824
    v_mfma_f32_16x16x32_bf16 v[52:55], v[96:99], v[92:95], v[52:55]
    ds_read_b64_tr_b16 v[152:153], v221 offset:9256
    v_mfma_f32_16x16x32_bf16 v[20:23], v[100:103], v[88:91], v[20:23]
    ds_read_b64_tr_b16 v[154:155], v221 offset:13864
    v_mfma_f32_16x16x32_bf16 v[56:59], v[100:103], v[92:95], v[56:59]
    ds_read_b64_tr_b16 v[156:157], v223 offset:9216
    v_mfma_f32_16x16x32_bf16 v[24:27], v[104:107], v[88:91], v[24:27]
    ds_read_b64_tr_b16 v[158:159], v223 offset:13824
    v_mfma_f32_16x16x32_bf16 v[60:63], v[104:107], v[92:95], v[60:63]
    ds_read_b64_tr_b16 v[160:161], v223 offset:9256
    v_mfma_f32_16x16x32_bf16 v[28:31], v[108:111], v[88:91], v[28:31]
    ds_read_b64_tr_b16 v[162:163], v223 offset:13864
    v_mfma_f32_16x16x32_bf16 v[64:67], v[108:111], v[92:95], v[64:67]
    ds_read_b64_tr_b16 v[164:165], v225 offset:9216
    v_mfma_f32_16x16x32_bf16 v[32:35], v[112:115], v[88:91], v[32:35]
    ds_read_b64_tr_b16 v[166:167], v225 offset:13824
    v_mfma_f32_16x16x32_bf16 v[68:71], v[112:115], v[92:95], v[68:71]
    ds_read_b64_tr_b16 v[168:169], v225 offset:9256
    v_mfma_f32_16x16x32_bf16 v[36:39], v[116:119], v[88:91], v[36:39]
    ds_read_b64_tr_b16 v[170:171], v225 offset:13864
    v_mfma_f32_16x16x32_bf16 v[72:75], v[116:119], v[92:95], v[72:75]
    ds_read_b64_tr_b16 v[172:173], v9 offset:9216
    v_mfma_f32_16x16x32_bf16 v[40:43], v[120:123], v[88:91], v[40:43]
    ds_read_b64_tr_b16 v[174:175], v9 offset:13824
    v_mfma_f32_16x16x32_bf16 v[76:79], v[120:123], v[92:95], v[76:79]
    v_mfma_f32_16x16x32_bf16 v[44:47], v[124:127], v[88:91], v[44:47]
    v_mfma_f32_16x16x32_bf16 v[80:83], v[124:127], v[92:95], v[80:83]
    v_mfma_f32_16x16x32_bf16 v[48:51], v[128:131], v[88:91], v[48:51]
    v_mfma_f32_16x16x32_bf16 v[84:87], v[128:131], v[92:95], v[84:87]
    s_waitcnt lgkmcnt(0)
    s_barrier
    v_mfma_f32_16x16x32_bf16 v[196:199], v[192:195], v[132:135], v[196:199]
    ds_read_b128 v[88:91], v4 offset:0
    v_mfma_f32_16x16x32_bf16 v[204:207], v[132:135], v[132:135], v[204:207]
    ds_read_b128 v[92:95], v4 offset:2048
    v_mfma_f32_16x16x32_bf16 v[200:203], v[192:195], v[136:139], v[200:203]
    ds_read_b64_tr_b16 v[96:97], v218 offset:0
    v_mfma_f32_16x16x32_bf16 v[208:211], v[136:139], v[136:139], v[208:211]
    ds_read_b64_tr_b16 v[98:99], v218 offset:4608
    v_mfma_f32_16x16x32_bf16 v[226:229], v[192:195], v[140:143], v[226:229]
    ds_read_b64_tr_b16 v[100:101], v218 offset:40
    v_mfma_f32_16x16x32_bf16 v[230:233], v[192:195], v[144:147], v[230:233]
    ds_read_b64_tr_b16 v[102:103], v218 offset:4648
    v_mfma_f32_16x16x32_bf16 v[234:237], v[192:195], v[172:175], v[234:237]
    ds_read_b64_tr_b16 v[104:105], v220 offset:0
    v_mfma_f32_16x16x32_bf16 v[16:19], v[140:143], v[132:135], v[16:19]
    ds_read_b64_tr_b16 v[106:107], v220 offset:4608
    v_mfma_f32_16x16x32_bf16 v[52:55], v[140:143], v[136:139], v[52:55]
    ds_read_b64_tr_b16 v[108:109], v220 offset:40
    v_mfma_f32_16x16x32_bf16 v[20:23], v[144:147], v[132:135], v[20:23]
    ds_read_b64_tr_b16 v[110:111], v220 offset:4648
    v_mfma_f32_16x16x32_bf16 v[56:59], v[144:147], v[136:139], v[56:59]
    ds_read_b64_tr_b16 v[112:113], v222 offset:0
    v_mfma_f32_16x16x32_bf16 v[24:27], v[148:151], v[132:135], v[24:27]
    ds_read_b64_tr_b16 v[114:115], v222 offset:4608
    v_mfma_f32_16x16x32_bf16 v[60:63], v[148:151], v[136:139], v[60:63]
    ds_read_b64_tr_b16 v[116:117], v222 offset:40
    v_mfma_f32_16x16x32_bf16 v[28:31], v[152:155], v[132:135], v[28:31]
    ds_read_b64_tr_b16 v[118:119], v222 offset:4648
    v_mfma_f32_16x16x32_bf16 v[64:67], v[152:155], v[136:139], v[64:67]
    ds_read_b64_tr_b16 v[120:121], v224 offset:0
    v_mfma_f32_16x16x32_bf16 v[32:35], v[156:159], v[132:135], v[32:35]
    ds_read_b64_tr_b16 v[122:123], v224 offset:4608
    v_mfma_f32_16x16x32_bf16 v[68:71], v[156:159], v[136:139], v[68:71]
    ds_read_b64_tr_b16 v[124:125], v224 offset:40
    v_mfma_f32_16x16x32_bf16 v[36:39], v[160:163], v[132:135], v[36:39]
    ds_read_b64_tr_b16 v[126:127], v224 offset:4648
    v_mfma_f32_16x16x32_bf16 v[72:75], v[160:163], v[136:139], v[72:75]
    ds_read_b64_tr_b16 v[128:129], v8 offset:0
    v_mfma_f32_16x16x32_bf16 v[40:43], v[164:167], v[132:135], v[40:43]
    ds_read_b64_tr_b16 v[130:131], v8 offset:4608
    v_mfma_f32_16x16x32_bf16 v[76:79], v[164:167], v[136:139], v[76:79]
    v_mfma_f32_16x16x32_bf16 v[44:47], v[168:171], v[132:135], v[44:47]
    v_mfma_f32_16x16x32_bf16 v[80:83], v[168:171], v[136:139], v[80:83]
    v_mfma_f32_16x16x32_bf16 v[48:51], v[172:175], v[132:135], v[48:51]
    v_mfma_f32_16x16x32_bf16 v[84:87], v[172:175], v[136:139], v[84:87]
    s_waitcnt lgkmcnt(0)
    v_mfma_f32_16x16x32_bf16 v[196:199], v[192:195], v[88:91], v[196:199]
    ds_read_b128 v[132:135], v5 offset:0
    v_mfma_f32_16x16x32_bf16 v[204:207], v[88:91], v[88:91], v[204:207]
    ds_read_b128 v[136:139], v5 offset:2048
    v_mfma_f32_16x16x32_bf16 v[200:203], v[192:195], v[92:95], v[200:203]
    ds_read_b64_tr_b16 v[140:141], v218 offset:9216
    v_mfma_f32_16x16x32_bf16 v[208:211], v[92:95], v[92:95], v[208:211]
    ds_read_b64_tr_b16 v[142:143], v218 offset:13824
    v_mfma_f32_16x16x32_bf16 v[226:229], v[192:195], v[96:99], v[226:229]
    ds_read_b64_tr_b16 v[144:145], v218 offset:9256
    v_mfma_f32_16x16x32_bf16 v[230:233], v[192:195], v[100:103], v[230:233]
    ds_read_b64_tr_b16 v[146:147], v218 offset:13864
    v_mfma_f32_16x16x32_bf16 v[234:237], v[192:195], v[128:131], v[234:237]
    ds_read_b64_tr_b16 v[148:149], v220 offset:9216
    v_mfma_f32_16x16x32_bf16 v[16:19], v[96:99], v[88:91], v[16:19]
    ds_read_b64_tr_b16 v[150:151], v220 offset:13824
    v_mfma_f32_16x16x32_bf16 v[52:55], v[96:99], v[92:95], v[52:55]
    ds_read_b64_tr_b16 v[152:153], v220 offset:9256
    v_mfma_f32_16x16x32_bf16 v[20:23], v[100:103], v[88:91], v[20:23]
    ds_read_b64_tr_b16 v[154:155], v220 offset:13864
    v_mfma_f32_16x16x32_bf16 v[56:59], v[100:103], v[92:95], v[56:59]
    ds_read_b64_tr_b16 v[156:157], v222 offset:9216
    v_mfma_f32_16x16x32_bf16 v[24:27], v[104:107], v[88:91], v[24:27]
    ds_read_b64_tr_b16 v[158:159], v222 offset:13824
    v_mfma_f32_16x16x32_bf16 v[60:63], v[104:107], v[92:95], v[60:63]
    ds_read_b64_tr_b16 v[160:161], v222 offset:9256
    v_mfma_f32_16x16x32_bf16 v[28:31], v[108:111], v[88:91], v[28:31]
    ds_read_b64_tr_b16 v[162:163], v222 offset:13864
    v_mfma_f32_16x16x32_bf16 v[64:67], v[108:111], v[92:95], v[64:67]
    ds_read_b64_tr_b16 v[164:165], v224 offset:9216
    v_mfma_f32_16x16x32_bf16 v[32:35], v[112:115], v[88:91], v[32:35]
    ds_read_b64_tr_b16 v[166:167], v224 offset:13824
    v_mfma_f32_16x16x32_bf16 v[68:71], v[112:115], v[92:95], v[68:71]
    ds_read_b64_tr_b16 v[168:169], v224 offset:9256
    v_mfma_f32_16x16x32_bf16 v[36:39], v[116:119], v[88:91], v[36:39]
    ds_read_b64_tr_b16 v[170:171], v224 offset:13864
    v_mfma_f32_16x16x32_bf16 v[72:75], v[116:119], v[92:95], v[72:75]
    ds_read_b64_tr_b16 v[172:173], v8 offset:9216
    v_mfma_f32_16x16x32_bf16 v[40:43], v[120:123], v[88:91], v[40:43]
    ds_read_b64_tr_b16 v[174:175], v8 offset:13824
    v_mfma_f32_16x16x32_bf16 v[76:79], v[120:123], v[92:95], v[76:79]
    v_mfma_f32_16x16x32_bf16 v[44:47], v[124:127], v[88:91], v[44:47]
    v_mfma_f32_16x16x32_bf16 v[80:83], v[124:127], v[92:95], v[80:83]
    v_mfma_f32_16x16x32_bf16 v[48:51], v[128:131], v[88:91], v[48:51]
    v_mfma_f32_16x16x32_bf16 v[84:87], v[128:131], v[92:95], v[84:87]
    s_waitcnt lgkmcnt(0)
    v_mfma_f32_16x16x32_bf16 v[196:199], v[192:195], v[132:135], v[196:199]
    v_mfma_f32_16x16x32_bf16 v[204:207], v[132:135], v[132:135], v[204:207]
    v_mfma_f32_16x16x32_bf16 v[200:203], v[192:195], v[136:139], v[200:203]
    v_mfma_f32_16x16x32_bf16 v[208:211], v[136:139], v[136:139], v[208:211]
    v_mfma_f32_16x16x32_bf16 v[226:229], v[192:195], v[140:143], v[226:229]
    v_mfma_f32_16x16x32_bf16 v[230:233], v[192:195], v[144:147], v[230:233]
    v_mfma_f32_16x16x32_bf16 v[234:237], v[192:195], v[172:175], v[234:237]
    v_mfma_f32_16x16x32_bf16 v[16:19], v[140:143], v[132:135], v[16:19]
    v_mfma_f32_16x16x32_bf16 v[52:55], v[140:143], v[136:139], v[52:55]
    v_mfma_f32_16x16x32_bf16 v[20:23], v[144:147], v[132:135], v[20:23]
    v_mfma_f32_16x16x32_bf16 v[56:59], v[144:147], v[136:139], v[56:59]
    s_nop 1
    ds_write_b32 v246, v226
    ds_write_b32 v246, v230 offset:64
    ds_write_b32 v247, v234
    v_mfma_f32_16x16x32_bf16 v[24:27], v[148:151], v[132:135], v[24:27]
    v_cndmask_b32 v213, v204, v205, s[30:31]
    v_cndmask_b32 v215, v208, v209, s[30:31]
    v_mfma_f32_16x16x32_bf16 v[60:63], v[148:151], v[136:139], v[60:63]
    v_mul_f32 v214, s28, v196
    v_mul_f32 v216, s28, v200
    v_mfma_f32_16x16x32_bf16 v[28:31], v[152:155], v[132:135], v[28:31]
    v_cndmask_b32 v213, v213, v206, s[34:35]
    v_cndmask_b32 v215, v215, v210, s[34:35]
    v_mfma_f32_16x16x32_bf16 v[64:67], v[152:155], v[136:139], v[64:67]
    v_cndmask_b32 v213, v213, v207, s[36:37]
    v_cndmask_b32 v215, v215, v211, s[36:37]
    v_mfma_f32_16x16x32_bf16 v[32:35], v[156:159], v[132:135], v[32:35]
    v_mul_f32 v213, s28, v213
    v_mul_f32 v215, s28, v215
    v_mfma_f32_16x16x32_bf16 v[68:71], v[156:159], v[136:139], v[68:71]
    v_fma_f32 v213, -v214, v214, v213
    v_fma_f32 v215, -v216, v216, v215
    v_mfma_f32_16x16x32_bf16 v[36:39], v[160:163], v[132:135], v[36:39]
    v_max_f32 v213, 0, v213
    v_max_f32 v215, 0, v215
    v_mfma_f32_16x16x32_bf16 v[72:75], v[160:163], v[136:139], v[72:75]
    v_add_f32 v213, s32, v213
    v_add_f32 v215, s32, v215
    v_mfma_f32_16x16x32_bf16 v[40:43], v[164:167], v[132:135], v[40:43]
    v_rsq_f32 v213, v213
    v_rsq_f32 v215, v215
    v_mfma_f32_16x16x32_bf16 v[76:79], v[164:167], v[136:139], v[76:79]
    v_sub_f32 v214, 0, v214
    v_sub_f32 v216, 0, v216
    v_mfma_f32_16x16x32_bf16 v[44:47], v[168:171], v[132:135], v[44:47]
    v_mul_f32 v213, s29, v213
    v_mul_f32 v215, s29, v215
    v_mfma_f32_16x16x32_bf16 v[80:83], v[168:171], v[136:139], v[80:83]
    v_mul_f32 v214, v214, v213
    v_mul_f32 v216, v216, v215
    v_mfma_f32_16x16x32_bf16 v[48:51], v[172:175], v[132:135], v[48:51]
    ds_write_b32 v212, v213 offset:0
    ds_write_b32 v212, v215 offset:64
    v_mfma_f32_16x16x32_bf16 v[84:87], v[172:175], v[136:139], v[84:87]
    ds_write_b32 v212, v214 offset:128
    ds_write_b32 v212, v216 offset:192
    s_waitcnt lgkmcnt(0)
    s_barrier
    ds_read2_b32 v[124:125], v13 offset0:0 offset1:32
    ds_read2_b32 v[126:127], v13 offset0:16 offset1:48
    ds_read_b128 v[140:143], v238 offset:0
    ds_read_b128 v[144:147], v238 offset:64
    ds_read_b128 v[148:151], v239 offset:0
    ds_read_b128 v[152:155], v239 offset:64
    ds_read_b128 v[156:159], v240 offset:0
    ds_read_b128 v[160:163], v240 offset:64
    ds_read_b128 v[164:167], v241 offset:0
    ds_read_b128 v[168:171], v241 offset:64
    ds_read_b128 v[172:175], v14 offset:512
    s_waitcnt lgkmcnt(0)
    s_nop 0
    v_pk_mul_f32 v[16:17], v[16:17], v[124:125] op_sel_hi:[1,0]
    v_pk_mul_f32 v[18:19], v[18:19], v[124:125] op_sel_hi:[1,0]
    v_pk_mul_f32 v[52:53], v[52:53], v[126:127] op_sel_hi:[1,0]
    v_pk_mul_f32 v[54:55], v[54:55], v[126:127] op_sel_hi:[1,0]
    v_pk_fma_f32 v[16:17], v[140:141], v[124:125], v[16:17] op_sel:[0,1,0]
    v_pk_fma_f32 v[18:19], v[142:143], v[124:125], v[18:19] op_sel:[0,1,0]
    v_pk_fma_f32 v[52:53], v[140:141], v[126:127], v[52:53] op_sel:[0,1,0]
    v_pk_fma_f32 v[54:55], v[142:143], v[126:127], v[54:55] op_sel:[0,1,0]
    v_cvt_pk_bf16_f32 v88, v16, v17
    v_cvt_pk_bf16_f32 v89, v18, v19
    v_cvt_pk_bf16_f32 v90, v52, v53
    v_cvt_pk_bf16_f32 v91, v54, v55
    s_nop 0
    v_permlane16_swap_b32 v88, v90
    v_permlane16_swap_b32 v89, v91
    buffer_store_dwordx4 v[88:91], v3, s[16:19], s50 offen sc1
    s_add_u32 s50, s50, 65536
    s_nop 0
    v_pk_mul_f32 v[20:21], v[20:21], v[124:125] op_sel_hi:[1,0]
    v_pk_mul_f32 v[22:23], v[22:23], v[124:125] op_sel_hi:[1,0]
    v_pk_mul_f32 v[56:57], v[56:57], v[126:127] op_sel_hi:[1,0]
    v_pk_mul_f32 v[58:59], v[58:59], v[126:127] op_sel_hi:[1,0]
    v_pk_fma_f32 v[20:21], v[144:145], v[124:125], v[20:21] op_sel:[0,1,0]
    v_pk_fma_f32 v[22:23], v[146:147], v[124:125], v[22:23] op_sel:[0,1,0]
    v_pk_fma_f32 v[56:57], v[144:145], v[126:127], v[56:57] op_sel:[0,1,0]
    v_pk_fma_f32 v[58:59], v[146:147], v[126:127], v[58:59] op_sel:[0,1,0]
    v_cvt_pk_bf16_f32 v92, v20, v21
    v_cvt_pk_bf16_f32 v93, v22, v23
    v_cvt_pk_bf16_f32 v94, v56, v57
    v_cvt_pk_bf16_f32 v95, v58, v59
    s_nop 0
    v_permlane16_swap_b32 v92, v94
    v_permlane16_swap_b32 v93, v95
    buffer_store_dwordx4 v[92:95], v3, s[16:19], s50 offen sc1
    s_nop 0
    v_pk_mul_f32 v[24:25], v[24:25], v[124:125] op_sel_hi:[1,0]
    v_pk_mul_f32 v[26:27], v[26:27], v[124:125] op_sel_hi:[1,0]
    v_pk_mul_f32 v[60:61], v[60:61], v[126:127] op_sel_hi:[1,0]
    v_pk_mul_f32 v[62:63], v[62:63], v[126:127] op_sel_hi:[1,0]
    v_pk_fma_f32 v[24:25], v[148:149], v[124:125], v[24:25] op_sel:[0,1,0]
    v_pk_fma_f32 v[26:27], v[150:151], v[124:125], v[26:27] op_sel:[0,1,0]
    v_pk_fma_f32 v[60:61], v[148:149], v[126:127], v[60:61] op_sel:[0,1,0]
    v_pk_fma_f32 v[62:63], v[150:151], v[126:127], v[62:63] op_sel:[0,1,0]
    v_cvt_pk_bf16_f32 v96, v24, v25
    v_cvt_pk_bf16_f32 v97, v26, v27
    v_cvt_pk_bf16_f32 v98, v60, v61
    v_cvt_pk_bf16_f32 v99, v62, v63
    s_nop 0
    v_permlane16_swap_b32 v96, v98
    v_permlane16_swap_b32 v97, v99
    buffer_store_dwordx4 v[96:99], v3, s[16:19], s51 offen sc1
    s_add_u32 s51, s51, 65536
    s_nop 0
    v_pk_mul_f32 v[28:29], v[28:29], v[124:125] op_sel_hi:[1,0]
    v_pk_mul_f32 v[30:31], v[30:31], v[124:125] op_sel_hi:[1,0]
    v_pk_mul_f32 v[64:65], v[64:65], v[126:127] op_sel_hi:[1,0]
    v_pk_mul_f32 v[66:67], v[66:67], v[126:127] op_sel_hi:[1,0]
    v_pk_fma_f32 v[28:29], v[152:153], v[124:125], v[28:29] op_sel:[0,1,0]
    v_pk_fma_f32 v[30:31], v[154:155], v[124:125], v[30:31] op_sel:[0,1,0]
    v_pk_fma_f32 v[64:65], v[152:153], v[126:127], v[64:65] op_sel:[0,1,0]
    v_pk_fma_f32 v[66:67], v[154:155], v[126:127], v[66:67] op_sel:[0,1,0]
    v_cvt_pk_bf16_f32 v100, v28, v29
    v_cvt_pk_bf16_f32 v101, v30, v31
    v_cvt_pk_bf16_f32 v102, v64, v65
    v_cvt_pk_bf16_f32 v103, v66, v67
    s_nop 0
    v_permlane16_swap_b32 v100, v102
    v_permlane16_swap_b32 v101, v103
    buffer_store_dwordx4 v[100:103], v3, s[16:19], s51 offen sc1
    s_nop 0
    v_pk_mul_f32 v[32:33], v[32:33], v[124:125] op_sel_hi:[1,0]
    v_pk_mul_f32 v[34:35], v[34:35], v[124:125] op_sel_hi:[1,0]
    v_pk_mul_f32 v[68:69], v[68:69], v[126:127] op_sel_hi:[1,0]
    v_pk_mul_f32 v[70:71], v[70:71], v[126:127] op_sel_hi:[1,0]
    v_pk_fma_f32 v[32:33], v[156:157], v[124:125], v[32:33] op_sel:[0,1,0]
    v_pk_fma_f32 v[34:35], v[158:159], v[124:125], v[34:35] op_sel:[0,1,0]
    v_pk_fma_f32 v[68:69], v[156:157], v[126:127], v[68:69] op_sel:[0,1,0]
    v_pk_fma_f32 v[70:71], v[158:159], v[126:127], v[70:71] op_sel:[0,1,0]
    v_cvt_pk_bf16_f32 v88, v32, v33
    v_cvt_pk_bf16_f32 v89, v34, v35
    v_cvt_pk_bf16_f32 v90, v68, v69
    v_cvt_pk_bf16_f32 v91, v70, v71
    s_nop 0
    v_permlane16_swap_b32 v88, v90
    v_permlane16_swap_b32 v89, v91
    buffer_store_dwordx4 v[88:91], v3, s[16:19], s52 offen sc1
    s_add_u32 s52, s52, 65536
    s_nop 0
    v_pk_mul_f32 v[36:37], v[36:37], v[124:125] op_sel_hi:[1,0]
    v_pk_mul_f32 v[38:39], v[38:39], v[124:125] op_sel_hi:[1,0]
    v_pk_mul_f32 v[72:73], v[72:73], v[126:127] op_sel_hi:[1,0]
    v_pk_mul_f32 v[74:75], v[74:75], v[126:127] op_sel_hi:[1,0]
    v_pk_fma_f32 v[36:37], v[160:161], v[124:125], v[36:37] op_sel:[0,1,0]
    v_pk_fma_f32 v[38:39], v[162:163], v[124:125], v[38:39] op_sel:[0,1,0]
    v_pk_fma_f32 v[72:73], v[160:161], v[126:127], v[72:73] op_sel:[0,1,0]
    v_pk_fma_f32 v[74:75], v[162:163], v[126:127], v[74:75] op_sel:[0,1,0]
    v_cvt_pk_bf16_f32 v92, v36, v37
    v_cvt_pk_bf16_f32 v93, v38, v39
    v_cvt_pk_bf16_f32 v94, v72, v73
    v_cvt_pk_bf16_f32 v95, v74, v75
    s_nop 0
    v_permlane16_swap_b32 v92, v94
    v_permlane16_swap_b32 v93, v95
    buffer_store_dwordx4 v[92:95], v3, s[16:19], s52 offen sc1
    s_nop 0
    v_pk_mul_f32 v[40:41], v[40:41], v[124:125] op_sel_hi:[1,0]
    v_pk_mul_f32 v[42:43], v[42:43], v[124:125] op_sel_hi:[1,0]
    v_pk_mul_f32 v[76:77], v[76:77], v[126:127] op_sel_hi:[1,0]
    v_pk_mul_f32 v[78:79], v[78:79], v[126:127] op_sel_hi:[1,0]
    v_pk_fma_f32 v[40:41], v[164:165], v[124:125], v[40:41] op_sel:[0,1,0]
    v_pk_fma_f32 v[42:43], v[166:167], v[124:125], v[42:43] op_sel:[0,1,0]
    v_pk_fma_f32 v[76:77], v[164:165], v[126:127], v[76:77] op_sel:[0,1,0]
    v_pk_fma_f32 v[78:79], v[166:167], v[126:127], v[78:79] op_sel:[0,1,0]
    v_cvt_pk_bf16_f32 v96, v40, v41
    v_cvt_pk_bf16_f32 v97, v42, v43
    v_cvt_pk_bf16_f32 v98, v76, v77
    v_cvt_pk_bf16_f32 v99, v78, v79
    s_nop 0
    v_permlane16_swap_b32 v96, v98
    v_permlane16_swap_b32 v97, v99
    buffer_store_dwordx4 v[96:99], v3, s[16:19], s53 offen sc1
    s_add_u32 s53, s53, 65536
    s_nop 0
    v_pk_mul_f32 v[44:45], v[44:45], v[124:125] op_sel_hi:[1,0]
    v_pk_mul_f32 v[46:47], v[46:47], v[124:125] op_sel_hi:[1,0]
    v_pk_mul_f32 v[80:81], v[80:81], v[126:127] op_sel_hi:[1,0]
    v_pk_mul_f32 v[82:83], v[82:83], v[126:127] op_sel_hi:[1,0]
    v_pk_fma_f32 v[44:45], v[168:169], v[124:125], v[44:45] op_sel:[0,1,0]
    v_pk_fma_f32 v[46:47], v[170:171], v[124:125], v[46:47] op_sel:[0,1,0]
    v_pk_fma_f32 v[80:81], v[168:169], v[126:127], v[80:81] op_sel:[0,1,0]
    v_pk_fma_f32 v[82:83], v[170:171], v[126:127], v[82:83] op_sel:[0,1,0]
    v_cvt_pk_bf16_f32 v100, v44, v45
    v_cvt_pk_bf16_f32 v101, v46, v47
    v_cvt_pk_bf16_f32 v102, v80, v81
    v_cvt_pk_bf16_f32 v103, v82, v83
    s_nop 0
    v_permlane16_swap_b32 v100, v102
    v_permlane16_swap_b32 v101, v103
    buffer_store_dwordx4 v[100:103], v3, s[16:19], s53 offen sc1
    s_nop 0
    v_pk_mul_f32 v[48:49], v[48:49], v[124:125] op_sel_hi:[1,0]
    v_pk_mul_f32 v[50:51], v[50:51], v[124:125] op_sel_hi:[1,0]
    v_pk_mul_f32 v[84:85], v[84:85], v[126:127] op_sel_hi:[1,0]
    v_pk_mul_f32 v[86:87], v[86:87], v[126:127] op_sel_hi:[1,0]
    v_pk_fma_f32 v[48:49], v[172:173], v[124:125], v[48:49] op_sel:[0,1,0]
    v_pk_fma_f32 v[50:51], v[174:175], v[124:125], v[50:51] op_sel:[0,1,0]
    v_pk_fma_f32 v[84:85], v[172:173], v[126:127], v[84:85] op_sel:[0,1,0]
    v_pk_fma_f32 v[86:87], v[174:175], v[126:127], v[86:87] op_sel:[0,1,0]
    v_cvt_pk_bf16_f32 v88, v48, v49
    v_cvt_pk_bf16_f32 v89, v50, v51
    v_cvt_pk_bf16_f32 v90, v84, v85
    v_cvt_pk_bf16_f32 v91, v86, v87
    s_nop 0
    v_permlane16_swap_b32 v88, v90
    v_permlane16_swap_b32 v89, v91
    buffer_store_dword v88, v10, s[16:19], s49 offen sc1
    s_add_u32 s49, s49, 8192
    buffer_store_dword v89, v10, s[16:19], s49 offen sc1
    s_add_u32 s49, s49, 8192
    buffer_store_dword v90, v10, s[16:19], s49 offen sc1
    s_add_u32 s49, s49, 8192
    buffer_store_dword v91, v10, s[16:19], s49 offen sc1
    s_add_u32 s49, s49, 8192
    v_mov_b32 v9, 147496
    v_mov_b32 v10, 1
    v_mov_b32_e64 v8, 0
    s_waitcnt vmcnt(0)
    s_mov_b64 exec, 1
    ds_add_rtn_u32 v10, v9, v10
    s_waitcnt lgkmcnt(0)
    v_cmp_eq_u32 vcc, 3, v10
    s_nop 0
    s_and_b64 exec, exec, vcc
    buffer_store_dword v8, v8, s[16:19], s43 offen sc1
    s_mov_b64 exec, -1
    s_branch sequential_preLN__sliding_block__mixer_gmlp__prompt_kernel_p1done
sequential_preLN__sliding_block__mixer_gmlp__prompt_kernel_v1:
    v_lshl_add_u32 v13, v12, 4, s45
    v_lshlrev_b32_e64 v14, 2, v11
    v_add_u32 v14, 140288, v14
    s_mul_i32 s47, s44, 36864
    s_sub_u32 s46, s22, 8
    s_mul_i32 s46, s46, 2304
    s_add_u32 s47, s47, s46
    s_add_u32 s48, s47, 2048
    v_mul_u32_u24 v10, 9216, v12
    v_lshl_add_u32 v10, v11, 4, v10
    s_lshl_b32 s38, s50, 7
    v_add_u32 v238, s38, v14
    s_lshl_b32 s50, s50, 9
    s_add_u32 s50, s50, s47
    s_lshl_b32 s38, s51, 7
    v_add_u32 v239, s38, v14
    s_lshl_b32 s51, s51, 9
    s_add_u32 s51, s51, s47
    s_lshl_b32 s38, s52, 7
    v_add_u32 v240, s38, v14
    s_lshl_b32 s52, s52, 9
    s_add_u32 s52, s52, s47
    s_lshl_b32 s38, s53, 7
    v_add_u32_e64 v241, s38, v14
    s_lshl_b32 s53, s53, 9
    s_add_u32 s53, s53, s47
    s_barrier
    ds_read_b128 v[88:91], v4 offset:0
    ds_read_b128 v[92:95], v4 offset:2048
    ds_read_b64_tr_b16 v[96:97], v218 offset:0
    ds_read_b64_tr_b16 v[98:99], v218 offset:4608
    ds_read_b64_tr_b16 v[100:101], v218 offset:32
    ds_read_b64_tr_b16 v[102:103], v218 offset:4640
    ds_read_b64_tr_b16 v[104:105], v220 offset:0
    ds_read_b64_tr_b16 v[106:107], v220 offset:4608
    ds_read_b64_tr_b16 v[108:109], v220 offset:32
    ds_read_b64_tr_b16 v[110:111], v220 offset:4640
    ds_read_b64_tr_b16 v[112:113], v222 offset:0
    ds_read_b64_tr_b16 v[114:115], v222 offset:4608
    ds_read_b64_tr_b16 v[116:117], v222 offset:32
    ds_read_b64_tr_b16 v[118:119], v222 offset:4640
    ds_read_b64_tr_b16 v[120:121], v224 offset:0
    ds_read_b64_tr_b16 v[122:123], v224 offset:4608
    ds_read_b64_tr_b16 v[124:125], v224 offset:32
    ds_read_b64_tr_b16 v[126:127], v224 offset:4640
    ds_read_b64_tr_b16 v[128:129], v6 offset:256
    ds_read_b64_tr_b16 v[130:131], v6 offset:4864
    s_waitcnt lgkmcnt(0)
    v_mfma_f32_16x16x32_bf16 v[196:199], v[192:195], v[88:91], 0
    ds_read_b128 v[132:135], v5 offset:0
    v_mfma_f32_16x16x32_bf16 v[204:207], v[88:91], v[88:91], 0
    ds_read_b128 v[136:139], v5 offset:2048
    v_mfma_f32_16x16x32_bf16 v[200:203], v[192:195], v[92:95], 0
    ds_read_b64_tr_b16 v[140:141], v218 offset:9216
    v_mfma_f32_16x16x32_bf16 v[208:211], v[92:95], v[92:95], 0
    ds_read_b64_tr_b16 v[142:143], v218 offset:13824
    v_mfma_f32_16x16x32_bf16 v[226:229], v[192:195], v[96:99], 0
    ds_read_b64_tr_b16 v[144:145], v218 offset:9248
    v_mfma_f32_16x16x32_bf16 v[230:233], v[192:195], v[100:103], 0
    ds_read_b64_tr_b16 v[146:147], v218 offset:13856
    v_mfma_f32_16x16x32_bf16 v[234:237], v[192:195], v[128:131], 0
    ds_read_b64_tr_b16 v[148:149], v220 offset:9216
    v_mfma_f32_16x16x32_bf16 v[16:19], v[88:91], v[96:99], 0
    ds_read_b64_tr_b16 v[150:151], v220 offset:13824
    v_mfma_f32_16x16x32_bf16 v[52:55], v[92:95], v[96:99], 0
    ds_read_b64_tr_b16 v[152:153], v220 offset:9248
    v_mfma_f32_16x16x32_bf16 v[20:23], v[88:91], v[100:103], 0
    ds_read_b64_tr_b16 v[154:155], v220 offset:13856
    v_mfma_f32_16x16x32_bf16 v[56:59], v[92:95], v[100:103], 0
    ds_read_b64_tr_b16 v[156:157], v222 offset:9216
    v_mfma_f32_16x16x32_bf16 v[24:27], v[88:91], v[104:107], 0
    ds_read_b64_tr_b16 v[158:159], v222 offset:13824
    v_mfma_f32_16x16x32_bf16 v[60:63], v[92:95], v[104:107], 0
    ds_read_b64_tr_b16 v[160:161], v222 offset:9248
    v_mfma_f32_16x16x32_bf16 v[28:31], v[88:91], v[108:111], 0
    ds_read_b64_tr_b16 v[162:163], v222 offset:13856
    v_mfma_f32_16x16x32_bf16 v[64:67], v[92:95], v[108:111], 0
    ds_read_b64_tr_b16 v[164:165], v224 offset:9216
    v_mfma_f32_16x16x32_bf16 v[32:35], v[88:91], v[112:115], 0
    ds_read_b64_tr_b16 v[166:167], v224 offset:13824
    v_mfma_f32_16x16x32_bf16 v[68:71], v[92:95], v[112:115], 0
    ds_read_b64_tr_b16 v[168:169], v224 offset:9248
    v_mfma_f32_16x16x32_bf16 v[36:39], v[88:91], v[116:119], 0
    ds_read_b64_tr_b16 v[170:171], v224 offset:13856
    v_mfma_f32_16x16x32_bf16 v[72:75], v[92:95], v[116:119], 0
    ds_read_b64_tr_b16 v[172:173], v6 offset:9472
    v_mfma_f32_16x16x32_bf16 v[40:43], v[88:91], v[120:123], 0
    ds_read_b64_tr_b16 v[174:175], v6 offset:14080
    v_mfma_f32_16x16x32_bf16 v[76:79], v[92:95], v[120:123], 0
    v_mfma_f32_16x16x32_bf16 v[44:47], v[88:91], v[124:127], 0
    v_mfma_f32_16x16x32_bf16 v[80:83], v[92:95], v[124:127], 0
    v_mfma_f32_16x16x32_bf16 v[48:51], v[88:91], v[128:131], 0
    v_mfma_f32_16x16x32_bf16 v[84:87], v[92:95], v[128:131], 0
    s_waitcnt lgkmcnt(0)
    s_barrier
    v_mfma_f32_16x16x32_bf16 v[196:199], v[192:195], v[132:135], v[196:199]
    ds_read_b128 v[88:91], v4 offset:16384
    v_mfma_f32_16x16x32_bf16 v[204:207], v[132:135], v[132:135], v[204:207]
    ds_read_b128 v[92:95], v4 offset:18432
    v_mfma_f32_16x16x32_bf16 v[200:203], v[192:195], v[136:139], v[200:203]
    ds_read_b64_tr_b16 v[96:97], v218 offset:18432
    v_mfma_f32_16x16x32_bf16 v[208:211], v[136:139], v[136:139], v[208:211]
    ds_read_b64_tr_b16 v[98:99], v218 offset:23040
    v_mfma_f32_16x16x32_bf16 v[226:229], v[192:195], v[140:143], v[226:229]
    ds_read_b64_tr_b16 v[100:101], v218 offset:18464
    v_mfma_f32_16x16x32_bf16 v[230:233], v[192:195], v[144:147], v[230:233]
    ds_read_b64_tr_b16 v[102:103], v218 offset:23072
    v_mfma_f32_16x16x32_bf16 v[234:237], v[192:195], v[172:175], v[234:237]
    ds_read_b64_tr_b16 v[104:105], v220 offset:18432
    v_mfma_f32_16x16x32_bf16 v[16:19], v[132:135], v[140:143], v[16:19]
    ds_read_b64_tr_b16 v[106:107], v220 offset:23040
    v_mfma_f32_16x16x32_bf16 v[52:55], v[136:139], v[140:143], v[52:55]
    ds_read_b64_tr_b16 v[108:109], v220 offset:18464
    v_mfma_f32_16x16x32_bf16 v[20:23], v[132:135], v[144:147], v[20:23]
    ds_read_b64_tr_b16 v[110:111], v220 offset:23072
    v_mfma_f32_16x16x32_bf16 v[56:59], v[136:139], v[144:147], v[56:59]
    ds_read_b64_tr_b16 v[112:113], v222 offset:18432
    v_mfma_f32_16x16x32_bf16 v[24:27], v[132:135], v[148:151], v[24:27]
    ds_read_b64_tr_b16 v[114:115], v222 offset:23040
    v_mfma_f32_16x16x32_bf16 v[60:63], v[136:139], v[148:151], v[60:63]
    ds_read_b64_tr_b16 v[116:117], v222 offset:18464
    v_mfma_f32_16x16x32_bf16 v[28:31], v[132:135], v[152:155], v[28:31]
    ds_read_b64_tr_b16 v[118:119], v222 offset:23072
    v_mfma_f32_16x16x32_bf16 v[64:67], v[136:139], v[152:155], v[64:67]
    ds_read_b64_tr_b16 v[120:121], v224 offset:18432
    v_mfma_f32_16x16x32_bf16 v[32:35], v[132:135], v[156:159], v[32:35]
    ds_read_b64_tr_b16 v[122:123], v224 offset:23040
    v_mfma_f32_16x16x32_bf16 v[68:71], v[136:139], v[156:159], v[68:71]
    ds_read_b64_tr_b16 v[124:125], v224 offset:18464
    v_mfma_f32_16x16x32_bf16 v[36:39], v[132:135], v[160:163], v[36:39]
    ds_read_b64_tr_b16 v[126:127], v224 offset:23072
    v_mfma_f32_16x16x32_bf16 v[72:75], v[136:139], v[160:163], v[72:75]
    ds_read_b64_tr_b16 v[128:129], v6 offset:18688
    v_mfma_f32_16x16x32_bf16 v[40:43], v[132:135], v[164:167], v[40:43]
    ds_read_b64_tr_b16 v[130:131], v6 offset:23296
    v_mfma_f32_16x16x32_bf16 v[76:79], v[136:139], v[164:167], v[76:79]
    v_mfma_f32_16x16x32_bf16 v[44:47], v[132:135], v[168:171], v[44:47]
    v_mfma_f32_16x16x32_bf16 v[80:83], v[136:139], v[168:171], v[80:83]
    v_mfma_f32_16x16x32_bf16 v[48:51], v[132:135], v[172:175], v[48:51]
    v_mfma_f32_16x16x32_bf16 v[84:87], v[136:139], v[172:175], v[84:87]
    s_waitcnt lgkmcnt(0)
    v_mfma_f32_16x16x32_bf16 v[196:199], v[192:195], v[88:91], v[196:199]
    ds_read_b128 v[132:135], v5 offset:16384
    v_mfma_f32_16x16x32_bf16 v[204:207], v[88:91], v[88:91], v[204:207]
    ds_read_b128 v[136:139], v5 offset:18432
    v_mfma_f32_16x16x32_bf16 v[200:203], v[192:195], v[92:95], v[200:203]
    ds_read_b64_tr_b16 v[140:141], v218 offset:27648
    v_mfma_f32_16x16x32_bf16 v[208:211], v[92:95], v[92:95], v[208:211]
    ds_read_b64_tr_b16 v[142:143], v218 offset:32256
    v_mfma_f32_16x16x32_bf16 v[226:229], v[192:195], v[96:99], v[226:229]
    ds_read_b64_tr_b16 v[144:145], v218 offset:27680
    v_mfma_f32_16x16x32_bf16 v[230:233], v[192:195], v[100:103], v[230:233]
    ds_read_b64_tr_b16 v[146:147], v218 offset:32288
    v_mfma_f32_16x16x32_bf16 v[234:237], v[192:195], v[128:131], v[234:237]
    ds_read_b64_tr_b16 v[148:149], v220 offset:27648
    v_mfma_f32_16x16x32_bf16 v[16:19], v[88:91], v[96:99], v[16:19]
    ds_read_b64_tr_b16 v[150:151], v220 offset:32256
    v_mfma_f32_16x16x32_bf16 v[52:55], v[92:95], v[96:99], v[52:55]
    ds_read_b64_tr_b16 v[152:153], v220 offset:27680
    v_mfma_f32_16x16x32_bf16 v[20:23], v[88:91], v[100:103], v[20:23]
    ds_read_b64_tr_b16 v[154:155], v220 offset:32288
    v_mfma_f32_16x16x32_bf16 v[56:59], v[92:95], v[100:103], v[56:59]
    ds_read_b64_tr_b16 v[156:157], v222 offset:27648
    v_mfma_f32_16x16x32_bf16 v[24:27], v[88:91], v[104:107], v[24:27]
    ds_read_b64_tr_b16 v[158:159], v222 offset:32256
    v_mfma_f32_16x16x32_bf16 v[60:63], v[92:95], v[104:107], v[60:63]
    ds_read_b64_tr_b16 v[160:161], v222 offset:27680
    v_mfma_f32_16x16x32_bf16 v[28:31], v[88:91], v[108:111], v[28:31]
    ds_read_b64_tr_b16 v[162:163], v222 offset:32288
    v_mfma_f32_16x16x32_bf16 v[64:67], v[92:95], v[108:111], v[64:67]
    ds_read_b64_tr_b16 v[164:165], v224 offset:27648
    v_mfma_f32_16x16x32_bf16 v[32:35], v[88:91], v[112:115], v[32:35]
    ds_read_b64_tr_b16 v[166:167], v224 offset:32256
    v_mfma_f32_16x16x32_bf16 v[68:71], v[92:95], v[112:115], v[68:71]
    ds_read_b64_tr_b16 v[168:169], v224 offset:27680
    v_mfma_f32_16x16x32_bf16 v[36:39], v[88:91], v[116:119], v[36:39]
    ds_read_b64_tr_b16 v[170:171], v224 offset:32288
    v_mfma_f32_16x16x32_bf16 v[72:75], v[92:95], v[116:119], v[72:75]
    ds_read_b64_tr_b16 v[172:173], v6 offset:27904
    v_mfma_f32_16x16x32_bf16 v[40:43], v[88:91], v[120:123], v[40:43]
    ds_read_b64_tr_b16 v[174:175], v6 offset:32512
    v_mfma_f32_16x16x32_bf16 v[76:79], v[92:95], v[120:123], v[76:79]
    v_mfma_f32_16x16x32_bf16 v[44:47], v[88:91], v[124:127], v[44:47]
    v_mfma_f32_16x16x32_bf16 v[80:83], v[92:95], v[124:127], v[80:83]
    v_mfma_f32_16x16x32_bf16 v[48:51], v[88:91], v[128:131], v[48:51]
    v_mfma_f32_16x16x32_bf16 v[84:87], v[92:95], v[128:131], v[84:87]
    s_waitcnt lgkmcnt(0)
    s_barrier
    v_mfma_f32_16x16x32_bf16 v[196:199], v[192:195], v[132:135], v[196:199]
    ds_read_b128 v[88:91], v4 offset:32768
    v_mfma_f32_16x16x32_bf16 v[204:207], v[132:135], v[132:135], v[204:207]
    ds_read_b128 v[92:95], v4 offset:34816
    v_mfma_f32_16x16x32_bf16 v[200:203], v[192:195], v[136:139], v[200:203]
    ds_read_b64_tr_b16 v[96:97], v218 offset:36864
    v_mfma_f32_16x16x32_bf16 v[208:211], v[136:139], v[136:139], v[208:211]
    ds_read_b64_tr_b16 v[98:99], v218 offset:41472
    v_mfma_f32_16x16x32_bf16 v[226:229], v[192:195], v[140:143], v[226:229]
    ds_read_b64_tr_b16 v[100:101], v218 offset:36896
    v_mfma_f32_16x16x32_bf16 v[230:233], v[192:195], v[144:147], v[230:233]
    ds_read_b64_tr_b16 v[102:103], v218 offset:41504
    v_mfma_f32_16x16x32_bf16 v[234:237], v[192:195], v[172:175], v[234:237]
    ds_read_b64_tr_b16 v[104:105], v220 offset:36864
    v_mfma_f32_16x16x32_bf16 v[16:19], v[132:135], v[140:143], v[16:19]
    ds_read_b64_tr_b16 v[106:107], v220 offset:41472
    v_mfma_f32_16x16x32_bf16 v[52:55], v[136:139], v[140:143], v[52:55]
    ds_read_b64_tr_b16 v[108:109], v220 offset:36896
    v_mfma_f32_16x16x32_bf16 v[20:23], v[132:135], v[144:147], v[20:23]
    ds_read_b64_tr_b16 v[110:111], v220 offset:41504
    v_mfma_f32_16x16x32_bf16 v[56:59], v[136:139], v[144:147], v[56:59]
    ds_read_b64_tr_b16 v[112:113], v222 offset:36864
    v_mfma_f32_16x16x32_bf16 v[24:27], v[132:135], v[148:151], v[24:27]
    ds_read_b64_tr_b16 v[114:115], v222 offset:41472
    v_mfma_f32_16x16x32_bf16 v[60:63], v[136:139], v[148:151], v[60:63]
    ds_read_b64_tr_b16 v[116:117], v222 offset:36896
    v_mfma_f32_16x16x32_bf16 v[28:31], v[132:135], v[152:155], v[28:31]
    ds_read_b64_tr_b16 v[118:119], v222 offset:41504
    v_mfma_f32_16x16x32_bf16 v[64:67], v[136:139], v[152:155], v[64:67]
    ds_read_b64_tr_b16 v[120:121], v224 offset:36864
    v_mfma_f32_16x16x32_bf16 v[32:35], v[132:135], v[156:159], v[32:35]
    ds_read_b64_tr_b16 v[122:123], v224 offset:41472
    v_mfma_f32_16x16x32_bf16 v[68:71], v[136:139], v[156:159], v[68:71]
    ds_read_b64_tr_b16 v[124:125], v224 offset:36896
    v_mfma_f32_16x16x32_bf16 v[36:39], v[132:135], v[160:163], v[36:39]
    ds_read_b64_tr_b16 v[126:127], v224 offset:41504
    v_mfma_f32_16x16x32_bf16 v[72:75], v[136:139], v[160:163], v[72:75]
    ds_read_b64_tr_b16 v[128:129], v6 offset:37120
    v_mfma_f32_16x16x32_bf16 v[40:43], v[132:135], v[164:167], v[40:43]
    ds_read_b64_tr_b16 v[130:131], v6 offset:41728
    v_mfma_f32_16x16x32_bf16 v[76:79], v[136:139], v[164:167], v[76:79]
    v_mfma_f32_16x16x32_bf16 v[44:47], v[132:135], v[168:171], v[44:47]
    v_mfma_f32_16x16x32_bf16 v[80:83], v[136:139], v[168:171], v[80:83]
    v_mfma_f32_16x16x32_bf16 v[48:51], v[132:135], v[172:175], v[48:51]
    v_mfma_f32_16x16x32_bf16 v[84:87], v[136:139], v[172:175], v[84:87]
    s_waitcnt lgkmcnt(0)
    v_mfma_f32_16x16x32_bf16 v[196:199], v[192:195], v[88:91], v[196:199]
    ds_read_b128 v[132:135], v5 offset:32768
    v_mfma_f32_16x16x32_bf16 v[204:207], v[88:91], v[88:91], v[204:207]
    ds_read_b128 v[136:139], v5 offset:34816
    v_mfma_f32_16x16x32_bf16 v[200:203], v[192:195], v[92:95], v[200:203]
    ds_read_b64_tr_b16 v[140:141], v218 offset:46080
    v_mfma_f32_16x16x32_bf16 v[208:211], v[92:95], v[92:95], v[208:211]
    ds_read_b64_tr_b16 v[142:143], v218 offset:50688
    v_mfma_f32_16x16x32_bf16 v[226:229], v[192:195], v[96:99], v[226:229]
    ds_read_b64_tr_b16 v[144:145], v218 offset:46112
    v_mfma_f32_16x16x32_bf16 v[230:233], v[192:195], v[100:103], v[230:233]
    ds_read_b64_tr_b16 v[146:147], v218 offset:50720
    v_mfma_f32_16x16x32_bf16 v[234:237], v[192:195], v[128:131], v[234:237]
    ds_read_b64_tr_b16 v[148:149], v220 offset:46080
    v_mfma_f32_16x16x32_bf16 v[16:19], v[88:91], v[96:99], v[16:19]
    ds_read_b64_tr_b16 v[150:151], v220 offset:50688
    v_mfma_f32_16x16x32_bf16 v[52:55], v[92:95], v[96:99], v[52:55]
    ds_read_b64_tr_b16 v[152:153], v220 offset:46112
    v_mfma_f32_16x16x32_bf16 v[20:23], v[88:91], v[100:103], v[20:23]
    ds_read_b64_tr_b16 v[154:155], v220 offset:50720
    v_mfma_f32_16x16x32_bf16 v[56:59], v[92:95], v[100:103], v[56:59]
    ds_read_b64_tr_b16 v[156:157], v222 offset:46080
    v_mfma_f32_16x16x32_bf16 v[24:27], v[88:91], v[104:107], v[24:27]
    ds_read_b64_tr_b16 v[158:159], v222 offset:50688
    v_mfma_f32_16x16x32_bf16 v[60:63], v[92:95], v[104:107], v[60:63]
    ds_read_b64_tr_b16 v[160:161], v222 offset:46112
    v_mfma_f32_16x16x32_bf16 v[28:31], v[88:91], v[108:111], v[28:31]
    ds_read_b64_tr_b16 v[162:163], v222 offset:50720
    v_mfma_f32_16x16x32_bf16 v[64:67], v[92:95], v[108:111], v[64:67]
    ds_read_b64_tr_b16 v[164:165], v224 offset:46080
    v_mfma_f32_16x16x32_bf16 v[32:35], v[88:91], v[112:115], v[32:35]
    ds_read_b64_tr_b16 v[166:167], v224 offset:50688
    v_mfma_f32_16x16x32_bf16 v[68:71], v[92:95], v[112:115], v[68:71]
    ds_read_b64_tr_b16 v[168:169], v224 offset:46112
    v_mfma_f32_16x16x32_bf16 v[36:39], v[88:91], v[116:119], v[36:39]
    ds_read_b64_tr_b16 v[170:171], v224 offset:50720
    v_mfma_f32_16x16x32_bf16 v[72:75], v[92:95], v[116:119], v[72:75]
    ds_read_b64_tr_b16 v[172:173], v6 offset:46336
    v_mfma_f32_16x16x32_bf16 v[40:43], v[88:91], v[120:123], v[40:43]
    ds_read_b64_tr_b16 v[174:175], v6 offset:50944
    v_mfma_f32_16x16x32_bf16 v[76:79], v[92:95], v[120:123], v[76:79]
    v_mfma_f32_16x16x32_bf16 v[44:47], v[88:91], v[124:127], v[44:47]
    v_mfma_f32_16x16x32_bf16 v[80:83], v[92:95], v[124:127], v[80:83]
    v_mfma_f32_16x16x32_bf16 v[48:51], v[88:91], v[128:131], v[48:51]
    v_mfma_f32_16x16x32_bf16 v[84:87], v[92:95], v[128:131], v[84:87]
    s_waitcnt lgkmcnt(0)
    s_barrier
    v_mfma_f32_16x16x32_bf16 v[196:199], v[192:195], v[132:135], v[196:199]
    ds_read_b128 v[88:91], v4 offset:49152
    v_mfma_f32_16x16x32_bf16 v[204:207], v[132:135], v[132:135], v[204:207]
    ds_read_b128 v[92:95], v4 offset:51200
    v_mfma_f32_16x16x32_bf16 v[200:203], v[192:195], v[136:139], v[200:203]
    ds_read_b64_tr_b16 v[96:97], v219 offset:0
    v_mfma_f32_16x16x32_bf16 v[208:211], v[136:139], v[136:139], v[208:211]
    ds_read_b64_tr_b16 v[98:99], v219 offset:4608
    v_mfma_f32_16x16x32_bf16 v[226:229], v[192:195], v[140:143], v[226:229]
    ds_read_b64_tr_b16 v[100:101], v219 offset:32
    v_mfma_f32_16x16x32_bf16 v[230:233], v[192:195], v[144:147], v[230:233]
    ds_read_b64_tr_b16 v[102:103], v219 offset:4640
    v_mfma_f32_16x16x32_bf16 v[234:237], v[192:195], v[172:175], v[234:237]
    ds_read_b64_tr_b16 v[104:105], v221 offset:0
    v_mfma_f32_16x16x32_bf16 v[16:19], v[132:135], v[140:143], v[16:19]
    ds_read_b64_tr_b16 v[106:107], v221 offset:4608
    v_mfma_f32_16x16x32_bf16 v[52:55], v[136:139], v[140:143], v[52:55]
    ds_read_b64_tr_b16 v[108:109], v221 offset:32
    v_mfma_f32_16x16x32_bf16 v[20:23], v[132:135], v[144:147], v[20:23]
    ds_read_b64_tr_b16 v[110:111], v221 offset:4640
    v_mfma_f32_16x16x32_bf16 v[56:59], v[136:139], v[144:147], v[56:59]
    ds_read_b64_tr_b16 v[112:113], v223 offset:0
    v_mfma_f32_16x16x32_bf16 v[24:27], v[132:135], v[148:151], v[24:27]
    ds_read_b64_tr_b16 v[114:115], v223 offset:4608
    v_mfma_f32_16x16x32_bf16 v[60:63], v[136:139], v[148:151], v[60:63]
    ds_read_b64_tr_b16 v[116:117], v223 offset:32
    v_mfma_f32_16x16x32_bf16 v[28:31], v[132:135], v[152:155], v[28:31]
    ds_read_b64_tr_b16 v[118:119], v223 offset:4640
    v_mfma_f32_16x16x32_bf16 v[64:67], v[136:139], v[152:155], v[64:67]
    ds_read_b64_tr_b16 v[120:121], v225 offset:0
    v_mfma_f32_16x16x32_bf16 v[32:35], v[132:135], v[156:159], v[32:35]
    ds_read_b64_tr_b16 v[122:123], v225 offset:4608
    v_mfma_f32_16x16x32_bf16 v[68:71], v[136:139], v[156:159], v[68:71]
    ds_read_b64_tr_b16 v[124:125], v225 offset:32
    v_mfma_f32_16x16x32_bf16 v[36:39], v[132:135], v[160:163], v[36:39]
    ds_read_b64_tr_b16 v[126:127], v225 offset:4640
    v_mfma_f32_16x16x32_bf16 v[72:75], v[136:139], v[160:163], v[72:75]
    ds_read_b64_tr_b16 v[128:129], v7 offset:256
    v_mfma_f32_16x16x32_bf16 v[40:43], v[132:135], v[164:167], v[40:43]
    ds_read_b64_tr_b16 v[130:131], v7 offset:4864
    v_mfma_f32_16x16x32_bf16 v[76:79], v[136:139], v[164:167], v[76:79]
    v_mfma_f32_16x16x32_bf16 v[44:47], v[132:135], v[168:171], v[44:47]
    v_mfma_f32_16x16x32_bf16 v[80:83], v[136:139], v[168:171], v[80:83]
    v_mfma_f32_16x16x32_bf16 v[48:51], v[132:135], v[172:175], v[48:51]
    v_mfma_f32_16x16x32_bf16 v[84:87], v[136:139], v[172:175], v[84:87]
    s_waitcnt lgkmcnt(0)
    v_mfma_f32_16x16x32_bf16 v[196:199], v[192:195], v[88:91], v[196:199]
    ds_read_b128 v[132:135], v5 offset:49152
    v_mfma_f32_16x16x32_bf16 v[204:207], v[88:91], v[88:91], v[204:207]
    ds_read_b128 v[136:139], v5 offset:51200
    v_mfma_f32_16x16x32_bf16 v[200:203], v[192:195], v[92:95], v[200:203]
    ds_read_b64_tr_b16 v[140:141], v219 offset:9216
    v_mfma_f32_16x16x32_bf16 v[208:211], v[92:95], v[92:95], v[208:211]
    ds_read_b64_tr_b16 v[142:143], v219 offset:13824
    v_mfma_f32_16x16x32_bf16 v[226:229], v[192:195], v[96:99], v[226:229]
    ds_read_b64_tr_b16 v[144:145], v219 offset:9248
    v_mfma_f32_16x16x32_bf16 v[230:233], v[192:195], v[100:103], v[230:233]
    ds_read_b64_tr_b16 v[146:147], v219 offset:13856
    v_mfma_f32_16x16x32_bf16 v[234:237], v[192:195], v[128:131], v[234:237]
    ds_read_b64_tr_b16 v[148:149], v221 offset:9216
    v_mfma_f32_16x16x32_bf16 v[16:19], v[88:91], v[96:99], v[16:19]
    ds_read_b64_tr_b16 v[150:151], v221 offset:13824
    v_mfma_f32_16x16x32_bf16 v[52:55], v[92:95], v[96:99], v[52:55]
    ds_read_b64_tr_b16 v[152:153], v221 offset:9248
    v_mfma_f32_16x16x32_bf16 v[20:23], v[88:91], v[100:103], v[20:23]
    ds_read_b64_tr_b16 v[154:155], v221 offset:13856
    v_mfma_f32_16x16x32_bf16 v[56:59], v[92:95], v[100:103], v[56:59]
    ds_read_b64_tr_b16 v[156:157], v223 offset:9216
    v_mfma_f32_16x16x32_bf16 v[24:27], v[88:91], v[104:107], v[24:27]
    ds_read_b64_tr_b16 v[158:159], v223 offset:13824
    v_mfma_f32_16x16x32_bf16 v[60:63], v[92:95], v[104:107], v[60:63]
    ds_read_b64_tr_b16 v[160:161], v223 offset:9248
    v_mfma_f32_16x16x32_bf16 v[28:31], v[88:91], v[108:111], v[28:31]
    ds_read_b64_tr_b16 v[162:163], v223 offset:13856
    v_mfma_f32_16x16x32_bf16 v[64:67], v[92:95], v[108:111], v[64:67]
    ds_read_b64_tr_b16 v[164:165], v225 offset:9216
    v_mfma_f32_16x16x32_bf16 v[32:35], v[88:91], v[112:115], v[32:35]
    ds_read_b64_tr_b16 v[166:167], v225 offset:13824
    v_mfma_f32_16x16x32_bf16 v[68:71], v[92:95], v[112:115], v[68:71]
    ds_read_b64_tr_b16 v[168:169], v225 offset:9248
    v_mfma_f32_16x16x32_bf16 v[36:39], v[88:91], v[116:119], v[36:39]
    ds_read_b64_tr_b16 v[170:171], v225 offset:13856
    v_mfma_f32_16x16x32_bf16 v[72:75], v[92:95], v[116:119], v[72:75]
    ds_read_b64_tr_b16 v[172:173], v7 offset:9472
    v_mfma_f32_16x16x32_bf16 v[40:43], v[88:91], v[120:123], v[40:43]
    ds_read_b64_tr_b16 v[174:175], v7 offset:14080
    v_mfma_f32_16x16x32_bf16 v[76:79], v[92:95], v[120:123], v[76:79]
    v_mfma_f32_16x16x32_bf16 v[44:47], v[88:91], v[124:127], v[44:47]
    v_mfma_f32_16x16x32_bf16 v[80:83], v[92:95], v[124:127], v[80:83]
    v_mfma_f32_16x16x32_bf16 v[48:51], v[88:91], v[128:131], v[48:51]
    v_mfma_f32_16x16x32_bf16 v[84:87], v[92:95], v[128:131], v[84:87]
    s_waitcnt lgkmcnt(0)
    s_barrier
    v_mfma_f32_16x16x32_bf16 v[196:199], v[192:195], v[132:135], v[196:199]
    ds_read_b128 v[88:91], v4 offset:0
    v_mfma_f32_16x16x32_bf16 v[204:207], v[132:135], v[132:135], v[204:207]
    ds_read_b128 v[92:95], v4 offset:2048
    v_mfma_f32_16x16x32_bf16 v[200:203], v[192:195], v[136:139], v[200:203]
    ds_read_b64_tr_b16 v[96:97], v218 offset:0
    v_mfma_f32_16x16x32_bf16 v[208:211], v[136:139], v[136:139], v[208:211]
    ds_read_b64_tr_b16 v[98:99], v218 offset:4608
    v_mfma_f32_16x16x32_bf16 v[226:229], v[192:195], v[140:143], v[226:229]
    ds_read_b64_tr_b16 v[100:101], v218 offset:32
    v_mfma_f32_16x16x32_bf16 v[230:233], v[192:195], v[144:147], v[230:233]
    ds_read_b64_tr_b16 v[102:103], v218 offset:4640
    v_mfma_f32_16x16x32_bf16 v[234:237], v[192:195], v[172:175], v[234:237]
    ds_read_b64_tr_b16 v[104:105], v220 offset:0
    v_mfma_f32_16x16x32_bf16 v[16:19], v[132:135], v[140:143], v[16:19]
    ds_read_b64_tr_b16 v[106:107], v220 offset:4608
    v_mfma_f32_16x16x32_bf16 v[52:55], v[136:139], v[140:143], v[52:55]
    ds_read_b64_tr_b16 v[108:109], v220 offset:32
    v_mfma_f32_16x16x32_bf16 v[20:23], v[132:135], v[144:147], v[20:23]
    ds_read_b64_tr_b16 v[110:111], v220 offset:4640
    v_mfma_f32_16x16x32_bf16 v[56:59], v[136:139], v[144:147], v[56:59]
    ds_read_b64_tr_b16 v[112:113], v222 offset:0
    v_mfma_f32_16x16x32_bf16 v[24:27], v[132:135], v[148:151], v[24:27]
    ds_read_b64_tr_b16 v[114:115], v222 offset:4608
    v_mfma_f32_16x16x32_bf16 v[60:63], v[136:139], v[148:151], v[60:63]
    ds_read_b64_tr_b16 v[116:117], v222 offset:32
    v_mfma_f32_16x16x32_bf16 v[28:31], v[132:135], v[152:155], v[28:31]
    ds_read_b64_tr_b16 v[118:119], v222 offset:4640
    v_mfma_f32_16x16x32_bf16 v[64:67], v[136:139], v[152:155], v[64:67]
    ds_read_b64_tr_b16 v[120:121], v224 offset:0
    v_mfma_f32_16x16x32_bf16 v[32:35], v[132:135], v[156:159], v[32:35]
    ds_read_b64_tr_b16 v[122:123], v224 offset:4608
    v_mfma_f32_16x16x32_bf16 v[68:71], v[136:139], v[156:159], v[68:71]
    ds_read_b64_tr_b16 v[124:125], v224 offset:32
    v_mfma_f32_16x16x32_bf16 v[36:39], v[132:135], v[160:163], v[36:39]
    ds_read_b64_tr_b16 v[126:127], v224 offset:4640
    v_mfma_f32_16x16x32_bf16 v[72:75], v[136:139], v[160:163], v[72:75]
    ds_read_b64_tr_b16 v[128:129], v6 offset:256
    v_mfma_f32_16x16x32_bf16 v[40:43], v[132:135], v[164:167], v[40:43]
    ds_read_b64_tr_b16 v[130:131], v6 offset:4864
    v_mfma_f32_16x16x32_bf16 v[76:79], v[136:139], v[164:167], v[76:79]
    v_mfma_f32_16x16x32_bf16 v[44:47], v[132:135], v[168:171], v[44:47]
    v_mfma_f32_16x16x32_bf16 v[80:83], v[136:139], v[168:171], v[80:83]
    v_mfma_f32_16x16x32_bf16 v[48:51], v[132:135], v[172:175], v[48:51]
    v_mfma_f32_16x16x32_bf16 v[84:87], v[136:139], v[172:175], v[84:87]
    s_waitcnt lgkmcnt(0)
    v_mfma_f32_16x16x32_bf16 v[196:199], v[192:195], v[88:91], v[196:199]
    ds_read_b128 v[132:135], v5 offset:0
    v_mfma_f32_16x16x32_bf16 v[204:207], v[88:91], v[88:91], v[204:207]
    ds_read_b128 v[136:139], v5 offset:2048
    v_mfma_f32_16x16x32_bf16 v[200:203], v[192:195], v[92:95], v[200:203]
    ds_read_b64_tr_b16 v[140:141], v218 offset:9216
    v_mfma_f32_16x16x32_bf16 v[208:211], v[92:95], v[92:95], v[208:211]
    ds_read_b64_tr_b16 v[142:143], v218 offset:13824
    v_mfma_f32_16x16x32_bf16 v[226:229], v[192:195], v[96:99], v[226:229]
    ds_read_b64_tr_b16 v[144:145], v218 offset:9248
    v_mfma_f32_16x16x32_bf16 v[230:233], v[192:195], v[100:103], v[230:233]
    ds_read_b64_tr_b16 v[146:147], v218 offset:13856
    v_mfma_f32_16x16x32_bf16 v[234:237], v[192:195], v[128:131], v[234:237]
    ds_read_b64_tr_b16 v[148:149], v220 offset:9216
    v_mfma_f32_16x16x32_bf16 v[16:19], v[88:91], v[96:99], v[16:19]
    ds_read_b64_tr_b16 v[150:151], v220 offset:13824
    v_mfma_f32_16x16x32_bf16 v[52:55], v[92:95], v[96:99], v[52:55]
    ds_read_b64_tr_b16 v[152:153], v220 offset:9248
    v_mfma_f32_16x16x32_bf16 v[20:23], v[88:91], v[100:103], v[20:23]
    ds_read_b64_tr_b16 v[154:155], v220 offset:13856
    v_mfma_f32_16x16x32_bf16 v[56:59], v[92:95], v[100:103], v[56:59]
    ds_read_b64_tr_b16 v[156:157], v222 offset:9216
    v_mfma_f32_16x16x32_bf16 v[24:27], v[88:91], v[104:107], v[24:27]
    ds_read_b64_tr_b16 v[158:159], v222 offset:13824
    v_mfma_f32_16x16x32_bf16 v[60:63], v[92:95], v[104:107], v[60:63]
    ds_read_b64_tr_b16 v[160:161], v222 offset:9248
    v_mfma_f32_16x16x32_bf16 v[28:31], v[88:91], v[108:111], v[28:31]
    ds_read_b64_tr_b16 v[162:163], v222 offset:13856
    v_mfma_f32_16x16x32_bf16 v[64:67], v[92:95], v[108:111], v[64:67]
    ds_read_b64_tr_b16 v[164:165], v224 offset:9216
    v_mfma_f32_16x16x32_bf16 v[32:35], v[88:91], v[112:115], v[32:35]
    ds_read_b64_tr_b16 v[166:167], v224 offset:13824
    v_mfma_f32_16x16x32_bf16 v[68:71], v[92:95], v[112:115], v[68:71]
    ds_read_b64_tr_b16 v[168:169], v224 offset:9248
    v_mfma_f32_16x16x32_bf16 v[36:39], v[88:91], v[116:119], v[36:39]
    ds_read_b64_tr_b16 v[170:171], v224 offset:13856
    v_mfma_f32_16x16x32_bf16 v[72:75], v[92:95], v[116:119], v[72:75]
    ds_read_b64_tr_b16 v[172:173], v6 offset:9472
    v_mfma_f32_16x16x32_bf16 v[40:43], v[88:91], v[120:123], v[40:43]
    ds_read_b64_tr_b16 v[174:175], v6 offset:14080
    v_mfma_f32_16x16x32_bf16 v[76:79], v[92:95], v[120:123], v[76:79]
    v_mfma_f32_16x16x32_bf16 v[44:47], v[88:91], v[124:127], v[44:47]
    v_mfma_f32_16x16x32_bf16 v[80:83], v[92:95], v[124:127], v[80:83]
    v_mfma_f32_16x16x32_bf16 v[48:51], v[88:91], v[128:131], v[48:51]
    v_mfma_f32_16x16x32_bf16 v[84:87], v[92:95], v[128:131], v[84:87]
    s_waitcnt lgkmcnt(0)
    s_barrier
    v_mfma_f32_16x16x32_bf16 v[196:199], v[192:195], v[132:135], v[196:199]
    ds_read_b128 v[88:91], v4 offset:16384
    v_mfma_f32_16x16x32_bf16 v[204:207], v[132:135], v[132:135], v[204:207]
    ds_read_b128 v[92:95], v4 offset:18432
    v_mfma_f32_16x16x32_bf16 v[200:203], v[192:195], v[136:139], v[200:203]
    ds_read_b64_tr_b16 v[96:97], v218 offset:18432
    v_mfma_f32_16x16x32_bf16 v[208:211], v[136:139], v[136:139], v[208:211]
    ds_read_b64_tr_b16 v[98:99], v218 offset:23040
    v_mfma_f32_16x16x32_bf16 v[226:229], v[192:195], v[140:143], v[226:229]
    ds_read_b64_tr_b16 v[100:101], v218 offset:18464
    v_mfma_f32_16x16x32_bf16 v[230:233], v[192:195], v[144:147], v[230:233]
    ds_read_b64_tr_b16 v[102:103], v218 offset:23072
    v_mfma_f32_16x16x32_bf16 v[234:237], v[192:195], v[172:175], v[234:237]
    ds_read_b64_tr_b16 v[104:105], v220 offset:18432
    v_mfma_f32_16x16x32_bf16 v[16:19], v[132:135], v[140:143], v[16:19]
    ds_read_b64_tr_b16 v[106:107], v220 offset:23040
    v_mfma_f32_16x16x32_bf16 v[52:55], v[136:139], v[140:143], v[52:55]
    ds_read_b64_tr_b16 v[108:109], v220 offset:18464
    v_mfma_f32_16x16x32_bf16 v[20:23], v[132:135], v[144:147], v[20:23]
    ds_read_b64_tr_b16 v[110:111], v220 offset:23072
    v_mfma_f32_16x16x32_bf16 v[56:59], v[136:139], v[144:147], v[56:59]
    ds_read_b64_tr_b16 v[112:113], v222 offset:18432
    v_mfma_f32_16x16x32_bf16 v[24:27], v[132:135], v[148:151], v[24:27]
    ds_read_b64_tr_b16 v[114:115], v222 offset:23040
    v_mfma_f32_16x16x32_bf16 v[60:63], v[136:139], v[148:151], v[60:63]
    ds_read_b64_tr_b16 v[116:117], v222 offset:18464
    v_mfma_f32_16x16x32_bf16 v[28:31], v[132:135], v[152:155], v[28:31]
    ds_read_b64_tr_b16 v[118:119], v222 offset:23072
    v_mfma_f32_16x16x32_bf16 v[64:67], v[136:139], v[152:155], v[64:67]
    ds_read_b64_tr_b16 v[120:121], v224 offset:18432
    v_mfma_f32_16x16x32_bf16 v[32:35], v[132:135], v[156:159], v[32:35]
    ds_read_b64_tr_b16 v[122:123], v224 offset:23040
    v_mfma_f32_16x16x32_bf16 v[68:71], v[136:139], v[156:159], v[68:71]
    ds_read_b64_tr_b16 v[124:125], v224 offset:18464
    v_mfma_f32_16x16x32_bf16 v[36:39], v[132:135], v[160:163], v[36:39]
    ds_read_b64_tr_b16 v[126:127], v224 offset:23072
    v_mfma_f32_16x16x32_bf16 v[72:75], v[136:139], v[160:163], v[72:75]
    ds_read_b64_tr_b16 v[128:129], v6 offset:18688
    v_mfma_f32_16x16x32_bf16 v[40:43], v[132:135], v[164:167], v[40:43]
    ds_read_b64_tr_b16 v[130:131], v6 offset:23296
    v_mfma_f32_16x16x32_bf16 v[76:79], v[136:139], v[164:167], v[76:79]
    v_mfma_f32_16x16x32_bf16 v[44:47], v[132:135], v[168:171], v[44:47]
    v_mfma_f32_16x16x32_bf16 v[80:83], v[136:139], v[168:171], v[80:83]
    v_mfma_f32_16x16x32_bf16 v[48:51], v[132:135], v[172:175], v[48:51]
    v_mfma_f32_16x16x32_bf16 v[84:87], v[136:139], v[172:175], v[84:87]
    s_waitcnt lgkmcnt(0)
    v_mfma_f32_16x16x32_bf16 v[196:199], v[192:195], v[88:91], v[196:199]
    ds_read_b128 v[132:135], v5 offset:16384
    v_mfma_f32_16x16x32_bf16 v[204:207], v[88:91], v[88:91], v[204:207]
    ds_read_b128 v[136:139], v5 offset:18432
    v_mfma_f32_16x16x32_bf16 v[200:203], v[192:195], v[92:95], v[200:203]
    ds_read_b64_tr_b16 v[140:141], v218 offset:27648
    v_mfma_f32_16x16x32_bf16 v[208:211], v[92:95], v[92:95], v[208:211]
    ds_read_b64_tr_b16 v[142:143], v218 offset:32256
    v_mfma_f32_16x16x32_bf16 v[226:229], v[192:195], v[96:99], v[226:229]
    ds_read_b64_tr_b16 v[144:145], v218 offset:27680
    v_mfma_f32_16x16x32_bf16 v[230:233], v[192:195], v[100:103], v[230:233]
    ds_read_b64_tr_b16 v[146:147], v218 offset:32288
    v_mfma_f32_16x16x32_bf16 v[234:237], v[192:195], v[128:131], v[234:237]
    ds_read_b64_tr_b16 v[148:149], v220 offset:27648
    v_mfma_f32_16x16x32_bf16 v[16:19], v[88:91], v[96:99], v[16:19]
    ds_read_b64_tr_b16 v[150:151], v220 offset:32256
    v_mfma_f32_16x16x32_bf16 v[52:55], v[92:95], v[96:99], v[52:55]
    ds_read_b64_tr_b16 v[152:153], v220 offset:27680
    v_mfma_f32_16x16x32_bf16 v[20:23], v[88:91], v[100:103], v[20:23]
    ds_read_b64_tr_b16 v[154:155], v220 offset:32288
    v_mfma_f32_16x16x32_bf16 v[56:59], v[92:95], v[100:103], v[56:59]
    ds_read_b64_tr_b16 v[156:157], v222 offset:27648
    v_mfma_f32_16x16x32_bf16 v[24:27], v[88:91], v[104:107], v[24:27]
    ds_read_b64_tr_b16 v[158:159], v222 offset:32256
    v_mfma_f32_16x16x32_bf16 v[60:63], v[92:95], v[104:107], v[60:63]
    ds_read_b64_tr_b16 v[160:161], v222 offset:27680
    v_mfma_f32_16x16x32_bf16 v[28:31], v[88:91], v[108:111], v[28:31]
    ds_read_b64_tr_b16 v[162:163], v222 offset:32288
    v_mfma_f32_16x16x32_bf16 v[64:67], v[92:95], v[108:111], v[64:67]
    ds_read_b64_tr_b16 v[164:165], v224 offset:27648
    v_mfma_f32_16x16x32_bf16 v[32:35], v[88:91], v[112:115], v[32:35]
    ds_read_b64_tr_b16 v[166:167], v224 offset:32256
    v_mfma_f32_16x16x32_bf16 v[68:71], v[92:95], v[112:115], v[68:71]
    ds_read_b64_tr_b16 v[168:169], v224 offset:27680
    v_mfma_f32_16x16x32_bf16 v[36:39], v[88:91], v[116:119], v[36:39]
    ds_read_b64_tr_b16 v[170:171], v224 offset:32288
    v_mfma_f32_16x16x32_bf16 v[72:75], v[92:95], v[116:119], v[72:75]
    ds_read_b64_tr_b16 v[172:173], v6 offset:27904
    v_mfma_f32_16x16x32_bf16 v[40:43], v[88:91], v[120:123], v[40:43]
    ds_read_b64_tr_b16 v[174:175], v6 offset:32512
    v_mfma_f32_16x16x32_bf16 v[76:79], v[92:95], v[120:123], v[76:79]
    v_mfma_f32_16x16x32_bf16 v[44:47], v[88:91], v[124:127], v[44:47]
    v_mfma_f32_16x16x32_bf16 v[80:83], v[92:95], v[124:127], v[80:83]
    v_mfma_f32_16x16x32_bf16 v[48:51], v[88:91], v[128:131], v[48:51]
    v_mfma_f32_16x16x32_bf16 v[84:87], v[92:95], v[128:131], v[84:87]
    s_waitcnt lgkmcnt(0)
    s_barrier
    v_mfma_f32_16x16x32_bf16 v[196:199], v[192:195], v[132:135], v[196:199]
    ds_read_b128 v[88:91], v4 offset:32768
    v_mfma_f32_16x16x32_bf16 v[204:207], v[132:135], v[132:135], v[204:207]
    ds_read_b128 v[92:95], v4 offset:34816
    v_mfma_f32_16x16x32_bf16 v[200:203], v[192:195], v[136:139], v[200:203]
    ds_read_b64_tr_b16 v[96:97], v218 offset:36864
    v_mfma_f32_16x16x32_bf16 v[208:211], v[136:139], v[136:139], v[208:211]
    ds_read_b64_tr_b16 v[98:99], v218 offset:41472
    v_mfma_f32_16x16x32_bf16 v[226:229], v[192:195], v[140:143], v[226:229]
    ds_read_b64_tr_b16 v[100:101], v218 offset:36896
    v_mfma_f32_16x16x32_bf16 v[230:233], v[192:195], v[144:147], v[230:233]
    ds_read_b64_tr_b16 v[102:103], v218 offset:41504
    v_mfma_f32_16x16x32_bf16 v[234:237], v[192:195], v[172:175], v[234:237]
    ds_read_b64_tr_b16 v[104:105], v220 offset:36864
    v_mfma_f32_16x16x32_bf16 v[16:19], v[132:135], v[140:143], v[16:19]
    ds_read_b64_tr_b16 v[106:107], v220 offset:41472
    v_mfma_f32_16x16x32_bf16 v[52:55], v[136:139], v[140:143], v[52:55]
    ds_read_b64_tr_b16 v[108:109], v220 offset:36896
    v_mfma_f32_16x16x32_bf16 v[20:23], v[132:135], v[144:147], v[20:23]
    ds_read_b64_tr_b16 v[110:111], v220 offset:41504
    v_mfma_f32_16x16x32_bf16 v[56:59], v[136:139], v[144:147], v[56:59]
    ds_read_b64_tr_b16 v[112:113], v222 offset:36864
    v_mfma_f32_16x16x32_bf16 v[24:27], v[132:135], v[148:151], v[24:27]
    ds_read_b64_tr_b16 v[114:115], v222 offset:41472
    v_mfma_f32_16x16x32_bf16 v[60:63], v[136:139], v[148:151], v[60:63]
    ds_read_b64_tr_b16 v[116:117], v222 offset:36896
    v_mfma_f32_16x16x32_bf16 v[28:31], v[132:135], v[152:155], v[28:31]
    ds_read_b64_tr_b16 v[118:119], v222 offset:41504
    v_mfma_f32_16x16x32_bf16 v[64:67], v[136:139], v[152:155], v[64:67]
    ds_read_b64_tr_b16 v[120:121], v224 offset:36864
    v_mfma_f32_16x16x32_bf16 v[32:35], v[132:135], v[156:159], v[32:35]
    ds_read_b64_tr_b16 v[122:123], v224 offset:41472
    v_mfma_f32_16x16x32_bf16 v[68:71], v[136:139], v[156:159], v[68:71]
    ds_read_b64_tr_b16 v[124:125], v224 offset:36896
    v_mfma_f32_16x16x32_bf16 v[36:39], v[132:135], v[160:163], v[36:39]
    ds_read_b64_tr_b16 v[126:127], v224 offset:41504
    v_mfma_f32_16x16x32_bf16 v[72:75], v[136:139], v[160:163], v[72:75]
    ds_read_b64_tr_b16 v[128:129], v6 offset:37120
    v_mfma_f32_16x16x32_bf16 v[40:43], v[132:135], v[164:167], v[40:43]
    ds_read_b64_tr_b16 v[130:131], v6 offset:41728
    v_mfma_f32_16x16x32_bf16 v[76:79], v[136:139], v[164:167], v[76:79]
    v_mfma_f32_16x16x32_bf16 v[44:47], v[132:135], v[168:171], v[44:47]
    v_mfma_f32_16x16x32_bf16 v[80:83], v[136:139], v[168:171], v[80:83]
    v_mfma_f32_16x16x32_bf16 v[48:51], v[132:135], v[172:175], v[48:51]
    v_mfma_f32_16x16x32_bf16 v[84:87], v[136:139], v[172:175], v[84:87]
    s_waitcnt lgkmcnt(0)
    v_mfma_f32_16x16x32_bf16 v[196:199], v[192:195], v[88:91], v[196:199]
    ds_read_b128 v[132:135], v5 offset:32768
    v_mfma_f32_16x16x32_bf16 v[204:207], v[88:91], v[88:91], v[204:207]
    ds_read_b128 v[136:139], v5 offset:34816
    v_mfma_f32_16x16x32_bf16 v[200:203], v[192:195], v[92:95], v[200:203]
    ds_read_b64_tr_b16 v[140:141], v218 offset:46080
    v_mfma_f32_16x16x32_bf16 v[208:211], v[92:95], v[92:95], v[208:211]
    ds_read_b64_tr_b16 v[142:143], v218 offset:50688
    v_mfma_f32_16x16x32_bf16 v[226:229], v[192:195], v[96:99], v[226:229]
    ds_read_b64_tr_b16 v[144:145], v218 offset:46112
    v_mfma_f32_16x16x32_bf16 v[230:233], v[192:195], v[100:103], v[230:233]
    ds_read_b64_tr_b16 v[146:147], v218 offset:50720
    v_mfma_f32_16x16x32_bf16 v[234:237], v[192:195], v[128:131], v[234:237]
    ds_read_b64_tr_b16 v[148:149], v220 offset:46080
    v_mfma_f32_16x16x32_bf16 v[16:19], v[88:91], v[96:99], v[16:19]
    ds_read_b64_tr_b16 v[150:151], v220 offset:50688
    v_mfma_f32_16x16x32_bf16 v[52:55], v[92:95], v[96:99], v[52:55]
    ds_read_b64_tr_b16 v[152:153], v220 offset:46112
    v_mfma_f32_16x16x32_bf16 v[20:23], v[88:91], v[100:103], v[20:23]
    ds_read_b64_tr_b16 v[154:155], v220 offset:50720
    v_mfma_f32_16x16x32_bf16 v[56:59], v[92:95], v[100:103], v[56:59]
    ds_read_b64_tr_b16 v[156:157], v222 offset:46080
    v_mfma_f32_16x16x32_bf16 v[24:27], v[88:91], v[104:107], v[24:27]
    ds_read_b64_tr_b16 v[158:159], v222 offset:50688
    v_mfma_f32_16x16x32_bf16 v[60:63], v[92:95], v[104:107], v[60:63]
    ds_read_b64_tr_b16 v[160:161], v222 offset:46112
    v_mfma_f32_16x16x32_bf16 v[28:31], v[88:91], v[108:111], v[28:31]
    ds_read_b64_tr_b16 v[162:163], v222 offset:50720
    v_mfma_f32_16x16x32_bf16 v[64:67], v[92:95], v[108:111], v[64:67]
    ds_read_b64_tr_b16 v[164:165], v224 offset:46080
    v_mfma_f32_16x16x32_bf16 v[32:35], v[88:91], v[112:115], v[32:35]
    ds_read_b64_tr_b16 v[166:167], v224 offset:50688
    v_mfma_f32_16x16x32_bf16 v[68:71], v[92:95], v[112:115], v[68:71]
    ds_read_b64_tr_b16 v[168:169], v224 offset:46112
    v_mfma_f32_16x16x32_bf16 v[36:39], v[88:91], v[116:119], v[36:39]
    ds_read_b64_tr_b16 v[170:171], v224 offset:50720
    v_mfma_f32_16x16x32_bf16 v[72:75], v[92:95], v[116:119], v[72:75]
    ds_read_b64_tr_b16 v[172:173], v6 offset:46336
    v_mfma_f32_16x16x32_bf16 v[40:43], v[88:91], v[120:123], v[40:43]
    ds_read_b64_tr_b16 v[174:175], v6 offset:50944
    v_mfma_f32_16x16x32_bf16 v[76:79], v[92:95], v[120:123], v[76:79]
    v_mfma_f32_16x16x32_bf16 v[44:47], v[88:91], v[124:127], v[44:47]
    v_mfma_f32_16x16x32_bf16 v[80:83], v[92:95], v[124:127], v[80:83]
    v_mfma_f32_16x16x32_bf16 v[48:51], v[88:91], v[128:131], v[48:51]
    v_mfma_f32_16x16x32_bf16 v[84:87], v[92:95], v[128:131], v[84:87]
    s_waitcnt lgkmcnt(0)
    s_barrier
    v_mfma_f32_16x16x32_bf16 v[196:199], v[192:195], v[132:135], v[196:199]
    ds_read_b128 v[88:91], v4 offset:49152
    v_mfma_f32_16x16x32_bf16 v[204:207], v[132:135], v[132:135], v[204:207]
    ds_read_b128 v[92:95], v4 offset:51200
    v_mfma_f32_16x16x32_bf16 v[200:203], v[192:195], v[136:139], v[200:203]
    ds_read_b64_tr_b16 v[96:97], v219 offset:0
    v_mfma_f32_16x16x32_bf16 v[208:211], v[136:139], v[136:139], v[208:211]
    ds_read_b64_tr_b16 v[98:99], v219 offset:4608
    v_mfma_f32_16x16x32_bf16 v[226:229], v[192:195], v[140:143], v[226:229]
    ds_read_b64_tr_b16 v[100:101], v219 offset:32
    v_mfma_f32_16x16x32_bf16 v[230:233], v[192:195], v[144:147], v[230:233]
    ds_read_b64_tr_b16 v[102:103], v219 offset:4640
    v_mfma_f32_16x16x32_bf16 v[234:237], v[192:195], v[172:175], v[234:237]
    ds_read_b64_tr_b16 v[104:105], v221 offset:0
    v_mfma_f32_16x16x32_bf16 v[16:19], v[132:135], v[140:143], v[16:19]
    ds_read_b64_tr_b16 v[106:107], v221 offset:4608
    v_mfma_f32_16x16x32_bf16 v[52:55], v[136:139], v[140:143], v[52:55]
    ds_read_b64_tr_b16 v[108:109], v221 offset:32
    v_mfma_f32_16x16x32_bf16 v[20:23], v[132:135], v[144:147], v[20:23]
    ds_read_b64_tr_b16 v[110:111], v221 offset:4640
    v_mfma_f32_16x16x32_bf16 v[56:59], v[136:139], v[144:147], v[56:59]
    ds_read_b64_tr_b16 v[112:113], v223 offset:0
    v_mfma_f32_16x16x32_bf16 v[24:27], v[132:135], v[148:151], v[24:27]
    ds_read_b64_tr_b16 v[114:115], v223 offset:4608
    v_mfma_f32_16x16x32_bf16 v[60:63], v[136:139], v[148:151], v[60:63]
    ds_read_b64_tr_b16 v[116:117], v223 offset:32
    v_mfma_f32_16x16x32_bf16 v[28:31], v[132:135], v[152:155], v[28:31]
    ds_read_b64_tr_b16 v[118:119], v223 offset:4640
    v_mfma_f32_16x16x32_bf16 v[64:67], v[136:139], v[152:155], v[64:67]
    ds_read_b64_tr_b16 v[120:121], v225 offset:0
    v_mfma_f32_16x16x32_bf16 v[32:35], v[132:135], v[156:159], v[32:35]
    ds_read_b64_tr_b16 v[122:123], v225 offset:4608
    v_mfma_f32_16x16x32_bf16 v[68:71], v[136:139], v[156:159], v[68:71]
    ds_read_b64_tr_b16 v[124:125], v225 offset:32
    v_mfma_f32_16x16x32_bf16 v[36:39], v[132:135], v[160:163], v[36:39]
    ds_read_b64_tr_b16 v[126:127], v225 offset:4640
    v_mfma_f32_16x16x32_bf16 v[72:75], v[136:139], v[160:163], v[72:75]
    ds_read_b64_tr_b16 v[128:129], v7 offset:256
    v_mfma_f32_16x16x32_bf16 v[40:43], v[132:135], v[164:167], v[40:43]
    ds_read_b64_tr_b16 v[130:131], v7 offset:4864
    v_mfma_f32_16x16x32_bf16 v[76:79], v[136:139], v[164:167], v[76:79]
    v_mfma_f32_16x16x32_bf16 v[44:47], v[132:135], v[168:171], v[44:47]
    v_mfma_f32_16x16x32_bf16 v[80:83], v[136:139], v[168:171], v[80:83]
    v_mfma_f32_16x16x32_bf16 v[48:51], v[132:135], v[172:175], v[48:51]
    v_mfma_f32_16x16x32_bf16 v[84:87], v[136:139], v[172:175], v[84:87]
    s_waitcnt lgkmcnt(0)
    v_mfma_f32_16x16x32_bf16 v[196:199], v[192:195], v[88:91], v[196:199]
    ds_read_b128 v[132:135], v5 offset:49152
    v_mfma_f32_16x16x32_bf16 v[204:207], v[88:91], v[88:91], v[204:207]
    ds_read_b128 v[136:139], v5 offset:51200
    v_mfma_f32_16x16x32_bf16 v[200:203], v[192:195], v[92:95], v[200:203]
    ds_read_b64_tr_b16 v[140:141], v219 offset:9216
    v_mfma_f32_16x16x32_bf16 v[208:211], v[92:95], v[92:95], v[208:211]
    ds_read_b64_tr_b16 v[142:143], v219 offset:13824
    v_mfma_f32_16x16x32_bf16 v[226:229], v[192:195], v[96:99], v[226:229]
    ds_read_b64_tr_b16 v[144:145], v219 offset:9248
    v_mfma_f32_16x16x32_bf16 v[230:233], v[192:195], v[100:103], v[230:233]
    ds_read_b64_tr_b16 v[146:147], v219 offset:13856
    v_mfma_f32_16x16x32_bf16 v[234:237], v[192:195], v[128:131], v[234:237]
    ds_read_b64_tr_b16 v[148:149], v221 offset:9216
    v_mfma_f32_16x16x32_bf16 v[16:19], v[88:91], v[96:99], v[16:19]
    ds_read_b64_tr_b16 v[150:151], v221 offset:13824
    v_mfma_f32_16x16x32_bf16 v[52:55], v[92:95], v[96:99], v[52:55]
    ds_read_b64_tr_b16 v[152:153], v221 offset:9248
    v_mfma_f32_16x16x32_bf16 v[20:23], v[88:91], v[100:103], v[20:23]
    ds_read_b64_tr_b16 v[154:155], v221 offset:13856
    v_mfma_f32_16x16x32_bf16 v[56:59], v[92:95], v[100:103], v[56:59]
    ds_read_b64_tr_b16 v[156:157], v223 offset:9216
    v_mfma_f32_16x16x32_bf16 v[24:27], v[88:91], v[104:107], v[24:27]
    ds_read_b64_tr_b16 v[158:159], v223 offset:13824
    v_mfma_f32_16x16x32_bf16 v[60:63], v[92:95], v[104:107], v[60:63]
    ds_read_b64_tr_b16 v[160:161], v223 offset:9248
    v_mfma_f32_16x16x32_bf16 v[28:31], v[88:91], v[108:111], v[28:31]
    ds_read_b64_tr_b16 v[162:163], v223 offset:13856
    v_mfma_f32_16x16x32_bf16 v[64:67], v[92:95], v[108:111], v[64:67]
    ds_read_b64_tr_b16 v[164:165], v225 offset:9216
    v_mfma_f32_16x16x32_bf16 v[32:35], v[88:91], v[112:115], v[32:35]
    ds_read_b64_tr_b16 v[166:167], v225 offset:13824
    v_mfma_f32_16x16x32_bf16 v[68:71], v[92:95], v[112:115], v[68:71]
    ds_read_b64_tr_b16 v[168:169], v225 offset:9248
    v_mfma_f32_16x16x32_bf16 v[36:39], v[88:91], v[116:119], v[36:39]
    ds_read_b64_tr_b16 v[170:171], v225 offset:13856
    v_mfma_f32_16x16x32_bf16 v[72:75], v[92:95], v[116:119], v[72:75]
    ds_read_b64_tr_b16 v[172:173], v7 offset:9472
    v_mfma_f32_16x16x32_bf16 v[40:43], v[88:91], v[120:123], v[40:43]
    ds_read_b64_tr_b16 v[174:175], v7 offset:14080
    v_mfma_f32_16x16x32_bf16 v[76:79], v[92:95], v[120:123], v[76:79]
    v_mfma_f32_16x16x32_bf16 v[44:47], v[88:91], v[124:127], v[44:47]
    v_mfma_f32_16x16x32_bf16 v[80:83], v[92:95], v[124:127], v[80:83]
    v_mfma_f32_16x16x32_bf16 v[48:51], v[88:91], v[128:131], v[48:51]
    v_mfma_f32_16x16x32_bf16 v[84:87], v[92:95], v[128:131], v[84:87]
    s_waitcnt lgkmcnt(0)
    s_barrier
    v_mfma_f32_16x16x32_bf16 v[196:199], v[192:195], v[132:135], v[196:199]
    ds_read_b128 v[88:91], v4 offset:0
    v_mfma_f32_16x16x32_bf16 v[204:207], v[132:135], v[132:135], v[204:207]
    ds_read_b128 v[92:95], v4 offset:2048
    v_mfma_f32_16x16x32_bf16 v[200:203], v[192:195], v[136:139], v[200:203]
    ds_read_b64_tr_b16 v[96:97], v218 offset:0
    v_mfma_f32_16x16x32_bf16 v[208:211], v[136:139], v[136:139], v[208:211]
    ds_read_b64_tr_b16 v[98:99], v218 offset:4608
    v_mfma_f32_16x16x32_bf16 v[226:229], v[192:195], v[140:143], v[226:229]
    ds_read_b64_tr_b16 v[100:101], v218 offset:32
    v_mfma_f32_16x16x32_bf16 v[230:233], v[192:195], v[144:147], v[230:233]
    ds_read_b64_tr_b16 v[102:103], v218 offset:4640
    v_mfma_f32_16x16x32_bf16 v[234:237], v[192:195], v[172:175], v[234:237]
    ds_read_b64_tr_b16 v[104:105], v220 offset:0
    v_mfma_f32_16x16x32_bf16 v[16:19], v[132:135], v[140:143], v[16:19]
    ds_read_b64_tr_b16 v[106:107], v220 offset:4608
    v_mfma_f32_16x16x32_bf16 v[52:55], v[136:139], v[140:143], v[52:55]
    ds_read_b64_tr_b16 v[108:109], v220 offset:32
    v_mfma_f32_16x16x32_bf16 v[20:23], v[132:135], v[144:147], v[20:23]
    ds_read_b64_tr_b16 v[110:111], v220 offset:4640
    v_mfma_f32_16x16x32_bf16 v[56:59], v[136:139], v[144:147], v[56:59]
    ds_read_b64_tr_b16 v[112:113], v222 offset:0
    v_mfma_f32_16x16x32_bf16 v[24:27], v[132:135], v[148:151], v[24:27]
    ds_read_b64_tr_b16 v[114:115], v222 offset:4608
    v_mfma_f32_16x16x32_bf16 v[60:63], v[136:139], v[148:151], v[60:63]
    ds_read_b64_tr_b16 v[116:117], v222 offset:32
    v_mfma_f32_16x16x32_bf16 v[28:31], v[132:135], v[152:155], v[28:31]
    ds_read_b64_tr_b16 v[118:119], v222 offset:4640
    v_mfma_f32_16x16x32_bf16 v[64:67], v[136:139], v[152:155], v[64:67]
    ds_read_b64_tr_b16 v[120:121], v224 offset:0
    v_mfma_f32_16x16x32_bf16 v[32:35], v[132:135], v[156:159], v[32:35]
    ds_read_b64_tr_b16 v[122:123], v224 offset:4608
    v_mfma_f32_16x16x32_bf16 v[68:71], v[136:139], v[156:159], v[68:71]
    ds_read_b64_tr_b16 v[124:125], v224 offset:32
    v_mfma_f32_16x16x32_bf16 v[36:39], v[132:135], v[160:163], v[36:39]
    ds_read_b64_tr_b16 v[126:127], v224 offset:4640
    v_mfma_f32_16x16x32_bf16 v[72:75], v[136:139], v[160:163], v[72:75]
    ds_read_b64_tr_b16 v[128:129], v6 offset:256
    v_mfma_f32_16x16x32_bf16 v[40:43], v[132:135], v[164:167], v[40:43]
    ds_read_b64_tr_b16 v[130:131], v6 offset:4864
    v_mfma_f32_16x16x32_bf16 v[76:79], v[136:139], v[164:167], v[76:79]
    v_mfma_f32_16x16x32_bf16 v[44:47], v[132:135], v[168:171], v[44:47]
    v_mfma_f32_16x16x32_bf16 v[80:83], v[136:139], v[168:171], v[80:83]
    v_mfma_f32_16x16x32_bf16 v[48:51], v[132:135], v[172:175], v[48:51]
    v_mfma_f32_16x16x32_bf16 v[84:87], v[136:139], v[172:175], v[84:87]
    s_waitcnt lgkmcnt(0)
    v_mfma_f32_16x16x32_bf16 v[196:199], v[192:195], v[88:91], v[196:199]
    ds_read_b128 v[132:135], v5 offset:0
    v_mfma_f32_16x16x32_bf16 v[204:207], v[88:91], v[88:91], v[204:207]
    ds_read_b128 v[136:139], v5 offset:2048
    v_mfma_f32_16x16x32_bf16 v[200:203], v[192:195], v[92:95], v[200:203]
    ds_read_b64_tr_b16 v[140:141], v218 offset:9216
    v_mfma_f32_16x16x32_bf16 v[208:211], v[92:95], v[92:95], v[208:211]
    ds_read_b64_tr_b16 v[142:143], v218 offset:13824
    v_mfma_f32_16x16x32_bf16 v[226:229], v[192:195], v[96:99], v[226:229]
    ds_read_b64_tr_b16 v[144:145], v218 offset:9248
    v_mfma_f32_16x16x32_bf16 v[230:233], v[192:195], v[100:103], v[230:233]
    ds_read_b64_tr_b16 v[146:147], v218 offset:13856
    v_mfma_f32_16x16x32_bf16 v[234:237], v[192:195], v[128:131], v[234:237]
    ds_read_b64_tr_b16 v[148:149], v220 offset:9216
    v_mfma_f32_16x16x32_bf16 v[16:19], v[88:91], v[96:99], v[16:19]
    ds_read_b64_tr_b16 v[150:151], v220 offset:13824
    v_mfma_f32_16x16x32_bf16 v[52:55], v[92:95], v[96:99], v[52:55]
    ds_read_b64_tr_b16 v[152:153], v220 offset:9248
    v_mfma_f32_16x16x32_bf16 v[20:23], v[88:91], v[100:103], v[20:23]
    ds_read_b64_tr_b16 v[154:155], v220 offset:13856
    v_mfma_f32_16x16x32_bf16 v[56:59], v[92:95], v[100:103], v[56:59]
    ds_read_b64_tr_b16 v[156:157], v222 offset:9216
    v_mfma_f32_16x16x32_bf16 v[24:27], v[88:91], v[104:107], v[24:27]
    ds_read_b64_tr_b16 v[158:159], v222 offset:13824
    v_mfma_f32_16x16x32_bf16 v[60:63], v[92:95], v[104:107], v[60:63]
    ds_read_b64_tr_b16 v[160:161], v222 offset:9248
    v_mfma_f32_16x16x32_bf16 v[28:31], v[88:91], v[108:111], v[28:31]
    ds_read_b64_tr_b16 v[162:163], v222 offset:13856
    v_mfma_f32_16x16x32_bf16 v[64:67], v[92:95], v[108:111], v[64:67]
    ds_read_b64_tr_b16 v[164:165], v224 offset:9216
    v_mfma_f32_16x16x32_bf16 v[32:35], v[88:91], v[112:115], v[32:35]
    ds_read_b64_tr_b16 v[166:167], v224 offset:13824
    v_mfma_f32_16x16x32_bf16 v[68:71], v[92:95], v[112:115], v[68:71]
    ds_read_b64_tr_b16 v[168:169], v224 offset:9248
    v_mfma_f32_16x16x32_bf16 v[36:39], v[88:91], v[116:119], v[36:39]
    ds_read_b64_tr_b16 v[170:171], v224 offset:13856
    v_mfma_f32_16x16x32_bf16 v[72:75], v[92:95], v[116:119], v[72:75]
    ds_read_b64_tr_b16 v[172:173], v6 offset:9472
    v_mfma_f32_16x16x32_bf16 v[40:43], v[88:91], v[120:123], v[40:43]
    ds_read_b64_tr_b16 v[174:175], v6 offset:14080
    v_mfma_f32_16x16x32_bf16 v[76:79], v[92:95], v[120:123], v[76:79]
    v_mfma_f32_16x16x32_bf16 v[44:47], v[88:91], v[124:127], v[44:47]
    v_mfma_f32_16x16x32_bf16 v[80:83], v[92:95], v[124:127], v[80:83]
    v_mfma_f32_16x16x32_bf16 v[48:51], v[88:91], v[128:131], v[48:51]
    v_mfma_f32_16x16x32_bf16 v[84:87], v[92:95], v[128:131], v[84:87]
    s_waitcnt lgkmcnt(0)
    v_mfma_f32_16x16x32_bf16 v[196:199], v[192:195], v[132:135], v[196:199]
    v_mfma_f32_16x16x32_bf16 v[204:207], v[132:135], v[132:135], v[204:207]
    v_mfma_f32_16x16x32_bf16 v[200:203], v[192:195], v[136:139], v[200:203]
    v_mfma_f32_16x16x32_bf16 v[208:211], v[136:139], v[136:139], v[208:211]
    v_mfma_f32_16x16x32_bf16 v[226:229], v[192:195], v[140:143], v[226:229]
    v_mfma_f32_16x16x32_bf16 v[230:233], v[192:195], v[144:147], v[230:233]
    v_mfma_f32_16x16x32_bf16 v[234:237], v[192:195], v[172:175], v[234:237]
    v_mfma_f32_16x16x32_bf16 v[16:19], v[132:135], v[140:143], v[16:19]
    v_mfma_f32_16x16x32_bf16 v[52:55], v[136:139], v[140:143], v[52:55]
    v_mfma_f32_16x16x32_bf16 v[20:23], v[132:135], v[144:147], v[20:23]
    v_mfma_f32_16x16x32_bf16 v[56:59], v[136:139], v[144:147], v[56:59]
    s_nop 1
    ds_write_b32 v246, v226
    ds_write_b32 v246, v230 offset:64
    ds_write_b32 v247, v234
    v_mfma_f32_16x16x32_bf16 v[24:27], v[132:135], v[148:151], v[24:27]
    v_cndmask_b32 v213, v204, v205, s[30:31]
    v_cndmask_b32 v215, v208, v209, s[30:31]
    v_mfma_f32_16x16x32_bf16 v[60:63], v[136:139], v[148:151], v[60:63]
    v_mul_f32 v214, s28, v196
    v_mul_f32_e64 v216, s28, v200
    v_mfma_f32_16x16x32_bf16 v[28:31], v[132:135], v[152:155], v[28:31]
    v_cndmask_b32 v213, v213, v206, s[34:35]
    v_cndmask_b32 v215, v215, v210, s[34:35]
    v_mfma_f32_16x16x32_bf16 v[64:67], v[136:139], v[152:155], v[64:67]
    v_cndmask_b32 v213, v213, v207, s[36:37]
    v_cndmask_b32 v215, v215, v211, s[36:37]
    v_mfma_f32_16x16x32_bf16 v[32:35], v[132:135], v[156:159], v[32:35]
    v_mul_f32 v213, s28, v213
    v_mul_f32 v215, s28, v215
    v_mfma_f32_16x16x32_bf16 v[68:71], v[136:139], v[156:159], v[68:71]
    v_fma_f32 v213, -v214, v214, v213
    v_fma_f32 v215, -v216, v216, v215
    v_mfma_f32_16x16x32_bf16 v[36:39], v[132:135], v[160:163], v[36:39]
    v_max_f32 v213, 0, v213
    v_max_f32 v215, 0, v215
    v_mfma_f32_16x16x32_bf16 v[72:75], v[136:139], v[160:163], v[72:75]
    v_add_f32 v213, s32, v213
    v_add_f32 v215, s32, v215
    v_mfma_f32_16x16x32_bf16 v[40:43], v[132:135], v[164:167], v[40:43]
    v_rsq_f32 v213, v213
    v_rsq_f32 v215, v215
    v_mfma_f32_16x16x32_bf16 v[76:79], v[136:139], v[164:167], v[76:79]
    v_sub_f32 v214, 0, v214
    v_sub_f32 v216, 0, v216
    v_mfma_f32_16x16x32_bf16 v[44:47], v[132:135], v[168:171], v[44:47]
    v_mul_f32 v213, s29, v213
    v_mul_f32 v215, s29, v215
    v_mfma_f32_16x16x32_bf16 v[80:83], v[136:139], v[168:171], v[80:83]
    v_mul_f32 v214, v214, v213
    v_mul_f32 v216, v216, v215
    v_mfma_f32_16x16x32_bf16 v[48:51], v[132:135], v[172:175], v[48:51]
    ds_write_b32 v212, v213 offset:0
    ds_write_b32 v212, v215 offset:64
    v_mfma_f32_16x16x32_bf16 v[84:87], v[136:139], v[172:175], v[84:87]
    ds_write_b32 v212, v214 offset:128
    ds_write_b32 v212, v216 offset:192
    s_waitcnt lgkmcnt(0)
    s_barrier
    ds_read_b128 v[124:127], v13 offset:0
    ds_read_b128 v[128:131], v13 offset:128
    ds_read_b128 v[132:135], v13 offset:64
    ds_read_b128 v[136:139], v13 offset:192
    ds_read_b32 v140, v238 offset:0
    ds_read_b32 v141, v238 offset:64
    ds_read_b32 v142, v239 offset:0
    ds_read_b32 v143, v239 offset:64
    ds_read_b32 v144, v240 offset:0
    ds_read_b32 v145, v240 offset:64
    ds_read_b32 v146, v241 offset:0
    ds_read_b32 v147, v241 offset:64
    ds_read_b32 v148, v14 offset:512
    s_waitcnt lgkmcnt(0)
    s_nop 0
    v_pk_mul_f32 v[16:17], v[16:17], v[124:125]
    v_pk_mul_f32 v[18:19], v[18:19], v[126:127]
    v_pk_mul_f32 v[52:53], v[52:53], v[132:133]
    v_pk_mul_f32 v[54:55], v[54:55], v[134:135]
    v_pk_fma_f32 v[16:17], v[140:141], v[128:129], v[16:17] op_sel:[0,0,0] op_sel_hi:[0,1,1]
    v_pk_fma_f32 v[18:19], v[140:141], v[130:131], v[18:19] op_sel:[0,0,0] op_sel_hi:[0,1,1]
    v_pk_fma_f32 v[52:53], v[140:141], v[136:137], v[52:53] op_sel:[0,0,0] op_sel_hi:[0,1,1]
    v_pk_fma_f32 v[54:55], v[140:141], v[138:139], v[54:55] op_sel:[0,0,0] op_sel_hi:[0,1,1]
    v_cvt_pk_bf16_f32 v88, v16, v17
    v_cvt_pk_bf16_f32 v89, v18, v19
    v_cvt_pk_bf16_f32 v90, v52, v53
    v_cvt_pk_bf16_f32 v91, v54, v55
    s_nop 0
    v_permlane32_swap_b32 v88, v90
    v_permlane32_swap_b32 v89, v91
    buffer_store_dwordx4 v[88:91], v10, s[24:27], s50 offen offset:0 sc1
    s_nop 0
    v_pk_mul_f32 v[20:21], v[20:21], v[124:125]
    v_pk_mul_f32 v[22:23], v[22:23], v[126:127]
    v_pk_mul_f32 v[56:57], v[56:57], v[132:133]
    v_pk_mul_f32 v[58:59], v[58:59], v[134:135]
    v_pk_fma_f32 v[20:21], v[140:141], v[128:129], v[20:21] op_sel:[1,0,0] op_sel_hi:[1,1,1]
    v_pk_fma_f32 v[22:23], v[140:141], v[130:131], v[22:23] op_sel:[1,0,0] op_sel_hi:[1,1,1]
    v_pk_fma_f32 v[56:57], v[140:141], v[136:137], v[56:57] op_sel:[1,0,0] op_sel_hi:[1,1,1]
    v_pk_fma_f32 v[58:59], v[140:141], v[138:139], v[58:59] op_sel:[1,0,0] op_sel_hi:[1,1,1]
    v_cvt_pk_bf16_f32 v92, v20, v21
    v_cvt_pk_bf16_f32 v93, v22, v23
    v_cvt_pk_bf16_f32 v94, v56, v57
    v_cvt_pk_bf16_f32 v95, v58, v59
    s_nop 0
    v_permlane32_swap_b32 v92, v94
    v_permlane32_swap_b32 v93, v95
    buffer_store_dwordx4 v[92:95], v10, s[24:27], s50 offen offset:256 sc1
    s_nop 0
    v_pk_mul_f32 v[24:25], v[24:25], v[124:125]
    v_pk_mul_f32 v[26:27], v[26:27], v[126:127]
    v_pk_mul_f32 v[60:61], v[60:61], v[132:133]
    v_pk_mul_f32 v[62:63], v[62:63], v[134:135]
    v_pk_fma_f32 v[24:25], v[142:143], v[128:129], v[24:25] op_sel:[0,0,0] op_sel_hi:[0,1,1]
    v_pk_fma_f32 v[26:27], v[142:143], v[130:131], v[26:27] op_sel:[0,0,0] op_sel_hi:[0,1,1]
    v_pk_fma_f32 v[60:61], v[142:143], v[136:137], v[60:61] op_sel:[0,0,0] op_sel_hi:[0,1,1]
    v_pk_fma_f32 v[62:63], v[142:143], v[138:139], v[62:63] op_sel:[0,0,0] op_sel_hi:[0,1,1]
    v_cvt_pk_bf16_f32 v96, v24, v25
    v_cvt_pk_bf16_f32 v97, v26, v27
    v_cvt_pk_bf16_f32 v98, v60, v61
    v_cvt_pk_bf16_f32 v99, v62, v63
    s_nop 0
    v_permlane32_swap_b32 v96, v98
    v_permlane32_swap_b32 v97, v99
    buffer_store_dwordx4 v[96:99], v10, s[24:27], s51 offen offset:0 sc1
    s_nop 0
    v_pk_mul_f32 v[28:29], v[28:29], v[124:125]
    v_pk_mul_f32 v[30:31], v[30:31], v[126:127]
    v_pk_mul_f32 v[64:65], v[64:65], v[132:133]
    v_pk_mul_f32 v[66:67], v[66:67], v[134:135]
    v_pk_fma_f32 v[28:29], v[142:143], v[128:129], v[28:29] op_sel:[1,0,0] op_sel_hi:[1,1,1]
    v_pk_fma_f32 v[30:31], v[142:143], v[130:131], v[30:31] op_sel:[1,0,0] op_sel_hi:[1,1,1]
    v_pk_fma_f32 v[64:65], v[142:143], v[136:137], v[64:65] op_sel:[1,0,0] op_sel_hi:[1,1,1]
    v_pk_fma_f32 v[66:67], v[142:143], v[138:139], v[66:67] op_sel:[1,0,0] op_sel_hi:[1,1,1]
    v_cvt_pk_bf16_f32 v100, v28, v29
    v_cvt_pk_bf16_f32 v101, v30, v31
    v_cvt_pk_bf16_f32 v102, v64, v65
    v_cvt_pk_bf16_f32 v103, v66, v67
    s_nop 0
    v_permlane32_swap_b32 v100, v102
    v_permlane32_swap_b32 v101, v103
    buffer_store_dwordx4 v[100:103], v10, s[24:27], s51 offen offset:256 sc1
    s_nop 0
    v_pk_mul_f32 v[32:33], v[32:33], v[124:125]
    v_pk_mul_f32 v[34:35], v[34:35], v[126:127]
    v_pk_mul_f32 v[68:69], v[68:69], v[132:133]
    v_pk_mul_f32 v[70:71], v[70:71], v[134:135]
    v_pk_fma_f32 v[32:33], v[144:145], v[128:129], v[32:33] op_sel:[0,0,0] op_sel_hi:[0,1,1]
    v_pk_fma_f32 v[34:35], v[144:145], v[130:131], v[34:35] op_sel:[0,0,0] op_sel_hi:[0,1,1]
    v_pk_fma_f32 v[68:69], v[144:145], v[136:137], v[68:69] op_sel:[0,0,0] op_sel_hi:[0,1,1]
    v_pk_fma_f32 v[70:71], v[144:145], v[138:139], v[70:71] op_sel:[0,0,0] op_sel_hi:[0,1,1]
    v_cvt_pk_bf16_f32 v88, v32, v33
    v_cvt_pk_bf16_f32 v89, v34, v35
    v_cvt_pk_bf16_f32 v90, v68, v69
    v_cvt_pk_bf16_f32 v91, v70, v71
    s_nop 0
    v_permlane32_swap_b32 v88, v90
    v_permlane32_swap_b32 v89, v91
    buffer_store_dwordx4 v[88:91], v10, s[24:27], s52 offen offset:0 sc1
    s_nop 0
    v_pk_mul_f32 v[36:37], v[36:37], v[124:125]
    v_pk_mul_f32 v[38:39], v[38:39], v[126:127]
    v_pk_mul_f32 v[72:73], v[72:73], v[132:133]
    v_pk_mul_f32 v[74:75], v[74:75], v[134:135]
    v_pk_fma_f32 v[36:37], v[144:145], v[128:129], v[36:37] op_sel:[1,0,0] op_sel_hi:[1,1,1]
    v_pk_fma_f32 v[38:39], v[144:145], v[130:131], v[38:39] op_sel:[1,0,0] op_sel_hi:[1,1,1]
    v_pk_fma_f32 v[72:73], v[144:145], v[136:137], v[72:73] op_sel:[1,0,0] op_sel_hi:[1,1,1]
    v_pk_fma_f32 v[74:75], v[144:145], v[138:139], v[74:75] op_sel:[1,0,0] op_sel_hi:[1,1,1]
    v_cvt_pk_bf16_f32 v92, v36, v37
    v_cvt_pk_bf16_f32 v93, v38, v39
    v_cvt_pk_bf16_f32 v94, v72, v73
    v_cvt_pk_bf16_f32 v95, v74, v75
    s_nop 0
    v_permlane32_swap_b32 v92, v94
    v_permlane32_swap_b32 v93, v95
    buffer_store_dwordx4 v[92:95], v10, s[24:27], s52 offen offset:256 sc1
    s_nop 0
    v_pk_mul_f32 v[40:41], v[40:41], v[124:125]
    v_pk_mul_f32 v[42:43], v[42:43], v[126:127]
    v_pk_mul_f32 v[76:77], v[76:77], v[132:133]
    v_pk_mul_f32 v[78:79], v[78:79], v[134:135]
    v_pk_fma_f32 v[40:41], v[146:147], v[128:129], v[40:41] op_sel:[0,0,0] op_sel_hi:[0,1,1]
    v_pk_fma_f32 v[42:43], v[146:147], v[130:131], v[42:43] op_sel:[0,0,0] op_sel_hi:[0,1,1]
    v_pk_fma_f32 v[76:77], v[146:147], v[136:137], v[76:77] op_sel:[0,0,0] op_sel_hi:[0,1,1]
    v_pk_fma_f32 v[78:79], v[146:147], v[138:139], v[78:79] op_sel:[0,0,0] op_sel_hi:[0,1,1]
    v_cvt_pk_bf16_f32 v96, v40, v41
    v_cvt_pk_bf16_f32 v97, v42, v43
    v_cvt_pk_bf16_f32 v98, v76, v77
    v_cvt_pk_bf16_f32 v99, v78, v79
    s_nop 0
    v_permlane32_swap_b32 v96, v98
    v_permlane32_swap_b32 v97, v99
    buffer_store_dwordx4 v[96:99], v10, s[24:27], s53 offen offset:0 sc1
    s_nop 0
    v_pk_mul_f32 v[44:45], v[44:45], v[124:125]
    v_pk_mul_f32 v[46:47], v[46:47], v[126:127]
    v_pk_mul_f32 v[80:81], v[80:81], v[132:133]
    v_pk_mul_f32 v[82:83], v[82:83], v[134:135]
    v_pk_fma_f32 v[44:45], v[146:147], v[128:129], v[44:45] op_sel:[1,0,0] op_sel_hi:[1,1,1]
    v_pk_fma_f32 v[46:47], v[146:147], v[130:131], v[46:47] op_sel:[1,0,0] op_sel_hi:[1,1,1]
    v_pk_fma_f32 v[80:81], v[146:147], v[136:137], v[80:81] op_sel:[1,0,0] op_sel_hi:[1,1,1]
    v_pk_fma_f32 v[82:83], v[146:147], v[138:139], v[82:83] op_sel:[1,0,0] op_sel_hi:[1,1,1]
    v_cvt_pk_bf16_f32 v100, v44, v45
    v_cvt_pk_bf16_f32 v101, v46, v47
    v_cvt_pk_bf16_f32 v102, v80, v81
    v_cvt_pk_bf16_f32 v103, v82, v83
    s_nop 0
    v_permlane32_swap_b32 v100, v102
    v_permlane32_swap_b32 v101, v103
    buffer_store_dwordx4 v[100:103], v10, s[24:27], s53 offen offset:256 sc1
    s_nop 0
    v_pk_mul_f32 v[48:49], v[48:49], v[124:125]
    v_pk_mul_f32 v[50:51], v[50:51], v[126:127]
    v_pk_mul_f32 v[84:85], v[84:85], v[132:133]
    v_pk_mul_f32 v[86:87], v[86:87], v[134:135]
    v_pk_fma_f32 v[48:49], v[148:149], v[128:129], v[48:49] op_sel:[0,0,0] op_sel_hi:[0,1,1]
    v_pk_fma_f32 v[50:51], v[148:149], v[130:131], v[50:51] op_sel:[0,0,0] op_sel_hi:[0,1,1]
    v_pk_fma_f32 v[84:85], v[148:149], v[136:137], v[84:85] op_sel:[0,0,0] op_sel_hi:[0,1,1]
    v_pk_fma_f32 v[86:87], v[148:149], v[138:139], v[86:87] op_sel:[0,0,0] op_sel_hi:[0,1,1]
    v_cvt_pk_bf16_f32 v88, v48, v49
    v_cvt_pk_bf16_f32 v89, v50, v51
    v_cvt_pk_bf16_f32 v90, v84, v85
    v_cvt_pk_bf16_f32 v91, v86, v87
    s_nop 0
    v_permlane32_swap_b32 v88, v90
    v_permlane32_swap_b32 v89, v91
    buffer_store_dwordx4 v[88:91], v10, s[24:27], s48 offen offset:0 sc1
    v_mov_b32 v9, 147496
    v_mov_b32 v10, 1
    v_mov_b32_e64 v8, 0
    s_waitcnt vmcnt(0)
    s_mov_b64 exec, 1
    ds_add_rtn_u32 v10, v9, v10
    s_waitcnt lgkmcnt(0)
    v_cmp_eq_u32 vcc, 3, v10
    s_nop 0
    s_and_b64 exec, exec, vcc
    buffer_store_dword v8, v8, s[16:19], s43 offen sc1
    s_mov_b64 exec, -1
    s_branch sequential_preLN__sliding_block__mixer_gmlp__prompt_kernel_p1done
sequential_preLN__sliding_block__mixer_gmlp__prompt_kernel_side:
    s_mov_b32 s21, s2
    v_lshlrev_b32 v3, 4, v1
    v_mov_b32 v15, 1073741824
    v_and_b32 v11, 15, v1
    v_lshrrev_b32 v12, 4, v1
    s_waitcnt lgkmcnt(0)
    s_mov_b32 s46, 256
    s_mov_b32 s47, 0x20000
    s_mov_b32 s16, s40
    s_mov_b32 s17, s41
    s_mov_b32 s18, 268435456
    s_mov_b32 s19, 0x20000
    v_mov_b32 v16, 0x3f803f80
    v_mov_b32 v17, 0x3f803f80
    v_mov_b32 v18, 0x3f803f80
    v_mov_b32 v19, 0x3f803f80
    s_mov_b32 s14, s50
    s_mov_b32 s15, s51
    s_mov_b32 s50, 5308416
    s_mov_b32 s51, 0x20000
    v_mov_b32 v20, -1
    v_mov_b32 v21, -1
    v_mov_b32 v22, -1
    v_mov_b32 v23, -1
    v_lshlrev_b32_e64 v6, 4, v0
    s_mul_i32 s38, s21, 7680
    s_add_u32 s38, s38, 15204352
    v_cmp_gt_u32 vcc, 7680, v6
    s_nop 1
    v_cndmask_b32 v6, v15, v6, vcc
    buffer_store_dwordx4 v[20:23], v6, s[16:19], s38 offen sc1
    v_mov_b32 v6, 15073280
    s_or_b32 s38, s21, s20
    s_cmp_eq_u32 s38, 0
    s_cselect_b64 exec, 1, 0
    buffer_store_dwordx4 v[16:19], v6, s[16:19], 0 offen sc1
    s_mov_b64 exec, -1
sequential_preLN__sliding_block__mixer_gmlp__prompt_kernel_sj1:
    s_getpc_b64 s[38:39]
sequential_preLN__sliding_block__mixer_gmlp__prompt_kernel_pc:
    s_add_u32 s38, s38, sequential_preLN__sliding_block__mixer_gmlp__prompt_kernel_p1done-sequential_preLN__sliding_block__mixer_gmlp__prompt_kernel_pc
    s_addc_u32 s39, s39, 0
    s_lshr_b32 s42, s21, 3
    s_lshl_b32 s42, s42, 3
    s_add_u32 s42, s42, s20
    s_lshl_b32 s42, s42, 10
    v_add_u32_e64 v4, s42, v3
    v_min_u32 v4, sequential_preLN__sliding_block__mixer_gmlp__prompt_kernel_codeend-sequential_preLN__sliding_block__mixer_gmlp__prompt_kernel_p1done-16, v4
    global_load_dwordx4 v[24:27], v4, s[38:39]
    s_waitcnt vmcnt(0)
    s_barrier
    s_cmp_lg_u32 s20, 0
    s_cbranch_scc1 sequential_preLN__sliding_block__mixer_gmlp__prompt_kernel_arra
    v_mov_b32 v8, 1
    v_mov_b32_e64 v9, 0
    s_mov_b64 exec, 1
    buffer_atomic_add v8, v9, s[44:47], 0 offen sc0 sc1
    s_waitcnt vmcnt(0)
    v_cmp_eq_u32 vcc, 63, v8
    s_nop 0
    s_and_b64 exec, exec, vcc
    buffer_store_dword v8, v9, s[44:47], 0 offen offset:128 sc1
    s_mov_b64 exec, -1
sequential_preLN__sliding_block__mixer_gmlp__prompt_kernel_arra:
    s_mov_b32 s24, s14
    s_mov_b32 s25, s15
    s_mov_b32 s26, 663552
    s_mov_b32 s27, 0x20000
    s_mul_i32 s54, s20, 18432
    s_add_u32 s55, s54, 9216
    s_sub_u32 s38, s20, 1
    s_cmp_gt_u32 s38, 2
    s_cbranch_scc1 sequential_preLN__sliding_block__mixer_gmlp__prompt_kernel_sNoWo
    s_cmp_ge_u32 s21, 48
    s_cbranch_scc1 sequential_preLN__sliding_block__mixer_gmlp__prompt_kernel_sNoWo
    s_mul_i32 s42, s21, 3
    s_add_u32 s42, s42, s38
    s_mul_i32 s43, s42, 3641
    s_lshr_b32 s43, s43, 16
    s_mul_i32 s32, s43, 18
    s_sub_u32 s32, s42, s32
    s_mul_i32 s42, s42, 5120
    s_add_u32 s42, s42, 54525952
    s_mul_i32 s43, s43, 144
    s_cmp_ge_u32 s32, 16
    s_cbranch_scc1 sequential_preLN__sliding_block__mixer_gmlp__prompt_kernel_sWoT
    v_add_u32 v11, 0, v1
    v_mul_u32_u24 v12, 205, v11
    v_lshrrev_b32 v12, 11, v12
    v_mul_u32_u24 v13, 10, v12
    v_sub_u32_e64 v13, v11, v13
    v_bfe_u32 v14, v12, 0, 3
    v_mul_u32_u24 v30, 1152, v14
    v_bfe_u32 v14, v12, 3, 1
    s_mov_b32 s39, 20736
    v_mad_u32_u24 v30, v14, s39, v30
    v_bfe_u32 v14, v12, 4, 1
    s_mov_b32 s39, 9216
    v_mad_u32_u24 v30, v14, s39, v30
    v_lshl_add_u32 v30, v13, 4, v30
    v_add_u32_e64 v11, 64, v1
    v_mul_u32_u24 v12, 205, v11
    v_lshrrev_b32 v12, 11, v12
    v_mul_u32_u24 v13, 10, v12
    v_sub_u32_e64 v13, v11, v13
    v_bfe_u32 v14, v12, 0, 3
    v_mul_u32_u24 v31, 1152, v14
    v_bfe_u32 v14, v12, 3, 1
    s_mov_b32 s39, 20736
    v_mad_u32_u24 v31, v14, s39, v31
    v_bfe_u32 v14, v12, 4, 1
    s_mov_b32 s39, 9216
    v_mad_u32_u24 v31, v14, s39, v31
    v_lshl_add_u32 v31, v13, 4, v31
    v_add_u32 v11, 128, v1
    v_mul_u32_u24 v12, 205, v11
    v_lshrrev_b32 v12, 11, v12
    v_mul_u32_u24 v13, 10, v12
    v_sub_u32_e64 v13, v11, v13
    v_bfe_u32 v14, v12, 0, 3
    v_mul_u32_u24 v32, 1152, v14
    v_bfe_u32 v14, v12, 3, 1
    s_mov_b32 s39, 20736
    v_mad_u32_u24 v32, v14, s39, v32
    v_bfe_u32 v14, v12, 4, 1
    s_mov_b32 s39, 9216
    v_mad_u32_u24 v32, v14, s39, v32
    v_lshl_add_u32 v32, v13, 4, v32
    v_add_u32 v11, 192, v1
    v_mul_u32_u24 v12, 205, v11
    v_lshrrev_b32 v12, 11, v12
    v_mul_u32_u24 v13, 10, v12
    v_sub_u32_e64 v13, v11, v13
    v_bfe_u32 v14, v12, 0, 3
    v_mul_u32_u24 v33, 1152, v14
    v_bfe_u32 v14, v12, 3, 1
    s_mov_b32 s39, 20736
    v_mad_u32_u24 v33, v14, s39, v33
    v_bfe_u32 v14, v12, 4, 1
    s_mov_b32 s39, 9216
    v_mad_u32_u24 v33, v14, s39, v33
    v_lshl_add_u32 v33, v13, 4, v33
    v_add_u32 v11, 256, v1
    v_mul_u32_u24 v12, 205, v11
    v_lshrrev_b32 v12, 11, v12
    v_mul_u32_u24 v13, 10, v12
    v_sub_u32_e64 v13, v11, v13
    v_bfe_u32 v14, v12, 0, 3
    v_mul_u32_u24 v34, 1152, v14
    v_bfe_u32 v14, v12, 3, 1
    s_mov_b32 s39, 20736
    v_mad_u32_u24 v34, v14, s39, v34
    v_bfe_u32 v14, v12, 4, 1
    s_mov_b32 s39, 9216
    v_mad_u32_u24 v34, v14, s39, v34
    v_lshl_add_u32 v34, v13, 4, v34
    s_mul_i32 s32, s32, 41472
    s_branch sequential_preLN__sliding_block__mixer_gmlp__prompt_kernel_sWo2
sequential_preLN__sliding_block__mixer_gmlp__prompt_kernel_sWoT:
    v_add_u32 v11, 0, v1
    v_mul_u32_u24 v12, 205, v11
    v_lshrrev_b32 v12, 11, v12
    v_mul_u32_u24 v13, 10, v12
    v_sub_u32_e64 v13, v11, v13
    v_bfe_u32 v14, v12, 0, 1
    v_mul_u32_u24 v30, 1152, v14
    v_bfe_u32 v14, v12, 1, 1
    s_mov_b32 s39, 20736
    v_mad_u32_u24 v30, v14, s39, v30
    v_bfe_u32 v14, v12, 2, 2
    s_mov_b32 s39, 82944
    v_mad_u32_u24 v30, v14, s39, v30
    v_bfe_u32 v14, v12, 4, 1
    s_mov_b32 s39, 41472
    v_mad_u32_u24 v30, v14, s39, v30
    v_add_u32 v30, 18432, v30
    v_lshl_add_u32 v30, v13, 4, v30
    v_add_u32_e64 v11, 64, v1
    v_mul_u32_u24 v12, 205, v11
    v_lshrrev_b32 v12, 11, v12
    v_mul_u32_u24 v13, 10, v12
    v_sub_u32_e64 v13, v11, v13
    v_bfe_u32 v14, v12, 0, 1
    v_mul_u32_u24 v31, 1152, v14
    v_bfe_u32 v14, v12, 1, 1
    s_mov_b32 s39, 20736
    v_mad_u32_u24 v31, v14, s39, v31
    v_bfe_u32 v14, v12, 2, 2
    s_mov_b32 s39, 82944
    v_mad_u32_u24 v31, v14, s39, v31
    v_bfe_u32 v14, v12, 4, 1
    s_mov_b32 s39, 41472
    v_mad_u32_u24 v31, v14, s39, v31
    v_add_u32 v31, 18432, v31
    v_lshl_add_u32 v31, v13, 4, v31
    v_add_u32 v11, 128, v1
    v_mul_u32_u24 v12, 205, v11
    v_lshrrev_b32 v12, 11, v12
    v_mul_u32_u24 v13, 10, v12
    v_sub_u32_e64 v13, v11, v13
    v_bfe_u32 v14, v12, 0, 1
    v_mul_u32_u24 v32, 1152, v14
    v_bfe_u32 v14, v12, 1, 1
    s_mov_b32 s39, 20736
    v_mad_u32_u24 v32, v14, s39, v32
    v_bfe_u32 v14, v12, 2, 2
    s_mov_b32 s39, 82944
    v_mad_u32_u24 v32, v14, s39, v32
    v_bfe_u32 v14, v12, 4, 1
    s_mov_b32 s39, 41472
    v_mad_u32_u24 v32, v14, s39, v32
    v_add_u32 v32, 18432, v32
    v_lshl_add_u32 v32, v13, 4, v32
    v_add_u32 v11, 192, v1
    v_mul_u32_u24 v12, 205, v11
    v_lshrrev_b32 v12, 11, v12
    v_mul_u32_u24 v13, 10, v12
    v_sub_u32_e64 v13, v11, v13
    v_bfe_u32 v14, v12, 0, 1
    v_mul_u32_u24 v33, 1152, v14
    v_bfe_u32 v14, v12, 1, 1
    s_mov_b32 s39, 20736
    v_mad_u32_u24 v33, v14, s39, v33
    v_bfe_u32 v14, v12, 2, 2
    s_mov_b32 s39, 82944
    v_mad_u32_u24 v33, v14, s39, v33
    v_bfe_u32 v14, v12, 4, 1
    s_mov_b32 s39, 41472
    v_mad_u32_u24 v33, v14, s39, v33
    v_add_u32 v33, 18432, v33
    v_lshl_add_u32 v33, v13, 4, v33
    v_add_u32 v11, 256, v1
    v_mul_u32_u24 v12, 205, v11
    v_lshrrev_b32 v12, 11, v12
    v_mul_u32_u24 v13, 10, v12
    v_sub_u32_e64 v13, v11, v13
    v_bfe_u32 v14, v12, 0, 1
    v_mul_u32_u24 v34, 1152, v14
    v_bfe_u32 v14, v12, 1, 1
    s_mov_b32 s39, 20736
    v_mad_u32_u24 v34, v14, s39, v34
    v_bfe_u32 v14, v12, 2, 2
    s_mov_b32 s39, 82944
    v_mad_u32_u24 v34, v14, s39, v34
    v_bfe_u32 v14, v12, 4, 1
    s_mov_b32 s39, 41472
    v_mad_u32_u24 v34, v14, s39, v34
    v_add_u32 v34, 18432, v34
    v_lshl_add_u32 v34, v13, 4, v34
    s_sub_u32 s32, s32, 16
    s_mul_i32 s32, s32, 331776
sequential_preLN__sliding_block__mixer_gmlp__prompt_kernel_sWo2:
    s_add_u32 s32, s32, s43
    s_add_u32 m0, s55, 0
    s_nop 0
    buffer_load_dwordx4 v30, s[24:27], s32 offen lds
    s_add_u32 m0, s55, 1024
    s_nop 0
    buffer_load_dwordx4 v31, s[24:27], s32 offen lds
    s_add_u32 m0, s55, 2048
    s_nop 0
    buffer_load_dwordx4 v32, s[24:27], s32 offen lds
    s_add_u32 m0, s55, 3072
    s_nop 0
    buffer_load_dwordx4 v33, s[24:27], s32 offen lds
    s_add_u32 m0, s55, 4096
    s_nop 0
    buffer_load_dwordx4 v34, s[24:27], s32 offen lds
    s_waitcnt vmcnt(0)
    v_lshrrev_b32 v11, 2, v1
    v_mul_u32_u24 v11, 160, v11
    v_and_b32_e64 v12, 3, v1
    v_lshl_add_u32 v11, v12, 3, v11
    v_add_u32_e64 v11, s55, v11
    ds_read_b64_tr_b16 v[80:81], v11 offset:0
    ds_read_b64_tr_b16 v[82:83], v11 offset:2560
    ds_read_b64_tr_b16 v[84:85], v11 offset:32
    ds_read_b64_tr_b16 v[86:87], v11 offset:2592
    ds_read_b64_tr_b16 v[88:89], v11 offset:64
    ds_read_b64_tr_b16 v[90:91], v11 offset:2624
    ds_read_b64_tr_b16 v[92:93], v11 offset:96
    ds_read_b64_tr_b16 v[94:95], v11 offset:2656
    ds_read_b64_tr_b16 v[96:97], v11 offset:128
    ds_read_b64_tr_b16 v[98:99], v11 offset:2688
    s_waitcnt lgkmcnt(0)
    buffer_store_dwordx4 v[80:83], v3, s[16:19], s42 offen offset:0 sc1
    buffer_store_dwordx4 v[84:87], v3, s[16:19], s42 offen offset:1024 sc1
    buffer_store_dwordx4 v[88:91], v3, s[16:19], s42 offen offset:2048 sc1
    buffer_store_dwordx4 v[92:95], v3, s[16:19], s42 offen offset:3072 sc1
    s_add_u32 s42, s42, 4096
    buffer_store_dwordx4 v[96:99], v3, s[16:19], s42 offen offset:0 sc1
sequential_preLN__sliding_block__mixer_gmlp__prompt_kernel_sNoWo:
    s_lshr_b32 s22, s21, 1
    s_and_b32 s53, s21, 1
    v_add_u32 v32, 0, v1
    v_mul_u32_u24 v33, 911, v32
    v_lshrrev_b32 v33, 14, v33
    v_mul_u32_u24 v34, 18, v33
    v_sub_u32_e64 v34, v32, v34
    v_mul_u32_u24 v160, 9216, v33
    v_lshl_add_u32 v160, v34, 4, v160
    v_add_u32_e64 v32, 64, v1
    v_mul_u32_u24 v33, 911, v32
    v_lshrrev_b32 v33, 14, v33
    v_mul_u32_u24 v34, 18, v33
    v_sub_u32_e64 v34, v32, v34
    v_mul_u32_u24 v161, 9216, v33
    v_lshl_add_u32 v161, v34, 4, v161
    v_add_u32 v32, 128, v1
    v_mul_u32_u24 v33, 911, v32
    v_lshrrev_b32 v33, 14, v33
    v_mul_u32_u24 v34, 18, v33
    v_sub_u32_e64 v34, v32, v34
    v_mul_u32_u24 v162, 9216, v33
    v_lshl_add_u32 v162, v34, 4, v162
    v_add_u32 v32, 192, v1
    v_mul_u32_u24 v33, 911, v32
    v_lshrrev_b32 v33, 14, v33
    v_mul_u32_u24 v34, 18, v33
    v_sub_u32_e64 v34, v32, v34
    v_mul_u32_u24 v163, 9216, v33
    v_lshl_add_u32 v163, v34, 4, v163
    v_add_u32 v32, 256, v1
    v_mul_u32_u24 v33, 911, v32
    v_lshrrev_b32 v33, 14, v33
    v_mul_u32_u24 v34, 18, v33
    v_sub_u32_e64 v34, v32, v34
    v_mul_u32_u24 v164, 9216, v33
    v_lshl_add_u32 v164, v34, 4, v164
    v_add_u32 v32, 320, v1
    v_mul_u32_u24 v33, 911, v32
    v_lshrrev_b32 v33, 14, v33
    v_mul_u32_u24 v34, 18, v33
    v_sub_u32_e64 v34, v32, v34
    v_mul_u32_u24 v165, 9216, v33
    v_lshl_add_u32 v165, v34, 4, v165
    v_add_u32 v32, 384, v1
    v_mul_u32_u24 v33, 911, v32
    v_lshrrev_b32 v33, 14, v33
    v_mul_u32_u24 v34, 18, v33
    v_sub_u32_e64 v34, v32, v34
    v_mul_u32_u24 v166, 9216, v33
    v_lshl_add_u32 v166, v34, 4, v166
    v_add_u32 v32, 448, v1
    v_mul_u32_u24 v33, 911, v32
    v_lshrrev_b32 v33, 14, v33
    v_mul_u32_u24 v34, 18, v33
    v_sub_u32_e64 v34, v32, v34
    v_mul_u32_u24 v167, 9216, v33
    v_lshl_add_u32 v167, v34, 4, v167
    v_add_u32 v32, 512, v1
    v_mul_u32_u24 v33, 911, v32
    v_lshrrev_b32 v33, 14, v33
    v_mul_u32_u24 v34, 18, v33
    v_sub_u32_e64 v34, v32, v34
    v_mul_u32_u24 v168, 9216, v33
    v_lshl_add_u32 v168, v34, 4, v168
    s_mul_i32 s10, s20, 663552
    s_mul_i32 s38, s53, 294912
    s_add_u32 s10, s10, s38
    s_mul_i32 s11, s22, 288
    s_add_u32 s10, s10, s11
    s_add_u32 m0, s54, 0
    s_nop 0
    buffer_load_dwordx4 v160, s[48:51], s10 offen lds
    s_add_u32 m0, s54, 1024
    s_nop 0
    buffer_load_dwordx4 v161, s[48:51], s10 offen lds
    s_add_u32 m0, s54, 2048
    s_nop 0
    buffer_load_dwordx4 v162, s[48:51], s10 offen lds
    s_add_u32 m0, s54, 3072
    s_nop 0
    buffer_load_dwordx4 v163, s[48:51], s10 offen lds
    s_add_u32 m0, s54, 4096
    s_nop 0
    buffer_load_dwordx4 v164, s[48:51], s10 offen lds
    s_add_u32 m0, s54, 5120
    s_nop 0
    buffer_load_dwordx4 v165, s[48:51], s10 offen lds
    s_add_u32 m0, s54, 6144
    s_nop 0
    buffer_load_dwordx4 v166, s[48:51], s10 offen lds
    s_add_u32 m0, s54, 7168
    s_nop 0
    buffer_load_dwordx4 v167, s[48:51], s10 offen lds
    s_add_u32 m0, s54, 8192
    s_nop 0
    buffer_load_dwordx4 v168, s[48:51], s10 offen lds
    s_waitcnt vmcnt(9)
    s_barrier
    s_cmp_lg_u32 s20, 0
    s_cbranch_scc1 sequential_preLN__sliding_block__mixer_gmlp__prompt_kernel_arrc
    v_mov_b32 v8, 1
    v_mov_b32_e64 v9, 8
    s_mov_b64 exec, 1
    buffer_atomic_add v8, v9, s[44:47], 0 offen sc0 sc1
    s_waitcnt vmcnt(0)
    v_cmp_eq_u32 vcc, 63, v8
    s_nop 0
    s_and_b64 exec, exec, vcc
    buffer_store_dword v8, v9, s[44:47], 0 offen offset:128 sc1
    s_mov_b64 exec, -1
sequential_preLN__sliding_block__mixer_gmlp__prompt_kernel_arrc:
    s_mul_i32 s33, s22, 165888
    s_add_u32 s33, s33, 48234496
    s_mul_i32 s38, s53, 9216
    s_add_u32 s33, s33, s38
    s_mul_i32 s38, s20, 18432
    s_add_u32 s34, s33, s38
    s_add_u32 s35, s33, 147456
    s_cmp_lg_u32 s20, 4
    s_cbranch_scc1 sequential_preLN__sliding_block__mixer_gmlp__prompt_kernel_sNone
    v_add_u32 v11, 0, v1
    v_mul_u32_u24 v12, 911, v11
    v_lshrrev_b32 v12, 14, v12
    v_mul_u32_u24 v13, 18, v12
    v_sub_u32_e64 v13, v11, v13
    v_bfe_u32 v14, v12, 0, 2
    v_mul_u32_u24 v30, 9216, v14
    v_bfe_u32 v14, v12, 2, 2
    s_mov_b32 s39, 663552
    v_mad_u32_u24 v30, v14, s39, v30
    v_bfe_u32 v14, v12, 4, 1
    s_mov_b32 s39, 36864
    v_mad_u32_u24 v30, v14, s39, v30
    v_add_u32 v30, 589824, v30
    v_lshl_add_u32 v30, v13, 4, v30
    v_add_u32_e64 v11, 64, v1
    v_mul_u32_u24 v12, 911, v11
    v_lshrrev_b32 v12, 14, v12
    v_mul_u32_u24 v13, 18, v12
    v_sub_u32_e64 v13, v11, v13
    v_bfe_u32 v14, v12, 0, 2
    v_mul_u32_u24 v31, 9216, v14
    v_bfe_u32 v14, v12, 2, 2
    s_mov_b32 s39, 663552
    v_mad_u32_u24 v31, v14, s39, v31
    v_bfe_u32 v14, v12, 4, 1
    s_mov_b32 s39, 36864
    v_mad_u32_u24 v31, v14, s39, v31
    v_add_u32 v31, 589824, v31
    v_lshl_add_u32 v31, v13, 4, v31
    v_add_u32 v11, 128, v1
    v_mul_u32_u24 v12, 911, v11
    v_lshrrev_b32 v12, 14, v12
    v_mul_u32_u24 v13, 18, v12
    v_sub_u32_e64 v13, v11, v13
    v_bfe_u32 v14, v12, 0, 2
    v_mul_u32_u24 v32, 9216, v14
    v_bfe_u32 v14, v12, 2, 2
    s_mov_b32 s39, 663552
    v_mad_u32_u24 v32, v14, s39, v32
    v_bfe_u32 v14, v12, 4, 1
    s_mov_b32 s39, 36864
    v_mad_u32_u24 v32, v14, s39, v32
    v_add_u32 v32, 589824, v32
    v_lshl_add_u32 v32, v13, 4, v32
    v_add_u32 v11, 192, v1
    v_mul_u32_u24 v12, 911, v11
    v_lshrrev_b32 v12, 14, v12
    v_mul_u32_u24 v13, 18, v12
    v_sub_u32_e64 v13, v11, v13
    v_bfe_u32 v14, v12, 0, 2
    v_mul_u32_u24 v33, 9216, v14
    v_bfe_u32 v14, v12, 2, 2
    s_mov_b32 s39, 663552
    v_mad_u32_u24 v33, v14, s39, v33
    v_bfe_u32 v14, v12, 4, 1
    s_mov_b32 s39, 36864
    v_mad_u32_u24 v33, v14, s39, v33
    v_add_u32 v33, 589824, v33
    v_lshl_add_u32 v33, v13, 4, v33
    v_add_u32 v11, 256, v1
    v_mul_u32_u24 v12, 911, v11
    v_lshrrev_b32 v12, 14, v12
    v_mul_u32_u24 v13, 18, v12
    v_sub_u32_e64 v13, v11, v13
    v_bfe_u32 v14, v12, 0, 2
    v_mul_u32_u24 v34, 9216, v14
    v_bfe_u32 v14, v12, 2, 2
    s_mov_b32 s39, 663552
    v_mad_u32_u24 v34, v14, s39, v34
    v_bfe_u32 v14, v12, 4, 1
    s_mov_b32 s39, 36864
    v_mad_u32_u24 v34, v14, s39, v34
    v_add_u32 v34, 589824, v34
    v_lshl_add_u32 v34, v13, 4, v34
    v_add_u32 v11, 320, v1
    v_mul_u32_u24 v12, 911, v11
    v_lshrrev_b32 v12, 14, v12
    v_mul_u32_u24 v13, 18, v12
    v_sub_u32_e64 v13, v11, v13
    v_bfe_u32 v14, v12, 0, 2
    v_mul_u32_u24 v35, 9216, v14
    v_bfe_u32 v14, v12, 2, 2
    s_mov_b32 s39, 663552
    v_mad_u32_u24 v35, v14, s39, v35
    v_bfe_u32 v14, v12, 4, 1
    s_mov_b32 s39, 36864
    v_mad_u32_u24 v35, v14, s39, v35
    v_add_u32 v35, 589824, v35
    v_lshl_add_u32 v35, v13, 4, v35
    v_add_u32 v11, 384, v1
    v_mul_u32_u24 v12, 911, v11
    v_lshrrev_b32 v12, 14, v12
    v_mul_u32_u24 v13, 18, v12
    v_sub_u32_e64 v13, v11, v13
    v_bfe_u32 v14, v12, 0, 2
    v_mul_u32_u24 v36, 9216, v14
    v_bfe_u32 v14, v12, 2, 2
    s_mov_b32 s39, 663552
    v_mad_u32_u24 v36, v14, s39, v36
    v_bfe_u32 v14, v12, 4, 1
    s_mov_b32 s39, 36864
    v_mad_u32_u24 v36, v14, s39, v36
    v_add_u32 v36, 589824, v36
    v_lshl_add_u32 v36, v13, 4, v36
    v_add_u32 v11, 448, v1
    v_mul_u32_u24 v12, 911, v11
    v_lshrrev_b32 v12, 14, v12
    v_mul_u32_u24 v13, 18, v12
    v_sub_u32_e64 v13, v11, v13
    v_bfe_u32 v14, v12, 0, 2
    v_mul_u32_u24 v37, 9216, v14
    v_bfe_u32 v14, v12, 2, 2
    s_mov_b32 s39, 663552
    v_mad_u32_u24 v37, v14, s39, v37
    v_bfe_u32 v14, v12, 4, 1
    s_mov_b32 s39, 36864
    v_mad_u32_u24 v37, v14, s39, v37
    v_add_u32 v37, 589824, v37
    v_lshl_add_u32 v37, v13, 4, v37
    v_add_u32 v11, 512, v1
    v_mul_u32_u24 v12, 911, v11
    v_lshrrev_b32 v12, 14, v12
    v_mul_u32_u24 v13, 18, v12
    v_sub_u32_e64 v13, v11, v13
    v_bfe_u32 v14, v12, 0, 2
    v_mul_u32_u24 v38, 9216, v14
    v_bfe_u32 v14, v12, 2, 2
    s_mov_b32 s39, 663552
    v_mad_u32_u24 v38, v14, s39, v38
    v_bfe_u32 v14, v12, 4, 1
    s_mov_b32 s39, 36864
    v_mad_u32_u24 v38, v14, s39, v38
    v_add_u32 v38, 589824, v38
    v_lshl_add_u32 v38, v13, 4, v38
    s_mul_i32 s32, s53, 2654208
    s_add_u32 s32, s32, s11
    s_add_u32 m0, s55, 0
    s_nop 0
    buffer_load_dwordx4 v30, s[48:51], s32 offen lds
    s_add_u32 m0, s55, 1024
    s_nop 0
    buffer_load_dwordx4 v31, s[48:51], s32 offen lds
    s_add_u32 m0, s55, 2048
    s_nop 0
    buffer_load_dwordx4 v32, s[48:51], s32 offen lds
    s_add_u32 m0, s55, 3072
    s_nop 0
    buffer_load_dwordx4 v33, s[48:51], s32 offen lds
    s_add_u32 m0, s55, 4096
    s_nop 0
    buffer_load_dwordx4 v34, s[48:51], s32 offen lds
    s_add_u32 m0, s55, 5120
    s_nop 0
    buffer_load_dwordx4 v35, s[48:51], s32 offen lds
    s_add_u32 m0, s55, 6144
    s_nop 0
    buffer_load_dwordx4 v36, s[48:51], s32 offen lds
    s_add_u32 m0, s55, 7168
    s_nop 0
    buffer_load_dwordx4 v37, s[48:51], s32 offen lds
    s_add_u32 m0, s55, 8192
    s_nop 0
    buffer_load_dwordx4 v38, s[48:51], s32 offen lds
    s_waitcnt vmcnt(9)
    v_lshrrev_b32_e64 v11, 2, v1
    v_mul_u32_u24 v11, 288, v11
    v_and_b32_e64 v12, 3, v1
    v_lshl_add_u32 v11, v12, 3, v11
    v_add_u32_e64 v11, s54, v11
    ds_read_b64_tr_b16 v[40:41], v11 offset:0
    ds_read_b64_tr_b16 v[42:43], v11 offset:4608
    ds_read_b64_tr_b16 v[44:45], v11 offset:32
    ds_read_b64_tr_b16 v[46:47], v11 offset:4640
    ds_read_b64_tr_b16 v[48:49], v11 offset:64
    ds_read_b64_tr_b16 v[50:51], v11 offset:4672
    ds_read_b64_tr_b16 v[52:53], v11 offset:96
    ds_read_b64_tr_b16 v[54:55], v11 offset:4704
    ds_read_b64_tr_b16 v[56:57], v11 offset:128
    ds_read_b64_tr_b16 v[58:59], v11 offset:4736
    ds_read_b64_tr_b16 v[60:61], v11 offset:160
    ds_read_b64_tr_b16 v[62:63], v11 offset:4768
    ds_read_b64_tr_b16 v[64:65], v11 offset:192
    ds_read_b64_tr_b16 v[66:67], v11 offset:4800
    ds_read_b64_tr_b16 v[68:69], v11 offset:224
    ds_read_b64_tr_b16 v[70:71], v11 offset:4832
    ds_read_b64_tr_b16 v[72:73], v11 offset:256
    ds_read_b64_tr_b16 v[74:75], v11 offset:4864
    s_waitcnt lgkmcnt(0)
    buffer_store_dwordx4 v[40:43], v3, s[16:19], s34 offen offset:0 sc1
    buffer_store_dwordx4 v[44:47], v3, s[16:19], s34 offen offset:1024 sc1
    buffer_store_dwordx4 v[48:51], v3, s[16:19], s34 offen offset:2048 sc1
    buffer_store_dwordx4 v[52:55], v3, s[16:19], s34 offen offset:3072 sc1
    s_add_u32 s34, s34, 4096
    buffer_store_dwordx4 v[56:59], v3, s[16:19], s34 offen offset:0 sc1
    buffer_store_dwordx4 v[60:63], v3, s[16:19], s34 offen offset:1024 sc1
    buffer_store_dwordx4 v[64:67], v3, s[16:19], s34 offen offset:2048 sc1
    buffer_store_dwordx4 v[68:71], v3, s[16:19], s34 offen offset:3072 sc1
    s_add_u32 s34, s34, 4096
    buffer_store_dwordx4 v[72:75], v3, s[16:19], s34 offen offset:0 sc1
    v_mfma_f32_16x16x32_bf16 v[120:123], v[16:19], v[40:43], 0
    v_mfma_f32_16x16x32_bf16 v[124:127], v[16:19], v[44:47], 0
    v_mfma_f32_16x16x32_bf16 v[128:131], v[16:19], v[48:51], 0
    v_mfma_f32_16x16x32_bf16 v[132:135], v[16:19], v[52:55], 0
    v_mfma_f32_16x16x32_bf16 v[136:139], v[16:19], v[56:59], 0
    v_mfma_f32_16x16x32_bf16 v[140:143], v[16:19], v[60:63], 0
    v_mfma_f32_16x16x32_bf16 v[144:147], v[16:19], v[64:67], 0
    v_mfma_f32_16x16x32_bf16 v[148:151], v[16:19], v[68:71], 0
    v_mfma_f32_16x16x32_bf16 v[152:155], v[16:19], v[72:75], 0
    s_waitcnt vmcnt(9)
    v_lshrrev_b32_e64 v11, 2, v1
    v_mul_u32_u24 v11, 288, v11
    v_and_b32_e64 v12, 3, v1
    v_lshl_add_u32 v11, v12, 3, v11
    v_add_u32_e64 v11, s55, v11
    ds_read_b64_tr_b16 v[80:81], v11 offset:0
    ds_read_b64_tr_b16 v[82:83], v11 offset:4608
    ds_read_b64_tr_b16 v[84:85], v11 offset:32
    ds_read_b64_tr_b16 v[86:87], v11 offset:4640
    ds_read_b64_tr_b16 v[88:89], v11 offset:64
    ds_read_b64_tr_b16 v[90:91], v11 offset:4672
    ds_read_b64_tr_b16 v[92:93], v11 offset:96
    ds_read_b64_tr_b16 v[94:95], v11 offset:4704
    ds_read_b64_tr_b16 v[96:97], v11 offset:128
    ds_read_b64_tr_b16 v[98:99], v11 offset:4736
    ds_read_b64_tr_b16 v[100:101], v11 offset:160
    ds_read_b64_tr_b16 v[102:103], v11 offset:4768
    ds_read_b64_tr_b16 v[104:105], v11 offset:192
    ds_read_b64_tr_b16 v[106:107], v11 offset:4800
    ds_read_b64_tr_b16 v[108:109], v11 offset:224
    ds_read_b64_tr_b16 v[110:111], v11 offset:4832
    ds_read_b64_tr_b16 v[112:113], v11 offset:256
    ds_read_b64_tr_b16 v[114:115], v11 offset:4864
    s_waitcnt lgkmcnt(0)
    buffer_store_dwordx4 v[80:83], v3, s[16:19], s35 offen offset:0 sc1
    buffer_store_dwordx4 v[84:87], v3, s[16:19], s35 offen offset:1024 sc1
    buffer_store_dwordx4 v[88:91], v3, s[16:19], s35 offen offset:2048 sc1
    buffer_store_dwordx4 v[92:95], v3, s[16:19], s35 offen offset:3072 sc1
    s_add_u32 s35, s35, 4096
    buffer_store_dwordx4 v[96:99], v3, s[16:19], s35 offen offset:0 sc1
    buffer_store_dwordx4 v[100:103], v3, s[16:19], s35 offen offset:1024 sc1
    buffer_store_dwordx4 v[104:107], v3, s[16:19], s35 offen offset:2048 sc1
    buffer_store_dwordx4 v[108:111], v3, s[16:19], s35 offen offset:3072 sc1
    s_add_u32 s35, s35, 4096
    buffer_store_dwordx4 v[112:115], v3, s[16:19], s35 offen offset:0 sc1
    v_mfma_f32_16x16x32_bf16 v[120:123], v[16:19], v[80:83], v[120:123]
    v_mfma_f32_16x16x32_bf16 v[124:127], v[16:19], v[84:87], v[124:127]
    v_mfma_f32_16x16x32_bf16 v[128:131], v[16:19], v[88:91], v[128:131]
    v_mfma_f32_16x16x32_bf16 v[132:135], v[16:19], v[92:95], v[132:135]
    v_mfma_f32_16x16x32_bf16 v[136:139], v[16:19], v[96:99], v[136:139]
    v_mfma_f32_16x16x32_bf16 v[140:143], v[16:19], v[100:103], v[140:143]
    v_mfma_f32_16x16x32_bf16 v[144:147], v[16:19], v[104:107], v[144:147]
    v_mfma_f32_16x16x32_bf16 v[148:151], v[16:19], v[108:111], v[148:151]
    v_mfma_f32_16x16x32_bf16 v[152:155], v[16:19], v[112:115], v[152:155]
    s_branch sequential_preLN__sliding_block__mixer_gmlp__prompt_kernel_sCs
sequential_preLN__sliding_block__mixer_gmlp__prompt_kernel_sNone:
    s_waitcnt vmcnt(0)
    v_lshrrev_b32 v11, 2, v1
    v_mul_u32_u24 v11, 288, v11
    v_and_b32_e64 v12, 3, v1
    v_lshl_add_u32 v11, v12, 3, v11
    v_add_u32_e64 v11, s54, v11
    ds_read_b64_tr_b16 v[40:41], v11 offset:0
    ds_read_b64_tr_b16 v[42:43], v11 offset:4608
    ds_read_b64_tr_b16 v[44:45], v11 offset:32
    ds_read_b64_tr_b16 v[46:47], v11 offset:4640
    ds_read_b64_tr_b16 v[48:49], v11 offset:64
    ds_read_b64_tr_b16 v[50:51], v11 offset:4672
    ds_read_b64_tr_b16 v[52:53], v11 offset:96
    ds_read_b64_tr_b16 v[54:55], v11 offset:4704
    ds_read_b64_tr_b16 v[56:57], v11 offset:128
    ds_read_b64_tr_b16 v[58:59], v11 offset:4736
    ds_read_b64_tr_b16 v[60:61], v11 offset:160
    ds_read_b64_tr_b16 v[62:63], v11 offset:4768
    ds_read_b64_tr_b16 v[64:65], v11 offset:192
    ds_read_b64_tr_b16 v[66:67], v11 offset:4800
    ds_read_b64_tr_b16 v[68:69], v11 offset:224
    ds_read_b64_tr_b16 v[70:71], v11 offset:4832
    ds_read_b64_tr_b16 v[72:73], v11 offset:256
    ds_read_b64_tr_b16 v[74:75], v11 offset:4864
    s_waitcnt lgkmcnt(0)
    buffer_store_dwordx4 v[40:43], v3, s[16:19], s34 offen offset:0 sc1
    buffer_store_dwordx4 v[44:47], v3, s[16:19], s34 offen offset:1024 sc1
    buffer_store_dwordx4 v[48:51], v3, s[16:19], s34 offen offset:2048 sc1
    buffer_store_dwordx4 v[52:55], v3, s[16:19], s34 offen offset:3072 sc1
    s_add_u32 s34, s34, 4096
    buffer_store_dwordx4 v[56:59], v3, s[16:19], s34 offen offset:0 sc1
    buffer_store_dwordx4 v[60:63], v3, s[16:19], s34 offen offset:1024 sc1
    buffer_store_dwordx4 v[64:67], v3, s[16:19], s34 offen offset:2048 sc1
    buffer_store_dwordx4 v[68:71], v3, s[16:19], s34 offen offset:3072 sc1
    s_add_u32 s34, s34, 4096
    buffer_store_dwordx4 v[72:75], v3, s[16:19], s34 offen offset:0 sc1
    v_mfma_f32_16x16x32_bf16 v[120:123], v[16:19], v[40:43], 0
    v_mfma_f32_16x16x32_bf16 v[124:127], v[16:19], v[44:47], 0
    v_mfma_f32_16x16x32_bf16 v[128:131], v[16:19], v[48:51], 0
    v_mfma_f32_16x16x32_bf16 v[132:135], v[16:19], v[52:55], 0
    v_mfma_f32_16x16x32_bf16 v[136:139], v[16:19], v[56:59], 0
    v_mfma_f32_16x16x32_bf16 v[140:143], v[16:19], v[60:63], 0
    v_mfma_f32_16x16x32_bf16 v[144:147], v[16:19], v[64:67], 0
    v_mfma_f32_16x16x32_bf16 v[148:151], v[16:19], v[68:71], 0
    v_mfma_f32_16x16x32_bf16 v[152:155], v[16:19], v[72:75], 0
sequential_preLN__sliding_block__mixer_gmlp__prompt_kernel_sCs:
    v_and_b32 v11, 15, v1
    s_mul_i32 s38, s20, 576
    s_add_u32 s38, s38, 147968
    v_lshl_add_u32 v11, v11, 2, s38
    ds_write_b32 v11, v120 offset:0
    ds_write_b32 v11, v124 offset:64
    ds_write_b32 v11, v128 offset:128
    ds_write_b32 v11, v132 offset:192
    ds_write_b32 v11, v136 offset:256
    ds_write_b32 v11, v140 offset:320
    ds_write_b32 v11, v144 offset:384
    ds_write_b32 v11, v148 offset:448
    ds_write_b32 v11, v152 offset:512
    s_waitcnt lgkmcnt(0)
    s_barrier
    v_min_u32 v7, 143, v0
    v_lshlrev_b32_e64 v7, 2, v7
    v_add_u32 v8, 147968, v7
    ds_read_b32 v20, v8 offset:0
    ds_read_b32 v21, v8 offset:576
    ds_read_b32 v22, v8 offset:1152
    ds_read_b32 v23, v8 offset:1728
    ds_read_b32 v24, v8 offset:2304
    ds_read_b32 v25, v8 offset:2880
    ds_read_b32 v26, v8 offset:3456
    ds_read_b32 v27, v8 offset:4032
    s_waitcnt lgkmcnt(0)
    v_add_f32 v20, v20, v21
    v_add_f32 v20, v20, v22
    v_add_f32 v20, v20, v23
    v_add_f32 v20, v20, v24
    v_add_f32 v20, v20, v25
    v_add_f32 v20, v20, v26
    v_add_f32 v20, v20, v27
    v_cmp_gt_u32 vcc, 144, v0
    s_nop 1
    v_cndmask_b32 v7, v15, v7, vcc
    s_mul_i32 s38, s22, 576
    s_mul_i32 s39, s53, 18432
    s_add_u32 s38, s38, s39
    s_add_u32 s38, s38, 14942208
    buffer_store_dword v20, v7, s[16:19], s38 offen sc1
    s_waitcnt vmcnt(0)
    s_barrier
    s_cmp_lg_u32 s20, 0
    s_cbranch_scc1 sequential_preLN__sliding_block__mixer_gmlp__prompt_kernel_arrb
    v_mov_b32 v8, 1
    v_mov_b32 v9, 4
    s_mov_b64 exec, 1
    buffer_atomic_add v8, v9, s[44:47], 0 offen sc0 sc1
    s_waitcnt vmcnt(0)
    v_cmp_eq_u32 vcc, 63, v8
    s_nop 0
    s_and_b64 exec, exec, vcc
    buffer_store_dword v8, v9, s[44:47], 0 offen offset:128 sc1
    s_mov_b64 exec, -1
sequential_preLN__sliding_block__mixer_gmlp__prompt_kernel_arrb:
sequential_preLN__sliding_block__mixer_gmlp__prompt_kernel_p1done:
    s_bfe_u32 s21, s2, 0x30003
    s_and_b32 s38, s2, 7
    s_lshl_b32 s38, s38, 2
    s_lshr_b32 s22, s2, 6
    s_add_u32 s22, s22, s38
    s_lshl_b32 s38, s22, 16
    s_lshl_b32 s39, s21, 13
    s_add_u32 s38, s38, s39
    s_lshl_b32 s39, s20, 10
    s_add_u32 s32, s38, s39
    s_add_u32 s32, s32, 0
    s_lshl_b32 s39, s20, 11
    s_add_u32 s44, s38, s39
    s_add_u32 s44, s44, 2088960
    s_lshr_b32 s38, s38, 3
    s_lshl_b32 s39, s20, 7
    s_add_u32 s45, s38, s39
    s_add_u32 s45, s45, 4194304
    s_lshl_b32 s39, s20, 8
    s_add_u32 s46, s38, s39
    s_add_u32 s46, s46, 4455424
    s_add_u32 s55, s39, 136192
    s_mul_i32 s47, s21, 294912
    s_mul_i32 s39, s22, 288
    s_add_u32 s47, s47, s39
    s_add_u32 s47, s47, 4423680
    s_lshl_b32 s39, s21, 3
    s_add_u32 s48, s39, s20
    s_cmp_lt_u32 s48, 4
    s_cselect_b32 s44, 1073741824, s44
    s_cselect_b32 s46, 1073741824, s46
    v_lshlrev_b32 v3, 4, v1
    v_lshlrev_b32 v7, 2, v1
    v_mov_b32 v15, 1073741824
    v_cmp_gt_u32 vcc, 32, v1
    s_load_dwordx2 s[24:25], s[0:1], 72
    s_mov_b32 s26, 256
    s_mov_b32 s27, 0x20000
    v_min_u32 v9, 9, v1
    v_subrev_u32 v10, 2, v9
    v_and_b32 v11, 3, v10
    v_subrev_u32 v11, 2, v11
    v_cmp_gt_u32 s[28:29], 2, v9
    v_lshrrev_b32 v10, 2, v10
    v_add_u32 v10, 1, v10
    v_cndmask_b32 v11, v11, v9, s[28:29]
    v_cndmask_b32 v10, v10, 0, s[28:29]
    s_lshl_b32 s38, s21, 1
    v_add_u32 v11, s38, v11
    v_max_i32 v11, 0, v11
    v_lshlrev_b32 v11, 4, v11
    v_lshl_add_u32 v11, v10, 2, v11
    s_lshr_b32 s38, s22, 3
    v_add_u32 v11, s38, v11
    v_lshlrev_b32_e64 v253, 7, v11
    v_mov_b32 v254, 128
    v_mov_b32 v249, 136
    s_mov_b32 s33, 15663104
    s_cmp_eq_u32 s21, 0
    s_cselect_b32 s42, 32, 0
    v_cndmask_b32 v8, v15, v7, vcc
    s_lshl_b32 s38, s20, 6
    s_add_u32 s38, s38, 0
    v_add_u32 v11, s38, v1
    v_mul_u32_u24 v12, 1725, v11
    v_lshrrev_b32 v12, 15, v12
    v_mul_u32_u24 v13, 19, v12
    v_sub_u32_e64 v13, v11, v13
    v_mul_u32_u24 v14, 9216, v12
    v_lshl_add_u32 v250, v13, 4, v14
    v_add_u32_e64 v250, s47, v250
    v_cmp_eq_u32 s[28:29], 18, v13
    v_mov_b32 v14, 15073280
    s_nop 0
    v_cndmask_b32 v250, v250, v14, s[28:29]
    v_cmp_gt_u32 s[28:29], s42, v12
    v_cmp_lt_u32 s[30:31], 63, v12
    s_nop 0
    v_cndmask_b32 v250, v250, v15, s[28:29]
    s_lshl_b32 s38, s20, 6
    s_add_u32 s38, s38, 512
    v_add_u32 v11, s38, v1
    v_mul_u32_u24 v12, 1725, v11
    v_lshrrev_b32 v12, 15, v12
    v_mul_u32_u24 v13, 19, v12
    v_sub_u32_e64 v13, v11, v13
    v_mul_u32_u24 v14, 9216, v12
    v_lshl_add_u32 v251, v13, 4, v14
    v_add_u32_e64 v251, s47, v251
    v_cmp_eq_u32 s[28:29], 18, v13
    v_mov_b32 v14, 15073280
    s_nop 0
    v_cndmask_b32 v251, v251, v14, s[28:29]
    v_cmp_gt_u32 s[28:29], s42, v12
    v_cmp_lt_u32 s[30:31], 63, v12
    s_nop 0
    v_cndmask_b32 v251, v251, v15, s[28:29]
    s_lshl_b32 s38, s20, 6
    s_add_u32 s38, s38, 1024
    v_add_u32 v11, s38, v1
    v_mul_u32_u24 v12, 1725, v11
    v_lshrrev_b32 v12, 15, v12
    v_mul_u32_u24 v13, 19, v12
    v_sub_u32_e64 v13, v11, v13
    v_mul_u32_u24 v14, 9216, v12
    v_lshl_add_u32 v252, v13, 4, v14
    v_add_u32_e64 v252, s47, v252
    v_cmp_eq_u32 s[28:29], 18, v13
    v_mov_b32 v14, 15073280
    s_nop 0
    v_cndmask_b32 v252, v252, v14, s[28:29]
    v_cmp_gt_u32 s[28:29], s42, v12
    v_cmp_lt_u32 s[30:31], 63, v12
    s_nop 0
    v_cndmask_b32 v252, v252, v15, s[28:29]
    v_cndmask_b32 v252, v252, v15, s[30:31]
    s_lshl_b32 s54, s20, 10
    v_cndmask_b32 v21, 0, 1.0, vcc
    v_lshrrev_b32 v21, 16, v21
    v_mov_b32 v22, 0
    v_mov_b32 v23, 0
    s_add_u32 s39, s54, 49152
    v_add_u32 v4, s39, v3
    v_and_b32 v11, 31, v1
    v_lshrrev_b32 v12, 5, v1
    s_lshl_b32 s39, s20, 7
    s_add_u32 s39, s39, 136192
    v_lshl_add_u32 v5, v11, 2, s39
    s_mul_i32 s39, s20, 1216
    s_add_u32 s39, s39, 111616
    v_min_u32_e64 v13, 18, v11
    v_mul_u32_u24 v14, 304, v12
    v_lshl_add_u32 v13, v13, 4, v14
    v_add_u32 v6, s39, v13
    s_cmp_lt_u32 s48, 8
    s_cselect_b32 s39, 0xff7f, 0
    v_mov_b32 v25, s39
    s_cmp_lt_u32 s48, 7
    s_cselect_b32 s39, 0xff7f, 0
    v_mov_b32 v27, s39
    s_cmp_lt_u32 s48, 6
    s_cselect_b32 s39, 0xff7f, 0
    v_mov_b32 v29, s39
    s_cmp_lt_u32 s48, 5
    s_cselect_b32 s39, 0xff7f, 0
    v_mov_b32 v31, s39
    s_cmp_lt_u32 s48, 4
    s_cselect_b32 s39, 0xff7f, 0
    v_mov_b32 v33, s39
    s_cmp_lt_u32 s48, 3
    s_cselect_b32 s39, 0xff7f, 0
    v_mov_b32 v35, s39
    s_cmp_lt_u32 s48, 2
    s_cselect_b32 s39, 0xff7f, 0
    v_mov_b32 v37, s39
    s_cmp_lt_u32 s48, 1
    s_cselect_b32 s39, 0xff7f, 0
    v_mov_b32 v39, s39
    v_mov_b32 v41, 0
    v_mov_b32 v43, 0
    v_mov_b32 v42, 0
    v_lshlrev_b32 v14, 2, v12
    v_sub_u32 v14, v11, v14
    v_subrev_u32 v80, 0, v14
    v_ashrrev_i32 v80, 31, v80
    v_subrev_u32 v81, 1, v14
    v_ashrrev_i32 v81, 31, v81
    v_subrev_u32 v82, 2, v14
    v_ashrrev_i32 v82, 31, v82
    v_subrev_u32 v83, 3, v14
    v_ashrrev_i32 v83, 31, v83
    v_subrev_u32 v84, 8, v14
    v_ashrrev_i32 v84, 31, v84
    v_subrev_u32 v85, 9, v14
    v_ashrrev_i32 v85, 31, v85
    v_subrev_u32 v86, 10, v14
    v_ashrrev_i32 v86, 31, v86
    v_subrev_u32 v87, 11, v14
    v_ashrrev_i32 v87, 31, v87
    v_subrev_u32 v88, 16, v14
    v_ashrrev_i32 v88, 31, v88
    v_subrev_u32 v89, 17, v14
    v_ashrrev_i32 v89, 31, v89
    v_subrev_u32 v90, 18, v14
    v_ashrrev_i32 v90, 31, v90
    v_subrev_u32 v91, 19, v14
    v_ashrrev_i32 v91, 31, v91
    v_subrev_u32 v92, 24, v14
    v_ashrrev_i32 v92, 31, v92
    v_subrev_u32 v93, 25, v14
    v_ashrrev_i32 v93, 31, v93
    v_subrev_u32 v94, 26, v14
    v_ashrrev_i32 v94, 31, v94
    v_subrev_u32 v95, 27, v14
    v_ashrrev_i32 v95, 31, v95
    s_mov_b32 s39, 0xffff
    v_bfi_b32 v44, s39, v80, v81
    v_bfi_b32 v45, s39, v82, v83
    v_bfi_b32 v46, s39, v84, v85
    v_bfi_b32 v47, s39, v86, v87
    v_bfi_b32 v48, s39, v88, v89
    v_bfi_b32 v49, s39, v90, v91
    v_bfi_b32 v50, s39, v92, v93
    v_bfi_b32 v51, s39, v94, v95
    v_lshrrev_b32 v13, 4, v11
    v_lshlrev_b32 v13, 14, v13
    v_and_b32_e64 v14, 15, v1
    v_lshl_add_u32 v9, v14, 4, v13
    v_lshl_add_u32 v2, v12, 8, v9
    v_mov_b32 v9, v8
    s_lshl_b32 s49, s48, 15
    s_add_u32 s49, s49, 7077888
    s_lshl_b32 s39, s22, 9
    s_add_u32 s49, s49, s39
    s_lshl_b32 s50, s48, 5
    s_add_u32 s50, s50, s22
    s_lshl_b32 s50, s50, 7
    s_add_u32 s50, s50, 9175040
    s_lshl_b32 s51, s2, 1
    s_add_u32 s51, s51, s20
    s_add_u32 s38, s2, 512
    s_cmp_eq_u32 s20, 2
    s_cselect_b32 s51, s38, s51
    s_cmp_gt_u32 s20, 2
    s_cselect_b32 s51, 576, s51
    s_lshr_b32 s42, s51, 3
    s_and_b32 s53, s51, 7
    s_mul_i32 s43, s53, 144
    s_and_b32 s52, s42, 15
    s_mul_i32 s52, s52, 144
    s_lshr_b32 s39, s42, 4
    s_lshl_b32 s39, s39, 5
    s_add_u32 s52, s52, s39
    s_mul_i32 s39, s42, 288
    s_sub_u32 s39, s39, 18304
    s_cmp_ge_u32 s42, 64
    s_cselect_b32 s52, s39, s52
    s_cselect_b32 s39, 147456, 0
    s_mul_i32 s52, s52, 1152
    s_add_u32 s52, s52, s43
    v_add_u32 v245, 0, v1
    v_mul_u32_u24 v246, 205, v245
    v_lshrrev_b32 v246, 11, v246
    v_mul_u32_u24 v247, 10, v246
    v_sub_u32_e64 v247, v245, v247
    v_mul_u32_u24 v240, 1152, v246
    v_lshl_add_u32 v240, v247, 4, v240
    v_lshrrev_b32_e64 v246, 4, v246
    v_mad_u32_u24 v240, v246, s39, v240
    v_add_u32_e64 v245, 64, v1
    v_mul_u32_u24 v246, 205, v245
    v_lshrrev_b32 v246, 11, v246
    v_mul_u32_u24 v247, 10, v246
    v_sub_u32_e64 v247, v245, v247
    v_mul_u32_u24 v241, 1152, v246
    v_lshl_add_u32 v241, v247, 4, v241
    v_lshrrev_b32_e64 v246, 4, v246
    v_mad_u32_u24 v241, v246, s39, v241
    v_add_u32 v245, 128, v1
    v_mul_u32_u24 v246, 205, v245
    v_lshrrev_b32 v246, 11, v246
    v_mul_u32_u24 v247, 10, v246
    v_sub_u32_e64 v247, v245, v247
    v_mul_u32_u24 v242, 1152, v246
    v_lshl_add_u32 v242, v247, 4, v242
    v_lshrrev_b32_e64 v246, 4, v246
    v_mad_u32_u24 v242, v246, s39, v242
    v_add_u32 v245, 192, v1
    v_mul_u32_u24 v246, 205, v245
    v_lshrrev_b32 v246, 11, v246
    v_mul_u32_u24 v247, 10, v246
    v_sub_u32_e64 v247, v245, v247
    v_mul_u32_u24 v243, 1152, v246
    v_lshl_add_u32 v243, v247, 4, v243
    v_lshrrev_b32_e64 v246, 4, v246
    v_mad_u32_u24 v243, v246, s39, v243
    v_add_u32 v245, 256, v1
    v_mul_u32_u24 v246, 205, v245
    v_lshrrev_b32 v246, 11, v246
    v_mul_u32_u24 v247, 10, v246
    v_sub_u32_e64 v247, v245, v247
    v_mul_u32_u24 v244, 1152, v246
    v_lshl_add_u32 v244, v247, 4, v244
    v_lshrrev_b32_e64 v246, 4, v246
    v_mad_u32_u24 v244, v246, s39, v244
    s_mul_i32 s53, s53, 72
    s_add_u32 s53, s53, s42
    s_mul_i32 s53, s53, 5120
    s_add_u32 s53, s53, 55574528
    s_min_u32 s54, s20, 2
    s_mul_i32 s54, s54, 5120
    s_add_u32 s54, s54, 147712
    s_mov_b32 s14, 2654208
    s_mov_b32 s15, 0x20000
    s_cmp_lt_u32 s51, 576
    s_cselect_b64 s[36:37], -1, 0
    s_waitcnt lgkmcnt(0)
    s_barrier
    s_cmp_lg_u32 s20, 4
    s_cbranch_scc1 sequential_preLN__sliding_block__mixer_gmlp__prompt_kernel_f1ok
    s_mov_b32 s42, 0x20000
sequential_preLN__sliding_block__mixer_gmlp__prompt_kernel_f1g:
    buffer_load_dword v10, v253, s[16:19], s33 offen sc1
    buffer_load_dword v11, v254, s[24:27], 0 offen sc1
    s_waitcnt vmcnt(0)
    v_cmp_eq_u32 s[28:29], -1, v10
    v_cmp_eq_u32 s[30:31], 0, v11
    s_sub_u32 s42, s42, 1
    s_or_b64 s[28:29], s[28:29], s[30:31]
    s_cbranch_scc1 sequential_preLN__sliding_block__mixer_gmlp__prompt_kernel_f1r
sequential_preLN__sliding_block__mixer_gmlp__prompt_kernel_f1ok:
    s_barrier
    s_lshl_b32 s38, s20, 11
    s_add_u32 m0, s38, 49152
    s_lshl_b32 s38, s20, 10
    buffer_load_dwordx4 v3, s[16:19], s44 offen sc1 lds
    buffer_load_dwordx4 v3, s[16:19], s44 offen offset:1024 sc1 lds
    s_mov_b32 m0, s55
    buffer_load_dwordx4 v[16:19], v3, s[16:19], s32 offen sc1
    buffer_load_dword v7, s[16:19], s46 offen sc1 lds
    buffer_load_dword v20, v8, s[16:19], s45 offen sc1
    buffer_load_dword v248, v249, s[24:27], 0 offen sc1
    s_lshl_b32 s38, s20, 10
    s_add_u32 m0, s38, 111616
    s_nop 0
    buffer_load_dwordx4 v250, s[16:19], 0 offen sc1 lds
    s_add_u32 m0, s38, 119808
    s_nop 0
    buffer_load_dwordx4 v251, s[16:19], 0 offen sc1 lds
    s_add_u32 m0, s38, 128000
    s_nop 0
    buffer_load_dwordx4 v252, s[16:19], 0 offen sc1 lds
    s_waitcnt vmcnt(3)
    s_barrier
    s_cmp_lt_u32 s20, 4
    s_cbranch_scc1 sequential_preLN__sliding_block__mixer_gmlp__prompt_kernel_pr1
    s_setprio 1
sequential_preLN__sliding_block__mixer_gmlp__prompt_kernel_pr1:
    ds_read_b32 v24, v5 offset:0
    ds_read_b32 v40, v5 offset:1024
    ds_read_b32 v26, v5 offset:128
    ds_read_b32 v28, v5 offset:256
    ds_read_b32 v30, v5 offset:384
    ds_read_b32 v32, v5 offset:512
    ds_read_b32 v34, v5 offset:640
    ds_read_b32 v36, v5 offset:768
    ds_read_b32 v38, v5 offset:896
    ds_read_b128 v[52:55], v4 offset:0
    ds_read_b128 v[56:59], v4 offset:8192
    ds_read_b128 v[60:63], v4 offset:1024
    s_waitcnt lgkmcnt(2)
    v_mfma_f32_32x32x16_bf16 v[96:111], v[52:55], v[16:19], 0
    v_mfma_f32_32x32x16_bf16 v[96:111], v[24:27], v[20:23], v[96:111]
    ds_read_b128 v[52:55], v4 offset:2048
    s_waitcnt lgkmcnt(2)
    v_mfma_f32_32x32x16_bf16 v[224:239], v[56:59], v[16:19], 0
    v_mfma_f32_32x32x16_bf16 v[224:239], v[40:43], v[20:23], v[224:239]
    ds_read_b128 v[56:59], v4 offset:3072
    s_waitcnt lgkmcnt(2)
    v_mfma_f32_32x32x16_bf16 v[112:127], v[60:63], v[16:19], 0
    v_mfma_f32_32x32x16_bf16 v[112:127], v[26:29], v[20:23], v[112:127]
    ds_read_b128 v[60:63], v4 offset:4096
    s_waitcnt lgkmcnt(2)
    v_mfma_f32_32x32x16_bf16 v[128:143], v[52:55], v[16:19], 0
    s_nop 4
    v_bfi_b32 v96, v80, v96, v224
    v_bfi_b32 v97, v81, v97, v225
    v_bfi_b32 v98, v82, v98, v226
    v_bfi_b32 v99, v83, v99, v227
    v_mfma_f32_32x32x16_bf16 v[128:143], v[28:31], v[20:23], v[128:143]
    ds_read_b128 v[52:55], v4 offset:5120
    s_nop 0
    v_bfi_b32 v100, v84, v100, v228
    v_bfi_b32 v101, v85, v101, v229
    v_bfi_b32 v102, v86, v102, v230
    v_bfi_b32 v103, v87, v103, v231
    v_bfi_b32 v104, v88, v104, v232
    v_bfi_b32 v105, v89, v105, v233
    s_waitcnt lgkmcnt(2)
    v_mfma_f32_32x32x16_bf16 v[144:159], v[56:59], v[16:19], 0
    v_bfi_b32 v106, v90, v106, v234
    v_bfi_b32 v107, v91, v107, v235
    v_bfi_b32 v108, v92, v108, v236
    v_bfi_b32 v109, v93, v109, v237
    v_mfma_f32_32x32x16_bf16 v[144:159], v[30:33], v[20:23], v[144:159]
    ds_read_b128 v[56:59], v4 offset:6144
    v_bfi_b32 v110, v94, v110, v238
    v_bfi_b32 v111, v95, v111, v239
    v_max_f32 v10, v96, v97
    v_max_f32_e64 v11, v98, v99
    v_max3_f32 v10, v100, v101, v10
    v_max3_f32 v11, v102, v103, v11
    s_waitcnt vmcnt(0)
    s_barrier
    v_cmp_eq_u32_e64 vcc, 0, v248
    s_mov_b32 s42, 0x10000
    s_nop 3
    s_cbranch_vccnz sequential_preLN__sliding_block__mixer_gmlp__prompt_kernel_g3r
sequential_preLN__sliding_block__mixer_gmlp__prompt_kernel_g3ok:
    s_and_b32 s38, s2, 3
    s_lshl_b32 s38, s38, 3
    s_bfe_u32 s39, s2, 0x30003
    s_add_u32 s24, s38, s39
    s_bfe_u32 s38, s2, 0x10002
    s_lshl_b32 s38, s38, 2
    s_lshr_b32 s39, s2, 6
    s_add_u32 s25, s38, s39
    v_lshlrev_b32 v3, 4, v1
    s_lshr_b32 s26, s20, 2
    s_mul_i32 s28, s25, 92160
    s_mul_i32 s38, s26, 46080
    s_add_u32 s28, s28, s38
    s_lshl_b32 s39, s23, 10
    s_add_u32 s28, s28, s39
    s_add_u32 s28, s28, 54525952
    s_lshl_b32 s27, s26, 16
    s_add_u32 s29, s27, s39
    s_cmp_eq_u32 s23, 0
    s_cselect_b64 s[30:31], -1, 0
    s_waitcnt lgkmcnt(2)
    v_mfma_f32_32x32x16_bf16 v[160:175], v[60:63], v[16:19], 0
    v_max3_f32 v10, v104, v105, v10
    v_max3_f32 v11, v106, v107, v11
    v_max3_f32 v10, v108, v109, v10
    v_max3_f32 v11, v110, v111, v11
    v_mfma_f32_32x32x16_bf16 v[160:175], v[32:35], v[20:23], v[160:175]
    ds_read_b128 v[60:63], v4 offset:7168
    v_max3_f32 v10, v112, v113, v10
    v_max3_f32 v11, v114, v115, v11
    v_max3_f32 v10, v116, v117, v10
    v_max3_f32 v11, v118, v119, v11
    v_max3_f32 v10, v120, v121, v10
    v_max3_f32 v11, v122, v123, v11
    s_waitcnt lgkmcnt(2)
    v_mfma_f32_32x32x16_bf16 v[176:191], v[52:55], v[16:19], 0
    v_max3_f32 v10, v124, v125, v10
    v_max3_f32 v11, v126, v127, v11
    v_max3_f32 v10, v128, v129, v10
    v_max3_f32 v11, v130, v131, v11
    v_mfma_f32_32x32x16_bf16 v[176:191], v[34:37], v[20:23], v[176:191]
    s_nop 0
    v_max3_f32 v10, v132, v133, v10
    v_max3_f32 v11, v134, v135, v11
    v_max3_f32 v10, v136, v137, v10
    v_max3_f32 v11, v138, v139, v11
    v_max3_f32 v10, v140, v141, v10
    v_max3_f32 v11, v142, v143, v11
    s_waitcnt lgkmcnt(1)
    v_mfma_f32_32x32x16_bf16 v[192:207], v[56:59], v[16:19], 0
    v_max3_f32 v10, v144, v145, v10
    v_max3_f32 v11, v146, v147, v11
    v_max3_f32 v10, v148, v149, v10
    v_max3_f32 v11, v150, v151, v11
    v_mfma_f32_32x32x16_bf16 v[192:207], v[36:39], v[20:23], v[192:207]
    v_max3_f32 v10, v152, v153, v10
    v_max3_f32 v11, v154, v155, v11
    v_max3_f32 v10, v156, v157, v10
    v_max3_f32 v11, v158, v159, v11
    s_waitcnt lgkmcnt(0)
    v_mfma_f32_32x32x16_bf16 v[208:223], v[60:63], v[16:19], 0
    v_max3_f32 v10, v160, v161, v10
    v_max3_f32 v11, v162, v163, v11
    v_max3_f32 v10, v164, v165, v10
    v_max3_f32 v11, v166, v167, v11
    v_mfma_f32_32x32x16_bf16 v[208:223], v[38:41], v[20:23], v[208:223]
    v_max3_f32 v10, v168, v169, v10
    v_max3_f32 v11, v170, v171, v11
    v_max3_f32 v10, v172, v173, v10
    v_max3_f32 v11, v174, v175, v11
    ds_read_b128 v[64:67], v6 offset:0
    ds_read_b128 v[68:71], v6 offset:608
    ds_read_b128 v[72:75], v6 offset:9728
    ds_read_b128 v[76:79], v6 offset:10336
    v_max3_f32 v10, v176, v177, v10
    v_max3_f32 v11, v178, v179, v11
    v_max3_f32 v10, v180, v181, v10
    v_max3_f32 v11, v182, v183, v11
    v_max3_f32 v10, v184, v185, v10
    v_max3_f32 v11, v186, v187, v11
    v_max3_f32 v10, v188, v189, v10
    v_max3_f32 v11, v190, v191, v11
    v_max3_f32 v10, v192, v193, v10
    v_max3_f32 v11, v194, v195, v11
    v_max3_f32 v10, v196, v197, v10
    v_max3_f32 v11, v198, v199, v11
    v_max3_f32 v10, v200, v201, v10
    v_max3_f32 v11, v202, v203, v11
    v_max3_f32 v10, v204, v205, v10
    v_max3_f32 v11, v206, v207, v11
    v_max3_f32 v10, v208, v209, v10
    v_max3_f32 v11, v210, v211, v11
    v_max3_f32 v10, v212, v213, v10
    v_max3_f32 v11, v214, v215, v11
    v_max3_f32 v10, v216, v217, v10
    v_max3_f32 v11, v218, v219, v11
    v_max3_f32 v10, v220, v221, v10
    v_max3_f32 v11, v222, v223, v11
    v_max_f32 v10, v10, v11
    v_mov_b32 v11, v10
    s_nop 1
    v_permlane32_swap_b32 v11, v10
    v_max_f32_e64 v10, v10, v11
    v_pk_add_f32 v[96:97], v[96:97], v[10:11] op_sel_hi:[1,0] neg_lo:[0,1] neg_hi:[0,1]
    v_pk_add_f32 v[98:99], v[98:99], v[10:11] op_sel_hi:[1,0] neg_lo:[0,1] neg_hi:[0,1]
    v_pk_add_f32 v[100:101], v[100:101], v[10:11] op_sel_hi:[1,0] neg_lo:[0,1] neg_hi:[0,1]
    v_pk_add_f32 v[102:103], v[102:103], v[10:11] op_sel_hi:[1,0] neg_lo:[0,1] neg_hi:[0,1]
    v_pk_add_f32 v[104:105], v[104:105], v[10:11] op_sel_hi:[1,0] neg_lo:[0,1] neg_hi:[0,1]
    v_pk_add_f32 v[106:107], v[106:107], v[10:11] op_sel_hi:[1,0] neg_lo:[0,1] neg_hi:[0,1]
    v_pk_add_f32 v[108:109], v[108:109], v[10:11] op_sel_hi:[1,0] neg_lo:[0,1] neg_hi:[0,1]
    v_pk_add_f32 v[110:111], v[110:111], v[10:11] op_sel_hi:[1,0] neg_lo:[0,1] neg_hi:[0,1]
    v_exp_f32 v96, v96
    v_exp_f32 v97, v97
    v_exp_f32 v98, v98
    v_exp_f32 v99, v99
    v_cvt_pk_bf16_f32 v96, v96, v97
    v_exp_f32 v100, v100
    v_exp_f32 v101, v101
    v_cvt_pk_bf16_f32 v97, v98, v99
    v_exp_f32 v102, v102
    v_exp_f32 v103, v103
    v_cvt_pk_bf16_f32 v98, v100, v101
    s_add_u32 m0, s54, 0
    s_mov_b64 exec, s[36:37]
    buffer_load_dwordx4 v240, s[12:15], s52 offen lds
    s_mov_b64 exec, -1
    v_exp_f32 v104, v104
    v_exp_f32_e64 v105, v105
    v_cvt_pk_bf16_f32 v99, v102, v103
    v_exp_f32 v106, v106
    v_exp_f32 v107, v107
    v_cvt_pk_bf16_f32 v100, v104, v105
    v_exp_f32 v108, v108
    v_exp_f32 v109, v109
    v_cvt_pk_bf16_f32 v101, v106, v107
    v_exp_f32 v110, v110
    v_exp_f32 v111, v111
    s_add_u32 m0, s54, 1024
    s_mov_b64 exec, s[36:37]
    buffer_load_dwordx4 v241, s[12:15], s52 offen lds
    s_mov_b64 exec, -1
    v_cvt_pk_bf16_f32 v102, v108, v109
    v_cvt_pk_bf16_f32 v103, v110, v111
    v_pk_add_f32 v[112:113], v[112:113], v[10:11] op_sel_hi:[1,0] neg_lo:[0,1] neg_hi:[0,1]
    v_pk_add_f32 v[114:115], v[114:115], v[10:11] op_sel_hi:[1,0] neg_lo:[0,1] neg_hi:[0,1]
    v_pk_add_f32 v[116:117], v[116:117], v[10:11] op_sel_hi:[1,0] neg_lo:[0,1] neg_hi:[0,1]
    v_pk_add_f32 v[118:119], v[118:119], v[10:11] op_sel_hi:[1,0] neg_lo:[0,1] neg_hi:[0,1]
    v_pk_add_f32 v[120:121], v[120:121], v[10:11] op_sel_hi:[1,0] neg_lo:[0,1] neg_hi:[0,1]
    v_pk_add_f32 v[122:123], v[122:123], v[10:11] op_sel_hi:[1,0] neg_lo:[0,1] neg_hi:[0,1]
    v_pk_add_f32 v[124:125], v[124:125], v[10:11] op_sel_hi:[1,0] neg_lo:[0,1] neg_hi:[0,1]
    v_pk_add_f32 v[126:127], v[126:127], v[10:11] op_sel_hi:[1,0] neg_lo:[0,1] neg_hi:[0,1]
    v_and_b32 v104, v44, v96
    v_and_b32 v105, v45, v97
    v_and_b32 v106, v46, v98
    v_and_b32 v107, v47, v99
    v_and_b32 v108, v48, v100
    v_and_b32 v109, v49, v101
    v_and_b32 v110, v50, v102
    v_and_b32 v111, v51, v103
    v_xor_b32 v96, v104, v96
    v_xor_b32 v97, v105, v97
    v_xor_b32 v98, v106, v98
    v_xor_b32 v99, v107, v99
    v_xor_b32 v100, v108, v100
    v_xor_b32 v101, v109, v101
    v_xor_b32 v102, v110, v102
    v_xor_b32_e64 v103, v111, v103
    s_waitcnt lgkmcnt(3)
    v_mfma_f32_32x32x16_bf16 v[80:95], v[64:67], v[104:107], 0
    ds_read_b128 v[64:67], v6 offset:1216
    v_exp_f32 v112, v112
    v_exp_f32 v113, v113
    v_exp_f32 v114, v114
    v_exp_f32 v115, v115
    v_cvt_pk_bf16_f32 v112, v112, v113
    s_waitcnt lgkmcnt(3)
    v_mfma_f32_32x32x16_bf16 v[80:95], v[68:71], v[108:111], v[80:95]
    ds_read_b128 v[68:71], v6 offset:1824
    v_exp_f32 v116, v116
    v_exp_f32_e64 v117, v117
    v_cvt_pk_bf16_f32 v113, v114, v115
    v_exp_f32 v118, v118
    v_exp_f32_e64 v119, v119
    s_waitcnt lgkmcnt(3)
    v_mfma_f32_32x32x16_bf16 v[80:95], v[72:75], v[96:99], v[80:95]
    ds_read_b128 v[72:75], v6 offset:2432
    v_cvt_pk_bf16_f32 v114, v116, v117
    v_exp_f32 v120, v120
    v_exp_f32 v121, v121
    v_cvt_pk_bf16_f32 v115, v118, v119
    v_exp_f32 v122, v122
    s_waitcnt lgkmcnt(3)
    v_mfma_f32_32x32x16_bf16 v[80:95], v[76:79], v[100:103], v[80:95]
    ds_read_b128 v[76:79], v6 offset:3040
    v_exp_f32_e64 v123, v123
    v_cvt_pk_bf16_f32 v116, v120, v121
    v_exp_f32 v124, v124
    v_exp_f32 v125, v125
    v_cvt_pk_bf16_f32 v117, v122, v123
    v_exp_f32 v126, v126
    v_exp_f32 v127, v127
    v_cvt_pk_bf16_f32 v118, v124, v125
    v_cvt_pk_bf16_f32 v119, v126, v127
    v_pk_add_f32 v[128:129], v[128:129], v[10:11] op_sel_hi:[1,0] neg_lo:[0,1] neg_hi:[0,1]
    v_pk_add_f32 v[130:131], v[130:131], v[10:11] op_sel_hi:[1,0] neg_lo:[0,1] neg_hi:[0,1]
    s_add_u32 m0, s54, 2048
    s_mov_b64 exec, s[36:37]
    buffer_load_dwordx4 v242, s[12:15], s52 offen lds
    s_mov_b64 exec, -1
    v_pk_add_f32 v[132:133], v[132:133], v[10:11] op_sel_hi:[1,0] neg_lo:[0,1] neg_hi:[0,1]
    v_pk_add_f32 v[134:135], v[134:135], v[10:11] op_sel_hi:[1,0] neg_lo:[0,1] neg_hi:[0,1]
    v_pk_add_f32 v[136:137], v[136:137], v[10:11] op_sel_hi:[1,0] neg_lo:[0,1] neg_hi:[0,1]
    v_pk_add_f32 v[138:139], v[138:139], v[10:11] op_sel_hi:[1,0] neg_lo:[0,1] neg_hi:[0,1]
    v_pk_add_f32 v[140:141], v[140:141], v[10:11] op_sel_hi:[1,0] neg_lo:[0,1] neg_hi:[0,1]
    v_pk_add_f32 v[142:143], v[142:143], v[10:11] op_sel_hi:[1,0] neg_lo:[0,1] neg_hi:[0,1]
    s_add_u32 m0, s54, 3072
    s_mov_b64 exec, s[36:37]
    buffer_load_dwordx4 v243, s[12:15], s52 offen lds
    s_mov_b64 exec, -1
    s_waitcnt lgkmcnt(3)
    v_mfma_f32_32x32x16_bf16 v[80:95], v[64:67], v[112:115], v[80:95]
    ds_read_b128 v[64:67], v6 offset:3648
    v_exp_f32 v128, v128
    v_exp_f32 v129, v129
    v_exp_f32 v130, v130
    v_exp_f32_e64 v131, v131
    v_cvt_pk_bf16_f32 v128, v128, v129
    s_waitcnt lgkmcnt(3)
    v_mfma_f32_32x32x16_bf16 v[80:95], v[68:71], v[116:119], v[80:95]
    ds_read_b128 v[68:71], v6 offset:4256
    v_exp_f32 v132, v132
    v_exp_f32_e64 v133, v133
    v_cvt_pk_bf16_f32 v129, v130, v131
    v_exp_f32 v134, v134
    v_exp_f32 v135, v135
    v_cvt_pk_bf16_f32 v130, v132, v133
    v_exp_f32 v136, v136
    v_exp_f32 v137, v137
    v_cvt_pk_bf16_f32 v131, v134, v135
    v_exp_f32 v138, v138
    v_exp_f32 v139, v139
    s_add_u32 m0, s54, 4096
    s_mov_b64 exec, s[36:37]
    buffer_load_dwordx4 v244, s[12:15], s52 offen lds
    s_mov_b64 exec, -1
    v_cvt_pk_bf16_f32 v132, v136, v137
    v_exp_f32 v140, v140
    v_exp_f32 v141, v141
    v_cvt_pk_bf16_f32 v133, v138, v139
    v_exp_f32 v142, v142
    v_exp_f32 v143, v143
    s_add_u32 m0, s29, 0
    s_nop 0
    buffer_load_dwordx4 v3, s[16:19], s28 offen sc1 lds
    s_add_u32 s28, s28, 4096
    v_cvt_pk_bf16_f32 v134, v140, v141
    v_cvt_pk_bf16_f32 v135, v142, v143
    v_pk_add_f32 v[144:145], v[144:145], v[10:11] op_sel_hi:[1,0] neg_lo:[0,1] neg_hi:[0,1]
    v_pk_add_f32 v[146:147], v[146:147], v[10:11] op_sel_hi:[1,0] neg_lo:[0,1] neg_hi:[0,1]
    v_pk_add_f32 v[148:149], v[148:149], v[10:11] op_sel_hi:[1,0] neg_lo:[0,1] neg_hi:[0,1]
    v_pk_add_f32 v[150:151], v[150:151], v[10:11] op_sel_hi:[1,0] neg_lo:[0,1] neg_hi:[0,1]
    s_add_u32 m0, s29, 4096
    s_nop 0
    buffer_load_dwordx4 v3, s[16:19], s28 offen sc1 lds
    s_add_u32 s28, s28, 4096
    v_pk_add_f32 v[152:153], v[152:153], v[10:11] op_sel_hi:[1,0] neg_lo:[0,1] neg_hi:[0,1]
    v_pk_add_f32 v[154:155], v[154:155], v[10:11] op_sel_hi:[1,0] neg_lo:[0,1] neg_hi:[0,1]
    v_pk_add_f32 v[156:157], v[156:157], v[10:11] op_sel_hi:[1,0] neg_lo:[0,1] neg_hi:[0,1]
    v_pk_add_f32 v[158:159], v[158:159], v[10:11] op_sel_hi:[1,0] neg_lo:[0,1] neg_hi:[0,1]
    s_waitcnt lgkmcnt(3)
    v_mfma_f32_32x32x16_bf16 v[80:95], v[72:75], v[128:131], v[80:95]
    ds_read_b128 v[72:75], v6 offset:4864
    v_exp_f32 v144, v144
    v_exp_f32 v145, v145
    v_exp_f32 v146, v146
    v_exp_f32 v147, v147
    v_cvt_pk_bf16_f32 v144, v144, v145
    s_waitcnt lgkmcnt(3)
    v_mfma_f32_32x32x16_bf16 v[80:95], v[76:79], v[132:135], v[80:95]
    ds_read_b128 v[76:79], v6 offset:5472
    v_exp_f32 v148, v148
    v_exp_f32_e64 v149, v149
    v_cvt_pk_bf16_f32 v145, v146, v147
    v_exp_f32 v150, v150
    v_exp_f32 v151, v151
    v_cvt_pk_bf16_f32 v146, v148, v149
    v_exp_f32 v152, v152
    v_exp_f32 v153, v153
    v_cvt_pk_bf16_f32 v147, v150, v151
    v_exp_f32 v154, v154
    v_exp_f32 v155, v155
    s_add_u32 m0, s29, 8192
    s_nop 0
    buffer_load_dwordx4 v3, s[16:19], s28 offen sc1 lds
    s_add_u32 s28, s28, 4096
    v_cvt_pk_bf16_f32 v148, v152, v153
    v_exp_f32 v156, v156
    v_exp_f32_e64 v157, v157
    v_cvt_pk_bf16_f32 v149, v154, v155
    v_exp_f32 v158, v158
    v_exp_f32 v159, v159
    s_add_u32 m0, s29, 12288
    s_nop 0
    buffer_load_dwordx4 v3, s[16:19], s28 offen sc1 lds
    s_add_u32 s28, s28, 4096
    s_nop 0
    v_cvt_pk_bf16_f32 v150, v156, v157
    v_cvt_pk_bf16_f32 v151, v158, v159
    v_pk_add_f32 v[160:161], v[160:161], v[10:11] op_sel_hi:[1,0] neg_lo:[0,1] neg_hi:[0,1]
    v_pk_add_f32 v[162:163], v[162:163], v[10:11] op_sel_hi:[1,0] neg_lo:[0,1] neg_hi:[0,1]
    v_pk_add_f32 v[164:165], v[164:165], v[10:11] op_sel_hi:[1,0] neg_lo:[0,1] neg_hi:[0,1]
    v_pk_add_f32 v[166:167], v[166:167], v[10:11] op_sel_hi:[1,0] neg_lo:[0,1] neg_hi:[0,1]
    s_add_u32 m0, s29, 16384
    s_nop 0
    buffer_load_dwordx4 v3, s[16:19], s28 offen sc1 lds
    s_add_u32 s28, s28, 4096
    v_pk_add_f32 v[168:169], v[168:169], v[10:11] op_sel_hi:[1,0] neg_lo:[0,1] neg_hi:[0,1]
    v_pk_add_f32 v[170:171], v[170:171], v[10:11] op_sel_hi:[1,0] neg_lo:[0,1] neg_hi:[0,1]
    v_pk_add_f32 v[172:173], v[172:173], v[10:11] op_sel_hi:[1,0] neg_lo:[0,1] neg_hi:[0,1]
    v_pk_add_f32 v[174:175], v[174:175], v[10:11] op_sel_hi:[1,0] neg_lo:[0,1] neg_hi:[0,1]
    s_setprio 0
    s_waitcnt lgkmcnt(3)
    v_mfma_f32_32x32x16_bf16 v[80:95], v[64:67], v[144:147], v[80:95]
    ds_read_b128 v[64:67], v6 offset:6080
    v_exp_f32 v160, v160
    v_exp_f32 v161, v161
    v_exp_f32 v162, v162
    v_exp_f32_e64 v163, v163
    v_cvt_pk_bf16_f32 v160, v160, v161
    s_waitcnt lgkmcnt(3)
    v_mfma_f32_32x32x16_bf16 v[80:95], v[68:71], v[148:151], v[80:95]
    ds_read_b128 v[68:71], v6 offset:6688
    v_exp_f32 v164, v164
    v_exp_f32_e64 v165, v165
    v_cvt_pk_bf16_f32 v161, v162, v163
    v_exp_f32 v166, v166
    v_exp_f32 v167, v167
    v_cvt_pk_bf16_f32 v162, v164, v165
    v_exp_f32 v168, v168
    v_exp_f32 v169, v169
    v_cvt_pk_bf16_f32 v163, v166, v167
    v_exp_f32 v170, v170
    v_exp_f32 v171, v171
    s_add_u32 m0, s29, 20480
    s_nop 0
    buffer_load_dwordx4 v3, s[16:19], s28 offen sc1 lds
    s_add_u32 s28, s28, 4096
    v_cvt_pk_bf16_f32 v164, v168, v169
    v_exp_f32 v172, v172
    v_exp_f32_e64 v173, v173
    v_cvt_pk_bf16_f32 v165, v170, v171
    v_exp_f32 v174, v174
    v_exp_f32 v175, v175
    s_add_u32 m0, s29, 24576
    s_nop 0
    buffer_load_dwordx4 v3, s[16:19], s28 offen sc1 lds
    s_add_u32 s28, s28, 4096
    s_nop 0
    v_cvt_pk_bf16_f32 v166, v172, v173
    v_cvt_pk_bf16_f32 v167, v174, v175
    v_pk_add_f32 v[176:177], v[176:177], v[10:11] op_sel_hi:[1,0] neg_lo:[0,1] neg_hi:[0,1]
    v_pk_add_f32 v[178:179], v[178:179], v[10:11] op_sel_hi:[1,0] neg_lo:[0,1] neg_hi:[0,1]
    v_pk_add_f32 v[180:181], v[180:181], v[10:11] op_sel_hi:[1,0] neg_lo:[0,1] neg_hi:[0,1]
    v_pk_add_f32 v[182:183], v[182:183], v[10:11] op_sel_hi:[1,0] neg_lo:[0,1] neg_hi:[0,1]
    s_add_u32 m0, s29, 28672
    s_nop 0
    buffer_load_dwordx4 v3, s[16:19], s28 offen sc1 lds
    s_add_u32 s28, s28, 4096
    v_pk_add_f32 v[184:185], v[184:185], v[10:11] op_sel_hi:[1,0] neg_lo:[0,1] neg_hi:[0,1]
    v_pk_add_f32 v[186:187], v[186:187], v[10:11] op_sel_hi:[1,0] neg_lo:[0,1] neg_hi:[0,1]
    v_pk_add_f32 v[188:189], v[188:189], v[10:11] op_sel_hi:[1,0] neg_lo:[0,1] neg_hi:[0,1]
    v_pk_add_f32 v[190:191], v[190:191], v[10:11] op_sel_hi:[1,0] neg_lo:[0,1] neg_hi:[0,1]
    s_waitcnt lgkmcnt(3)
    v_mfma_f32_32x32x16_bf16 v[80:95], v[72:75], v[160:163], v[80:95]
    ds_read_b128 v[72:75], v6 offset:7296
    v_exp_f32 v176, v176
    v_exp_f32 v177, v177
    v_exp_f32 v178, v178
    v_exp_f32 v179, v179
    v_cvt_pk_bf16_f32 v176, v176, v177
    s_waitcnt lgkmcnt(3)
    v_mfma_f32_32x32x16_bf16 v[80:95], v[76:79], v[164:167], v[80:95]
    ds_read_b128 v[76:79], v6 offset:7904
    v_exp_f32 v180, v180
    v_exp_f32_e64 v181, v181
    v_cvt_pk_bf16_f32 v177, v178, v179
    v_exp_f32 v182, v182
    v_exp_f32 v183, v183
    v_cvt_pk_bf16_f32 v178, v180, v181
    v_exp_f32 v184, v184
    v_exp_f32 v185, v185
    v_cvt_pk_bf16_f32 v179, v182, v183
    v_exp_f32 v186, v186
    v_exp_f32 v187, v187
    s_add_u32 m0, s29, 32768
    s_nop 0
    buffer_load_dwordx4 v3, s[16:19], s28 offen sc1 lds
    s_add_u32 s28, s28, 4096
    v_cvt_pk_bf16_f32 v180, v184, v185
    v_exp_f32 v188, v188
    v_exp_f32_e64 v189, v189
    v_cvt_pk_bf16_f32 v181, v186, v187
    v_exp_f32 v190, v190
    v_exp_f32 v191, v191
    s_add_u32 m0, s29, 36864
    s_nop 0
    buffer_load_dwordx4 v3, s[16:19], s28 offen sc1 lds
    s_add_u32 s28, s28, 4096
    s_nop 0
    v_cvt_pk_bf16_f32 v182, v188, v189
    v_cvt_pk_bf16_f32 v183, v190, v191
    v_pk_add_f32 v[192:193], v[192:193], v[10:11] op_sel_hi:[1,0] neg_lo:[0,1] neg_hi:[0,1]
    v_pk_add_f32 v[194:195], v[194:195], v[10:11] op_sel_hi:[1,0] neg_lo:[0,1] neg_hi:[0,1]
    v_pk_add_f32 v[196:197], v[196:197], v[10:11] op_sel_hi:[1,0] neg_lo:[0,1] neg_hi:[0,1]
    v_pk_add_f32 v[198:199], v[198:199], v[10:11] op_sel_hi:[1,0] neg_lo:[0,1] neg_hi:[0,1]
    s_add_u32 m0, s29, 40960
    s_nop 0
    buffer_load_dwordx4 v3, s[16:19], s28 offen sc1 lds
    s_add_u32 s28, s28, 4096
    v_pk_add_f32 v[200:201], v[200:201], v[10:11] op_sel_hi:[1,0] neg_lo:[0,1] neg_hi:[0,1]
    v_pk_add_f32 v[202:203], v[202:203], v[10:11] op_sel_hi:[1,0] neg_lo:[0,1] neg_hi:[0,1]
    v_pk_add_f32 v[204:205], v[204:205], v[10:11] op_sel_hi:[1,0] neg_lo:[0,1] neg_hi:[0,1]
    v_pk_add_f32 v[206:207], v[206:207], v[10:11] op_sel_hi:[1,0] neg_lo:[0,1] neg_hi:[0,1]
    s_waitcnt lgkmcnt(3)
    v_mfma_f32_32x32x16_bf16 v[80:95], v[64:67], v[176:179], v[80:95]
    ds_read_b128 v[64:67], v6 offset:8512
    v_exp_f32 v192, v192
    v_exp_f32 v193, v193
    v_exp_f32 v194, v194
    v_exp_f32 v195, v195
    v_cvt_pk_bf16_f32 v192, v192, v193
    s_waitcnt lgkmcnt(3)
    v_mfma_f32_32x32x16_bf16 v[80:95], v[68:71], v[180:183], v[80:95]
    ds_read_b128 v[68:71], v6 offset:9120
    v_exp_f32 v196, v196
    v_exp_f32_e64 v197, v197
    v_cvt_pk_bf16_f32 v193, v194, v195
    v_exp_f32 v198, v198
    v_exp_f32 v199, v199
    v_cvt_pk_bf16_f32 v194, v196, v197
    v_exp_f32 v200, v200
    v_exp_f32 v201, v201
    v_cvt_pk_bf16_f32 v195, v198, v199
    v_exp_f32 v202, v202
    v_exp_f32 v203, v203
    s_add_u32 m0, s29, 45056
    s_mov_b64 exec, s[30:31]
    buffer_load_dwordx4 v3, s[16:19], s28 offen sc1 lds
    s_mov_b64 exec, -1
    s_add_u32 s28, s28, 4096
    v_cvt_pk_bf16_f32 v196, v200, v201
    v_exp_f32 v204, v204
    v_exp_f32 v205, v205
    v_cvt_pk_bf16_f32 v197, v202, v203
    v_exp_f32 v206, v206
    v_exp_f32 v207, v207
    v_cvt_pk_bf16_f32 v198, v204, v205
    v_cvt_pk_bf16_f32 v199, v206, v207
    v_pk_add_f32 v[208:209], v[208:209], v[10:11] op_sel_hi:[1,0] neg_lo:[0,1] neg_hi:[0,1]
    v_pk_add_f32 v[210:211], v[210:211], v[10:11] op_sel_hi:[1,0] neg_lo:[0,1] neg_hi:[0,1]
    v_pk_add_f32 v[212:213], v[212:213], v[10:11] op_sel_hi:[1,0] neg_lo:[0,1] neg_hi:[0,1]
    v_pk_add_f32 v[214:215], v[214:215], v[10:11] op_sel_hi:[1,0] neg_lo:[0,1] neg_hi:[0,1]
    v_pk_add_f32 v[216:217], v[216:217], v[10:11] op_sel_hi:[1,0] neg_lo:[0,1] neg_hi:[0,1]
    v_pk_add_f32 v[218:219], v[218:219], v[10:11] op_sel_hi:[1,0] neg_lo:[0,1] neg_hi:[0,1]
    v_pk_add_f32 v[220:221], v[220:221], v[10:11] op_sel_hi:[1,0] neg_lo:[0,1] neg_hi:[0,1]
    v_pk_add_f32 v[222:223], v[222:223], v[10:11] op_sel_hi:[1,0] neg_lo:[0,1] neg_hi:[0,1]
    s_waitcnt vmcnt(11)
    v_lshrrev_b32 v12, 2, v1
    v_mul_u32_u24 v12, 160, v12
    v_and_b32_e64 v13, 3, v1
    v_lshl_add_u32 v12, v13, 3, v12
    v_add_u32_e64 v12, s54, v12
    ds_read_b64_tr_b16 v[112:113], v12 offset:0
    ds_read_b64_tr_b16 v[114:115], v12 offset:2560
    ds_read_b64_tr_b16 v[116:117], v12 offset:32
    ds_read_b64_tr_b16 v[118:119], v12 offset:2592
    ds_read_b64_tr_b16 v[120:121], v12 offset:64
    ds_read_b64_tr_b16 v[122:123], v12 offset:2624
    ds_read_b64_tr_b16 v[124:125], v12 offset:96
    ds_read_b64_tr_b16 v[126:127], v12 offset:2656
    ds_read_b64_tr_b16 v[128:129], v12 offset:128
    ds_read_b64_tr_b16 v[130:131], v12 offset:2688
    s_waitcnt lgkmcnt(0)
    v_mfma_f32_32x32x16_bf16 v[80:95], v[72:75], v[192:195], v[80:95]
    v_exp_f32 v208, v208
    v_exp_f32 v209, v209
    v_exp_f32 v210, v210
    v_exp_f32_e64 v211, v211
    v_cvt_pk_bf16_f32 v208, v208, v209
    v_mfma_f32_32x32x16_bf16 v[80:95], v[76:79], v[196:199], v[80:95]
    v_exp_f32 v212, v212
    v_exp_f32 v213, v213
    v_cvt_pk_bf16_f32 v209, v210, v211
    v_exp_f32 v214, v214
    v_exp_f32 v215, v215
    v_cvt_pk_bf16_f32 v210, v212, v213
    v_exp_f32 v216, v216
    v_exp_f32 v217, v217
    v_cvt_pk_bf16_f32 v211, v214, v215
    v_exp_f32 v218, v218
    v_exp_f32 v219, v219
    v_cvt_pk_bf16_f32 v212, v216, v217
    v_exp_f32 v220, v220
    v_exp_f32 v221, v221
    v_cvt_pk_bf16_f32 v213, v218, v219
    v_exp_f32 v222, v222
    v_exp_f32 v223, v223
    v_cvt_pk_bf16_f32 v214, v220, v221
    v_cvt_pk_bf16_f32 v215, v222, v223
    s_mov_b64 exec, s[36:37]
    buffer_store_dwordx4 v[112:115], v3, s[16:19], s53 offen offset:0 sc1
    buffer_store_dwordx4 v[116:119], v3, s[16:19], s53 offen offset:1024 sc1
    buffer_store_dwordx4 v[120:123], v3, s[16:19], s53 offen offset:2048 sc1
    buffer_store_dwordx4 v[124:127], v3, s[16:19], s53 offen offset:3072 sc1
    s_add_u32 s53, s53, 4096
    buffer_store_dwordx4 v[128:131], v3, s[16:19], s53 offen offset:0 sc1
    s_mov_b64 exec, -1
    v_mfma_f32_32x32x16_bf16 v[80:95], v[64:67], v[208:211], v[80:95]
    v_mfma_f32_32x32x16_bf16 v[80:95], v[68:71], v[212:215], v[80:95]
    s_nop 11
    v_rcp_f32_e64 v10, v90
    s_nop 0
    v_pk_mul_f32 v[80:81], v[80:81], v[10:11] op_sel_hi:[1,0]
    v_pk_mul_f32 v[82:83], v[82:83], v[10:11] op_sel_hi:[1,0]
    v_pk_mul_f32 v[84:85], v[84:85], v[10:11] op_sel_hi:[1,0]
    v_pk_mul_f32 v[86:87], v[86:87], v[10:11] op_sel_hi:[1,0]
    v_pk_mul_f32 v[88:89], v[88:89], v[10:11] op_sel_hi:[1,0]
    v_cvt_pk_bf16_f32 v64, v80, v81
    v_cvt_pk_bf16_f32 v65, v82, v83
    v_cvt_pk_bf16_f32 v66, v84, v85
    v_cvt_pk_bf16_f32 v67, v86, v87
    v_cvt_pk_bf16_f32 v68, v88, v89
    buffer_store_dwordx4 v[64:67], v2, s[16:19], s49 offen sc1
    buffer_store_dword v68, v9, s[16:19], s50 offen sc1
    s_lshl_b32 s54, s21, 5
    s_add_u32 s54, s54, s22
    s_lshl_b32 s54, s54, 7
    s_add_u32 s54, s54, 15466496
    v_mov_b32_e64 v8, 0
    s_cmp_eq_u32 s20, 0
    s_cselect_b64 s[36:37], 1, 0
    s_waitcnt vmcnt(0)
    s_barrier
    s_mov_b64 exec, s[36:37]
    buffer_store_dword v8, v8, s[16:19], s54 offen sc1
    s_mov_b64 exec, -1
    s_load_dwordx2 s[32:33], s[0:1], 72
    s_mov_b32 s34, 256
    s_mov_b32 s35, 0x20000
    v_mov_b32 v249, 132
    s_waitcnt lgkmcnt(0)
    buffer_load_dword v248, v249, s[32:35], 0 offen sc1
    s_lshl_b32 s45, s24, 2
    s_add_u32 s45, s45, s23
    s_mul_i32 s48, s45, 18432
    s_mul_i32 s38, s25, 144
    s_add_u32 s48, s48, s38
    s_mul_i32 s49, s23, 3072
    s_add_u32 s49, s49, 147712
    v_and_b32 v11, 15, v1
    v_lshrrev_b32 v12, 4, v1
    v_mov_b32 v15, 1073741824
    v_cmp_gt_u32_e64 vcc, 32, v1
    s_cmp_lt_u32 s20, 4
    s_cselect_b64 s[50:51], -1, 0
    s_mov_b32 s10, 2359296
    s_mov_b32 s11, 0x20000
    v_add_u32_e64 v8, 0, v1
    v_mul_u32_u24 v9, 205, v8
    v_lshrrev_b32 v9, 11, v9
    v_mul_u32_u24 v10, 10, v9
    v_sub_u32_e64 v10, v8, v10
    v_mul_u32_u24 v9, 1152, v9
    v_lshl_add_u32 v16, v10, 4, v9
    v_add_u32_e64 v8, 64, v1
    v_mul_u32_u24 v9, 205, v8
    v_lshrrev_b32 v9, 11, v9
    v_mul_u32_u24 v10, 10, v9
    v_sub_u32_e64 v10, v8, v10
    v_mul_u32_u24 v9, 1152, v9
    v_lshl_add_u32 v17, v10, 4, v9
    v_add_u32 v8, 128, v1
    v_mul_u32_u24 v9, 205, v8
    v_lshrrev_b32 v9, 11, v9
    v_mul_u32_u24 v10, 10, v9
    v_sub_u32_e64 v10, v8, v10
    v_mul_u32_u24 v9, 1152, v9
    v_lshl_add_u32 v18, v10, 4, v9
    v_cndmask_b32 v18, v15, v18, vcc
    s_mov_b64 exec, s[50:51]
    s_add_u32 m0, s49, 0
    s_nop 0
    buffer_load_dwordx4 v16, s[8:11], s48 offen lds
    s_add_u32 m0, s49, 1024
    s_nop 0
    buffer_load_dwordx4 v17, s[8:11], s48 offen lds
    s_add_u32 m0, s49, 2048
    s_nop 0
    buffer_load_dwordx4 v18, s[8:11], s48 offen lds
    s_mov_b64 exec, -1
    s_lshl_b32 s28, s45, 14
    s_add_u32 s28, s28, 7077888
    s_mul_i32 s38, s26, 9216
    s_add_u32 s28, s28, s38
    s_add_u32 s29, s28, 4096
    s_add_u32 s30, s28, 8192
    s_lshr_b32 s31, s45, 1
    s_lshl_b32 s31, s31, 12
    s_and_b32 s38, s45, 1
    s_lshl_b32 s38, s38, 6
    s_add_u32 s31, s31, s38
    s_add_u32 s31, s31, 9175040
    v_lshlrev_b32_e64 v13, 9, v12
    v_lshl_add_u32 v13, v11, 2, v13
    v_add_u32 v4, s27, v3
    v_lshlrev_b32 v7, 4, v11
    v_lshl_add_u32 v7, v12, 3, v7
    v_cndmask_b32_e64 v7, v15, v7, vcc
    v_mul_u32_u24 v8, 160, v11
    v_lshl_add_u32 v8, v12, 3, v8
    v_add_u32 v14, s49, v8
    s_and_b32 s42, s25, 3
    s_lshl_b32 s42, s42, 1
    s_and_b32 s42, s42, 7
    s_cmp_lt_u32 s20, 4
    s_cselect_b32 s43, 9, 7
    s_cselect_b32 s44, 0, 2
    s_add_u32 s38, s42, 0
    s_sub_u32 s38, s38, s44
    s_cmp_ge_i32 s38, s43
    s_cselect_b32 s39, s43, 0
    s_sub_u32 s38, s38, s39
    s_cmp_lt_u32 s20, 4
    s_cselect_b32 s38, s38, 7
    s_mul_i32 s39, s38, 5120
    v_add_u32 v120, s39, v4
    s_lshl_b32 s38, s38, 10
    v_add_u32 v130, s38, v3
    s_add_u32 s38, s42, 1
    s_sub_u32 s38, s38, s44
    s_cmp_ge_i32 s38, s43
    s_cselect_b32 s39, s43, 0
    s_sub_u32 s38, s38, s39
    s_cmp_lt_u32 s20, 4
    s_cselect_b32 s38, s38, 8
    s_mul_i32 s39, s38, 5120
    v_add_u32 v121, s39, v4
    s_lshl_b32 s38, s38, 10
    v_add_u32 v131, s38, v3
    s_add_u32 s38, s42, 2
    s_sub_u32 s38, s38, s44
    s_cmp_ge_i32 s38, s43
    s_cselect_b32 s39, s43, 0
    s_sub_u32 s38, s38, s39
    s_mul_i32 s39, s38, 5120
    v_add_u32 v122, s39, v4
    s_lshl_b32 s38, s38, 10
    v_add_u32 v132, s38, v3
    s_add_u32 s38, s42, 3
    s_sub_u32 s38, s38, s44
    s_cmp_ge_i32 s38, s43
    s_cselect_b32 s39, s43, 0
    s_sub_u32 s38, s38, s39
    s_mul_i32 s39, s38, 5120
    v_add_u32 v123, s39, v4
    s_lshl_b32 s38, s38, 10
    v_add_u32 v133, s38, v3
    s_add_u32 s38, s42, 4
    s_sub_u32 s38, s38, s44
    s_cmp_ge_i32 s38, s43
    s_cselect_b32 s39, s43, 0
    s_sub_u32 s38, s38, s39
    s_mul_i32 s39, s38, 5120
    v_add_u32 v124, s39, v4
    s_lshl_b32 s38, s38, 10
    v_add_u32 v134, s38, v3
    s_add_u32 s38, s42, 5
    s_sub_u32 s38, s38, s44
    s_cmp_ge_i32 s38, s43
    s_cselect_b32 s39, s43, 0
    s_sub_u32 s38, s38, s39
    s_mul_i32 s39, s38, 5120
    v_add_u32 v125, s39, v4
    s_lshl_b32 s38, s38, 10
    v_add_u32 v135, s38, v3
    s_add_u32 s38, s42, 6
    s_sub_u32 s38, s38, s44
    s_cmp_ge_i32 s38, s43
    s_cselect_b32 s39, s43, 0
    s_sub_u32 s38, s38, s39
    s_mul_i32 s39, s38, 5120
    v_add_u32 v126, s39, v4
    s_lshl_b32 s38, s38, 10
    v_add_u32 v136, s38, v3
    s_add_u32 s38, s42, 7
    s_sub_u32 s38, s38, s44
    s_cmp_ge_i32 s38, s43
    s_cselect_b32 s39, s43, 0
    s_sub_u32 s38, s38, s39
    s_mul_i32 s39, s38, 5120
    v_add_u32 v127, s39, v4
    s_lshl_b32 s38, s38, 10
    v_add_u32 v137, s38, v3
    s_add_u32 s38, s42, 8
    s_sub_u32 s38, s38, s44
    s_cmp_ge_i32 s38, s43
    s_cselect_b32 s39, s43, 0
    s_sub_u32 s38, s38, s39
    s_mul_i32 s39, s38, 5120
    v_add_u32 v128, s39, v4
    s_lshl_b32 s38, s38, 10
    v_add_u32_e64 v138, s38, v3
    s_lshr_b32 s38, s24, 2
    s_lshl_b32 s38, s38, 12
    s_add_u32 s42, s38, 15466496
    v_and_b32 v6, 31, v1
    v_lshlrev_b32_e64 v6, 7, v6
    s_cmp_lg_u32 s20, 0
    s_cbranch_scc1 sequential_preLN__sliding_block__mixer_gmlp__prompt_kernel_f2ok
    s_sleep 4
    buffer_load_dword v10, v6, s[16:19], s42 offen sc1
    s_mov_b32 s52, 0x20000
    s_waitcnt vmcnt(0)
    v_cmp_eq_u32_e64 vcc, -1, v10
    s_nop 4
    s_cbranch_vccnz sequential_preLN__sliding_block__mixer_gmlp__prompt_kernel_f2poll
sequential_preLN__sliding_block__mixer_gmlp__prompt_kernel_f2poll_ok:
sequential_preLN__sliding_block__mixer_gmlp__prompt_kernel_f2ok:
    s_waitcnt vmcnt(0)
    s_barrier
    s_mov_b64 exec, s[50:51]
    buffer_load_dwordx4 v[36:39], v130, s[16:19], s28 offen sc1
    buffer_load_dwordx4 v[40:43], v131, s[16:19], s28 offen sc1
    s_not_b64 exec, s[50:51]
    buffer_load_dword v36, v13, s[16:19], s31 offen offset:0 sc1
    buffer_load_dword v37, v13, s[16:19], s31 offen offset:128 sc1
    buffer_load_dword v38, v13, s[16:19], s31 offen offset:256 sc1
    buffer_load_dword v39, v13, s[16:19], s31 offen offset:384 sc1
    buffer_load_dword v40, v13, s[16:19], s31 offen offset:2048 sc1
    buffer_load_dword v41, v13, s[16:19], s31 offen offset:2176 sc1
    buffer_load_dword v42, v13, s[16:19], s31 offen offset:2304 sc1
    buffer_load_dword v43, v13, s[16:19], s31 offen offset:2432 sc1
    s_mov_b64 exec, -1
    buffer_load_dwordx4 v[44:47], v132, s[16:19], s28 offen sc1
    buffer_load_dwordx4 v[48:51], v133, s[16:19], s28 offen sc1
    buffer_load_dwordx4 v[52:55], v134, s[16:19], s28 offen sc1
    buffer_load_dwordx4 v[56:59], v135, s[16:19], s28 offen sc1
    buffer_load_dwordx4 v[60:63], v136, s[16:19], s28 offen sc1
    buffer_load_dwordx4 v[64:67], v137, s[16:19], s28 offen sc1
    buffer_load_dwordx4 v[68:71], v138, s[16:19], s28 offen sc1
    ds_read_b128 v[80:83], v120 offset:0
    ds_read_b128 v[84:87], v120 offset:1024
    ds_read_b128 v[88:91], v120 offset:2048
    ds_read_b128 v[92:95], v120 offset:3072
    ds_read_b128 v[96:99], v120 offset:4096
    s_waitcnt lgkmcnt(0) vmcnt(7)
    v_mfma_f32_16x16x32_bf16 v[16:19], v[80:83], v[36:39], 0
    ds_read_b128 v[100:103], v121 offset:0
    v_mfma_f32_16x16x32_bf16 v[20:23], v[84:87], v[36:39], 0
    ds_read_b128 v[104:107], v121 offset:1024
    v_mfma_f32_16x16x32_bf16 v[24:27], v[88:91], v[36:39], 0
    ds_read_b128 v[108:111], v121 offset:2048
    v_mfma_f32_16x16x32_bf16 v[28:31], v[92:95], v[36:39], 0
    ds_read_b128 v[112:115], v121 offset:3072
    v_mfma_f32_16x16x32_bf16 v[32:35], v[96:99], v[36:39], 0
    ds_read_b128 v[116:119], v121 offset:4096
    s_waitcnt lgkmcnt(0) vmcnt(7)
    v_mfma_f32_16x16x32_bf16 v[16:19], v[100:103], v[40:43], v[16:19]
    ds_read_b128 v[80:83], v122 offset:0
    v_mfma_f32_16x16x32_bf16 v[20:23], v[104:107], v[40:43], v[20:23]
    ds_read_b128 v[84:87], v122 offset:1024
    v_mfma_f32_16x16x32_bf16 v[24:27], v[108:111], v[40:43], v[24:27]
    ds_read_b128 v[88:91], v122 offset:2048
    v_mfma_f32_16x16x32_bf16 v[28:31], v[112:115], v[40:43], v[28:31]
    ds_read_b128 v[92:95], v122 offset:3072
    v_mfma_f32_16x16x32_bf16 v[32:35], v[116:119], v[40:43], v[32:35]
    ds_read_b128 v[96:99], v122 offset:4096
    s_waitcnt lgkmcnt(0) vmcnt(6)
    v_mfma_f32_16x16x32_bf16 v[16:19], v[80:83], v[44:47], v[16:19]
    ds_read_b128 v[100:103], v123 offset:0
    v_mfma_f32_16x16x32_bf16 v[20:23], v[84:87], v[44:47], v[20:23]
    ds_read_b128 v[104:107], v123 offset:1024
    v_mfma_f32_16x16x32_bf16 v[24:27], v[88:91], v[44:47], v[24:27]
    ds_read_b128 v[108:111], v123 offset:2048
    v_mfma_f32_16x16x32_bf16 v[28:31], v[92:95], v[44:47], v[28:31]
    ds_read_b128 v[112:115], v123 offset:3072
    v_mfma_f32_16x16x32_bf16 v[32:35], v[96:99], v[44:47], v[32:35]
    ds_read_b128 v[116:119], v123 offset:4096
    s_waitcnt lgkmcnt(0) vmcnt(5)
    v_mfma_f32_16x16x32_bf16 v[16:19], v[100:103], v[48:51], v[16:19]
    ds_read_b128 v[80:83], v124 offset:0
    v_mfma_f32_16x16x32_bf16 v[20:23], v[104:107], v[48:51], v[20:23]
    ds_read_b128 v[84:87], v124 offset:1024
    v_mfma_f32_16x16x32_bf16 v[24:27], v[108:111], v[48:51], v[24:27]
    ds_read_b128 v[88:91], v124 offset:2048
    v_mfma_f32_16x16x32_bf16 v[28:31], v[112:115], v[48:51], v[28:31]
    ds_read_b128 v[92:95], v124 offset:3072
    v_mfma_f32_16x16x32_bf16 v[32:35], v[116:119], v[48:51], v[32:35]
    ds_read_b128 v[96:99], v124 offset:4096
    s_waitcnt lgkmcnt(0) vmcnt(4)
    v_mfma_f32_16x16x32_bf16 v[16:19], v[80:83], v[52:55], v[16:19]
    ds_read_b128 v[100:103], v125 offset:0
    v_mfma_f32_16x16x32_bf16 v[20:23], v[84:87], v[52:55], v[20:23]
    ds_read_b128 v[104:107], v125 offset:1024
    v_mfma_f32_16x16x32_bf16 v[24:27], v[88:91], v[52:55], v[24:27]
    ds_read_b128 v[108:111], v125 offset:2048
    v_mfma_f32_16x16x32_bf16 v[28:31], v[92:95], v[52:55], v[28:31]
    ds_read_b128 v[112:115], v125 offset:3072
    v_mfma_f32_16x16x32_bf16 v[32:35], v[96:99], v[52:55], v[32:35]
    ds_read_b128 v[116:119], v125 offset:4096
    s_waitcnt lgkmcnt(0) vmcnt(3)
    v_mfma_f32_16x16x32_bf16 v[16:19], v[100:103], v[56:59], v[16:19]
    ds_read_b128 v[80:83], v126 offset:0
    v_mfma_f32_16x16x32_bf16 v[20:23], v[104:107], v[56:59], v[20:23]
    ds_read_b128 v[84:87], v126 offset:1024
    v_mfma_f32_16x16x32_bf16 v[24:27], v[108:111], v[56:59], v[24:27]
    ds_read_b128 v[88:91], v126 offset:2048
    v_mfma_f32_16x16x32_bf16 v[28:31], v[112:115], v[56:59], v[28:31]
    ds_read_b128 v[92:95], v126 offset:3072
    v_mfma_f32_16x16x32_bf16 v[32:35], v[116:119], v[56:59], v[32:35]
    ds_read_b128 v[96:99], v126 offset:4096
    s_waitcnt lgkmcnt(0) vmcnt(2)
    v_mfma_f32_16x16x32_bf16 v[16:19], v[80:83], v[60:63], v[16:19]
    ds_read_b128 v[100:103], v127 offset:0
    v_mfma_f32_16x16x32_bf16 v[20:23], v[84:87], v[60:63], v[20:23]
    ds_read_b128 v[104:107], v127 offset:1024
    v_mfma_f32_16x16x32_bf16 v[24:27], v[88:91], v[60:63], v[24:27]
    ds_read_b128 v[108:111], v127 offset:2048
    v_mfma_f32_16x16x32_bf16 v[28:31], v[92:95], v[60:63], v[28:31]
    ds_read_b128 v[112:115], v127 offset:3072
    v_mfma_f32_16x16x32_bf16 v[32:35], v[96:99], v[60:63], v[32:35]
    ds_read_b128 v[116:119], v127 offset:4096
    s_waitcnt lgkmcnt(0) vmcnt(1)
    v_mfma_f32_16x16x32_bf16 v[16:19], v[100:103], v[64:67], v[16:19]
    ds_read_b128 v[80:83], v128 offset:0
    v_mfma_f32_16x16x32_bf16 v[20:23], v[104:107], v[64:67], v[20:23]
    ds_read_b128 v[84:87], v128 offset:1024
    v_mfma_f32_16x16x32_bf16 v[24:27], v[108:111], v[64:67], v[24:27]
    ds_read_b128 v[88:91], v128 offset:2048
    v_mfma_f32_16x16x32_bf16 v[28:31], v[112:115], v[64:67], v[28:31]
    ds_read_b128 v[92:95], v128 offset:3072
    v_mfma_f32_16x16x32_bf16 v[32:35], v[116:119], v[64:67], v[32:35]
    ds_read_b128 v[96:99], v128 offset:4096
    s_waitcnt lgkmcnt(0) vmcnt(0)
    v_mfma_f32_16x16x32_bf16 v[16:19], v[80:83], v[68:71], v[16:19]
    v_mfma_f32_16x16x32_bf16 v[20:23], v[84:87], v[68:71], v[20:23]
    v_mfma_f32_16x16x32_bf16 v[24:27], v[88:91], v[68:71], v[24:27]
    v_mfma_f32_16x16x32_bf16 v[28:31], v[92:95], v[68:71], v[28:31]
    v_mfma_f32_16x16x32_bf16 v[32:35], v[96:99], v[68:71], v[32:35]
    s_lshl_b32 s38, s23, 12
    s_add_u32 s38, s38, 49152
    v_add_u32 v5, s38, v3
    s_lshl_b32 s38, s23, 10
    s_add_u32 s38, s38, 143360
    v_add_u32_e64 v6, s38, v3
    s_cmp_lt_u32 s20, 4
    s_cbranch_scc1 sequential_preLN__sliding_block__mixer_gmlp__prompt_kernel_A
    ds_write_b128 v5, v[16:19] offset:0
    ds_write_b128 v5, v[20:23] offset:1024
    ds_write_b128 v5, v[24:27] offset:2048
    ds_write_b128 v5, v[28:31] offset:3072
    ds_write_b128 v6, v[32:35]
    s_waitcnt lgkmcnt(0)
    s_barrier
    s_and_b32 s38, s2, 1
    s_lshl_b32 s38, s38, 3
    s_bfe_u32 s39, s2, 0x30003
    s_add_u32 s21, s38, s39
    s_bfe_u32 s38, s2, 0x20001
    s_lshl_b32 s38, s38, 2
    s_lshr_b32 s39, s2, 6
    s_add_u32 s22, s38, s39
    s_lshl_b32 s31, s23, 12
    s_add_u32 s32, s31, 65536
    s_and_b32 s39, s23, 1
    s_lshl_b32 s39, s39, 10
    s_add_u32 s33, s39, 81920
    s_cmp_lt_u32 s23, 2
    s_cselect_b64 s[34:35], -1, 0
    s_cselect_b64 s[36:37], 0, -1
    s_mov_b32 s46, 3184710632
    s_mov_b32 s47, 3222493025
    v_lshlrev_b32_e64 v3, 4, v1
    s_lshl_b32 s48, s21, 2
    s_add_u32 s48, s48, s23
    s_mul_i32 s48, s48, 36864
    s_add_u32 s48, s48, 11534336
    s_mul_i32 s38, s22, 165888
    s_add_u32 s38, s38, 48234496
    s_add_u32 s49, s38, s31
    s_add_u32 s53, s38, s39
    v_cmp_eq_u32_e64 vcc, 0, v248
    s_mov_b32 s52, 0x10000
    s_nop 3
    s_cbranch_vccnz sequential_preLN__sliding_block__mixer_gmlp__prompt_kernel_g2B
sequential_preLN__sliding_block__mixer_gmlp__prompt_kernel_g2B_ok:
    s_barrier
    s_add_u32 s30, s49, 2654208
    s_add_u32 m0, s32, 0
    s_add_u32 s28, s53, 2670592
    buffer_load_dwordx4 v3, s[16:19], s30 offen offset:0 sc1 lds
    buffer_load_dwordx4 v3, s[16:19], s30 offen offset:1024 sc1 lds
    buffer_load_dwordx4 v3, s[16:19], s30 offen offset:2048 sc1 lds
    buffer_load_dwordx4 v3, s[16:19], s30 offen offset:3072 sc1 lds
    s_add_u32 m0, s33, 0
    s_mov_b64 exec, s[34:35]
    buffer_load_dwordx4 v3, s[16:19], s28 offen sc1 lds
    s_mov_b64 exec, -1
    s_add_u32 s30, s49, 2672640
    s_add_u32 m0, s32, 18432
    s_add_u32 s28, s53, 2689024
    buffer_load_dwordx4 v3, s[16:19], s30 offen offset:0 sc1 lds
    buffer_load_dwordx4 v3, s[16:19], s30 offen offset:1024 sc1 lds
    buffer_load_dwordx4 v3, s[16:19], s30 offen offset:2048 sc1 lds
    buffer_load_dwordx4 v3, s[16:19], s30 offen offset:3072 sc1 lds
    s_add_u32 m0, s33, 18432
    s_mov_b64 exec, s[36:37]
    buffer_load_dwordx4 v3, s[16:19], s28 offen sc1 lds
    s_mov_b64 exec, -1
    s_add_u32 s30, s49, 2691072
    s_add_u32 m0, s32, 36864
    s_add_u32 s28, s53, 2707456
    buffer_load_dwordx4 v3, s[16:19], s30 offen offset:0 sc1 lds
    buffer_load_dwordx4 v3, s[16:19], s30 offen offset:1024 sc1 lds
    buffer_load_dwordx4 v3, s[16:19], s30 offen offset:2048 sc1 lds
    buffer_load_dwordx4 v3, s[16:19], s30 offen offset:3072 sc1 lds
    s_add_u32 m0, s33, 36864
    s_mov_b64 exec, s[34:35]
    buffer_load_dwordx4 v3, s[16:19], s28 offen sc1 lds
    s_mov_b64 exec, -1
    s_lshl_b32 s42, s21, 11
    s_add_u32 s42, s42, 15499264
    v_and_b32 v6, 15, v1
    v_lshlrev_b32 v6, 7, v6
    s_mov_b32 s52, 0x20000
    v_mov_b32 v9, 147464
    s_cmp_lg_u32 s23, 0
    s_cbranch_scc1 sequential_preLN__sliding_block__mixer_gmlp__prompt_kernel_f3poll_l
    v_mov_b32 v8, 147492
sequential_preLN__sliding_block__mixer_gmlp__prompt_kernel_f3poll_a:
    ds_read_b32 v10, v8
    s_waitcnt lgkmcnt(0)
    v_cmp_gt_u32 vcc, 4, v10
    s_sub_u32 s52, s52, 1
    s_nop 3
    s_cbranch_vccnz sequential_preLN__sliding_block__mixer_gmlp__prompt_kernel_f3poll_ar
sequential_preLN__sliding_block__mixer_gmlp__prompt_kernel_f3poll_ad:
    s_sleep 12
sequential_preLN__sliding_block__mixer_gmlp__prompt_kernel_f3poll_g:
    buffer_load_dword v10, v6, s[16:19], s42 offen sc1
    s_waitcnt vmcnt(0)
    v_cmp_eq_u32 vcc, -1, v10
    s_sub_u32 s52, s52, 1
    s_nop 3
    s_cbranch_vccnz sequential_preLN__sliding_block__mixer_gmlp__prompt_kernel_f3poll_gr
sequential_preLN__sliding_block__mixer_gmlp__prompt_kernel_f3poll_gd:
    v_mov_b32 v10, 1
    ds_write_b32 v9, v10
sequential_preLN__sliding_block__mixer_gmlp__prompt_kernel_f3poll_ok:
    s_add_u32 s28, s48, 0
    s_add_u32 s29, s48, 16384
    s_add_u32 m0, s31, 0
    s_nop 0
    buffer_load_dwordx4 v3, s[16:19], s28 offen offset:0 sc1 lds
    buffer_load_dwordx4 v3, s[16:19], s28 offen offset:1024 sc1 lds
    buffer_load_dwordx4 v3, s[16:19], s29 offen offset:2048 sc1 lds
    buffer_load_dwordx4 v3, s[16:19], s29 offen offset:3072 sc1 lds
    s_add_u32 s28, s48, 2048
    s_add_u32 s29, s48, 18432
    s_add_u32 m0, s31, 16384
    s_nop 0
    buffer_load_dwordx4 v3, s[16:19], s28 offen offset:0 sc1 lds
    buffer_load_dwordx4 v3, s[16:19], s28 offen offset:1024 sc1 lds
    buffer_load_dwordx4 v3, s[16:19], s29 offen offset:2048 sc1 lds
    buffer_load_dwordx4 v3, s[16:19], s29 offen offset:3072 sc1 lds
    s_add_u32 s28, s48, 4096
    s_add_u32 s29, s48, 20480
    s_add_u32 m0, s31, 32768
    s_nop 0
    buffer_load_dwordx4 v3, s[16:19], s28 offen offset:0 sc1 lds
    buffer_load_dwordx4 v3, s[16:19], s28 offen offset:1024 sc1 lds
    buffer_load_dwordx4 v3, s[16:19], s29 offen offset:2048 sc1 lds
    buffer_load_dwordx4 v3, s[16:19], s29 offen offset:3072 sc1 lds
    v_add_u32 v5, 65536, v3
    v_add_u32 v6, 55296, v5
    v_add_u32 v4, s31, v3
    s_waitcnt vmcnt(8)
    s_barrier
    s_add_u32 s28, s48, 6144
    s_add_u32 s29, s48, 22528
    s_add_u32 m0, s31, 49152
    s_nop 0
    buffer_load_dwordx4 v3, s[16:19], s28 offen offset:0 sc1 lds
    buffer_load_dwordx4 v3, s[16:19], s28 offen offset:1024 sc1 lds
    buffer_load_dwordx4 v3, s[16:19], s29 offen offset:2048 sc1 lds
    buffer_load_dwordx4 v3, s[16:19], s29 offen offset:3072 sc1 lds
    s_add_u32 s30, s49, 2709504
    s_add_u32 m0, s32, 55296
    s_add_u32 s28, s53, 2725888
    buffer_load_dwordx4 v3, s[16:19], s30 offen offset:0 sc1 lds
    buffer_load_dwordx4 v3, s[16:19], s30 offen offset:1024 sc1 lds
    buffer_load_dwordx4 v3, s[16:19], s30 offen offset:2048 sc1 lds
    buffer_load_dwordx4 v3, s[16:19], s30 offen offset:3072 sc1 lds
    s_add_u32 m0, s33, 55296
    s_mov_b64 exec, s[36:37]
    buffer_load_dwordx4 v3, s[16:19], s28 offen sc1 lds
    s_mov_b64 exec, -1
    s_waitcnt vmcnt(12)
    s_barrier
    s_add_u32 s28, s48, 8192
    s_add_u32 s29, s48, 24576
    s_add_u32 m0, s31, 0
    s_nop 0
    buffer_load_dwordx4 v3, s[16:19], s28 offen offset:0 sc1 lds
    buffer_load_dwordx4 v3, s[16:19], s28 offen offset:1024 sc1 lds
    buffer_load_dwordx4 v3, s[16:19], s29 offen offset:2048 sc1 lds
    buffer_load_dwordx4 v3, s[16:19], s29 offen offset:3072 sc1 lds
    s_add_u32 s30, s49, 2727936
    s_add_u32 m0, s32, 0
    s_add_u32 s28, s53, 2744320
    buffer_load_dwordx4 v3, s[16:19], s30 offen offset:0 sc1 lds
    buffer_load_dwordx4 v3, s[16:19], s30 offen offset:1024 sc1 lds
    buffer_load_dwordx4 v3, s[16:19], s30 offen offset:2048 sc1 lds
    buffer_load_dwordx4 v3, s[16:19], s30 offen offset:3072 sc1 lds
    s_add_u32 m0, s33, 0
    s_mov_b64 exec, s[34:35]
    buffer_load_dwordx4 v3, s[16:19], s28 offen sc1 lds
    s_mov_b64 exec, -1
    s_waitcnt vmcnt(17)
    s_barrier
    s_add_u32 s28, s48, 10240
    s_add_u32 s29, s48, 26624
    s_add_u32 m0, s31, 16384
    s_nop 0
    buffer_load_dwordx4 v3, s[16:19], s28 offen offset:0 sc1 lds
    buffer_load_dwordx4 v3, s[16:19], s28 offen offset:1024 sc1 lds
    buffer_load_dwordx4 v3, s[16:19], s29 offen offset:2048 sc1 lds
    buffer_load_dwordx4 v3, s[16:19], s29 offen offset:3072 sc1 lds
    s_add_u32 s30, s49, 2746368
    s_add_u32 m0, s32, 18432
    s_add_u32 s28, s53, 2762752
    buffer_load_dwordx4 v3, s[16:19], s30 offen offset:0 sc1 lds
    buffer_load_dwordx4 v3, s[16:19], s30 offen offset:1024 sc1 lds
    buffer_load_dwordx4 v3, s[16:19], s30 offen offset:2048 sc1 lds
    buffer_load_dwordx4 v3, s[16:19], s30 offen offset:3072 sc1 lds
    s_add_u32 m0, s33, 18432
    s_mov_b64 exec, s[36:37]
    buffer_load_dwordx4 v3, s[16:19], s28 offen sc1 lds
    s_mov_b64 exec, -1
    s_waitcnt vmcnt(17)
    s_barrier
    s_add_u32 s28, s48, 12288
    s_add_u32 s29, s48, 28672
    s_add_u32 m0, s31, 32768
    s_nop 0
    buffer_load_dwordx4 v3, s[16:19], s28 offen offset:0 sc1 lds
    buffer_load_dwordx4 v3, s[16:19], s28 offen offset:1024 sc1 lds
    buffer_load_dwordx4 v3, s[16:19], s29 offen offset:2048 sc1 lds
    buffer_load_dwordx4 v3, s[16:19], s29 offen offset:3072 sc1 lds
    s_add_u32 s30, s49, 2764800
    s_add_u32 m0, s32, 36864
    s_add_u32 s28, s53, 2781184
    buffer_load_dwordx4 v3, s[16:19], s30 offen offset:0 sc1 lds
    buffer_load_dwordx4 v3, s[16:19], s30 offen offset:1024 sc1 lds
    buffer_load_dwordx4 v3, s[16:19], s30 offen offset:2048 sc1 lds
    buffer_load_dwordx4 v3, s[16:19], s30 offen offset:3072 sc1 lds
    s_add_u32 m0, s33, 36864
    s_mov_b64 exec, s[34:35]
    buffer_load_dwordx4 v3, s[16:19], s28 offen sc1 lds
    s_mov_b64 exec, -1
    s_waitcnt vmcnt(17)
    s_barrier
    s_add_u32 s28, s48, 14336
    s_add_u32 s29, s48, 30720
    s_add_u32 m0, s31, 49152
    s_nop 0
    buffer_load_dwordx4 v3, s[16:19], s28 offen offset:0 sc1 lds
    buffer_load_dwordx4 v3, s[16:19], s28 offen offset:1024 sc1 lds
    buffer_load_dwordx4 v3, s[16:19], s29 offen offset:2048 sc1 lds
    buffer_load_dwordx4 v3, s[16:19], s29 offen offset:3072 sc1 lds
    s_add_u32 s30, s49, 2783232
    s_add_u32 m0, s32, 55296
    s_add_u32 s28, s53, 2799616
    buffer_load_dwordx4 v3, s[16:19], s30 offen offset:0 sc1 lds
    buffer_load_dwordx4 v3, s[16:19], s30 offen offset:1024 sc1 lds
    buffer_load_dwordx4 v3, s[16:19], s30 offen offset:2048 sc1 lds
    buffer_load_dwordx4 v3, s[16:19], s30 offen offset:3072 sc1 lds
    s_add_u32 m0, s33, 55296
    s_mov_b64 exec, s[36:37]
    buffer_load_dwordx4 v3, s[16:19], s28 offen sc1 lds
    s_mov_b64 exec, -1
    s_waitcnt vmcnt(17)
    s_barrier
    s_add_u32 s28, s48, 16384
    s_add_u32 s29, s48, 32768
    s_add_u32 m0, s31, 0
    s_nop 0
    buffer_load_dwordx4 v3, s[16:19], s28 offen offset:0 sc1 lds
    buffer_load_dwordx4 v3, s[16:19], s28 offen offset:1024 sc1 lds
    buffer_load_dwordx4 v3, s[16:19], s29 offen offset:2048 sc1 lds
    buffer_load_dwordx4 v3, s[16:19], s29 offen offset:3072 sc1 lds
    s_add_u32 s30, s49, 2801664
    s_add_u32 m0, s32, 0
    s_add_u32 s28, s53, 2818048
    buffer_load_dwordx4 v3, s[16:19], s30 offen offset:0 sc1 lds
    buffer_load_dwordx4 v3, s[16:19], s30 offen offset:1024 sc1 lds
    buffer_load_dwordx4 v3, s[16:19], s30 offen offset:2048 sc1 lds
    buffer_load_dwordx4 v3, s[16:19], s30 offen offset:3072 sc1 lds
    s_add_u32 m0, s33, 0
    s_mov_b64 exec, s[34:35]
    buffer_load_dwordx4 v3, s[16:19], s28 offen sc1 lds
    s_mov_b64 exec, -1
    s_waitcnt vmcnt(17)
    s_barrier
    s_add_u32 s28, s48, 0
    s_add_u32 s29, s48, 16384
    s_add_u32 m0, s31, 16384
    s_nop 0
    buffer_load_dwordx4 v3, s[16:19], s28 offen offset:0 sc1 lds
    buffer_load_dwordx4 v3, s[16:19], s28 offen offset:1024 sc1 lds
    buffer_load_dwordx4 v3, s[16:19], s29 offen offset:2048 sc1 lds
    buffer_load_dwordx4 v3, s[16:19], s29 offen offset:3072 sc1 lds
    s_add_u32 s30, s49, 0
    s_add_u32 m0, s32, 18432
    s_add_u32 s28, s53, 16384
    buffer_load_dwordx4 v3, s[16:19], s30 offen offset:0 sc1 lds
    buffer_load_dwordx4 v3, s[16:19], s30 offen offset:1024 sc1 lds
    buffer_load_dwordx4 v3, s[16:19], s30 offen offset:2048 sc1 lds
    buffer_load_dwordx4 v3, s[16:19], s30 offen offset:3072 sc1 lds
    s_add_u32 m0, s33, 18432
    s_mov_b64 exec, s[36:37]
    buffer_load_dwordx4 v3, s[16:19], s28 offen sc1 lds
    s_mov_b64 exec, -1
    s_waitcnt vmcnt(17)
    s_barrier
    s_add_u32 s28, s48, 2048
    s_add_u32 s29, s48, 18432
    s_add_u32 m0, s31, 32768
    s_nop 0
    buffer_load_dwordx4 v3, s[16:19], s28 offen offset:0 sc1 lds
    buffer_load_dwordx4 v3, s[16:19], s28 offen offset:1024 sc1 lds
    buffer_load_dwordx4 v3, s[16:19], s29 offen offset:2048 sc1 lds
    buffer_load_dwordx4 v3, s[16:19], s29 offen offset:3072 sc1 lds
    s_add_u32 s30, s49, 18432
    s_add_u32 m0, s32, 36864
    s_add_u32 s28, s53, 34816
    buffer_load_dwordx4 v3, s[16:19], s30 offen offset:0 sc1 lds
    buffer_load_dwordx4 v3, s[16:19], s30 offen offset:1024 sc1 lds
    buffer_load_dwordx4 v3, s[16:19], s30 offen offset:2048 sc1 lds
    buffer_load_dwordx4 v3, s[16:19], s30 offen offset:3072 sc1 lds
    s_add_u32 m0, s33, 36864
    s_mov_b64 exec, s[34:35]
    buffer_load_dwordx4 v3, s[16:19], s28 offen sc1 lds
    s_mov_b64 exec, -1
    s_waitcnt vmcnt(17)
    s_barrier
    s_add_u32 s28, s48, 4096
    s_add_u32 s29, s48, 20480
    s_add_u32 m0, s31, 49152
    s_nop 0
    buffer_load_dwordx4 v3, s[16:19], s28 offen offset:0 sc1 lds
    buffer_load_dwordx4 v3, s[16:19], s28 offen offset:1024 sc1 lds
    buffer_load_dwordx4 v3, s[16:19], s29 offen offset:2048 sc1 lds
    buffer_load_dwordx4 v3, s[16:19], s29 offen offset:3072 sc1 lds
    s_add_u32 s30, s49, 36864
    s_add_u32 m0, s32, 55296
    s_add_u32 s28, s53, 53248
    buffer_load_dwordx4 v3, s[16:19], s30 offen offset:0 sc1 lds
    buffer_load_dwordx4 v3, s[16:19], s30 offen offset:1024 sc1 lds
    buffer_load_dwordx4 v3, s[16:19], s30 offen offset:2048 sc1 lds
    buffer_load_dwordx4 v3, s[16:19], s30 offen offset:3072 sc1 lds
    s_add_u32 m0, s33, 55296
    s_mov_b64 exec, s[36:37]
    buffer_load_dwordx4 v3, s[16:19], s28 offen sc1 lds
    s_mov_b64 exec, -1
    s_waitcnt vmcnt(17)
    s_barrier
    s_mov_b32 s8, s4
    s_mov_b32 s9, s5
    s_mov_b32 s10, 8388608
    s_mov_b32 s11, 0x20000
    s_lshl_b32 s38, s2, 2
    s_add_u32 s38, s38, s23
    s_lshl_b32 s38, s38, 13
    s_add_u32 s39, s38, 4096
    s_mov_b32 m0, 143360
    s_nop 0
    buffer_load_dwordx4 v3, s[8:11], s38 offen offset:0 lds
    buffer_load_dwordx4 v3, s[8:11], s38 offen offset:1024 lds
    buffer_load_dwordx4 v3, s[8:11], s38 offen offset:2048 lds
    buffer_load_dwordx4 v3, s[8:11], s38 offen offset:3072 lds
    buffer_load_dwordx4 v3, s[8:11], s39 offen offset:0 lds
    buffer_load_dwordx4 v3, s[8:11], s39 offen offset:1024 lds
    buffer_load_dwordx4 v3, s[8:11], s39 offen offset:2048 lds
    buffer_load_dwordx4 v3, s[8:11], s39 offen offset:3072 lds
    s_add_u32 s28, s48, 6144
    s_add_u32 s29, s48, 22528
    s_add_u32 m0, s31, 0
    s_nop 0
    buffer_load_dwordx4 v3, s[16:19], s28 offen offset:0 sc1 lds
    buffer_load_dwordx4 v3, s[16:19], s28 offen offset:1024 sc1 lds
    buffer_load_dwordx4 v3, s[16:19], s29 offen offset:2048 sc1 lds
    buffer_load_dwordx4 v3, s[16:19], s29 offen offset:3072 sc1 lds
    s_add_u32 s30, s49, 55296
    s_add_u32 m0, s32, 0
    s_add_u32 s28, s53, 71680
    buffer_load_dwordx4 v3, s[16:19], s30 offen offset:0 sc1 lds
    buffer_load_dwordx4 v3, s[16:19], s30 offen offset:1024 sc1 lds
    buffer_load_dwordx4 v3, s[16:19], s30 offen offset:2048 sc1 lds
    buffer_load_dwordx4 v3, s[16:19], s30 offen offset:3072 sc1 lds
    s_add_u32 m0, s33, 0
    s_mov_b64 exec, s[34:35]
    buffer_load_dwordx4 v3, s[16:19], s28 offen sc1 lds
    s_mov_b64 exec, -1
    ds_read_b128 v[88:91], v4 offset:16384
    ds_read_b128 v[92:95], v4 offset:18432
    ds_read_b128 v[96:99], v5 offset:18432
    ds_read_b128 v[100:103], v5 offset:19456
    ds_read_b128 v[104:107], v5 offset:20480
    ds_read_b128 v[108:111], v5 offset:21504
    ds_read_b128 v[112:115], v5 offset:22528
    ds_read_b128 v[116:119], v5 offset:23552
    ds_read_b128 v[120:123], v5 offset:24576
    ds_read_b128 v[124:127], v5 offset:25600
    ds_read_b128 v[128:131], v5 offset:26624
    s_mov_b32 s24, s6
    s_mov_b32 s25, s7
    s_mov_b32 s26, 4096
    s_mov_b32 s27, 0x20000
    s_lshl_b32 s38, s21, 8
    s_lshl_b32 s39, s23, 6
    s_add_u32 s38, s38, s39
    v_and_b32 v12, 15, v1
    v_lshlrev_b32 v12, 1, v12
    buffer_load_ushort v14, v12, s[24:27], s38 offen
    buffer_load_ushort v15, v12, s[24:27], s38 offen offset:32
    s_waitcnt lgkmcnt(0)
    v_mfma_f32_16x16x32_bf16 v[16:19], v[96:99], v[88:91], 0
    ds_read_b128 v[132:135], v4 offset:17408
    v_mfma_f32_16x16x32_bf16 v[52:55], v[96:99], v[92:95], 0
    ds_read_b128 v[136:139], v4 offset:19456
    v_mfma_f32_16x16x32_bf16 v[20:23], v[100:103], v[88:91], 0
    ds_read_b128 v[140:143], v5 offset:27648
    v_mfma_f32_16x16x32_bf16 v[56:59], v[100:103], v[92:95], 0
    ds_read_b128 v[144:147], v5 offset:28672
    v_mfma_f32_16x16x32_bf16 v[24:27], v[104:107], v[88:91], 0
    ds_read_b128 v[148:151], v5 offset:29696
    v_mfma_f32_16x16x32_bf16 v[60:63], v[104:107], v[92:95], 0
    ds_read_b128 v[152:155], v5 offset:30720
    v_mfma_f32_16x16x32_bf16 v[28:31], v[108:111], v[88:91], 0
    ds_read_b128 v[156:159], v5 offset:31744
    v_mfma_f32_16x16x32_bf16 v[64:67], v[108:111], v[92:95], 0
    ds_read_b128 v[160:163], v5 offset:32768
    v_mfma_f32_16x16x32_bf16 v[32:35], v[112:115], v[88:91], 0
    ds_read_b128 v[164:167], v5 offset:33792
    v_mfma_f32_16x16x32_bf16 v[68:71], v[112:115], v[92:95], 0
    ds_read_b128 v[168:171], v5 offset:34816
    v_mfma_f32_16x16x32_bf16 v[36:39], v[116:119], v[88:91], 0
    ds_read_b128 v[172:175], v5 offset:35840
    v_mfma_f32_16x16x32_bf16 v[72:75], v[116:119], v[92:95], 0
    v_mfma_f32_16x16x32_bf16 v[40:43], v[120:123], v[88:91], 0
    v_mfma_f32_16x16x32_bf16 v[76:79], v[120:123], v[92:95], 0
    v_mfma_f32_16x16x32_bf16 v[44:47], v[124:127], v[88:91], 0
    v_mfma_f32_16x16x32_bf16 v[80:83], v[124:127], v[92:95], 0
    v_mfma_f32_16x16x32_bf16 v[48:51], v[128:131], v[88:91], 0
    v_mfma_f32_16x16x32_bf16 v[84:87], v[128:131], v[92:95], 0
    s_waitcnt lgkmcnt(0) vmcnt(27)
    s_barrier
    v_mfma_f32_16x16x32_bf16 v[16:19], v[140:143], v[132:135], v[16:19]
    ds_read_b128 v[88:91], v4 offset:32768
    v_mfma_f32_16x16x32_bf16 v[52:55], v[140:143], v[136:139], v[52:55]
    ds_read_b128 v[92:95], v4 offset:34816
    v_mfma_f32_16x16x32_bf16 v[20:23], v[144:147], v[132:135], v[20:23]
    ds_read_b128 v[96:99], v5 offset:36864
    v_mfma_f32_16x16x32_bf16 v[56:59], v[144:147], v[136:139], v[56:59]
    ds_read_b128 v[100:103], v5 offset:37888
    v_mfma_f32_16x16x32_bf16 v[24:27], v[148:151], v[132:135], v[24:27]
    ds_read_b128 v[104:107], v5 offset:38912
    v_mfma_f32_16x16x32_bf16 v[60:63], v[148:151], v[136:139], v[60:63]
    ds_read_b128 v[108:111], v5 offset:39936
    v_mfma_f32_16x16x32_bf16 v[28:31], v[152:155], v[132:135], v[28:31]
    ds_read_b128 v[112:115], v5 offset:40960
    v_mfma_f32_16x16x32_bf16 v[64:67], v[152:155], v[136:139], v[64:67]
    ds_read_b128 v[116:119], v5 offset:41984
    v_mfma_f32_16x16x32_bf16 v[32:35], v[156:159], v[132:135], v[32:35]
    ds_read_b128 v[120:123], v5 offset:43008
    v_mfma_f32_16x16x32_bf16 v[68:71], v[156:159], v[136:139], v[68:71]
    ds_read_b128 v[124:127], v5 offset:44032
    v_mfma_f32_16x16x32_bf16 v[36:39], v[160:163], v[132:135], v[36:39]
    ds_read_b128 v[128:131], v5 offset:45056
    v_mfma_f32_16x16x32_bf16 v[72:75], v[160:163], v[136:139], v[72:75]
    v_mfma_f32_16x16x32_bf16 v[40:43], v[164:167], v[132:135], v[40:43]
    v_mfma_f32_16x16x32_bf16 v[76:79], v[164:167], v[136:139], v[76:79]
    v_mfma_f32_16x16x32_bf16 v[44:47], v[168:171], v[132:135], v[44:47]
    v_mfma_f32_16x16x32_bf16 v[80:83], v[168:171], v[136:139], v[80:83]
    v_mfma_f32_16x16x32_bf16 v[48:51], v[172:175], v[132:135], v[48:51]
    v_mfma_f32_16x16x32_bf16 v[84:87], v[172:175], v[136:139], v[84:87]
    s_waitcnt lgkmcnt(0)
    v_mfma_f32_16x16x32_bf16 v[16:19], v[96:99], v[88:91], v[16:19]
    ds_read_b128 v[132:135], v4 offset:33792
    v_mfma_f32_16x16x32_bf16 v[52:55], v[96:99], v[92:95], v[52:55]
    ds_read_b128 v[136:139], v4 offset:35840
    v_mfma_f32_16x16x32_bf16 v[20:23], v[100:103], v[88:91], v[20:23]
    ds_read_b128 v[140:143], v5 offset:46080
    v_mfma_f32_16x16x32_bf16 v[56:59], v[100:103], v[92:95], v[56:59]
    ds_read_b128 v[144:147], v5 offset:47104
    v_mfma_f32_16x16x32_bf16 v[24:27], v[104:107], v[88:91], v[24:27]
    ds_read_b128 v[148:151], v5 offset:48128
    v_mfma_f32_16x16x32_bf16 v[60:63], v[104:107], v[92:95], v[60:63]
    ds_read_b128 v[152:155], v5 offset:49152
    v_mfma_f32_16x16x32_bf16 v[28:31], v[108:111], v[88:91], v[28:31]
    ds_read_b128 v[156:159], v5 offset:50176
    v_mfma_f32_16x16x32_bf16 v[64:67], v[108:111], v[92:95], v[64:67]
    ds_read_b128 v[160:163], v5 offset:51200
    v_mfma_f32_16x16x32_bf16 v[32:35], v[112:115], v[88:91], v[32:35]
    ds_read_b128 v[164:167], v5 offset:52224
    v_mfma_f32_16x16x32_bf16 v[68:71], v[112:115], v[92:95], v[68:71]
    ds_read_b128 v[168:171], v5 offset:53248
    v_mfma_f32_16x16x32_bf16 v[36:39], v[116:119], v[88:91], v[36:39]
    ds_read_b128 v[172:175], v5 offset:54272
    v_mfma_f32_16x16x32_bf16 v[72:75], v[116:119], v[92:95], v[72:75]
    v_mfma_f32_16x16x32_bf16 v[40:43], v[120:123], v[88:91], v[40:43]
    v_mfma_f32_16x16x32_bf16 v[76:79], v[120:123], v[92:95], v[76:79]
    v_mfma_f32_16x16x32_bf16 v[44:47], v[124:127], v[88:91], v[44:47]
    v_mfma_f32_16x16x32_bf16 v[80:83], v[124:127], v[92:95], v[80:83]
    v_mfma_f32_16x16x32_bf16 v[48:51], v[128:131], v[88:91], v[48:51]
    v_mfma_f32_16x16x32_bf16 v[84:87], v[128:131], v[92:95], v[84:87]
    s_waitcnt lgkmcnt(0) vmcnt(18)
    s_barrier
    v_mfma_f32_16x16x32_bf16 v[16:19], v[140:143], v[132:135], v[16:19]
    ds_read_b128 v[88:91], v4 offset:49152
    v_mfma_f32_16x16x32_bf16 v[52:55], v[140:143], v[136:139], v[52:55]
    ds_read_b128 v[92:95], v4 offset:51200
    v_mfma_f32_16x16x32_bf16 v[20:23], v[144:147], v[132:135], v[20:23]
    ds_read_b128 v[96:99], v6 offset:0
    v_mfma_f32_16x16x32_bf16 v[56:59], v[144:147], v[136:139], v[56:59]
    ds_read_b128 v[100:103], v6 offset:1024
    v_mfma_f32_16x16x32_bf16 v[24:27], v[148:151], v[132:135], v[24:27]
    ds_read_b128 v[104:107], v6 offset:2048
    v_mfma_f32_16x16x32_bf16 v[60:63], v[148:151], v[136:139], v[60:63]
    ds_read_b128 v[108:111], v6 offset:3072
    v_mfma_f32_16x16x32_bf16 v[28:31], v[152:155], v[132:135], v[28:31]
    ds_read_b128 v[112:115], v6 offset:4096
    v_mfma_f32_16x16x32_bf16 v[64:67], v[152:155], v[136:139], v[64:67]
    ds_read_b128 v[116:119], v6 offset:5120
    v_mfma_f32_16x16x32_bf16 v[32:35], v[156:159], v[132:135], v[32:35]
    ds_read_b128 v[120:123], v6 offset:6144
    v_mfma_f32_16x16x32_bf16 v[68:71], v[156:159], v[136:139], v[68:71]
    ds_read_b128 v[124:127], v6 offset:7168
    v_mfma_f32_16x16x32_bf16 v[36:39], v[160:163], v[132:135], v[36:39]
    ds_read_b128 v[128:131], v6 offset:8192
    v_mfma_f32_16x16x32_bf16 v[72:75], v[160:163], v[136:139], v[72:75]
    v_mfma_f32_16x16x32_bf16 v[40:43], v[164:167], v[132:135], v[40:43]
    v_mfma_f32_16x16x32_bf16 v[76:79], v[164:167], v[136:139], v[76:79]
    v_mfma_f32_16x16x32_bf16 v[44:47], v[168:171], v[132:135], v[44:47]
    v_mfma_f32_16x16x32_bf16 v[80:83], v[168:171], v[136:139], v[80:83]
    v_mfma_f32_16x16x32_bf16 v[48:51], v[172:175], v[132:135], v[48:51]
    v_mfma_f32_16x16x32_bf16 v[84:87], v[172:175], v[136:139], v[84:87]
    s_waitcnt lgkmcnt(0)
    v_mfma_f32_16x16x32_bf16 v[16:19], v[96:99], v[88:91], v[16:19]
    ds_read_b128 v[132:135], v4 offset:50176
    v_mfma_f32_16x16x32_bf16 v[52:55], v[96:99], v[92:95], v[52:55]
    ds_read_b128 v[136:139], v4 offset:52224
    v_mfma_f32_16x16x32_bf16 v[20:23], v[100:103], v[88:91], v[20:23]
    ds_read_b128 v[140:143], v6 offset:9216
    v_mfma_f32_16x16x32_bf16 v[56:59], v[100:103], v[92:95], v[56:59]
    ds_read_b128 v[144:147], v6 offset:10240
    v_mfma_f32_16x16x32_bf16 v[24:27], v[104:107], v[88:91], v[24:27]
    ds_read_b128 v[148:151], v6 offset:11264
    v_mfma_f32_16x16x32_bf16 v[60:63], v[104:107], v[92:95], v[60:63]
    ds_read_b128 v[152:155], v6 offset:12288
    v_mfma_f32_16x16x32_bf16 v[28:31], v[108:111], v[88:91], v[28:31]
    ds_read_b128 v[156:159], v6 offset:13312
    v_mfma_f32_16x16x32_bf16 v[64:67], v[108:111], v[92:95], v[64:67]
    ds_read_b128 v[160:163], v6 offset:14336
    v_mfma_f32_16x16x32_bf16 v[32:35], v[112:115], v[88:91], v[32:35]
    ds_read_b128 v[164:167], v6 offset:15360
    v_mfma_f32_16x16x32_bf16 v[68:71], v[112:115], v[92:95], v[68:71]
    ds_read_b128 v[168:171], v6 offset:16384
    v_mfma_f32_16x16x32_bf16 v[36:39], v[116:119], v[88:91], v[36:39]
    ds_read_b128 v[172:175], v6 offset:17408
    v_mfma_f32_16x16x32_bf16 v[72:75], v[116:119], v[92:95], v[72:75]
    v_mfma_f32_16x16x32_bf16 v[40:43], v[120:123], v[88:91], v[40:43]
    v_mfma_f32_16x16x32_bf16 v[76:79], v[120:123], v[92:95], v[76:79]
    v_mfma_f32_16x16x32_bf16 v[44:47], v[124:127], v[88:91], v[44:47]
    v_mfma_f32_16x16x32_bf16 v[80:83], v[124:127], v[92:95], v[80:83]
    v_mfma_f32_16x16x32_bf16 v[48:51], v[128:131], v[88:91], v[48:51]
    v_mfma_f32_16x16x32_bf16 v[84:87], v[128:131], v[92:95], v[84:87]
    s_waitcnt lgkmcnt(0) vmcnt(2)
    s_barrier
    v_mfma_f32_16x16x32_bf16 v[16:19], v[140:143], v[132:135], v[16:19]
    ds_read_b128 v[88:91], v4 offset:0
    v_mfma_f32_16x16x32_bf16 v[52:55], v[140:143], v[136:139], v[52:55]
    ds_read_b128 v[92:95], v4 offset:2048
    v_mfma_f32_16x16x32_bf16 v[20:23], v[144:147], v[132:135], v[20:23]
    ds_read_b128 v[96:99], v5 offset:0
    v_mfma_f32_16x16x32_bf16 v[56:59], v[144:147], v[136:139], v[56:59]
    ds_read_b128 v[100:103], v5 offset:1024
    v_mfma_f32_16x16x32_bf16 v[24:27], v[148:151], v[132:135], v[24:27]
    ds_read_b128 v[104:107], v5 offset:2048
    v_mfma_f32_16x16x32_bf16 v[60:63], v[148:151], v[136:139], v[60:63]
    ds_read_b128 v[108:111], v5 offset:3072
    v_mfma_f32_16x16x32_bf16 v[28:31], v[152:155], v[132:135], v[28:31]
    ds_read_b128 v[112:115], v5 offset:4096
    v_mfma_f32_16x16x32_bf16 v[64:67], v[152:155], v[136:139], v[64:67]
    ds_read_b128 v[116:119], v5 offset:5120
    v_mfma_f32_16x16x32_bf16 v[32:35], v[156:159], v[132:135], v[32:35]
    ds_read_b128 v[120:123], v5 offset:6144
    v_mfma_f32_16x16x32_bf16 v[68:71], v[156:159], v[136:139], v[68:71]
    ds_read_b128 v[124:127], v5 offset:7168
    v_mfma_f32_16x16x32_bf16 v[36:39], v[160:163], v[132:135], v[36:39]
    ds_read_b128 v[128:131], v5 offset:8192
    v_mfma_f32_16x16x32_bf16 v[72:75], v[160:163], v[136:139], v[72:75]
    v_mfma_f32_16x16x32_bf16 v[40:43], v[164:167], v[132:135], v[40:43]
    v_mfma_f32_16x16x32_bf16 v[76:79], v[164:167], v[136:139], v[76:79]
    v_mfma_f32_16x16x32_bf16 v[44:47], v[168:171], v[132:135], v[44:47]
    v_mfma_f32_16x16x32_bf16 v[80:83], v[168:171], v[136:139], v[80:83]
    v_mfma_f32_16x16x32_bf16 v[48:51], v[172:175], v[132:135], v[48:51]
    v_mfma_f32_16x16x32_bf16 v[84:87], v[172:175], v[136:139], v[84:87]
    s_waitcnt lgkmcnt(0)
    v_mfma_f32_16x16x32_bf16 v[16:19], v[96:99], v[88:91], v[16:19]
    ds_read_b128 v[132:135], v4 offset:1024
    v_mfma_f32_16x16x32_bf16 v[52:55], v[96:99], v[92:95], v[52:55]
    ds_read_b128 v[136:139], v4 offset:3072
    v_mfma_f32_16x16x32_bf16 v[20:23], v[100:103], v[88:91], v[20:23]
    ds_read_b128 v[140:143], v5 offset:9216
    v_mfma_f32_16x16x32_bf16 v[56:59], v[100:103], v[92:95], v[56:59]
    ds_read_b128 v[144:147], v5 offset:10240
    v_mfma_f32_16x16x32_bf16 v[24:27], v[104:107], v[88:91], v[24:27]
    ds_read_b128 v[148:151], v5 offset:11264
    v_mfma_f32_16x16x32_bf16 v[60:63], v[104:107], v[92:95], v[60:63]
    ds_read_b128 v[152:155], v5 offset:12288
    v_mfma_f32_16x16x32_bf16 v[28:31], v[108:111], v[88:91], v[28:31]
    ds_read_b128 v[156:159], v5 offset:13312
    v_mfma_f32_16x16x32_bf16 v[64:67], v[108:111], v[92:95], v[64:67]
    ds_read_b128 v[160:163], v5 offset:14336
    v_mfma_f32_16x16x32_bf16 v[32:35], v[112:115], v[88:91], v[32:35]
    ds_read_b128 v[164:167], v5 offset:15360
    v_mfma_f32_16x16x32_bf16 v[68:71], v[112:115], v[92:95], v[68:71]
    ds_read_b128 v[168:171], v5 offset:16384
    v_mfma_f32_16x16x32_bf16 v[36:39], v[116:119], v[88:91], v[36:39]
    ds_read_b128 v[172:175], v5 offset:17408
    v_mfma_f32_16x16x32_bf16 v[72:75], v[116:119], v[92:95], v[72:75]
    v_mfma_f32_16x16x32_bf16 v[40:43], v[120:123], v[88:91], v[40:43]
    v_mfma_f32_16x16x32_bf16 v[76:79], v[120:123], v[92:95], v[76:79]
    v_mfma_f32_16x16x32_bf16 v[44:47], v[124:127], v[88:91], v[44:47]
    v_mfma_f32_16x16x32_bf16 v[80:83], v[124:127], v[92:95], v[80:83]
    v_mfma_f32_16x16x32_bf16 v[48:51], v[128:131], v[88:91], v[48:51]
    v_mfma_f32_16x16x32_bf16 v[84:87], v[128:131], v[92:95], v[84:87]
    s_waitcnt lgkmcnt(0)
    s_barrier
    v_mfma_f32_16x16x32_bf16 v[16:19], v[140:143], v[132:135], v[16:19]
    ds_read_b128 v[88:91], v4 offset:16384
    v_mfma_f32_16x16x32_bf16 v[52:55], v[140:143], v[136:139], v[52:55]
    ds_read_b128 v[92:95], v4 offset:18432
    v_mfma_f32_16x16x32_bf16 v[20:23], v[144:147], v[132:135], v[20:23]
    ds_read_b128 v[96:99], v5 offset:18432
    v_mfma_f32_16x16x32_bf16 v[56:59], v[144:147], v[136:139], v[56:59]
    ds_read_b128 v[100:103], v5 offset:19456
    v_mfma_f32_16x16x32_bf16 v[24:27], v[148:151], v[132:135], v[24:27]
    ds_read_b128 v[104:107], v5 offset:20480
    v_mfma_f32_16x16x32_bf16 v[60:63], v[148:151], v[136:139], v[60:63]
    ds_read_b128 v[108:111], v5 offset:21504
    v_mfma_f32_16x16x32_bf16 v[28:31], v[152:155], v[132:135], v[28:31]
    ds_read_b128 v[112:115], v5 offset:22528
    v_mfma_f32_16x16x32_bf16 v[64:67], v[152:155], v[136:139], v[64:67]
    ds_read_b128 v[116:119], v5 offset:23552
    v_mfma_f32_16x16x32_bf16 v[32:35], v[156:159], v[132:135], v[32:35]
    ds_read_b128 v[120:123], v5 offset:24576
    v_mfma_f32_16x16x32_bf16 v[68:71], v[156:159], v[136:139], v[68:71]
    ds_read_b128 v[124:127], v5 offset:25600
    v_mfma_f32_16x16x32_bf16 v[36:39], v[160:163], v[132:135], v[36:39]
    ds_read_b128 v[128:131], v5 offset:26624
    v_mfma_f32_16x16x32_bf16 v[72:75], v[160:163], v[136:139], v[72:75]
    v_mfma_f32_16x16x32_bf16 v[40:43], v[164:167], v[132:135], v[40:43]
    v_mfma_f32_16x16x32_bf16 v[76:79], v[164:167], v[136:139], v[76:79]
    v_mfma_f32_16x16x32_bf16 v[44:47], v[168:171], v[132:135], v[44:47]
    v_mfma_f32_16x16x32_bf16 v[80:83], v[168:171], v[136:139], v[80:83]
    v_mfma_f32_16x16x32_bf16 v[48:51], v[172:175], v[132:135], v[48:51]
    v_mfma_f32_16x16x32_bf16 v[84:87], v[172:175], v[136:139], v[84:87]
    s_waitcnt lgkmcnt(0)
    v_mfma_f32_16x16x32_bf16 v[16:19], v[96:99], v[88:91], v[16:19]
    ds_read_b128 v[132:135], v4 offset:17408
    v_mfma_f32_16x16x32_bf16 v[52:55], v[96:99], v[92:95], v[52:55]
    ds_read_b128 v[136:139], v4 offset:19456
    v_mfma_f32_16x16x32_bf16 v[20:23], v[100:103], v[88:91], v[20:23]
    ds_read_b128 v[140:143], v5 offset:27648
    v_mfma_f32_16x16x32_bf16 v[56:59], v[100:103], v[92:95], v[56:59]
    ds_read_b128 v[144:147], v5 offset:28672
    v_mfma_f32_16x16x32_bf16 v[24:27], v[104:107], v[88:91], v[24:27]
    ds_read_b128 v[148:151], v5 offset:29696
    v_mfma_f32_16x16x32_bf16 v[60:63], v[104:107], v[92:95], v[60:63]
    ds_read_b128 v[152:155], v5 offset:30720
    v_mfma_f32_16x16x32_bf16 v[28:31], v[108:111], v[88:91], v[28:31]
    ds_read_b128 v[156:159], v5 offset:31744
    v_mfma_f32_16x16x32_bf16 v[64:67], v[108:111], v[92:95], v[64:67]
    ds_read_b128 v[160:163], v5 offset:32768
    v_mfma_f32_16x16x32_bf16 v[32:35], v[112:115], v[88:91], v[32:35]
    ds_read_b128 v[164:167], v5 offset:33792
    v_mfma_f32_16x16x32_bf16 v[68:71], v[112:115], v[92:95], v[68:71]
    ds_read_b128 v[168:171], v5 offset:34816
    v_mfma_f32_16x16x32_bf16 v[36:39], v[116:119], v[88:91], v[36:39]
    ds_read_b128 v[172:175], v5 offset:35840
    v_mfma_f32_16x16x32_bf16 v[72:75], v[116:119], v[92:95], v[72:75]
    v_mfma_f32_16x16x32_bf16 v[40:43], v[120:123], v[88:91], v[40:43]
    v_mfma_f32_16x16x32_bf16 v[76:79], v[120:123], v[92:95], v[76:79]
    v_mfma_f32_16x16x32_bf16 v[44:47], v[124:127], v[88:91], v[44:47]
    v_mfma_f32_16x16x32_bf16 v[80:83], v[124:127], v[92:95], v[80:83]
    v_mfma_f32_16x16x32_bf16 v[48:51], v[128:131], v[88:91], v[48:51]
    v_mfma_f32_16x16x32_bf16 v[84:87], v[128:131], v[92:95], v[84:87]
    s_waitcnt lgkmcnt(0)
    s_barrier
    v_mfma_f32_16x16x32_bf16 v[16:19], v[140:143], v[132:135], v[16:19]
    ds_read_b128 v[88:91], v4 offset:32768
    v_mfma_f32_16x16x32_bf16 v[52:55], v[140:143], v[136:139], v[52:55]
    ds_read_b128 v[92:95], v4 offset:34816
    v_mfma_f32_16x16x32_bf16 v[20:23], v[144:147], v[132:135], v[20:23]
    ds_read_b128 v[96:99], v5 offset:36864
    v_mfma_f32_16x16x32_bf16 v[56:59], v[144:147], v[136:139], v[56:59]
    ds_read_b128 v[100:103], v5 offset:37888
    v_mfma_f32_16x16x32_bf16 v[24:27], v[148:151], v[132:135], v[24:27]
    ds_read_b128 v[104:107], v5 offset:38912
    v_mfma_f32_16x16x32_bf16 v[60:63], v[148:151], v[136:139], v[60:63]
    ds_read_b128 v[108:111], v5 offset:39936
    v_mfma_f32_16x16x32_bf16 v[28:31], v[152:155], v[132:135], v[28:31]
    ds_read_b128 v[112:115], v5 offset:40960
    v_mfma_f32_16x16x32_bf16 v[64:67], v[152:155], v[136:139], v[64:67]
    ds_read_b128 v[116:119], v5 offset:41984
    v_mfma_f32_16x16x32_bf16 v[32:35], v[156:159], v[132:135], v[32:35]
    ds_read_b128 v[120:123], v5 offset:43008
    v_mfma_f32_16x16x32_bf16 v[68:71], v[156:159], v[136:139], v[68:71]
    ds_read_b128 v[124:127], v5 offset:44032
    v_mfma_f32_16x16x32_bf16 v[36:39], v[160:163], v[132:135], v[36:39]
    ds_read_b128 v[128:131], v5 offset:45056
    v_mfma_f32_16x16x32_bf16 v[72:75], v[160:163], v[136:139], v[72:75]
    v_mfma_f32_16x16x32_bf16 v[40:43], v[164:167], v[132:135], v[40:43]
    v_mfma_f32_16x16x32_bf16 v[76:79], v[164:167], v[136:139], v[76:79]
    v_mfma_f32_16x16x32_bf16 v[44:47], v[168:171], v[132:135], v[44:47]
    v_mfma_f32_16x16x32_bf16 v[80:83], v[168:171], v[136:139], v[80:83]
    v_mfma_f32_16x16x32_bf16 v[48:51], v[172:175], v[132:135], v[48:51]
    v_mfma_f32_16x16x32_bf16 v[84:87], v[172:175], v[136:139], v[84:87]
    s_waitcnt lgkmcnt(0)
    v_mfma_f32_16x16x32_bf16 v[16:19], v[96:99], v[88:91], v[16:19]
    ds_read_b128 v[132:135], v4 offset:33792
    v_mfma_f32_16x16x32_bf16 v[52:55], v[96:99], v[92:95], v[52:55]
    ds_read_b128 v[136:139], v4 offset:35840
    v_mfma_f32_16x16x32_bf16 v[20:23], v[100:103], v[88:91], v[20:23]
    ds_read_b128 v[140:143], v5 offset:46080
    v_mfma_f32_16x16x32_bf16 v[56:59], v[100:103], v[92:95], v[56:59]
    ds_read_b128 v[144:147], v5 offset:47104
    v_mfma_f32_16x16x32_bf16 v[24:27], v[104:107], v[88:91], v[24:27]
    ds_read_b128 v[148:151], v5 offset:48128
    v_mfma_f32_16x16x32_bf16 v[60:63], v[104:107], v[92:95], v[60:63]
    ds_read_b128 v[152:155], v5 offset:49152
    v_mfma_f32_16x16x32_bf16 v[28:31], v[108:111], v[88:91], v[28:31]
    ds_read_b128 v[156:159], v5 offset:50176
    v_mfma_f32_16x16x32_bf16 v[64:67], v[108:111], v[92:95], v[64:67]
    ds_read_b128 v[160:163], v5 offset:51200
    v_mfma_f32_16x16x32_bf16 v[32:35], v[112:115], v[88:91], v[32:35]
    ds_read_b128 v[164:167], v5 offset:52224
    v_mfma_f32_16x16x32_bf16 v[68:71], v[112:115], v[92:95], v[68:71]
    ds_read_b128 v[168:171], v5 offset:53248
    v_mfma_f32_16x16x32_bf16 v[36:39], v[116:119], v[88:91], v[36:39]
    ds_read_b128 v[172:175], v5 offset:54272
    v_mfma_f32_16x16x32_bf16 v[72:75], v[116:119], v[92:95], v[72:75]
    v_mfma_f32_16x16x32_bf16 v[40:43], v[120:123], v[88:91], v[40:43]
    v_mfma_f32_16x16x32_bf16 v[76:79], v[120:123], v[92:95], v[76:79]
    v_mfma_f32_16x16x32_bf16 v[44:47], v[124:127], v[88:91], v[44:47]
    v_mfma_f32_16x16x32_bf16 v[80:83], v[124:127], v[92:95], v[80:83]
    v_mfma_f32_16x16x32_bf16 v[48:51], v[128:131], v[88:91], v[48:51]
    v_mfma_f32_16x16x32_bf16 v[84:87], v[128:131], v[92:95], v[84:87]
    s_waitcnt lgkmcnt(0)
    s_barrier
    v_mfma_f32_16x16x32_bf16 v[16:19], v[140:143], v[132:135], v[16:19]
    ds_read_b128 v[88:91], v4 offset:49152
    v_mfma_f32_16x16x32_bf16 v[52:55], v[140:143], v[136:139], v[52:55]
    ds_read_b128 v[92:95], v4 offset:51200
    v_mfma_f32_16x16x32_bf16 v[20:23], v[144:147], v[132:135], v[20:23]
    ds_read_b128 v[96:99], v6 offset:0
    v_mfma_f32_16x16x32_bf16 v[56:59], v[144:147], v[136:139], v[56:59]
    ds_read_b128 v[100:103], v6 offset:1024
    v_mfma_f32_16x16x32_bf16 v[24:27], v[148:151], v[132:135], v[24:27]
    ds_read_b128 v[104:107], v6 offset:2048
    v_mfma_f32_16x16x32_bf16 v[60:63], v[148:151], v[136:139], v[60:63]
    ds_read_b128 v[108:111], v6 offset:3072
    v_mfma_f32_16x16x32_bf16 v[28:31], v[152:155], v[132:135], v[28:31]
    ds_read_b128 v[112:115], v6 offset:4096
    v_mfma_f32_16x16x32_bf16 v[64:67], v[152:155], v[136:139], v[64:67]
    ds_read_b128 v[116:119], v6 offset:5120
    v_mfma_f32_16x16x32_bf16 v[32:35], v[156:159], v[132:135], v[32:35]
    ds_read_b128 v[120:123], v6 offset:6144
    v_mfma_f32_16x16x32_bf16 v[68:71], v[156:159], v[136:139], v[68:71]
    ds_read_b128 v[124:127], v6 offset:7168
    v_mfma_f32_16x16x32_bf16 v[36:39], v[160:163], v[132:135], v[36:39]
    ds_read_b128 v[128:131], v6 offset:8192
    v_mfma_f32_16x16x32_bf16 v[72:75], v[160:163], v[136:139], v[72:75]
    v_mfma_f32_16x16x32_bf16 v[40:43], v[164:167], v[132:135], v[40:43]
    v_mfma_f32_16x16x32_bf16 v[76:79], v[164:167], v[136:139], v[76:79]
    v_mfma_f32_16x16x32_bf16 v[44:47], v[168:171], v[132:135], v[44:47]
    v_mfma_f32_16x16x32_bf16 v[80:83], v[168:171], v[136:139], v[80:83]
    v_mfma_f32_16x16x32_bf16 v[48:51], v[172:175], v[132:135], v[48:51]
    v_mfma_f32_16x16x32_bf16 v[84:87], v[172:175], v[136:139], v[84:87]
    s_waitcnt lgkmcnt(0)
    v_mfma_f32_16x16x32_bf16 v[16:19], v[96:99], v[88:91], v[16:19]
    ds_read_b128 v[132:135], v4 offset:50176
    v_mfma_f32_16x16x32_bf16 v[52:55], v[96:99], v[92:95], v[52:55]
    ds_read_b128 v[136:139], v4 offset:52224
    v_mfma_f32_16x16x32_bf16 v[20:23], v[100:103], v[88:91], v[20:23]
    ds_read_b128 v[140:143], v6 offset:9216
    v_mfma_f32_16x16x32_bf16 v[56:59], v[100:103], v[92:95], v[56:59]
    ds_read_b128 v[144:147], v6 offset:10240
    v_mfma_f32_16x16x32_bf16 v[24:27], v[104:107], v[88:91], v[24:27]
    ds_read_b128 v[148:151], v6 offset:11264
    v_mfma_f32_16x16x32_bf16 v[60:63], v[104:107], v[92:95], v[60:63]
    ds_read_b128 v[152:155], v6 offset:12288
    v_mfma_f32_16x16x32_bf16 v[28:31], v[108:111], v[88:91], v[28:31]
    ds_read_b128 v[156:159], v6 offset:13312
    v_mfma_f32_16x16x32_bf16 v[64:67], v[108:111], v[92:95], v[64:67]
    ds_read_b128 v[160:163], v6 offset:14336
    v_mfma_f32_16x16x32_bf16 v[32:35], v[112:115], v[88:91], v[32:35]
    ds_read_b128 v[164:167], v6 offset:15360
    v_mfma_f32_16x16x32_bf16 v[68:71], v[112:115], v[92:95], v[68:71]
    ds_read_b128 v[168:171], v6 offset:16384
    v_mfma_f32_16x16x32_bf16 v[36:39], v[116:119], v[88:91], v[36:39]
    ds_read_b128 v[172:175], v6 offset:17408
    v_mfma_f32_16x16x32_bf16 v[72:75], v[116:119], v[92:95], v[72:75]
    v_mfma_f32_16x16x32_bf16 v[40:43], v[120:123], v[88:91], v[40:43]
    v_mfma_f32_16x16x32_bf16 v[76:79], v[120:123], v[92:95], v[76:79]
    v_mfma_f32_16x16x32_bf16 v[44:47], v[124:127], v[88:91], v[44:47]
    v_mfma_f32_16x16x32_bf16 v[80:83], v[124:127], v[92:95], v[80:83]
    v_mfma_f32_16x16x32_bf16 v[48:51], v[128:131], v[88:91], v[48:51]
    v_mfma_f32_16x16x32_bf16 v[84:87], v[128:131], v[92:95], v[84:87]
    s_waitcnt lgkmcnt(0)
    s_barrier
    v_mfma_f32_16x16x32_bf16 v[16:19], v[140:143], v[132:135], v[16:19]
    ds_read_b128 v[88:91], v4 offset:0
    v_mfma_f32_16x16x32_bf16 v[52:55], v[140:143], v[136:139], v[52:55]
    ds_read_b128 v[92:95], v4 offset:2048
    v_mfma_f32_16x16x32_bf16 v[20:23], v[144:147], v[132:135], v[20:23]
    ds_read_b128 v[96:99], v5 offset:0
    v_mfma_f32_16x16x32_bf16 v[56:59], v[144:147], v[136:139], v[56:59]
    ds_read_b128 v[100:103], v5 offset:1024
    v_mfma_f32_16x16x32_bf16 v[24:27], v[148:151], v[132:135], v[24:27]
    ds_read_b128 v[104:107], v5 offset:2048
    v_mfma_f32_16x16x32_bf16 v[60:63], v[148:151], v[136:139], v[60:63]
    ds_read_b128 v[108:111], v5 offset:3072
    v_mfma_f32_16x16x32_bf16 v[28:31], v[152:155], v[132:135], v[28:31]
    ds_read_b128 v[112:115], v5 offset:4096
    v_mfma_f32_16x16x32_bf16 v[64:67], v[152:155], v[136:139], v[64:67]
    ds_read_b128 v[116:119], v5 offset:5120
    v_mfma_f32_16x16x32_bf16 v[32:35], v[156:159], v[132:135], v[32:35]
    ds_read_b128 v[120:123], v5 offset:6144
    v_mfma_f32_16x16x32_bf16 v[68:71], v[156:159], v[136:139], v[68:71]
    ds_read_b128 v[124:127], v5 offset:7168
    v_mfma_f32_16x16x32_bf16 v[36:39], v[160:163], v[132:135], v[36:39]
    ds_read_b128 v[128:131], v5 offset:8192
    v_mfma_f32_16x16x32_bf16 v[72:75], v[160:163], v[136:139], v[72:75]
    v_mfma_f32_16x16x32_bf16 v[40:43], v[164:167], v[132:135], v[40:43]
    v_mfma_f32_16x16x32_bf16 v[76:79], v[164:167], v[136:139], v[76:79]
    v_mfma_f32_16x16x32_bf16 v[44:47], v[168:171], v[132:135], v[44:47]
    v_mfma_f32_16x16x32_bf16 v[80:83], v[168:171], v[136:139], v[80:83]
    v_mfma_f32_16x16x32_bf16 v[48:51], v[172:175], v[132:135], v[48:51]
    v_mfma_f32_16x16x32_bf16 v[84:87], v[172:175], v[136:139], v[84:87]
    s_waitcnt lgkmcnt(0)
    v_mfma_f32_16x16x32_bf16 v[16:19], v[96:99], v[88:91], v[16:19]
    ds_read_b128 v[132:135], v4 offset:1024
    v_mfma_f32_16x16x32_bf16 v[52:55], v[96:99], v[92:95], v[52:55]
    ds_read_b128 v[136:139], v4 offset:3072
    v_mfma_f32_16x16x32_bf16 v[20:23], v[100:103], v[88:91], v[20:23]
    ds_read_b128 v[140:143], v5 offset:9216
    v_mfma_f32_16x16x32_bf16 v[56:59], v[100:103], v[92:95], v[56:59]
    ds_read_b128 v[144:147], v5 offset:10240
    v_mfma_f32_16x16x32_bf16 v[24:27], v[104:107], v[88:91], v[24:27]
    ds_read_b128 v[148:151], v5 offset:11264
    v_mfma_f32_16x16x32_bf16 v[60:63], v[104:107], v[92:95], v[60:63]
    ds_read_b128 v[152:155], v5 offset:12288
    v_mfma_f32_16x16x32_bf16 v[28:31], v[108:111], v[88:91], v[28:31]
    ds_read_b128 v[156:159], v5 offset:13312
    v_mfma_f32_16x16x32_bf16 v[64:67], v[108:111], v[92:95], v[64:67]
    ds_read_b128 v[160:163], v5 offset:14336
    v_mfma_f32_16x16x32_bf16 v[32:35], v[112:115], v[88:91], v[32:35]
    ds_read_b128 v[164:167], v5 offset:15360
    v_mfma_f32_16x16x32_bf16 v[68:71], v[112:115], v[92:95], v[68:71]
    ds_read_b128 v[168:171], v5 offset:16384
    v_mfma_f32_16x16x32_bf16 v[36:39], v[116:119], v[88:91], v[36:39]
    ds_read_b128 v[172:175], v5 offset:17408
    v_mfma_f32_16x16x32_bf16 v[72:75], v[116:119], v[92:95], v[72:75]
    v_mfma_f32_16x16x32_bf16 v[40:43], v[120:123], v[88:91], v[40:43]
    v_mfma_f32_16x16x32_bf16 v[76:79], v[120:123], v[92:95], v[76:79]
    v_mfma_f32_16x16x32_bf16 v[44:47], v[124:127], v[88:91], v[44:47]
    v_mfma_f32_16x16x32_bf16 v[80:83], v[124:127], v[92:95], v[80:83]
    v_mfma_f32_16x16x32_bf16 v[48:51], v[128:131], v[88:91], v[48:51]
    v_mfma_f32_16x16x32_bf16 v[84:87], v[128:131], v[92:95], v[84:87]
    s_waitcnt lgkmcnt(0)
    s_barrier
    v_mfma_f32_16x16x32_bf16 v[16:19], v[140:143], v[132:135], v[16:19]
    ds_read_b128 v[88:91], v4 offset:16384
    v_mfma_f32_16x16x32_bf16 v[52:55], v[140:143], v[136:139], v[52:55]
    ds_read_b128 v[92:95], v4 offset:18432
    v_mfma_f32_16x16x32_bf16 v[20:23], v[144:147], v[132:135], v[20:23]
    ds_read_b128 v[96:99], v5 offset:18432
    v_mfma_f32_16x16x32_bf16 v[56:59], v[144:147], v[136:139], v[56:59]
    ds_read_b128 v[100:103], v5 offset:19456
    v_mfma_f32_16x16x32_bf16 v[24:27], v[148:151], v[132:135], v[24:27]
    ds_read_b128 v[104:107], v5 offset:20480
    v_mfma_f32_16x16x32_bf16 v[60:63], v[148:151], v[136:139], v[60:63]
    ds_read_b128 v[108:111], v5 offset:21504
    v_mfma_f32_16x16x32_bf16 v[28:31], v[152:155], v[132:135], v[28:31]
    ds_read_b128 v[112:115], v5 offset:22528
    v_mfma_f32_16x16x32_bf16 v[64:67], v[152:155], v[136:139], v[64:67]
    ds_read_b128 v[116:119], v5 offset:23552
    v_mfma_f32_16x16x32_bf16 v[32:35], v[156:159], v[132:135], v[32:35]
    ds_read_b128 v[120:123], v5 offset:24576
    v_mfma_f32_16x16x32_bf16 v[68:71], v[156:159], v[136:139], v[68:71]
    ds_read_b128 v[124:127], v5 offset:25600
    v_mfma_f32_16x16x32_bf16 v[36:39], v[160:163], v[132:135], v[36:39]
    ds_read_b128 v[128:131], v5 offset:26624
    v_mfma_f32_16x16x32_bf16 v[72:75], v[160:163], v[136:139], v[72:75]
    v_mfma_f32_16x16x32_bf16 v[40:43], v[164:167], v[132:135], v[40:43]
    v_mfma_f32_16x16x32_bf16 v[76:79], v[164:167], v[136:139], v[76:79]
    v_mfma_f32_16x16x32_bf16 v[44:47], v[168:171], v[132:135], v[44:47]
    v_mfma_f32_16x16x32_bf16 v[80:83], v[168:171], v[136:139], v[80:83]
    v_mfma_f32_16x16x32_bf16 v[48:51], v[172:175], v[132:135], v[48:51]
    v_mfma_f32_16x16x32_bf16 v[84:87], v[172:175], v[136:139], v[84:87]
    s_lshl_b32 s38, s23, 8
    s_add_u32 s38, s38, 139264
    v_and_b32 v8, 15, v1
    v_lshl_add_u32 v8, v8, 2, s38
    v_lshrrev_b32 v9, 4, v1
    v_lshlrev_b32 v9, 4, v9
    v_add_u32 v9, 140288, v9
    s_waitcnt lgkmcnt(0)
    v_mfma_f32_16x16x32_bf16 v[16:19], v[96:99], v[88:91], v[16:19]
    ds_read_b128 v[132:135], v4 offset:17408
    v_mfma_f32_16x16x32_bf16 v[52:55], v[96:99], v[92:95], v[52:55]
    ds_read_b128 v[136:139], v4 offset:19456
    v_mfma_f32_16x16x32_bf16 v[20:23], v[100:103], v[88:91], v[20:23]
    ds_read_b128 v[140:143], v5 offset:27648
    v_mfma_f32_16x16x32_bf16 v[56:59], v[100:103], v[92:95], v[56:59]
    ds_read_b128 v[144:147], v5 offset:28672
    v_mfma_f32_16x16x32_bf16 v[24:27], v[104:107], v[88:91], v[24:27]
    ds_read_b128 v[148:151], v5 offset:29696
    v_mfma_f32_16x16x32_bf16 v[60:63], v[104:107], v[92:95], v[60:63]
    ds_read_b128 v[152:155], v5 offset:30720
    v_mfma_f32_16x16x32_bf16 v[28:31], v[108:111], v[88:91], v[28:31]
    ds_read_b128 v[156:159], v5 offset:31744
    v_mfma_f32_16x16x32_bf16 v[64:67], v[108:111], v[92:95], v[64:67]
    ds_read_b128 v[160:163], v5 offset:32768
    v_mfma_f32_16x16x32_bf16 v[32:35], v[112:115], v[88:91], v[32:35]
    ds_read_b128 v[164:167], v5 offset:33792
    v_mfma_f32_16x16x32_bf16 v[68:71], v[112:115], v[92:95], v[68:71]
    ds_read_b128 v[168:171], v5 offset:34816
    v_mfma_f32_16x16x32_bf16 v[36:39], v[116:119], v[88:91], v[36:39]
    ds_read_b128 v[172:175], v5 offset:35840
    v_mfma_f32_16x16x32_bf16 v[72:75], v[116:119], v[92:95], v[72:75]
    v_mfma_f32_16x16x32_bf16 v[40:43], v[120:123], v[88:91], v[40:43]
    v_mfma_f32_16x16x32_bf16 v[76:79], v[120:123], v[92:95], v[76:79]
    v_mfma_f32_16x16x32_bf16 v[44:47], v[124:127], v[88:91], v[44:47]
    v_mfma_f32_16x16x32_bf16 v[80:83], v[124:127], v[92:95], v[80:83]
    v_mfma_f32_16x16x32_bf16 v[48:51], v[128:131], v[88:91], v[48:51]
    v_mfma_f32_16x16x32_bf16 v[84:87], v[128:131], v[92:95], v[84:87]
    s_waitcnt lgkmcnt(0)
    v_mfma_f32_16x16x32_bf16 v[16:19], v[140:143], v[132:135], v[16:19]
    ds_read2_b32 v[240:241], v8 offset0:0 offset1:16
    v_mfma_f32_16x16x32_bf16 v[52:55], v[140:143], v[136:139], v[52:55]
    ds_read2_b32 v[10:11], v8 offset0:32 offset1:48
    v_mfma_f32_16x16x32_bf16 v[20:23], v[144:147], v[132:135], v[20:23]
    v_mfma_f32_16x16x32_bf16 v[56:59], v[144:147], v[136:139], v[56:59]
    ds_read_b128 v[88:91], v9 offset:0
    v_mfma_f32_16x16x32_bf16 v[24:27], v[148:151], v[132:135], v[24:27]
    ds_read_b128 v[92:95], v9 offset:64
    v_mfma_f32_16x16x32_bf16 v[60:63], v[148:151], v[136:139], v[60:63]
    v_mfma_f32_16x16x32_bf16 v[28:31], v[152:155], v[132:135], v[28:31]
    ds_read_b128 v[96:99], v9 offset:128
    v_mfma_f32_16x16x32_bf16 v[64:67], v[152:155], v[136:139], v[64:67]
    v_mfma_f32_16x16x32_bf16 v[32:35], v[156:159], v[132:135], v[32:35]
    ds_read_b128 v[100:103], v9 offset:192
    v_mfma_f32_16x16x32_bf16 v[68:71], v[156:159], v[136:139], v[68:71]
    ds_read_b128 v[104:107], v9 offset:256
    v_mfma_f32_16x16x32_bf16 v[36:39], v[160:163], v[132:135], v[36:39]
    v_mfma_f32_16x16x32_bf16 v[72:75], v[160:163], v[136:139], v[72:75]
    ds_read_b128 v[108:111], v9 offset:320
    v_mfma_f32_16x16x32_bf16 v[40:43], v[164:167], v[132:135], v[40:43]
    v_mfma_f32_16x16x32_bf16 v[76:79], v[164:167], v[136:139], v[76:79]
    ds_read_b128 v[112:115], v9 offset:384
    v_mfma_f32_16x16x32_bf16 v[44:47], v[168:171], v[132:135], v[44:47]
    ds_read_b128 v[116:119], v9 offset:448
    v_mfma_f32_16x16x32_bf16 v[80:83], v[168:171], v[136:139], v[80:83]
    v_mfma_f32_16x16x32_bf16 v[48:51], v[172:175], v[132:135], v[48:51]
    ds_read_b128 v[120:123], v9 offset:512
    v_mfma_f32_16x16x32_bf16 v[84:87], v[172:175], v[136:139], v[84:87]
    s_waitcnt lgkmcnt(0)
    s_nop 0
    v_pk_fma_f32 v[16:17], v[88:89], v[10:11], v[16:17] op_sel:[0,0,0] op_sel_hi:[1,0,1]
    v_pk_fma_f32 v[20:21], v[92:93], v[10:11], v[20:21] op_sel:[0,0,0] op_sel_hi:[1,0,1]
    v_pk_fma_f32 v[18:19], v[90:91], v[10:11], v[18:19] op_sel:[0,0,0] op_sel_hi:[1,0,1]
    v_pk_fma_f32 v[22:23], v[94:95], v[10:11], v[22:23] op_sel:[0,0,0] op_sel_hi:[1,0,1]
    v_pk_mul_f32 v[16:17], v[16:17], v[240:241] op_sel:[0,0] op_sel_hi:[1,0]
    v_pk_mul_f32 v[20:21], v[20:21], v[240:241] op_sel:[0,0] op_sel_hi:[1,0]
    v_pk_mul_f32 v[18:19], v[18:19], v[240:241] op_sel:[0,0] op_sel_hi:[1,0]
    v_pk_mul_f32 v[22:23], v[22:23], v[240:241] op_sel:[0,0] op_sel_hi:[1,0]
    v_pk_mul_f32 v[242:243], v[16:17], v[16:17]
    v_pk_mul_f32 v[246:247], v[20:21], v[20:21]
    v_pk_mul_f32 v[244:245], v[18:19], v[18:19]
    v_pk_mul_f32 v[248:249], v[22:23], v[22:23]
    v_pk_fma_f32 v[242:243], v[242:243], s[46:47], s[46:47] op_sel:[0,0,1] op_sel_hi:[1,0,1]
    v_pk_fma_f32 v[246:247], v[246:247], s[46:47], s[46:47] op_sel:[0,0,1] op_sel_hi:[1,0,1]
    v_pk_fma_f32 v[244:245], v[244:245], s[46:47], s[46:47] op_sel:[0,0,1] op_sel_hi:[1,0,1]
    v_pk_fma_f32 v[248:249], v[248:249], s[46:47], s[46:47] op_sel:[0,0,1] op_sel_hi:[1,0,1]
    v_pk_mul_f32 v[242:243], v[242:243], v[16:17]
    v_pk_mul_f32 v[246:247], v[246:247], v[20:21]
    v_pk_mul_f32 v[244:245], v[244:245], v[18:19]
    v_pk_mul_f32 v[248:249], v[248:249], v[22:23]
    v_exp_f32 v242, v242
    v_exp_f32 v246, v246
    v_exp_f32 v243, v243
    v_exp_f32 v247, v247
    v_exp_f32 v244, v244
    v_exp_f32 v248, v248
    v_exp_f32 v245, v245
    v_exp_f32 v249, v249
    v_pk_add_f32 v[242:243], v[242:243], 1.0 op_sel_hi:[1,0]
    v_pk_add_f32 v[246:247], v[246:247], 1.0 op_sel_hi:[1,0]
    v_pk_add_f32 v[244:245], v[244:245], 1.0 op_sel_hi:[1,0]
    v_pk_add_f32 v[248:249], v[248:249], 1.0 op_sel_hi:[1,0]
    v_rcp_f32 v242, v242
    v_rcp_f32 v246, v246
    v_rcp_f32 v243, v243
    v_rcp_f32 v247, v247
    v_rcp_f32 v244, v244
    v_rcp_f32 v248, v248
    v_rcp_f32 v245, v245
    v_rcp_f32 v249, v249
    v_pk_mul_f32 v[16:17], v[16:17], v[242:243]
    v_pk_mul_f32 v[20:21], v[20:21], v[246:247]
    v_pk_mul_f32 v[18:19], v[18:19], v[244:245]
    v_pk_mul_f32 v[22:23], v[22:23], v[248:249]
    v_cvt_pk_bf16_f32 v176, v16, v17
    v_cvt_pk_bf16_f32 v178, v20, v21
    v_cvt_pk_bf16_f32 v177, v18, v19
    v_cvt_pk_bf16_f32 v179, v22, v23
    v_pk_fma_f32 v[24:25], v[96:97], v[10:11], v[24:25] op_sel:[0,0,0] op_sel_hi:[1,0,1]
    v_pk_fma_f32 v[28:29], v[100:101], v[10:11], v[28:29] op_sel:[0,0,0] op_sel_hi:[1,0,1]
    v_pk_fma_f32 v[26:27], v[98:99], v[10:11], v[26:27] op_sel:[0,0,0] op_sel_hi:[1,0,1]
    v_pk_fma_f32 v[30:31], v[102:103], v[10:11], v[30:31] op_sel:[0,0,0] op_sel_hi:[1,0,1]
    v_pk_mul_f32 v[24:25], v[24:25], v[240:241] op_sel:[0,0] op_sel_hi:[1,0]
    v_pk_mul_f32 v[28:29], v[28:29], v[240:241] op_sel:[0,0] op_sel_hi:[1,0]
    v_pk_mul_f32 v[26:27], v[26:27], v[240:241] op_sel:[0,0] op_sel_hi:[1,0]
    v_pk_mul_f32 v[30:31], v[30:31], v[240:241] op_sel:[0,0] op_sel_hi:[1,0]
    v_pk_mul_f32 v[242:243], v[24:25], v[24:25]
    v_pk_mul_f32 v[246:247], v[28:29], v[28:29]
    v_pk_mul_f32 v[244:245], v[26:27], v[26:27]
    v_pk_mul_f32 v[248:249], v[30:31], v[30:31]
    v_pk_fma_f32 v[242:243], v[242:243], s[46:47], s[46:47] op_sel:[0,0,1] op_sel_hi:[1,0,1]
    v_pk_fma_f32 v[246:247], v[246:247], s[46:47], s[46:47] op_sel:[0,0,1] op_sel_hi:[1,0,1]
    v_pk_fma_f32 v[244:245], v[244:245], s[46:47], s[46:47] op_sel:[0,0,1] op_sel_hi:[1,0,1]
    v_pk_fma_f32 v[248:249], v[248:249], s[46:47], s[46:47] op_sel:[0,0,1] op_sel_hi:[1,0,1]
    v_pk_mul_f32 v[242:243], v[242:243], v[24:25]
    v_pk_mul_f32 v[246:247], v[246:247], v[28:29]
    v_pk_mul_f32 v[244:245], v[244:245], v[26:27]
    v_pk_mul_f32 v[248:249], v[248:249], v[30:31]
    v_exp_f32 v242, v242
    v_exp_f32 v246, v246
    v_exp_f32 v243, v243
    v_exp_f32 v247, v247
    v_exp_f32 v244, v244
    v_exp_f32 v248, v248
    v_exp_f32 v245, v245
    v_exp_f32 v249, v249
    v_pk_add_f32 v[242:243], v[242:243], 1.0 op_sel_hi:[1,0]
    v_pk_add_f32 v[246:247], v[246:247], 1.0 op_sel_hi:[1,0]
    v_pk_add_f32 v[244:245], v[244:245], 1.0 op_sel_hi:[1,0]
    v_pk_add_f32 v[248:249], v[248:249], 1.0 op_sel_hi:[1,0]
    v_rcp_f32 v242, v242
    v_rcp_f32 v246, v246
    v_rcp_f32 v243, v243
    v_rcp_f32 v247, v247
    v_rcp_f32 v244, v244
    v_rcp_f32 v248, v248
    v_rcp_f32 v245, v245
    v_rcp_f32 v249, v249
    v_pk_mul_f32 v[24:25], v[24:25], v[242:243]
    v_pk_mul_f32 v[28:29], v[28:29], v[246:247]
    v_pk_mul_f32 v[26:27], v[26:27], v[244:245]
    v_pk_mul_f32 v[30:31], v[30:31], v[248:249]
    v_cvt_pk_bf16_f32 v180, v24, v25
    v_cvt_pk_bf16_f32 v182, v28, v29
    v_cvt_pk_bf16_f32 v181, v26, v27
    v_cvt_pk_bf16_f32 v183, v30, v31
    v_pk_fma_f32 v[32:33], v[104:105], v[10:11], v[32:33] op_sel:[0,0,0] op_sel_hi:[1,0,1]
    v_pk_fma_f32 v[36:37], v[108:109], v[10:11], v[36:37] op_sel:[0,0,0] op_sel_hi:[1,0,1]
    v_pk_fma_f32 v[34:35], v[106:107], v[10:11], v[34:35] op_sel:[0,0,0] op_sel_hi:[1,0,1]
    v_pk_fma_f32 v[38:39], v[110:111], v[10:11], v[38:39] op_sel:[0,0,0] op_sel_hi:[1,0,1]
    v_pk_mul_f32 v[32:33], v[32:33], v[240:241] op_sel:[0,0] op_sel_hi:[1,0]
    v_pk_mul_f32 v[36:37], v[36:37], v[240:241] op_sel:[0,0] op_sel_hi:[1,0]
    v_pk_mul_f32 v[34:35], v[34:35], v[240:241] op_sel:[0,0] op_sel_hi:[1,0]
    v_pk_mul_f32 v[38:39], v[38:39], v[240:241] op_sel:[0,0] op_sel_hi:[1,0]
    v_pk_mul_f32 v[242:243], v[32:33], v[32:33]
    v_pk_mul_f32 v[246:247], v[36:37], v[36:37]
    v_pk_mul_f32 v[244:245], v[34:35], v[34:35]
    v_pk_mul_f32 v[248:249], v[38:39], v[38:39]
    v_pk_fma_f32 v[242:243], v[242:243], s[46:47], s[46:47] op_sel:[0,0,1] op_sel_hi:[1,0,1]
    v_pk_fma_f32 v[246:247], v[246:247], s[46:47], s[46:47] op_sel:[0,0,1] op_sel_hi:[1,0,1]
    v_pk_fma_f32 v[244:245], v[244:245], s[46:47], s[46:47] op_sel:[0,0,1] op_sel_hi:[1,0,1]
    v_pk_fma_f32 v[248:249], v[248:249], s[46:47], s[46:47] op_sel:[0,0,1] op_sel_hi:[1,0,1]
    v_pk_mul_f32 v[242:243], v[242:243], v[32:33]
    v_pk_mul_f32 v[246:247], v[246:247], v[36:37]
    v_pk_mul_f32 v[244:245], v[244:245], v[34:35]
    v_pk_mul_f32 v[248:249], v[248:249], v[38:39]
    v_exp_f32 v242, v242
    v_exp_f32 v246, v246
    v_exp_f32 v243, v243
    v_exp_f32 v247, v247
    v_exp_f32 v244, v244
    v_exp_f32 v248, v248
    v_exp_f32 v245, v245
    v_exp_f32 v249, v249
    v_pk_add_f32 v[242:243], v[242:243], 1.0 op_sel_hi:[1,0]
    v_pk_add_f32 v[246:247], v[246:247], 1.0 op_sel_hi:[1,0]
    v_pk_add_f32 v[244:245], v[244:245], 1.0 op_sel_hi:[1,0]
    v_pk_add_f32 v[248:249], v[248:249], 1.0 op_sel_hi:[1,0]
    v_rcp_f32 v242, v242
    v_rcp_f32 v246, v246
    v_rcp_f32 v243, v243
    v_rcp_f32 v247, v247
    v_rcp_f32 v244, v244
    v_rcp_f32 v248, v248
    v_rcp_f32 v245, v245
    v_rcp_f32 v249, v249
    v_pk_mul_f32 v[32:33], v[32:33], v[242:243]
    v_pk_mul_f32 v[36:37], v[36:37], v[246:247]
    v_pk_mul_f32 v[34:35], v[34:35], v[244:245]
    v_pk_mul_f32 v[38:39], v[38:39], v[248:249]
    v_cvt_pk_bf16_f32 v184, v32, v33
    v_cvt_pk_bf16_f32 v186, v36, v37
    v_cvt_pk_bf16_f32 v185, v34, v35
    v_cvt_pk_bf16_f32 v187, v38, v39
    v_pk_fma_f32 v[40:41], v[112:113], v[10:11], v[40:41] op_sel:[0,0,0] op_sel_hi:[1,0,1]
    v_pk_fma_f32 v[44:45], v[116:117], v[10:11], v[44:45] op_sel:[0,0,0] op_sel_hi:[1,0,1]
    v_pk_fma_f32 v[42:43], v[114:115], v[10:11], v[42:43] op_sel:[0,0,0] op_sel_hi:[1,0,1]
    v_pk_fma_f32 v[46:47], v[118:119], v[10:11], v[46:47] op_sel:[0,0,0] op_sel_hi:[1,0,1]
    v_pk_mul_f32 v[40:41], v[40:41], v[240:241] op_sel:[0,0] op_sel_hi:[1,0]
    v_pk_mul_f32 v[44:45], v[44:45], v[240:241] op_sel:[0,0] op_sel_hi:[1,0]
    v_pk_mul_f32 v[42:43], v[42:43], v[240:241] op_sel:[0,0] op_sel_hi:[1,0]
    v_pk_mul_f32 v[46:47], v[46:47], v[240:241] op_sel:[0,0] op_sel_hi:[1,0]
    v_pk_mul_f32 v[242:243], v[40:41], v[40:41]
    v_pk_mul_f32 v[246:247], v[44:45], v[44:45]
    v_pk_mul_f32 v[244:245], v[42:43], v[42:43]
    v_pk_mul_f32 v[248:249], v[46:47], v[46:47]
    v_pk_fma_f32 v[242:243], v[242:243], s[46:47], s[46:47] op_sel:[0,0,1] op_sel_hi:[1,0,1]
    v_pk_fma_f32 v[246:247], v[246:247], s[46:47], s[46:47] op_sel:[0,0,1] op_sel_hi:[1,0,1]
    v_pk_fma_f32 v[244:245], v[244:245], s[46:47], s[46:47] op_sel:[0,0,1] op_sel_hi:[1,0,1]
    v_pk_fma_f32 v[248:249], v[248:249], s[46:47], s[46:47] op_sel:[0,0,1] op_sel_hi:[1,0,1]
    v_pk_mul_f32 v[242:243], v[242:243], v[40:41]
    v_pk_mul_f32 v[246:247], v[246:247], v[44:45]
    v_pk_mul_f32 v[244:245], v[244:245], v[42:43]
    v_pk_mul_f32 v[248:249], v[248:249], v[46:47]
    v_exp_f32 v242, v242
    v_exp_f32 v246, v246
    v_exp_f32 v243, v243
    v_exp_f32 v247, v247
    v_exp_f32 v244, v244
    v_exp_f32 v248, v248
    v_exp_f32 v245, v245
    v_exp_f32 v249, v249
    v_pk_add_f32 v[242:243], v[242:243], 1.0 op_sel_hi:[1,0]
    v_pk_add_f32 v[246:247], v[246:247], 1.0 op_sel_hi:[1,0]
    v_pk_add_f32 v[244:245], v[244:245], 1.0 op_sel_hi:[1,0]
    v_pk_add_f32 v[248:249], v[248:249], 1.0 op_sel_hi:[1,0]
    v_rcp_f32 v242, v242
    v_rcp_f32 v246, v246
    v_rcp_f32 v243, v243
    v_rcp_f32 v247, v247
    v_rcp_f32 v244, v244
    v_rcp_f32 v248, v248
    v_rcp_f32 v245, v245
    v_rcp_f32 v249, v249
    v_pk_mul_f32 v[40:41], v[40:41], v[242:243]
    v_pk_mul_f32 v[44:45], v[44:45], v[246:247]
    v_pk_mul_f32 v[42:43], v[42:43], v[244:245]
    v_pk_mul_f32 v[46:47], v[46:47], v[248:249]
    v_cvt_pk_bf16_f32 v188, v40, v41
    v_cvt_pk_bf16_f32 v190, v44, v45
    v_cvt_pk_bf16_f32 v189, v42, v43
    v_cvt_pk_bf16_f32 v191, v46, v47
    v_pk_fma_f32 v[48:49], v[120:121], v[10:11], v[48:49] op_sel:[0,0,0] op_sel_hi:[1,0,1]
    v_pk_fma_f32 v[52:53], v[88:89], v[10:11], v[52:53] op_sel:[0,1,0] op_sel_hi:[1,1,1]
    v_pk_fma_f32 v[50:51], v[122:123], v[10:11], v[50:51] op_sel:[0,0,0] op_sel_hi:[1,0,1]
    v_pk_fma_f32 v[54:55], v[90:91], v[10:11], v[54:55] op_sel:[0,1,0] op_sel_hi:[1,1,1]
    v_pk_mul_f32 v[48:49], v[48:49], v[240:241] op_sel:[0,0] op_sel_hi:[1,0]
    v_pk_mul_f32 v[52:53], v[52:53], v[240:241] op_sel:[0,1] op_sel_hi:[1,1]
    v_pk_mul_f32 v[50:51], v[50:51], v[240:241] op_sel:[0,0] op_sel_hi:[1,0]
    v_pk_mul_f32 v[54:55], v[54:55], v[240:241] op_sel:[0,1] op_sel_hi:[1,1]
    v_pk_mul_f32 v[242:243], v[48:49], v[48:49]
    v_pk_mul_f32 v[246:247], v[52:53], v[52:53]
    v_pk_mul_f32 v[244:245], v[50:51], v[50:51]
    v_pk_mul_f32 v[248:249], v[54:55], v[54:55]
    v_pk_fma_f32 v[242:243], v[242:243], s[46:47], s[46:47] op_sel:[0,0,1] op_sel_hi:[1,0,1]
    v_pk_fma_f32 v[246:247], v[246:247], s[46:47], s[46:47] op_sel:[0,0,1] op_sel_hi:[1,0,1]
    v_pk_fma_f32 v[244:245], v[244:245], s[46:47], s[46:47] op_sel:[0,0,1] op_sel_hi:[1,0,1]
    v_pk_fma_f32 v[248:249], v[248:249], s[46:47], s[46:47] op_sel:[0,0,1] op_sel_hi:[1,0,1]
    v_pk_mul_f32 v[242:243], v[242:243], v[48:49]
    v_pk_mul_f32 v[246:247], v[246:247], v[52:53]
    v_pk_mul_f32 v[244:245], v[244:245], v[50:51]
    v_pk_mul_f32 v[248:249], v[248:249], v[54:55]
    v_exp_f32 v242, v242
    v_exp_f32 v246, v246
    v_exp_f32 v243, v243
    v_exp_f32 v247, v247
    v_exp_f32 v244, v244
    v_exp_f32 v248, v248
    v_exp_f32 v245, v245
    v_exp_f32 v249, v249
    v_pk_add_f32 v[242:243], v[242:243], 1.0 op_sel_hi:[1,0]
    v_pk_add_f32 v[246:247], v[246:247], 1.0 op_sel_hi:[1,0]
    v_pk_add_f32 v[244:245], v[244:245], 1.0 op_sel_hi:[1,0]
    v_pk_add_f32 v[248:249], v[248:249], 1.0 op_sel_hi:[1,0]
    v_rcp_f32 v242, v242
    v_rcp_f32 v246, v246
    v_rcp_f32 v243, v243
    v_rcp_f32 v247, v247
    v_rcp_f32 v244, v244
    v_rcp_f32 v248, v248
    v_rcp_f32 v245, v245
    v_rcp_f32 v249, v249
    v_pk_mul_f32 v[48:49], v[48:49], v[242:243]
    v_pk_mul_f32 v[52:53], v[52:53], v[246:247]
    v_pk_mul_f32 v[50:51], v[50:51], v[244:245]
    v_pk_mul_f32 v[54:55], v[54:55], v[248:249]
    v_cvt_pk_bf16_f32 v192, v48, v49
    v_cvt_pk_bf16_f32 v194, v52, v53
    v_cvt_pk_bf16_f32 v193, v50, v51
    v_cvt_pk_bf16_f32 v195, v54, v55
    v_pk_fma_f32 v[56:57], v[92:93], v[10:11], v[56:57] op_sel:[0,1,0] op_sel_hi:[1,1,1]
    v_pk_fma_f32 v[60:61], v[96:97], v[10:11], v[60:61] op_sel:[0,1,0] op_sel_hi:[1,1,1]
    v_pk_fma_f32 v[58:59], v[94:95], v[10:11], v[58:59] op_sel:[0,1,0] op_sel_hi:[1,1,1]
    v_pk_fma_f32 v[62:63], v[98:99], v[10:11], v[62:63] op_sel:[0,1,0] op_sel_hi:[1,1,1]
    v_pk_mul_f32 v[56:57], v[56:57], v[240:241] op_sel:[0,1] op_sel_hi:[1,1]
    v_pk_mul_f32 v[60:61], v[60:61], v[240:241] op_sel:[0,1] op_sel_hi:[1,1]
    v_pk_mul_f32 v[58:59], v[58:59], v[240:241] op_sel:[0,1] op_sel_hi:[1,1]
    v_pk_mul_f32 v[62:63], v[62:63], v[240:241] op_sel:[0,1] op_sel_hi:[1,1]
    v_pk_mul_f32 v[242:243], v[56:57], v[56:57]
    v_pk_mul_f32 v[246:247], v[60:61], v[60:61]
    v_pk_mul_f32 v[244:245], v[58:59], v[58:59]
    v_pk_mul_f32 v[248:249], v[62:63], v[62:63]
    v_pk_fma_f32 v[242:243], v[242:243], s[46:47], s[46:47] op_sel:[0,0,1] op_sel_hi:[1,0,1]
    v_pk_fma_f32 v[246:247], v[246:247], s[46:47], s[46:47] op_sel:[0,0,1] op_sel_hi:[1,0,1]
    v_pk_fma_f32 v[244:245], v[244:245], s[46:47], s[46:47] op_sel:[0,0,1] op_sel_hi:[1,0,1]
    v_pk_fma_f32 v[248:249], v[248:249], s[46:47], s[46:47] op_sel:[0,0,1] op_sel_hi:[1,0,1]
    v_pk_mul_f32 v[242:243], v[242:243], v[56:57]
    v_pk_mul_f32 v[246:247], v[246:247], v[60:61]
    v_pk_mul_f32 v[244:245], v[244:245], v[58:59]
    v_pk_mul_f32 v[248:249], v[248:249], v[62:63]
    v_exp_f32 v242, v242
    v_exp_f32 v246, v246
    v_exp_f32 v243, v243
    v_exp_f32 v247, v247
    v_exp_f32 v244, v244
    v_exp_f32 v248, v248
    v_exp_f32 v245, v245
    v_exp_f32 v249, v249
    v_pk_add_f32 v[242:243], v[242:243], 1.0 op_sel_hi:[1,0]
    v_pk_add_f32 v[246:247], v[246:247], 1.0 op_sel_hi:[1,0]
    v_pk_add_f32 v[244:245], v[244:245], 1.0 op_sel_hi:[1,0]
    v_pk_add_f32 v[248:249], v[248:249], 1.0 op_sel_hi:[1,0]
    v_rcp_f32 v242, v242
    v_rcp_f32 v246, v246
    v_rcp_f32 v243, v243
    v_rcp_f32 v247, v247
    v_rcp_f32 v244, v244
    v_rcp_f32 v248, v248
    v_rcp_f32 v245, v245
    v_rcp_f32 v249, v249
    v_pk_mul_f32 v[56:57], v[56:57], v[242:243]
    v_pk_mul_f32 v[60:61], v[60:61], v[246:247]
    v_pk_mul_f32 v[58:59], v[58:59], v[244:245]
    v_pk_mul_f32 v[62:63], v[62:63], v[248:249]
    v_cvt_pk_bf16_f32 v196, v56, v57
    v_cvt_pk_bf16_f32 v198, v60, v61
    v_cvt_pk_bf16_f32 v197, v58, v59
    v_cvt_pk_bf16_f32 v199, v62, v63
    v_pk_fma_f32 v[64:65], v[100:101], v[10:11], v[64:65] op_sel:[0,1,0] op_sel_hi:[1,1,1]
    v_pk_fma_f32 v[68:69], v[104:105], v[10:11], v[68:69] op_sel:[0,1,0] op_sel_hi:[1,1,1]
    v_pk_fma_f32 v[66:67], v[102:103], v[10:11], v[66:67] op_sel:[0,1,0] op_sel_hi:[1,1,1]
    v_pk_fma_f32 v[70:71], v[106:107], v[10:11], v[70:71] op_sel:[0,1,0] op_sel_hi:[1,1,1]
    v_pk_mul_f32 v[64:65], v[64:65], v[240:241] op_sel:[0,1] op_sel_hi:[1,1]
    v_pk_mul_f32 v[68:69], v[68:69], v[240:241] op_sel:[0,1] op_sel_hi:[1,1]
    v_pk_mul_f32 v[66:67], v[66:67], v[240:241] op_sel:[0,1] op_sel_hi:[1,1]
    v_pk_mul_f32 v[70:71], v[70:71], v[240:241] op_sel:[0,1] op_sel_hi:[1,1]
    v_pk_mul_f32 v[242:243], v[64:65], v[64:65]
    v_pk_mul_f32 v[246:247], v[68:69], v[68:69]
    v_pk_mul_f32 v[244:245], v[66:67], v[66:67]
    v_pk_mul_f32 v[248:249], v[70:71], v[70:71]
    v_pk_fma_f32 v[242:243], v[242:243], s[46:47], s[46:47] op_sel:[0,0,1] op_sel_hi:[1,0,1]
    v_pk_fma_f32 v[246:247], v[246:247], s[46:47], s[46:47] op_sel:[0,0,1] op_sel_hi:[1,0,1]
    v_pk_fma_f32 v[244:245], v[244:245], s[46:47], s[46:47] op_sel:[0,0,1] op_sel_hi:[1,0,1]
    v_pk_fma_f32 v[248:249], v[248:249], s[46:47], s[46:47] op_sel:[0,0,1] op_sel_hi:[1,0,1]
    v_pk_mul_f32 v[242:243], v[242:243], v[64:65]
    v_pk_mul_f32 v[246:247], v[246:247], v[68:69]
    v_pk_mul_f32 v[244:245], v[244:245], v[66:67]
    v_pk_mul_f32 v[248:249], v[248:249], v[70:71]
    v_exp_f32 v242, v242
    v_exp_f32 v246, v246
    v_exp_f32 v243, v243
    v_exp_f32 v247, v247
    v_exp_f32 v244, v244
    v_exp_f32 v248, v248
    v_exp_f32 v245, v245
    v_exp_f32 v249, v249
    v_pk_add_f32 v[242:243], v[242:243], 1.0 op_sel_hi:[1,0]
    v_pk_add_f32 v[246:247], v[246:247], 1.0 op_sel_hi:[1,0]
    v_pk_add_f32 v[244:245], v[244:245], 1.0 op_sel_hi:[1,0]
    v_pk_add_f32 v[248:249], v[248:249], 1.0 op_sel_hi:[1,0]
    v_rcp_f32 v242, v242
    v_rcp_f32 v246, v246
    v_rcp_f32 v243, v243
    v_rcp_f32 v247, v247
    v_rcp_f32 v244, v244
    v_rcp_f32 v248, v248
    v_rcp_f32 v245, v245
    v_rcp_f32 v249, v249
    v_pk_mul_f32 v[64:65], v[64:65], v[242:243]
    v_pk_mul_f32 v[68:69], v[68:69], v[246:247]
    v_pk_mul_f32 v[66:67], v[66:67], v[244:245]
    v_pk_mul_f32 v[70:71], v[70:71], v[248:249]
    v_cvt_pk_bf16_f32 v200, v64, v65
    v_cvt_pk_bf16_f32 v202, v68, v69
    v_cvt_pk_bf16_f32 v201, v66, v67
    v_cvt_pk_bf16_f32 v203, v70, v71
    v_pk_fma_f32 v[72:73], v[108:109], v[10:11], v[72:73] op_sel:[0,1,0] op_sel_hi:[1,1,1]
    v_pk_fma_f32 v[76:77], v[112:113], v[10:11], v[76:77] op_sel:[0,1,0] op_sel_hi:[1,1,1]
    v_pk_fma_f32 v[74:75], v[110:111], v[10:11], v[74:75] op_sel:[0,1,0] op_sel_hi:[1,1,1]
    v_pk_fma_f32 v[78:79], v[114:115], v[10:11], v[78:79] op_sel:[0,1,0] op_sel_hi:[1,1,1]
    v_pk_mul_f32 v[72:73], v[72:73], v[240:241] op_sel:[0,1] op_sel_hi:[1,1]
    v_pk_mul_f32 v[76:77], v[76:77], v[240:241] op_sel:[0,1] op_sel_hi:[1,1]
    v_pk_mul_f32 v[74:75], v[74:75], v[240:241] op_sel:[0,1] op_sel_hi:[1,1]
    v_pk_mul_f32 v[78:79], v[78:79], v[240:241] op_sel:[0,1] op_sel_hi:[1,1]
    v_pk_mul_f32 v[242:243], v[72:73], v[72:73]
    v_pk_mul_f32 v[246:247], v[76:77], v[76:77]
    v_pk_mul_f32 v[244:245], v[74:75], v[74:75]
    v_pk_mul_f32 v[248:249], v[78:79], v[78:79]
    v_pk_fma_f32 v[242:243], v[242:243], s[46:47], s[46:47] op_sel:[0,0,1] op_sel_hi:[1,0,1]
    v_pk_fma_f32 v[246:247], v[246:247], s[46:47], s[46:47] op_sel:[0,0,1] op_sel_hi:[1,0,1]
    v_pk_fma_f32 v[244:245], v[244:245], s[46:47], s[46:47] op_sel:[0,0,1] op_sel_hi:[1,0,1]
    v_pk_fma_f32 v[248:249], v[248:249], s[46:47], s[46:47] op_sel:[0,0,1] op_sel_hi:[1,0,1]
    v_pk_mul_f32 v[242:243], v[242:243], v[72:73]
    v_pk_mul_f32 v[246:247], v[246:247], v[76:77]
    v_pk_mul_f32 v[244:245], v[244:245], v[74:75]
    v_pk_mul_f32 v[248:249], v[248:249], v[78:79]
    v_exp_f32 v242, v242
    v_exp_f32 v246, v246
    v_exp_f32 v243, v243
    v_exp_f32 v247, v247
    v_exp_f32 v244, v244
    v_exp_f32 v248, v248
    v_exp_f32 v245, v245
    v_exp_f32 v249, v249
    v_pk_add_f32 v[242:243], v[242:243], 1.0 op_sel_hi:[1,0]
    v_pk_add_f32 v[246:247], v[246:247], 1.0 op_sel_hi:[1,0]
    v_pk_add_f32 v[244:245], v[244:245], 1.0 op_sel_hi:[1,0]
    v_pk_add_f32 v[248:249], v[248:249], 1.0 op_sel_hi:[1,0]
    v_rcp_f32 v242, v242
    v_rcp_f32 v246, v246
    v_rcp_f32 v243, v243
    v_rcp_f32 v247, v247
    v_rcp_f32 v244, v244
    v_rcp_f32 v248, v248
    v_rcp_f32 v245, v245
    v_rcp_f32 v249, v249
    v_pk_mul_f32 v[72:73], v[72:73], v[242:243]
    v_pk_mul_f32 v[76:77], v[76:77], v[246:247]
    v_pk_mul_f32 v[74:75], v[74:75], v[244:245]
    v_pk_mul_f32 v[78:79], v[78:79], v[248:249]
    v_cvt_pk_bf16_f32 v204, v72, v73
    v_cvt_pk_bf16_f32 v206, v76, v77
    v_cvt_pk_bf16_f32 v205, v74, v75
    v_cvt_pk_bf16_f32 v207, v78, v79
    v_pk_fma_f32 v[80:81], v[116:117], v[10:11], v[80:81] op_sel:[0,1,0] op_sel_hi:[1,1,1]
    v_pk_fma_f32 v[84:85], v[120:121], v[10:11], v[84:85] op_sel:[0,1,0] op_sel_hi:[1,1,1]
    v_pk_fma_f32 v[82:83], v[118:119], v[10:11], v[82:83] op_sel:[0,1,0] op_sel_hi:[1,1,1]
    v_pk_fma_f32 v[86:87], v[122:123], v[10:11], v[86:87] op_sel:[0,1,0] op_sel_hi:[1,1,1]
    v_pk_mul_f32 v[80:81], v[80:81], v[240:241] op_sel:[0,1] op_sel_hi:[1,1]
    v_pk_mul_f32 v[84:85], v[84:85], v[240:241] op_sel:[0,1] op_sel_hi:[1,1]
    v_pk_mul_f32 v[82:83], v[82:83], v[240:241] op_sel:[0,1] op_sel_hi:[1,1]
    v_pk_mul_f32 v[86:87], v[86:87], v[240:241] op_sel:[0,1] op_sel_hi:[1,1]
    v_pk_mul_f32 v[242:243], v[80:81], v[80:81]
    v_pk_mul_f32 v[246:247], v[84:85], v[84:85]
    v_pk_mul_f32 v[244:245], v[82:83], v[82:83]
    v_pk_mul_f32 v[248:249], v[86:87], v[86:87]
    v_pk_fma_f32 v[242:243], v[242:243], s[46:47], s[46:47] op_sel:[0,0,1] op_sel_hi:[1,0,1]
    v_pk_fma_f32 v[246:247], v[246:247], s[46:47], s[46:47] op_sel:[0,0,1] op_sel_hi:[1,0,1]
    v_pk_fma_f32 v[244:245], v[244:245], s[46:47], s[46:47] op_sel:[0,0,1] op_sel_hi:[1,0,1]
    v_pk_fma_f32 v[248:249], v[248:249], s[46:47], s[46:47] op_sel:[0,0,1] op_sel_hi:[1,0,1]
    v_pk_mul_f32 v[242:243], v[242:243], v[80:81]
    v_pk_mul_f32 v[246:247], v[246:247], v[84:85]
    v_pk_mul_f32 v[244:245], v[244:245], v[82:83]
    v_pk_mul_f32 v[248:249], v[248:249], v[86:87]
    v_exp_f32 v242, v242
    v_exp_f32 v246, v246
    v_exp_f32 v243, v243
    v_exp_f32 v247, v247
    v_exp_f32 v244, v244
    v_exp_f32 v248, v248
    v_exp_f32 v245, v245
    v_exp_f32 v249, v249
    v_pk_add_f32 v[242:243], v[242:243], 1.0 op_sel_hi:[1,0]
    v_pk_add_f32 v[246:247], v[246:247], 1.0 op_sel_hi:[1,0]
    v_pk_add_f32 v[244:245], v[244:245], 1.0 op_sel_hi:[1,0]
    v_pk_add_f32 v[248:249], v[248:249], 1.0 op_sel_hi:[1,0]
    v_rcp_f32 v242, v242
    v_rcp_f32 v246, v246
    v_rcp_f32 v243, v243
    v_rcp_f32 v247, v247
    v_rcp_f32 v244, v244
    v_rcp_f32 v248, v248
    v_rcp_f32 v245, v245
    v_rcp_f32 v249, v249
    v_pk_mul_f32 v[80:81], v[80:81], v[242:243]
    v_pk_mul_f32 v[84:85], v[84:85], v[246:247]
    v_pk_mul_f32 v[82:83], v[82:83], v[244:245]
    v_pk_mul_f32 v[86:87], v[86:87], v[248:249]
    v_cvt_pk_bf16_f32 v208, v80, v81
    v_cvt_pk_bf16_f32 v210, v84, v85
    v_cvt_pk_bf16_f32 v209, v82, v83
    v_cvt_pk_bf16_f32 v211, v86, v87
    v_and_b32 v10, 15, v1
    v_lshrrev_b32 v11, 4, v1
    v_lshrrev_b32 v12, 1, v10
    v_xor_b32 v11, v11, v12
    v_lshlrev_b32_e64 v11, 4, v11
    v_lshl_add_u32 v11, v10, 7, v11
    s_lshl_b32 s38, s23, 12
    v_add_u32 v4, s38, v11
    v_xor_b32 v7, 64, v4
    s_waitcnt vmcnt(0)
    v_lshlrev_b32 v14, 16, v14
    v_lshlrev_b32 v15, 16, v15
    v_mov_b32 v16, v14
    v_mov_b32 v17, v14
    v_mov_b32 v18, v14
    v_mov_b32 v19, v14
    v_mov_b32 v20, v14
    v_mov_b32 v21, v14
    v_mov_b32 v22, v14
    v_mov_b32 v23, v14
    v_mov_b32 v24, v14
    v_mov_b32 v25, v14
    v_mov_b32 v26, v14
    v_mov_b32 v27, v14
    v_mov_b32 v28, v14
    v_mov_b32 v29, v14
    v_mov_b32 v30, v14
    v_mov_b32 v31, v14
    v_mov_b32 v32, v14
    v_mov_b32 v33, v14
    v_mov_b32 v34, v14
    v_mov_b32 v35, v14
    v_mov_b32 v36, v14
    v_mov_b32 v37, v14
    v_mov_b32 v38, v14
    v_mov_b32 v39, v14
    v_mov_b32 v40, v14
    v_mov_b32 v41, v14
    v_mov_b32 v42, v14
    v_mov_b32 v43, v14
    v_mov_b32 v44, v14
    v_mov_b32 v45, v14
    v_mov_b32 v46, v14
    v_mov_b32 v47, v14
    v_mov_b32 v48, v14
    v_mov_b32 v49, v14
    v_mov_b32 v50, v14
    v_mov_b32 v51, v14
    v_mov_b32 v52, v15
    v_mov_b32 v53, v15
    v_mov_b32 v54, v15
    v_mov_b32 v55, v15
    v_mov_b32 v56, v15
    v_mov_b32 v57, v15
    v_mov_b32 v58, v15
    v_mov_b32 v59, v15
    v_mov_b32 v60, v15
    v_mov_b32 v61, v15
    v_mov_b32 v62, v15
    v_mov_b32 v63, v15
    v_mov_b32 v64, v15
    v_mov_b32 v65, v15
    v_mov_b32 v66, v15
    v_mov_b32 v67, v15
    v_mov_b32 v68, v15
    v_mov_b32 v69, v15
    v_mov_b32 v70, v15
    v_mov_b32 v71, v15
    v_mov_b32 v72, v15
    v_mov_b32 v73, v15
    v_mov_b32 v74, v15
    v_mov_b32 v75, v15
    v_mov_b32 v76, v15
    v_mov_b32 v77, v15
    v_mov_b32 v78, v15
    v_mov_b32 v79, v15
    v_mov_b32 v80, v15
    v_mov_b32 v81, v15
    v_mov_b32 v82, v15
    v_mov_b32 v83, v15
    v_mov_b32 v84, v15
    v_mov_b32 v85, v15
    v_mov_b32 v86, v15
    v_mov_b32 v87, v15
    s_and_b32 s38, s2, 3
    s_lshl_b32 s38, s38, 3
    s_bfe_u32 s39, s2, 0x30003
    s_add_u32 s24, s38, s39
    s_bfe_u32 s38, s2, 0x10002
    s_lshl_b32 s38, s38, 2
    s_lshr_b32 s39, s2, 6
    s_add_u32 s25, s38, s39
    s_lshl_b32 s26, s24, 2
    s_add_u32 s26, s26, s23
    s_mul_i32 s12, s26, 18432
    s_add_u32 s12, s12, 11534336
    s_lshl_b32 s38, s25, 8
    s_add_u32 s13, s12, s38
    s_add_u32 s13, s13, 16384
    s_lshl_b32 s38, s25, 11
    s_add_u32 s12, s12, s38
    v_and_b32 v11, 15, v1
    v_lshrrev_b32 v12, 4, v1
    v_mov_b32 v13, 1073741824
    v_lshlrev_b32 v8, 4, v11
    v_lshl_add_u32 v8, v12, 3, v8
    v_cmp_gt_u32 vcc, 32, v1
    s_nop 1
    v_cndmask_b32_e64 v8, v13, v8, vcc
    buffer_load_dwordx4 v[222:225], v3, s[16:19], s12 offen sc1
    buffer_load_dwordx4 v[226:229], v3, s[16:19], s12 offen offset:1024 sc1
    buffer_load_dwordx2 v[230:231], v8, s[16:19], s13 offen sc1
    s_mul_i32 s14, s26, 18432
    s_mul_i32 s38, s25, 144
    s_add_u32 s14, s14, s38
    v_mul_u32_u24 v8, 1152, v11
    v_and_b32 v9, 1, v12
    v_lshlrev_b32 v9, 5, v9
    v_lshrrev_b32 v10, 1, v12
    v_lshl_add_u32 v9, v10, 4, v9
    v_add_u32_e64 v232, v9, v8
    v_lshl_add_u32 v8, v12, 3, v8
    v_cndmask_b32 v233, v13, v8, vcc
    s_barrier
    ds_read_b128 v[88:91], v4 offset:32768
    ds_read_b128 v[92:95], v4 offset:34816
    ds_read_b128 v[96:99], v5 offset:36864
    ds_read_b128 v[100:103], v5 offset:37888
    ds_read_b128 v[104:107], v5 offset:38912
    ds_read_b128 v[108:111], v5 offset:39936
    ds_read_b128 v[112:115], v5 offset:40960
    ds_read_b128 v[116:119], v5 offset:41984
    ds_read_b128 v[120:123], v5 offset:43008
    ds_read_b128 v[124:127], v5 offset:44032
    ds_read_b128 v[128:131], v5 offset:45056
    s_mov_b32 s43, 7
sequential_preLN__sliding_block__mixer_gmlp__prompt_kernel_c5loop:
    s_waitcnt lgkmcnt(0)
    v_mfma_f32_16x16x32_bf16 v[16:19], v[96:99], v[88:91], v[16:19]
    ds_read_b128 v[132:135], v7 offset:32768
    v_mfma_f32_16x16x32_bf16 v[52:55], v[96:99], v[92:95], v[52:55]
    ds_read_b128 v[136:139], v7 offset:34816
    v_mfma_f32_16x16x32_bf16 v[20:23], v[100:103], v[88:91], v[20:23]
    ds_read_b128 v[140:143], v5 offset:46080
    v_mfma_f32_16x16x32_bf16 v[56:59], v[100:103], v[92:95], v[56:59]
    ds_read_b128 v[144:147], v5 offset:47104
    v_mfma_f32_16x16x32_bf16 v[24:27], v[104:107], v[88:91], v[24:27]
    ds_read_b128 v[148:151], v5 offset:48128
    v_mfma_f32_16x16x32_bf16 v[60:63], v[104:107], v[92:95], v[60:63]
    ds_read_b128 v[152:155], v5 offset:49152
    v_mfma_f32_16x16x32_bf16 v[28:31], v[108:111], v[88:91], v[28:31]
    ds_read_b128 v[156:159], v5 offset:50176
    v_mfma_f32_16x16x32_bf16 v[64:67], v[108:111], v[92:95], v[64:67]
    ds_read_b128 v[160:163], v5 offset:51200
    v_mfma_f32_16x16x32_bf16 v[32:35], v[112:115], v[88:91], v[32:35]
    ds_read_b128 v[164:167], v5 offset:52224
    v_mfma_f32_16x16x32_bf16 v[68:71], v[112:115], v[92:95], v[68:71]
    ds_read_b128 v[168:171], v5 offset:53248
    v_mfma_f32_16x16x32_bf16 v[36:39], v[116:119], v[88:91], v[36:39]
    ds_read_b128 v[172:175], v5 offset:54272
    v_mfma_f32_16x16x32_bf16 v[72:75], v[116:119], v[92:95], v[72:75]
    v_mfma_f32_16x16x32_bf16 v[40:43], v[120:123], v[88:91], v[40:43]
    v_mfma_f32_16x16x32_bf16 v[76:79], v[120:123], v[92:95], v[76:79]
    v_mfma_f32_16x16x32_bf16 v[44:47], v[124:127], v[88:91], v[44:47]
    v_mfma_f32_16x16x32_bf16 v[80:83], v[124:127], v[92:95], v[80:83]
    v_mfma_f32_16x16x32_bf16 v[48:51], v[128:131], v[88:91], v[48:51]
    v_mfma_f32_16x16x32_bf16 v[84:87], v[128:131], v[92:95], v[84:87]
    s_waitcnt lgkmcnt(0)
    s_barrier
    v_mfma_f32_16x16x32_bf16 v[16:19], v[140:143], v[132:135], v[16:19]
    ds_read_b128 v[88:91], v4 offset:49152
    v_mfma_f32_16x16x32_bf16 v[52:55], v[140:143], v[136:139], v[52:55]
    ds_read_b128 v[92:95], v4 offset:51200
    v_mfma_f32_16x16x32_bf16 v[20:23], v[144:147], v[132:135], v[20:23]
    ds_read_b128 v[96:99], v6 offset:0
    v_mfma_f32_16x16x32_bf16 v[56:59], v[144:147], v[136:139], v[56:59]
    ds_read_b128 v[100:103], v6 offset:1024
    v_mfma_f32_16x16x32_bf16 v[24:27], v[148:151], v[132:135], v[24:27]
    ds_read_b128 v[104:107], v6 offset:2048
    v_mfma_f32_16x16x32_bf16 v[60:63], v[148:151], v[136:139], v[60:63]
    ds_read_b128 v[108:111], v6 offset:3072
    v_mfma_f32_16x16x32_bf16 v[28:31], v[152:155], v[132:135], v[28:31]
    ds_read_b128 v[112:115], v6 offset:4096
    v_mfma_f32_16x16x32_bf16 v[64:67], v[152:155], v[136:139], v[64:67]
    ds_read_b128 v[116:119], v6 offset:5120
    v_mfma_f32_16x16x32_bf16 v[32:35], v[156:159], v[132:135], v[32:35]
    ds_read_b128 v[120:123], v6 offset:6144
    v_mfma_f32_16x16x32_bf16 v[68:71], v[156:159], v[136:139], v[68:71]
    ds_read_b128 v[124:127], v6 offset:7168
    v_mfma_f32_16x16x32_bf16 v[36:39], v[160:163], v[132:135], v[36:39]
    ds_read_b128 v[128:131], v6 offset:8192
    v_mfma_f32_16x16x32_bf16 v[72:75], v[160:163], v[136:139], v[72:75]
    v_mfma_f32_16x16x32_bf16 v[40:43], v[164:167], v[132:135], v[40:43]
    v_mfma_f32_16x16x32_bf16 v[76:79], v[164:167], v[136:139], v[76:79]
    v_mfma_f32_16x16x32_bf16 v[44:47], v[168:171], v[132:135], v[44:47]
    v_mfma_f32_16x16x32_bf16 v[80:83], v[168:171], v[136:139], v[80:83]
    v_mfma_f32_16x16x32_bf16 v[48:51], v[172:175], v[132:135], v[48:51]
    v_mfma_f32_16x16x32_bf16 v[84:87], v[172:175], v[136:139], v[84:87]
    s_waitcnt lgkmcnt(0)
    v_mfma_f32_16x16x32_bf16 v[16:19], v[96:99], v[88:91], v[16:19]
    ds_read_b128 v[132:135], v7 offset:49152
    v_mfma_f32_16x16x32_bf16 v[52:55], v[96:99], v[92:95], v[52:55]
    ds_read_b128 v[136:139], v7 offset:51200
    v_mfma_f32_16x16x32_bf16 v[20:23], v[100:103], v[88:91], v[20:23]
    ds_read_b128 v[140:143], v6 offset:9216
    v_mfma_f32_16x16x32_bf16 v[56:59], v[100:103], v[92:95], v[56:59]
    ds_read_b128 v[144:147], v6 offset:10240
    v_mfma_f32_16x16x32_bf16 v[24:27], v[104:107], v[88:91], v[24:27]
    ds_read_b128 v[148:151], v6 offset:11264
    v_mfma_f32_16x16x32_bf16 v[60:63], v[104:107], v[92:95], v[60:63]
    ds_read_b128 v[152:155], v6 offset:12288
    v_mfma_f32_16x16x32_bf16 v[28:31], v[108:111], v[88:91], v[28:31]
    ds_read_b128 v[156:159], v6 offset:13312
    v_mfma_f32_16x16x32_bf16 v[64:67], v[108:111], v[92:95], v[64:67]
    ds_read_b128 v[160:163], v6 offset:14336
    v_mfma_f32_16x16x32_bf16 v[32:35], v[112:115], v[88:91], v[32:35]
    ds_read_b128 v[164:167], v6 offset:15360
    v_mfma_f32_16x16x32_bf16 v[68:71], v[112:115], v[92:95], v[68:71]
    ds_read_b128 v[168:171], v6 offset:16384
    v_mfma_f32_16x16x32_bf16 v[36:39], v[116:119], v[88:91], v[36:39]
    ds_read_b128 v[172:175], v6 offset:17408
    v_mfma_f32_16x16x32_bf16 v[72:75], v[116:119], v[92:95], v[72:75]
    v_mfma_f32_16x16x32_bf16 v[40:43], v[120:123], v[88:91], v[40:43]
    v_mfma_f32_16x16x32_bf16 v[76:79], v[120:123], v[92:95], v[76:79]
    v_mfma_f32_16x16x32_bf16 v[44:47], v[124:127], v[88:91], v[44:47]
    v_mfma_f32_16x16x32_bf16 v[80:83], v[124:127], v[92:95], v[80:83]
    v_mfma_f32_16x16x32_bf16 v[48:51], v[128:131], v[88:91], v[48:51]
    v_mfma_f32_16x16x32_bf16 v[84:87], v[128:131], v[92:95], v[84:87]
    s_waitcnt lgkmcnt(0)
    s_barrier
    v_mfma_f32_16x16x32_bf16 v[16:19], v[140:143], v[132:135], v[16:19]
    ds_read_b128 v[88:91], v4 offset:0
    v_mfma_f32_16x16x32_bf16 v[52:55], v[140:143], v[136:139], v[52:55]
    ds_read_b128 v[92:95], v4 offset:2048
    v_mfma_f32_16x16x32_bf16 v[20:23], v[144:147], v[132:135], v[20:23]
    ds_read_b128 v[96:99], v5 offset:0
    v_mfma_f32_16x16x32_bf16 v[56:59], v[144:147], v[136:139], v[56:59]
    ds_read_b128 v[100:103], v5 offset:1024
    v_mfma_f32_16x16x32_bf16 v[24:27], v[148:151], v[132:135], v[24:27]
    ds_read_b128 v[104:107], v5 offset:2048
    v_mfma_f32_16x16x32_bf16 v[60:63], v[148:151], v[136:139], v[60:63]
    ds_read_b128 v[108:111], v5 offset:3072
    v_mfma_f32_16x16x32_bf16 v[28:31], v[152:155], v[132:135], v[28:31]
    ds_read_b128 v[112:115], v5 offset:4096
    v_mfma_f32_16x16x32_bf16 v[64:67], v[152:155], v[136:139], v[64:67]
    ds_read_b128 v[116:119], v5 offset:5120
    v_mfma_f32_16x16x32_bf16 v[32:35], v[156:159], v[132:135], v[32:35]
    ds_read_b128 v[120:123], v5 offset:6144
    v_mfma_f32_16x16x32_bf16 v[68:71], v[156:159], v[136:139], v[68:71]
    ds_read_b128 v[124:127], v5 offset:7168
    v_mfma_f32_16x16x32_bf16 v[36:39], v[160:163], v[132:135], v[36:39]
    ds_read_b128 v[128:131], v5 offset:8192
    v_mfma_f32_16x16x32_bf16 v[72:75], v[160:163], v[136:139], v[72:75]
    v_mfma_f32_16x16x32_bf16 v[40:43], v[164:167], v[132:135], v[40:43]
    v_mfma_f32_16x16x32_bf16 v[76:79], v[164:167], v[136:139], v[76:79]
    v_mfma_f32_16x16x32_bf16 v[44:47], v[168:171], v[132:135], v[44:47]
    v_mfma_f32_16x16x32_bf16 v[80:83], v[168:171], v[136:139], v[80:83]
    v_mfma_f32_16x16x32_bf16 v[48:51], v[172:175], v[132:135], v[48:51]
    v_mfma_f32_16x16x32_bf16 v[84:87], v[172:175], v[136:139], v[84:87]
    s_waitcnt lgkmcnt(0)
    v_mfma_f32_16x16x32_bf16 v[16:19], v[96:99], v[88:91], v[16:19]
    ds_read_b128 v[132:135], v7 offset:0
    v_mfma_f32_16x16x32_bf16 v[52:55], v[96:99], v[92:95], v[52:55]
    ds_read_b128 v[136:139], v7 offset:2048
    v_mfma_f32_16x16x32_bf16 v[20:23], v[100:103], v[88:91], v[20:23]
    ds_read_b128 v[140:143], v5 offset:9216
    v_mfma_f32_16x16x32_bf16 v[56:59], v[100:103], v[92:95], v[56:59]
    ds_read_b128 v[144:147], v5 offset:10240
    v_mfma_f32_16x16x32_bf16 v[24:27], v[104:107], v[88:91], v[24:27]
    ds_read_b128 v[148:151], v5 offset:11264
    v_mfma_f32_16x16x32_bf16 v[60:63], v[104:107], v[92:95], v[60:63]
    ds_read_b128 v[152:155], v5 offset:12288
    v_mfma_f32_16x16x32_bf16 v[28:31], v[108:111], v[88:91], v[28:31]
    ds_read_b128 v[156:159], v5 offset:13312
    v_mfma_f32_16x16x32_bf16 v[64:67], v[108:111], v[92:95], v[64:67]
    ds_read_b128 v[160:163], v5 offset:14336
    v_mfma_f32_16x16x32_bf16 v[32:35], v[112:115], v[88:91], v[32:35]
    ds_read_b128 v[164:167], v5 offset:15360
    v_mfma_f32_16x16x32_bf16 v[68:71], v[112:115], v[92:95], v[68:71]
    ds_read_b128 v[168:171], v5 offset:16384
    v_mfma_f32_16x16x32_bf16 v[36:39], v[116:119], v[88:91], v[36:39]
    ds_read_b128 v[172:175], v5 offset:17408
    v_mfma_f32_16x16x32_bf16 v[72:75], v[116:119], v[92:95], v[72:75]
    v_mfma_f32_16x16x32_bf16 v[40:43], v[120:123], v[88:91], v[40:43]
    v_mfma_f32_16x16x32_bf16 v[76:79], v[120:123], v[92:95], v[76:79]
    v_mfma_f32_16x16x32_bf16 v[44:47], v[124:127], v[88:91], v[44:47]
    v_mfma_f32_16x16x32_bf16 v[80:83], v[124:127], v[92:95], v[80:83]
    v_mfma_f32_16x16x32_bf16 v[48:51], v[128:131], v[88:91], v[48:51]
    v_mfma_f32_16x16x32_bf16 v[84:87], v[128:131], v[92:95], v[84:87]
    s_waitcnt lgkmcnt(0)
    s_barrier
    v_mfma_f32_16x16x32_bf16 v[16:19], v[140:143], v[132:135], v[16:19]
    ds_read_b128 v[88:91], v4 offset:16384
    v_mfma_f32_16x16x32_bf16 v[52:55], v[140:143], v[136:139], v[52:55]
    ds_read_b128 v[92:95], v4 offset:18432
    v_mfma_f32_16x16x32_bf16 v[20:23], v[144:147], v[132:135], v[20:23]
    ds_read_b128 v[96:99], v5 offset:18432
    v_mfma_f32_16x16x32_bf16 v[56:59], v[144:147], v[136:139], v[56:59]
    ds_read_b128 v[100:103], v5 offset:19456
    v_mfma_f32_16x16x32_bf16 v[24:27], v[148:151], v[132:135], v[24:27]
    ds_read_b128 v[104:107], v5 offset:20480
    v_mfma_f32_16x16x32_bf16 v[60:63], v[148:151], v[136:139], v[60:63]
    ds_read_b128 v[108:111], v5 offset:21504
    v_mfma_f32_16x16x32_bf16 v[28:31], v[152:155], v[132:135], v[28:31]
    ds_read_b128 v[112:115], v5 offset:22528
    v_mfma_f32_16x16x32_bf16 v[64:67], v[152:155], v[136:139], v[64:67]
    ds_read_b128 v[116:119], v5 offset:23552
    v_mfma_f32_16x16x32_bf16 v[32:35], v[156:159], v[132:135], v[32:35]
    ds_read_b128 v[120:123], v5 offset:24576
    v_mfma_f32_16x16x32_bf16 v[68:71], v[156:159], v[136:139], v[68:71]
    ds_read_b128 v[124:127], v5 offset:25600
    v_mfma_f32_16x16x32_bf16 v[36:39], v[160:163], v[132:135], v[36:39]
    ds_read_b128 v[128:131], v5 offset:26624
    v_mfma_f32_16x16x32_bf16 v[72:75], v[160:163], v[136:139], v[72:75]
    v_mfma_f32_16x16x32_bf16 v[40:43], v[164:167], v[132:135], v[40:43]
    v_mfma_f32_16x16x32_bf16 v[76:79], v[164:167], v[136:139], v[76:79]
    v_mfma_f32_16x16x32_bf16 v[44:47], v[168:171], v[132:135], v[44:47]
    v_mfma_f32_16x16x32_bf16 v[80:83], v[168:171], v[136:139], v[80:83]
    v_mfma_f32_16x16x32_bf16 v[48:51], v[172:175], v[132:135], v[48:51]
    v_mfma_f32_16x16x32_bf16 v[84:87], v[172:175], v[136:139], v[84:87]
    s_waitcnt lgkmcnt(0)
    v_mfma_f32_16x16x32_bf16 v[16:19], v[96:99], v[88:91], v[16:19]
    ds_read_b128 v[132:135], v7 offset:16384
    v_mfma_f32_16x16x32_bf16 v[52:55], v[96:99], v[92:95], v[52:55]
    ds_read_b128 v[136:139], v7 offset:18432
    v_mfma_f32_16x16x32_bf16 v[20:23], v[100:103], v[88:91], v[20:23]
    ds_read_b128 v[140:143], v5 offset:27648
    v_mfma_f32_16x16x32_bf16 v[56:59], v[100:103], v[92:95], v[56:59]
    ds_read_b128 v[144:147], v5 offset:28672
    v_mfma_f32_16x16x32_bf16 v[24:27], v[104:107], v[88:91], v[24:27]
    ds_read_b128 v[148:151], v5 offset:29696
    v_mfma_f32_16x16x32_bf16 v[60:63], v[104:107], v[92:95], v[60:63]
    ds_read_b128 v[152:155], v5 offset:30720
    v_mfma_f32_16x16x32_bf16 v[28:31], v[108:111], v[88:91], v[28:31]
    ds_read_b128 v[156:159], v5 offset:31744
    v_mfma_f32_16x16x32_bf16 v[64:67], v[108:111], v[92:95], v[64:67]
    ds_read_b128 v[160:163], v5 offset:32768
    v_mfma_f32_16x16x32_bf16 v[32:35], v[112:115], v[88:91], v[32:35]
    ds_read_b128 v[164:167], v5 offset:33792
    v_mfma_f32_16x16x32_bf16 v[68:71], v[112:115], v[92:95], v[68:71]
    ds_read_b128 v[168:171], v5 offset:34816
    v_mfma_f32_16x16x32_bf16 v[36:39], v[116:119], v[88:91], v[36:39]
    ds_read_b128 v[172:175], v5 offset:35840
    v_mfma_f32_16x16x32_bf16 v[72:75], v[116:119], v[92:95], v[72:75]
    v_mfma_f32_16x16x32_bf16 v[40:43], v[120:123], v[88:91], v[40:43]
    v_mfma_f32_16x16x32_bf16 v[76:79], v[120:123], v[92:95], v[76:79]
    v_mfma_f32_16x16x32_bf16 v[44:47], v[124:127], v[88:91], v[44:47]
    v_mfma_f32_16x16x32_bf16 v[80:83], v[124:127], v[92:95], v[80:83]
    v_mfma_f32_16x16x32_bf16 v[48:51], v[128:131], v[88:91], v[48:51]
    v_mfma_f32_16x16x32_bf16 v[84:87], v[128:131], v[92:95], v[84:87]
    s_waitcnt lgkmcnt(0)
    s_barrier
    v_mfma_f32_16x16x32_bf16 v[16:19], v[140:143], v[132:135], v[16:19]
    ds_read_b128 v[88:91], v4 offset:32768
    v_mfma_f32_16x16x32_bf16 v[52:55], v[140:143], v[136:139], v[52:55]
    ds_read_b128 v[92:95], v4 offset:34816
    v_mfma_f32_16x16x32_bf16 v[20:23], v[144:147], v[132:135], v[20:23]
    ds_read_b128 v[96:99], v5 offset:36864
    v_mfma_f32_16x16x32_bf16 v[56:59], v[144:147], v[136:139], v[56:59]
    ds_read_b128 v[100:103], v5 offset:37888
    v_mfma_f32_16x16x32_bf16 v[24:27], v[148:151], v[132:135], v[24:27]
    ds_read_b128 v[104:107], v5 offset:38912
    v_mfma_f32_16x16x32_bf16 v[60:63], v[148:151], v[136:139], v[60:63]
    ds_read_b128 v[108:111], v5 offset:39936
    v_mfma_f32_16x16x32_bf16 v[28:31], v[152:155], v[132:135], v[28:31]
    ds_read_b128 v[112:115], v5 offset:40960
    v_mfma_f32_16x16x32_bf16 v[64:67], v[152:155], v[136:139], v[64:67]
    ds_read_b128 v[116:119], v5 offset:41984
    v_mfma_f32_16x16x32_bf16 v[32:35], v[156:159], v[132:135], v[32:35]
    ds_read_b128 v[120:123], v5 offset:43008
    v_mfma_f32_16x16x32_bf16 v[68:71], v[156:159], v[136:139], v[68:71]
    ds_read_b128 v[124:127], v5 offset:44032
    v_mfma_f32_16x16x32_bf16 v[36:39], v[160:163], v[132:135], v[36:39]
    ds_read_b128 v[128:131], v5 offset:45056
    v_mfma_f32_16x16x32_bf16 v[72:75], v[160:163], v[136:139], v[72:75]
    v_mfma_f32_16x16x32_bf16 v[40:43], v[164:167], v[132:135], v[40:43]
    v_mfma_f32_16x16x32_bf16 v[76:79], v[164:167], v[136:139], v[76:79]
    v_mfma_f32_16x16x32_bf16 v[44:47], v[168:171], v[132:135], v[44:47]
    v_mfma_f32_16x16x32_bf16 v[80:83], v[168:171], v[136:139], v[80:83]
    v_mfma_f32_16x16x32_bf16 v[48:51], v[172:175], v[132:135], v[48:51]
    v_mfma_f32_16x16x32_bf16 v[84:87], v[172:175], v[136:139], v[84:87]
    s_sub_u32 s43, s43, 1
    s_cmp_lg_u32 s43, 0
    s_cbranch_scc1 sequential_preLN__sliding_block__mixer_gmlp__prompt_kernel_c5loop
    s_waitcnt lgkmcnt(0)
    v_mfma_f32_16x16x32_bf16 v[16:19], v[96:99], v[88:91], v[16:19]
    ds_read_b128 v[132:135], v7 offset:32768
    v_mfma_f32_16x16x32_bf16 v[52:55], v[96:99], v[92:95], v[52:55]
    ds_read_b128 v[136:139], v7 offset:34816
    v_mfma_f32_16x16x32_bf16 v[20:23], v[100:103], v[88:91], v[20:23]
    ds_read_b128 v[140:143], v5 offset:46080
    v_mfma_f32_16x16x32_bf16 v[56:59], v[100:103], v[92:95], v[56:59]
    ds_read_b128 v[144:147], v5 offset:47104
    v_mfma_f32_16x16x32_bf16 v[24:27], v[104:107], v[88:91], v[24:27]
    ds_read_b128 v[148:151], v5 offset:48128
    v_mfma_f32_16x16x32_bf16 v[60:63], v[104:107], v[92:95], v[60:63]
    ds_read_b128 v[152:155], v5 offset:49152
    v_mfma_f32_16x16x32_bf16 v[28:31], v[108:111], v[88:91], v[28:31]
    ds_read_b128 v[156:159], v5 offset:50176
    v_mfma_f32_16x16x32_bf16 v[64:67], v[108:111], v[92:95], v[64:67]
    ds_read_b128 v[160:163], v5 offset:51200
    v_mfma_f32_16x16x32_bf16 v[32:35], v[112:115], v[88:91], v[32:35]
    ds_read_b128 v[164:167], v5 offset:52224
    v_mfma_f32_16x16x32_bf16 v[68:71], v[112:115], v[92:95], v[68:71]
    ds_read_b128 v[168:171], v5 offset:53248
    v_mfma_f32_16x16x32_bf16 v[36:39], v[116:119], v[88:91], v[36:39]
    ds_read_b128 v[172:175], v5 offset:54272
    v_mfma_f32_16x16x32_bf16 v[72:75], v[116:119], v[92:95], v[72:75]
    v_mfma_f32_16x16x32_bf16 v[40:43], v[120:123], v[88:91], v[40:43]
    v_mfma_f32_16x16x32_bf16 v[76:79], v[120:123], v[92:95], v[76:79]
    v_mfma_f32_16x16x32_bf16 v[44:47], v[124:127], v[88:91], v[44:47]
    v_mfma_f32_16x16x32_bf16 v[80:83], v[124:127], v[92:95], v[80:83]
    v_mfma_f32_16x16x32_bf16 v[48:51], v[128:131], v[88:91], v[48:51]
    v_mfma_f32_16x16x32_bf16 v[84:87], v[128:131], v[92:95], v[84:87]
    s_waitcnt lgkmcnt(0)
    s_barrier
    v_mfma_f32_16x16x32_bf16 v[16:19], v[140:143], v[132:135], v[16:19]
    ds_read_b128 v[88:91], v4 offset:49152
    v_mfma_f32_16x16x32_bf16 v[52:55], v[140:143], v[136:139], v[52:55]
    ds_read_b128 v[92:95], v4 offset:51200
    v_mfma_f32_16x16x32_bf16 v[20:23], v[144:147], v[132:135], v[20:23]
    ds_read_b128 v[96:99], v6 offset:0
    v_mfma_f32_16x16x32_bf16 v[56:59], v[144:147], v[136:139], v[56:59]
    ds_read_b128 v[100:103], v6 offset:1024
    v_mfma_f32_16x16x32_bf16 v[24:27], v[148:151], v[132:135], v[24:27]
    ds_read_b128 v[104:107], v6 offset:2048
    v_mfma_f32_16x16x32_bf16 v[60:63], v[148:151], v[136:139], v[60:63]
    ds_read_b128 v[108:111], v6 offset:3072
    v_mfma_f32_16x16x32_bf16 v[28:31], v[152:155], v[132:135], v[28:31]
    ds_read_b128 v[112:115], v6 offset:4096
    v_mfma_f32_16x16x32_bf16 v[64:67], v[152:155], v[136:139], v[64:67]
    ds_read_b128 v[116:119], v6 offset:5120
    v_mfma_f32_16x16x32_bf16 v[32:35], v[156:159], v[132:135], v[32:35]
    ds_read_b128 v[120:123], v6 offset:6144
    v_mfma_f32_16x16x32_bf16 v[68:71], v[156:159], v[136:139], v[68:71]
    ds_read_b128 v[124:127], v6 offset:7168
    v_mfma_f32_16x16x32_bf16 v[36:39], v[160:163], v[132:135], v[36:39]
    ds_read_b128 v[128:131], v6 offset:8192
    v_mfma_f32_16x16x32_bf16 v[72:75], v[160:163], v[136:139], v[72:75]
    v_mfma_f32_16x16x32_bf16 v[40:43], v[164:167], v[132:135], v[40:43]
    v_mfma_f32_16x16x32_bf16 v[76:79], v[164:167], v[136:139], v[76:79]
    v_mfma_f32_16x16x32_bf16 v[44:47], v[168:171], v[132:135], v[44:47]
    v_mfma_f32_16x16x32_bf16 v[80:83], v[168:171], v[136:139], v[80:83]
    v_mfma_f32_16x16x32_bf16 v[48:51], v[172:175], v[132:135], v[48:51]
    v_mfma_f32_16x16x32_bf16 v[84:87], v[172:175], v[136:139], v[84:87]
    s_waitcnt lgkmcnt(0)
    v_mfma_f32_16x16x32_bf16 v[16:19], v[96:99], v[88:91], v[16:19]
    ds_read_b128 v[132:135], v7 offset:49152
    v_mfma_f32_16x16x32_bf16 v[52:55], v[96:99], v[92:95], v[52:55]
    ds_read_b128 v[136:139], v7 offset:51200
    v_mfma_f32_16x16x32_bf16 v[20:23], v[100:103], v[88:91], v[20:23]
    ds_read_b128 v[140:143], v6 offset:9216
    v_mfma_f32_16x16x32_bf16 v[56:59], v[100:103], v[92:95], v[56:59]
    ds_read_b128 v[144:147], v6 offset:10240
    v_mfma_f32_16x16x32_bf16 v[24:27], v[104:107], v[88:91], v[24:27]
    ds_read_b128 v[148:151], v6 offset:11264
    v_mfma_f32_16x16x32_bf16 v[60:63], v[104:107], v[92:95], v[60:63]
    ds_read_b128 v[152:155], v6 offset:12288
    v_mfma_f32_16x16x32_bf16 v[28:31], v[108:111], v[88:91], v[28:31]
    ds_read_b128 v[156:159], v6 offset:13312
    v_mfma_f32_16x16x32_bf16 v[64:67], v[108:111], v[92:95], v[64:67]
    ds_read_b128 v[160:163], v6 offset:14336
    v_mfma_f32_16x16x32_bf16 v[32:35], v[112:115], v[88:91], v[32:35]
    ds_read_b128 v[164:167], v6 offset:15360
    v_mfma_f32_16x16x32_bf16 v[68:71], v[112:115], v[92:95], v[68:71]
    ds_read_b128 v[168:171], v6 offset:16384
    v_mfma_f32_16x16x32_bf16 v[36:39], v[116:119], v[88:91], v[36:39]
    ds_read_b128 v[172:175], v6 offset:17408
    v_mfma_f32_16x16x32_bf16 v[72:75], v[116:119], v[92:95], v[72:75]
    v_mfma_f32_16x16x32_bf16 v[40:43], v[120:123], v[88:91], v[40:43]
    v_mfma_f32_16x16x32_bf16 v[76:79], v[120:123], v[92:95], v[76:79]
    v_mfma_f32_16x16x32_bf16 v[44:47], v[124:127], v[88:91], v[44:47]
    v_mfma_f32_16x16x32_bf16 v[80:83], v[124:127], v[92:95], v[80:83]
    v_mfma_f32_16x16x32_bf16 v[48:51], v[128:131], v[88:91], v[48:51]
    v_mfma_f32_16x16x32_bf16 v[84:87], v[128:131], v[92:95], v[84:87]
    s_waitcnt lgkmcnt(0)
    s_barrier
    v_mfma_f32_16x16x32_bf16 v[16:19], v[140:143], v[132:135], v[16:19]
    ds_read_b128 v[88:91], v4 offset:0
    v_mfma_f32_16x16x32_bf16 v[52:55], v[140:143], v[136:139], v[52:55]
    ds_read_b128 v[92:95], v4 offset:2048
    v_mfma_f32_16x16x32_bf16 v[20:23], v[144:147], v[132:135], v[20:23]
    ds_read_b128 v[96:99], v5 offset:0
    v_mfma_f32_16x16x32_bf16 v[56:59], v[144:147], v[136:139], v[56:59]
    ds_read_b128 v[100:103], v5 offset:1024
    v_mfma_f32_16x16x32_bf16 v[24:27], v[148:151], v[132:135], v[24:27]
    ds_read_b128 v[104:107], v5 offset:2048
    v_mfma_f32_16x16x32_bf16 v[60:63], v[148:151], v[136:139], v[60:63]
    ds_read_b128 v[108:111], v5 offset:3072
    v_mfma_f32_16x16x32_bf16 v[28:31], v[152:155], v[132:135], v[28:31]
    ds_read_b128 v[112:115], v5 offset:4096
    v_mfma_f32_16x16x32_bf16 v[64:67], v[152:155], v[136:139], v[64:67]
    ds_read_b128 v[116:119], v5 offset:5120
    v_mfma_f32_16x16x32_bf16 v[32:35], v[156:159], v[132:135], v[32:35]
    ds_read_b128 v[120:123], v5 offset:6144
    v_mfma_f32_16x16x32_bf16 v[68:71], v[156:159], v[136:139], v[68:71]
    ds_read_b128 v[124:127], v5 offset:7168
    v_mfma_f32_16x16x32_bf16 v[36:39], v[160:163], v[132:135], v[36:39]
    ds_read_b128 v[128:131], v5 offset:8192
    v_mfma_f32_16x16x32_bf16 v[72:75], v[160:163], v[136:139], v[72:75]
    v_mfma_f32_16x16x32_bf16 v[40:43], v[164:167], v[132:135], v[40:43]
    v_mfma_f32_16x16x32_bf16 v[76:79], v[164:167], v[136:139], v[76:79]
    v_mfma_f32_16x16x32_bf16 v[44:47], v[168:171], v[132:135], v[44:47]
    v_mfma_f32_16x16x32_bf16 v[80:83], v[168:171], v[136:139], v[80:83]
    v_mfma_f32_16x16x32_bf16 v[48:51], v[172:175], v[132:135], v[48:51]
    v_mfma_f32_16x16x32_bf16 v[84:87], v[172:175], v[136:139], v[84:87]
    s_waitcnt lgkmcnt(0)
    v_mfma_f32_16x16x32_bf16 v[16:19], v[96:99], v[88:91], v[16:19]
    ds_read_b128 v[132:135], v7 offset:0
    v_mfma_f32_16x16x32_bf16 v[52:55], v[96:99], v[92:95], v[52:55]
    ds_read_b128 v[136:139], v7 offset:2048
    v_mfma_f32_16x16x32_bf16 v[20:23], v[100:103], v[88:91], v[20:23]
    ds_read_b128 v[140:143], v5 offset:9216
    v_mfma_f32_16x16x32_bf16 v[56:59], v[100:103], v[92:95], v[56:59]
    ds_read_b128 v[144:147], v5 offset:10240
    v_mfma_f32_16x16x32_bf16 v[24:27], v[104:107], v[88:91], v[24:27]
    ds_read_b128 v[148:151], v5 offset:11264
    v_mfma_f32_16x16x32_bf16 v[60:63], v[104:107], v[92:95], v[60:63]
    ds_read_b128 v[152:155], v5 offset:12288
    v_mfma_f32_16x16x32_bf16 v[28:31], v[108:111], v[88:91], v[28:31]
    ds_read_b128 v[156:159], v5 offset:13312
    v_mfma_f32_16x16x32_bf16 v[64:67], v[108:111], v[92:95], v[64:67]
    ds_read_b128 v[160:163], v5 offset:14336
    v_mfma_f32_16x16x32_bf16 v[32:35], v[112:115], v[88:91], v[32:35]
    ds_read_b128 v[164:167], v5 offset:15360
    v_mfma_f32_16x16x32_bf16 v[68:71], v[112:115], v[92:95], v[68:71]
    ds_read_b128 v[168:171], v5 offset:16384
    v_mfma_f32_16x16x32_bf16 v[36:39], v[116:119], v[88:91], v[36:39]
    ds_read_b128 v[172:175], v5 offset:17408
    v_mfma_f32_16x16x32_bf16 v[72:75], v[116:119], v[92:95], v[72:75]
    v_mfma_f32_16x16x32_bf16 v[40:43], v[120:123], v[88:91], v[40:43]
    v_mfma_f32_16x16x32_bf16 v[76:79], v[120:123], v[92:95], v[76:79]
    v_mfma_f32_16x16x32_bf16 v[44:47], v[124:127], v[88:91], v[44:47]
    v_mfma_f32_16x16x32_bf16 v[80:83], v[124:127], v[92:95], v[80:83]
    v_mfma_f32_16x16x32_bf16 v[48:51], v[128:131], v[88:91], v[48:51]
    v_mfma_f32_16x16x32_bf16 v[84:87], v[128:131], v[92:95], v[84:87]
    s_waitcnt lgkmcnt(0)
    s_barrier
    v_mfma_f32_16x16x32_bf16 v[16:19], v[140:143], v[132:135], v[16:19]
    ds_read_b128 v[88:91], v4 offset:16384
    v_mfma_f32_16x16x32_bf16 v[52:55], v[140:143], v[136:139], v[52:55]
    ds_read_b128 v[92:95], v4 offset:18432
    v_mfma_f32_16x16x32_bf16 v[20:23], v[144:147], v[132:135], v[20:23]
    ds_read_b128 v[96:99], v5 offset:18432
    v_mfma_f32_16x16x32_bf16 v[56:59], v[144:147], v[136:139], v[56:59]
    ds_read_b128 v[100:103], v5 offset:19456
    v_mfma_f32_16x16x32_bf16 v[24:27], v[148:151], v[132:135], v[24:27]
    ds_read_b128 v[104:107], v5 offset:20480
    v_mfma_f32_16x16x32_bf16 v[60:63], v[148:151], v[136:139], v[60:63]
    ds_read_b128 v[108:111], v5 offset:21504
    v_mfma_f32_16x16x32_bf16 v[28:31], v[152:155], v[132:135], v[28:31]
    ds_read_b128 v[112:115], v5 offset:22528
    v_mfma_f32_16x16x32_bf16 v[64:67], v[152:155], v[136:139], v[64:67]
    ds_read_b128 v[116:119], v5 offset:23552
    v_mfma_f32_16x16x32_bf16 v[32:35], v[156:159], v[132:135], v[32:35]
    ds_read_b128 v[120:123], v5 offset:24576
    v_mfma_f32_16x16x32_bf16 v[68:71], v[156:159], v[136:139], v[68:71]
    ds_read_b128 v[124:127], v5 offset:25600
    v_mfma_f32_16x16x32_bf16 v[36:39], v[160:163], v[132:135], v[36:39]
    ds_read_b128 v[128:131], v5 offset:26624
    v_mfma_f32_16x16x32_bf16 v[72:75], v[160:163], v[136:139], v[72:75]
    v_mfma_f32_16x16x32_bf16 v[40:43], v[164:167], v[132:135], v[40:43]
    v_mfma_f32_16x16x32_bf16 v[76:79], v[164:167], v[136:139], v[76:79]
    v_mfma_f32_16x16x32_bf16 v[44:47], v[168:171], v[132:135], v[44:47]
    v_mfma_f32_16x16x32_bf16 v[80:83], v[168:171], v[136:139], v[80:83]
    v_mfma_f32_16x16x32_bf16 v[48:51], v[172:175], v[132:135], v[48:51]
    v_mfma_f32_16x16x32_bf16 v[84:87], v[172:175], v[136:139], v[84:87]
    s_waitcnt lgkmcnt(0)
    v_mfma_f32_16x16x32_bf16 v[16:19], v[96:99], v[88:91], v[16:19]
    ds_read_b128 v[132:135], v7 offset:16384
    v_mfma_f32_16x16x32_bf16 v[52:55], v[96:99], v[92:95], v[52:55]
    ds_read_b128 v[136:139], v7 offset:18432
    v_mfma_f32_16x16x32_bf16 v[20:23], v[100:103], v[88:91], v[20:23]
    ds_read_b128 v[140:143], v5 offset:27648
    v_mfma_f32_16x16x32_bf16 v[56:59], v[100:103], v[92:95], v[56:59]
    ds_read_b128 v[144:147], v5 offset:28672
    v_mfma_f32_16x16x32_bf16 v[24:27], v[104:107], v[88:91], v[24:27]
    ds_read_b128 v[148:151], v5 offset:29696
    v_mfma_f32_16x16x32_bf16 v[60:63], v[104:107], v[92:95], v[60:63]
    ds_read_b128 v[152:155], v5 offset:30720
    v_mfma_f32_16x16x32_bf16 v[28:31], v[108:111], v[88:91], v[28:31]
    ds_read_b128 v[156:159], v5 offset:31744
    v_mfma_f32_16x16x32_bf16 v[64:67], v[108:111], v[92:95], v[64:67]
    ds_read_b128 v[160:163], v5 offset:32768
    v_mfma_f32_16x16x32_bf16 v[32:35], v[112:115], v[88:91], v[32:35]
    ds_read_b128 v[164:167], v5 offset:33792
    v_mfma_f32_16x16x32_bf16 v[68:71], v[112:115], v[92:95], v[68:71]
    ds_read_b128 v[168:171], v5 offset:34816
    v_mfma_f32_16x16x32_bf16 v[36:39], v[116:119], v[88:91], v[36:39]
    ds_read_b128 v[172:175], v5 offset:35840
    v_mfma_f32_16x16x32_bf16 v[72:75], v[116:119], v[92:95], v[72:75]
    v_mfma_f32_16x16x32_bf16 v[40:43], v[120:123], v[88:91], v[40:43]
    v_mfma_f32_16x16x32_bf16 v[76:79], v[120:123], v[92:95], v[76:79]
    v_mfma_f32_16x16x32_bf16 v[44:47], v[124:127], v[88:91], v[44:47]
    v_mfma_f32_16x16x32_bf16 v[80:83], v[124:127], v[92:95], v[80:83]
    v_mfma_f32_16x16x32_bf16 v[48:51], v[128:131], v[88:91], v[48:51]
    v_mfma_f32_16x16x32_bf16 v[84:87], v[128:131], v[92:95], v[84:87]
    s_waitcnt lgkmcnt(0)
    s_barrier
    v_mfma_f32_16x16x32_bf16 v[16:19], v[140:143], v[132:135], v[16:19]
    v_mfma_f32_16x16x32_bf16 v[52:55], v[140:143], v[136:139], v[52:55]
    v_mfma_f32_16x16x32_bf16 v[20:23], v[144:147], v[132:135], v[20:23]
    v_mfma_f32_16x16x32_bf16 v[56:59], v[144:147], v[136:139], v[56:59]
    v_mfma_f32_16x16x32_bf16 v[24:27], v[148:151], v[132:135], v[24:27]
    v_mfma_f32_16x16x32_bf16 v[60:63], v[148:151], v[136:139], v[60:63]
    v_mfma_f32_16x16x32_bf16 v[28:31], v[152:155], v[132:135], v[28:31]
    v_mfma_f32_16x16x32_bf16 v[64:67], v[152:155], v[136:139], v[64:67]
    v_mfma_f32_16x16x32_bf16 v[32:35], v[156:159], v[132:135], v[32:35]
    v_mfma_f32_16x16x32_bf16 v[68:71], v[156:159], v[136:139], v[68:71]
    v_mfma_f32_16x16x32_bf16 v[36:39], v[160:163], v[132:135], v[36:39]
    v_mfma_f32_16x16x32_bf16 v[72:75], v[160:163], v[136:139], v[72:75]
    v_mfma_f32_16x16x32_bf16 v[40:43], v[164:167], v[132:135], v[40:43]
    v_mfma_f32_16x16x32_bf16 v[76:79], v[164:167], v[136:139], v[76:79]
    v_mfma_f32_16x16x32_bf16 v[44:47], v[168:171], v[132:135], v[44:47]
    v_mfma_f32_16x16x32_bf16 v[80:83], v[168:171], v[136:139], v[80:83]
    v_mfma_f32_16x16x32_bf16 v[48:51], v[172:175], v[132:135], v[48:51]
    v_mfma_f32_16x16x32_bf16 v[84:87], v[172:175], v[136:139], v[84:87]
    s_lshl_b32 s38, s21, 2
    s_add_u32 s38, s38, s23
    s_lshl_b32 s48, s38, 4
    s_add_u32 s48, s48, s22
    s_lshl_b32 s43, s48, 10
    s_add_u32 s43, s43, 8388608
    s_lshl_b32 s38, s38, 17
    s_lshl_b32 s39, s22, 10
    s_add_u32 s38, s38, s39
    s_add_u32 s38, s38, 0
    s_add_u32 s39, s38, 65536
    s_lshl_b32 s48, s21, 4
    s_add_u32 s48, s48, s22
    s_lshl_b32 s48, s48, 7
    s_add_u32 s48, s48, 15564800
    v_lshlrev_b32_e64 v8, 16, v176
    v_and_b32 v9, 0xffff0000, v176
    v_pk_mul_f32 v[16:17], v[16:17], v[8:9]
    v_lshlrev_b32_e64 v10, 16, v177
    v_and_b32 v11, 0xffff0000, v177
    v_pk_mul_f32 v[18:19], v[18:19], v[10:11]
    v_cvt_pk_bf16_f32 v88, v16, v17
    v_lshlrev_b32_e64 v8, 16, v178
    v_and_b32 v9, 0xffff0000, v178
    v_pk_mul_f32 v[20:21], v[20:21], v[8:9]
    v_cvt_pk_bf16_f32 v89, v18, v19
    v_lshlrev_b32_e64 v10, 16, v179
    v_and_b32 v11, 0xffff0000, v179
    v_pk_mul_f32 v[22:23], v[22:23], v[10:11]
    v_cvt_pk_bf16_f32 v90, v20, v21
    v_lshlrev_b32_e64 v8, 16, v194
    v_and_b32 v9, 0xffff0000, v194
    v_pk_mul_f32 v[52:53], v[52:53], v[8:9]
    v_cvt_pk_bf16_f32 v91, v22, v23
    buffer_store_dwordx4 v[88:91], v3, s[16:19], s38 offen sc1
    s_add_u32 s38, s38, 16384
    v_lshlrev_b32_e64 v10, 16, v195
    v_and_b32 v11, 0xffff0000, v195
    v_pk_mul_f32 v[54:55], v[54:55], v[10:11]
    v_cvt_pk_bf16_f32 v92, v52, v53
    v_lshlrev_b32_e64 v8, 16, v196
    v_and_b32 v9, 0xffff0000, v196
    v_pk_mul_f32 v[56:57], v[56:57], v[8:9]
    v_cvt_pk_bf16_f32 v93, v54, v55
    v_lshlrev_b32_e64 v10, 16, v197
    v_and_b32 v11, 0xffff0000, v197
    v_pk_mul_f32 v[58:59], v[58:59], v[10:11]
    v_cvt_pk_bf16_f32 v94, v56, v57
    v_lshlrev_b32_e64 v8, 16, v180
    v_and_b32 v9, 0xffff0000, v180
    v_pk_mul_f32 v[24:25], v[24:25], v[8:9]
    v_cvt_pk_bf16_f32 v95, v58, v59
    buffer_store_dwordx4 v[92:95], v3, s[16:19], s39 offen sc1
    s_add_u32 s39, s39, 16384
    v_lshlrev_b32_e64 v10, 16, v181
    v_and_b32 v11, 0xffff0000, v181
    v_pk_mul_f32 v[26:27], v[26:27], v[10:11]
    v_cvt_pk_bf16_f32 v96, v24, v25
    v_lshlrev_b32_e64 v8, 16, v182
    v_and_b32 v9, 0xffff0000, v182
    v_pk_mul_f32 v[28:29], v[28:29], v[8:9]
    v_cvt_pk_bf16_f32 v97, v26, v27
    v_lshlrev_b32_e64 v10, 16, v183
    v_and_b32 v11, 0xffff0000, v183
    v_pk_mul_f32 v[30:31], v[30:31], v[10:11]
    v_cvt_pk_bf16_f32 v98, v28, v29
    v_lshlrev_b32_e64 v8, 16, v198
    v_and_b32 v9, 0xffff0000, v198
    v_pk_mul_f32 v[60:61], v[60:61], v[8:9]
    v_cvt_pk_bf16_f32 v99, v30, v31
    v_lshlrev_b32_e64 v10, 16, v199
    v_and_b32 v11, 0xffff0000, v199
    v_pk_mul_f32 v[62:63], v[62:63], v[10:11]
    v_cvt_pk_bf16_f32 v100, v60, v61
    v_lshlrev_b32_e64 v8, 16, v200
    v_and_b32 v9, 0xffff0000, v200
    v_pk_mul_f32 v[64:65], v[64:65], v[8:9]
    v_cvt_pk_bf16_f32 v101, v62, v63
    v_lshlrev_b32_e64 v10, 16, v201
    v_and_b32 v11, 0xffff0000, v201
    v_pk_mul_f32 v[66:67], v[66:67], v[10:11]
    v_cvt_pk_bf16_f32 v102, v64, v65
    v_lshlrev_b32_e64 v8, 16, v184
    v_and_b32 v9, 0xffff0000, v184
    v_pk_mul_f32 v[32:33], v[32:33], v[8:9]
    v_cvt_pk_bf16_f32 v103, v66, v67
    v_lshlrev_b32_e64 v10, 16, v185
    v_and_b32 v11, 0xffff0000, v185
    v_pk_mul_f32 v[34:35], v[34:35], v[10:11]
    v_cvt_pk_bf16_f32 v104, v32, v33
    v_lshlrev_b32_e64 v8, 16, v186
    v_and_b32 v9, 0xffff0000, v186
    v_pk_mul_f32 v[36:37], v[36:37], v[8:9]
    v_cvt_pk_bf16_f32 v105, v34, v35
    v_lshlrev_b32_e64 v10, 16, v187
    v_and_b32 v11, 0xffff0000, v187
    v_pk_mul_f32 v[38:39], v[38:39], v[10:11]
    v_cvt_pk_bf16_f32 v106, v36, v37
    v_lshlrev_b32_e64 v8, 16, v202
    v_and_b32 v9, 0xffff0000, v202
    v_pk_mul_f32 v[68:69], v[68:69], v[8:9]
    v_cvt_pk_bf16_f32 v107, v38, v39
    v_lshlrev_b32_e64 v10, 16, v203
    v_and_b32 v11, 0xffff0000, v203
    v_pk_mul_f32 v[70:71], v[70:71], v[10:11]
    v_cvt_pk_bf16_f32 v108, v68, v69
    v_lshlrev_b32_e64 v8, 16, v204
    v_and_b32 v9, 0xffff0000, v204
    v_pk_mul_f32 v[72:73], v[72:73], v[8:9]
    v_cvt_pk_bf16_f32 v109, v70, v71
    v_lshlrev_b32_e64 v10, 16, v205
    v_and_b32 v11, 0xffff0000, v205
    v_pk_mul_f32 v[74:75], v[74:75], v[10:11]
    v_cvt_pk_bf16_f32 v110, v72, v73
    v_lshlrev_b32_e64 v8, 16, v188
    v_and_b32 v9, 0xffff0000, v188
    v_pk_mul_f32 v[40:41], v[40:41], v[8:9]
    v_cvt_pk_bf16_f32 v111, v74, v75
    v_lshlrev_b32_e64 v10, 16, v189
    v_and_b32 v11, 0xffff0000, v189
    v_pk_mul_f32 v[42:43], v[42:43], v[10:11]
    v_cvt_pk_bf16_f32 v112, v40, v41
    v_lshlrev_b32_e64 v8, 16, v190
    v_and_b32 v9, 0xffff0000, v190
    v_pk_mul_f32 v[44:45], v[44:45], v[8:9]
    v_cvt_pk_bf16_f32 v113, v42, v43
    v_lshlrev_b32_e64 v10, 16, v191
    v_and_b32 v11, 0xffff0000, v191
    v_pk_mul_f32 v[46:47], v[46:47], v[10:11]
    v_cvt_pk_bf16_f32 v114, v44, v45
    v_lshlrev_b32_e64 v8, 16, v206
    v_and_b32 v9, 0xffff0000, v206
    v_pk_mul_f32 v[76:77], v[76:77], v[8:9]
    v_cvt_pk_bf16_f32 v115, v46, v47
    v_lshlrev_b32_e64 v10, 16, v207
    v_and_b32 v11, 0xffff0000, v207
    v_pk_mul_f32 v[78:79], v[78:79], v[10:11]
    v_cvt_pk_bf16_f32 v116, v76, v77
    v_lshlrev_b32_e64 v8, 16, v208
    v_and_b32 v9, 0xffff0000, v208
    v_pk_mul_f32 v[80:81], v[80:81], v[8:9]
    v_cvt_pk_bf16_f32 v117, v78, v79
    v_lshlrev_b32_e64 v10, 16, v209
    v_and_b32 v11, 0xffff0000, v209
    v_pk_mul_f32 v[82:83], v[82:83], v[10:11]
    v_cvt_pk_bf16_f32 v118, v80, v81
    v_lshlrev_b32_e64 v8, 16, v192
    v_and_b32 v9, 0xffff0000, v192
    v_pk_mul_f32 v[48:49], v[48:49], v[8:9]
    v_cvt_pk_bf16_f32 v119, v82, v83
    v_lshlrev_b32_e64 v10, 16, v193
    v_and_b32 v11, 0xffff0000, v193
    v_pk_mul_f32 v[50:51], v[50:51], v[10:11]
    v_cvt_pk_bf16_f32 v120, v48, v49
    v_lshlrev_b32_e64 v8, 16, v210
    v_and_b32 v9, 0xffff0000, v210
    v_pk_mul_f32 v[84:85], v[84:85], v[8:9]
    v_cvt_pk_bf16_f32 v121, v50, v51
    v_lshlrev_b32_e64 v10, 16, v211
    v_and_b32 v11, 0xffff0000, v211
    v_pk_mul_f32 v[86:87], v[86:87], v[10:11]
    v_cvt_pk_bf16_f32 v122, v84, v85
    v_cvt_pk_bf16_f32 v123, v86, v87
    s_barrier
    v_mov_b32 v9, 147500
    v_mov_b32 v10, 1
    v_mov_b32_e64 v8, 0
    s_waitcnt vmcnt(0)
    s_mov_b64 exec, 1
    ds_add_rtn_u32 v10, v9, v10
    s_waitcnt lgkmcnt(0)
    v_cmp_eq_u32 vcc, 3, v10
    s_nop 0
    s_and_b64 exec, exec, vcc
    buffer_store_dword v8, v8, s[16:19], s48 offen sc1
    s_mov_b64 exec, -1
    s_add_u32 s48, s48, 32768
    buffer_store_dwordx4 v[96:99], v3, s[16:19], s38 offen sc1
    s_add_u32 s38, s38, 16384
    buffer_store_dwordx4 v[100:103], v3, s[16:19], s39 offen sc1
    s_add_u32 s39, s39, 16384
    v_mov_b32 v9, 147504
    v_mov_b32 v10, 1
    v_mov_b32_e64 v8, 0
    s_waitcnt vmcnt(0)
    s_mov_b64 exec, 1
    ds_add_rtn_u32 v10, v9, v10
    s_waitcnt lgkmcnt(0)
    v_cmp_eq_u32 vcc, 3, v10
    s_nop 0
    s_and_b64 exec, exec, vcc
    buffer_store_dword v8, v8, s[16:19], s48 offen sc1
    s_mov_b64 exec, -1
    s_add_u32 s48, s48, 32768
    buffer_store_dwordx4 v[104:107], v3, s[16:19], s38 offen sc1
    s_add_u32 s38, s38, 16384
    buffer_store_dwordx4 v[108:111], v3, s[16:19], s39 offen sc1
    s_add_u32 s39, s39, 16384
    buffer_store_dwordx4 v[112:115], v3, s[16:19], s38 offen sc1
    s_add_u32 s38, s38, 16384
    buffer_store_dwordx4 v[116:119], v3, s[16:19], s39 offen sc1
    s_add_u32 s39, s39, 16384
    buffer_store_dwordx4 v[120:123], v3, s[16:19], s43 offen sc1
    v_mov_b32 v9, 147508
    v_mov_b32 v10, 1
    v_mov_b32_e64 v8, 0
    s_waitcnt vmcnt(0)
    s_mov_b64 exec, 1
    ds_add_rtn_u32 v10, v9, v10
    s_waitcnt lgkmcnt(0)
    v_cmp_eq_u32 vcc, 3, v10
    s_nop 0
    s_and_b64 exec, exec, vcc
    buffer_store_dword v8, v8, s[16:19], s48 offen sc1
    s_mov_b64 exec, -1
    s_load_dwordx2 s[8:9], s[0:1], 64
    v_add_u32 v4, s31, v3
    v_add_u32 v6, 61440, v5
    s_and_b32 s38, s23, 2
    s_lshl_b32 s38, s38, 12
    s_and_b32 s39, s23, 1
    s_lshl_b32 s39, s39, 3
    s_add_u32 s38, s38, s39
    v_add_u32 v7, s38, v3
    v_mov_b32 v16, 0
    v_mov_b32 v17, 0
    v_mov_b32 v18, 0
    v_mov_b32 v19, 0
    v_mov_b32 v20, 0
    v_mov_b32 v21, 0
    v_mov_b32 v22, 0
    v_mov_b32 v23, 0
    v_mov_b32 v24, 0
    v_mov_b32 v25, 0
    v_mov_b32 v26, 0
    v_mov_b32 v27, 0
    v_mov_b32 v28, 0
    v_mov_b32 v29, 0
    v_mov_b32 v30, 0
    v_mov_b32 v31, 0
    v_mov_b32 v32, 0
    v_mov_b32 v33, 0
    v_mov_b32 v34, 0
    v_mov_b32_e64 v35, 0
    s_waitcnt lgkmcnt(0)
    s_mov_b32 s10, 2359296
    s_mov_b32 s11, 0x20000
    s_barrier
    ds_read_b128 v[36:39], v4 offset:32768
    ds_read_b128 v[40:43], v5 offset:40960
    ds_read_b128 v[44:47], v5 offset:41984
    ds_read_b128 v[48:51], v5 offset:43008
    ds_read_b128 v[52:55], v5 offset:44032
    ds_read_b128 v[56:59], v5 offset:45056
    ds_read_b128 v[60:63], v4 offset:33792
    ds_read_b128 v[64:67], v5 offset:46080
    ds_read_b128 v[68:71], v5 offset:47104
    ds_read_b128 v[72:75], v5 offset:48128
    ds_read_b128 v[76:79], v5 offset:49152
    ds_read_b128 v[80:83], v5 offset:50176
    s_mov_b32 s43, 3
sequential_preLN__sliding_block__mixer_gmlp__prompt_kernel_c6loop:
    s_waitcnt lgkmcnt(0)
    v_mfma_f32_16x16x32_bf16 v[16:19], v[40:43], v[36:39], v[16:19]
    ds_read_b128 v[84:87], v4 offset:34816
    ds_read_b128 v[88:91], v5 offset:51200
    v_mfma_f32_16x16x32_bf16 v[20:23], v[44:47], v[36:39], v[20:23]
    ds_read_b128 v[92:95], v5 offset:52224
    ds_read_b128 v[96:99], v5 offset:53248
    v_mfma_f32_16x16x32_bf16 v[24:27], v[48:51], v[36:39], v[24:27]
    ds_read_b128 v[100:103], v5 offset:54272
    ds_read_b128 v[104:107], v5 offset:55296
    v_mfma_f32_16x16x32_bf16 v[28:31], v[52:55], v[36:39], v[28:31]
    ds_read_b128 v[108:111], v4 offset:35840
    ds_read_b128 v[112:115], v5 offset:56320
    v_mfma_f32_16x16x32_bf16 v[32:35], v[56:59], v[36:39], v[32:35]
    ds_read_b128 v[116:119], v5 offset:57344
    ds_read_b128 v[120:123], v5 offset:58368
    v_mfma_f32_16x16x32_bf16 v[16:19], v[64:67], v[60:63], v[16:19]
    ds_read_b128 v[124:127], v5 offset:59392
    ds_read_b128 v[128:131], v5 offset:60416
    v_mfma_f32_16x16x32_bf16 v[20:23], v[68:71], v[60:63], v[20:23]
    v_mfma_f32_16x16x32_bf16 v[24:27], v[72:75], v[60:63], v[24:27]
    v_mfma_f32_16x16x32_bf16 v[28:31], v[76:79], v[60:63], v[28:31]
    v_mfma_f32_16x16x32_bf16 v[32:35], v[80:83], v[60:63], v[32:35]
    s_waitcnt lgkmcnt(0)
    s_barrier
    v_mfma_f32_16x16x32_bf16 v[16:19], v[88:91], v[84:87], v[16:19]
    ds_read_b128 v[36:39], v4 offset:49152
    ds_read_b128 v[40:43], v6 offset:0
    v_mfma_f32_16x16x32_bf16 v[20:23], v[92:95], v[84:87], v[20:23]
    ds_read_b128 v[44:47], v6 offset:1024
    ds_read_b128 v[48:51], v6 offset:2048
    v_mfma_f32_16x16x32_bf16 v[24:27], v[96:99], v[84:87], v[24:27]
    ds_read_b128 v[52:55], v6 offset:3072
    ds_read_b128 v[56:59], v6 offset:4096
    v_mfma_f32_16x16x32_bf16 v[28:31], v[100:103], v[84:87], v[28:31]
    ds_read_b128 v[60:63], v4 offset:50176
    ds_read_b128 v[64:67], v6 offset:5120
    v_mfma_f32_16x16x32_bf16 v[32:35], v[104:107], v[84:87], v[32:35]
    ds_read_b128 v[68:71], v6 offset:6144
    ds_read_b128 v[72:75], v6 offset:7168
    v_mfma_f32_16x16x32_bf16 v[16:19], v[112:115], v[108:111], v[16:19]
    ds_read_b128 v[76:79], v6 offset:8192
    ds_read_b128 v[80:83], v6 offset:9216
    v_mfma_f32_16x16x32_bf16 v[20:23], v[116:119], v[108:111], v[20:23]
    v_mfma_f32_16x16x32_bf16 v[24:27], v[120:123], v[108:111], v[24:27]
    v_mfma_f32_16x16x32_bf16 v[28:31], v[124:127], v[108:111], v[28:31]
    v_mfma_f32_16x16x32_bf16 v[32:35], v[128:131], v[108:111], v[32:35]
    s_waitcnt lgkmcnt(0)
    v_mfma_f32_16x16x32_bf16 v[16:19], v[40:43], v[36:39], v[16:19]
    ds_read_b128 v[84:87], v4 offset:51200
    ds_read_b128 v[88:91], v6 offset:10240
    v_mfma_f32_16x16x32_bf16 v[20:23], v[44:47], v[36:39], v[20:23]
    ds_read_b128 v[92:95], v6 offset:11264
    ds_read_b128 v[96:99], v6 offset:12288
    v_mfma_f32_16x16x32_bf16 v[24:27], v[48:51], v[36:39], v[24:27]
    ds_read_b128 v[100:103], v6 offset:13312
    ds_read_b128 v[104:107], v6 offset:14336
    v_mfma_f32_16x16x32_bf16 v[28:31], v[52:55], v[36:39], v[28:31]
    ds_read_b128 v[108:111], v4 offset:52224
    ds_read_b128 v[112:115], v6 offset:15360
    v_mfma_f32_16x16x32_bf16 v[32:35], v[56:59], v[36:39], v[32:35]
    ds_read_b128 v[116:119], v6 offset:16384
    ds_read_b128 v[120:123], v6 offset:17408
    v_mfma_f32_16x16x32_bf16 v[16:19], v[64:67], v[60:63], v[16:19]
    ds_read_b128 v[124:127], v6 offset:18432
    ds_read_b128 v[128:131], v6 offset:19456
    v_mfma_f32_16x16x32_bf16 v[20:23], v[68:71], v[60:63], v[20:23]
    v_mfma_f32_16x16x32_bf16 v[24:27], v[72:75], v[60:63], v[24:27]
    v_mfma_f32_16x16x32_bf16 v[28:31], v[76:79], v[60:63], v[28:31]
    v_mfma_f32_16x16x32_bf16 v[32:35], v[80:83], v[60:63], v[32:35]
    s_waitcnt lgkmcnt(0)
    s_barrier
    v_mfma_f32_16x16x32_bf16 v[16:19], v[88:91], v[84:87], v[16:19]
    ds_read_b128 v[36:39], v4 offset:0
    ds_read_b128 v[40:43], v5 offset:0
    v_mfma_f32_16x16x32_bf16 v[20:23], v[92:95], v[84:87], v[20:23]
    ds_read_b128 v[44:47], v5 offset:1024
    ds_read_b128 v[48:51], v5 offset:2048
    v_mfma_f32_16x16x32_bf16 v[24:27], v[96:99], v[84:87], v[24:27]
    ds_read_b128 v[52:55], v5 offset:3072
    ds_read_b128 v[56:59], v5 offset:4096
    v_mfma_f32_16x16x32_bf16 v[28:31], v[100:103], v[84:87], v[28:31]
    ds_read_b128 v[60:63], v4 offset:1024
    ds_read_b128 v[64:67], v5 offset:5120
    v_mfma_f32_16x16x32_bf16 v[32:35], v[104:107], v[84:87], v[32:35]
    ds_read_b128 v[68:71], v5 offset:6144
    ds_read_b128 v[72:75], v5 offset:7168
    v_mfma_f32_16x16x32_bf16 v[16:19], v[112:115], v[108:111], v[16:19]
    ds_read_b128 v[76:79], v5 offset:8192
    ds_read_b128 v[80:83], v5 offset:9216
    v_mfma_f32_16x16x32_bf16 v[20:23], v[116:119], v[108:111], v[20:23]
    v_mfma_f32_16x16x32_bf16 v[24:27], v[120:123], v[108:111], v[24:27]
    v_mfma_f32_16x16x32_bf16 v[28:31], v[124:127], v[108:111], v[28:31]
    v_mfma_f32_16x16x32_bf16 v[32:35], v[128:131], v[108:111], v[32:35]
    s_waitcnt lgkmcnt(0)
    v_mfma_f32_16x16x32_bf16 v[16:19], v[40:43], v[36:39], v[16:19]
    ds_read_b128 v[84:87], v4 offset:2048
    ds_read_b128 v[88:91], v5 offset:10240
    v_mfma_f32_16x16x32_bf16 v[20:23], v[44:47], v[36:39], v[20:23]
    ds_read_b128 v[92:95], v5 offset:11264
    ds_read_b128 v[96:99], v5 offset:12288
    v_mfma_f32_16x16x32_bf16 v[24:27], v[48:51], v[36:39], v[24:27]
    ds_read_b128 v[100:103], v5 offset:13312
    ds_read_b128 v[104:107], v5 offset:14336
    v_mfma_f32_16x16x32_bf16 v[28:31], v[52:55], v[36:39], v[28:31]
    ds_read_b128 v[108:111], v4 offset:3072
    ds_read_b128 v[112:115], v5 offset:15360
    v_mfma_f32_16x16x32_bf16 v[32:35], v[56:59], v[36:39], v[32:35]
    ds_read_b128 v[116:119], v5 offset:16384
    ds_read_b128 v[120:123], v5 offset:17408
    v_mfma_f32_16x16x32_bf16 v[16:19], v[64:67], v[60:63], v[16:19]
    ds_read_b128 v[124:127], v5 offset:18432
    ds_read_b128 v[128:131], v5 offset:19456
    v_mfma_f32_16x16x32_bf16 v[20:23], v[68:71], v[60:63], v[20:23]
    v_mfma_f32_16x16x32_bf16 v[24:27], v[72:75], v[60:63], v[24:27]
    v_mfma_f32_16x16x32_bf16 v[28:31], v[76:79], v[60:63], v[28:31]
    v_mfma_f32_16x16x32_bf16 v[32:35], v[80:83], v[60:63], v[32:35]
    s_waitcnt lgkmcnt(0)
    s_barrier
    v_mfma_f32_16x16x32_bf16 v[16:19], v[88:91], v[84:87], v[16:19]
    ds_read_b128 v[36:39], v4 offset:16384
    ds_read_b128 v[40:43], v5 offset:20480
    v_mfma_f32_16x16x32_bf16 v[20:23], v[92:95], v[84:87], v[20:23]
    ds_read_b128 v[44:47], v5 offset:21504
    ds_read_b128 v[48:51], v5 offset:22528
    v_mfma_f32_16x16x32_bf16 v[24:27], v[96:99], v[84:87], v[24:27]
    ds_read_b128 v[52:55], v5 offset:23552
    ds_read_b128 v[56:59], v5 offset:24576
    v_mfma_f32_16x16x32_bf16 v[28:31], v[100:103], v[84:87], v[28:31]
    ds_read_b128 v[60:63], v4 offset:17408
    ds_read_b128 v[64:67], v5 offset:25600
    v_mfma_f32_16x16x32_bf16 v[32:35], v[104:107], v[84:87], v[32:35]
    ds_read_b128 v[68:71], v5 offset:26624
    ds_read_b128 v[72:75], v5 offset:27648
    v_mfma_f32_16x16x32_bf16 v[16:19], v[112:115], v[108:111], v[16:19]
    ds_read_b128 v[76:79], v5 offset:28672
    ds_read_b128 v[80:83], v5 offset:29696
    v_mfma_f32_16x16x32_bf16 v[20:23], v[116:119], v[108:111], v[20:23]
    v_mfma_f32_16x16x32_bf16 v[24:27], v[120:123], v[108:111], v[24:27]
    v_mfma_f32_16x16x32_bf16 v[28:31], v[124:127], v[108:111], v[28:31]
    v_mfma_f32_16x16x32_bf16 v[32:35], v[128:131], v[108:111], v[32:35]
    s_waitcnt lgkmcnt(0)
    v_mfma_f32_16x16x32_bf16 v[16:19], v[40:43], v[36:39], v[16:19]
    ds_read_b128 v[84:87], v4 offset:18432
    ds_read_b128 v[88:91], v5 offset:30720
    v_mfma_f32_16x16x32_bf16 v[20:23], v[44:47], v[36:39], v[20:23]
    ds_read_b128 v[92:95], v5 offset:31744
    ds_read_b128 v[96:99], v5 offset:32768
    v_mfma_f32_16x16x32_bf16 v[24:27], v[48:51], v[36:39], v[24:27]
    ds_read_b128 v[100:103], v5 offset:33792
    ds_read_b128 v[104:107], v5 offset:34816
    v_mfma_f32_16x16x32_bf16 v[28:31], v[52:55], v[36:39], v[28:31]
    ds_read_b128 v[108:111], v4 offset:19456
    ds_read_b128 v[112:115], v5 offset:35840
    v_mfma_f32_16x16x32_bf16 v[32:35], v[56:59], v[36:39], v[32:35]
    ds_read_b128 v[116:119], v5 offset:36864
    ds_read_b128 v[120:123], v5 offset:37888
    v_mfma_f32_16x16x32_bf16 v[16:19], v[64:67], v[60:63], v[16:19]
    ds_read_b128 v[124:127], v5 offset:38912
    ds_read_b128 v[128:131], v5 offset:39936
    v_mfma_f32_16x16x32_bf16 v[20:23], v[68:71], v[60:63], v[20:23]
    v_mfma_f32_16x16x32_bf16 v[24:27], v[72:75], v[60:63], v[24:27]
    v_mfma_f32_16x16x32_bf16 v[28:31], v[76:79], v[60:63], v[28:31]
    v_mfma_f32_16x16x32_bf16 v[32:35], v[80:83], v[60:63], v[32:35]
    s_waitcnt lgkmcnt(0)
    s_barrier
    v_mfma_f32_16x16x32_bf16 v[16:19], v[88:91], v[84:87], v[16:19]
    ds_read_b128 v[36:39], v4 offset:32768
    ds_read_b128 v[40:43], v5 offset:40960
    v_mfma_f32_16x16x32_bf16 v[20:23], v[92:95], v[84:87], v[20:23]
    ds_read_b128 v[44:47], v5 offset:41984
    ds_read_b128 v[48:51], v5 offset:43008
    v_mfma_f32_16x16x32_bf16 v[24:27], v[96:99], v[84:87], v[24:27]
    ds_read_b128 v[52:55], v5 offset:44032
    ds_read_b128 v[56:59], v5 offset:45056
    v_mfma_f32_16x16x32_bf16 v[28:31], v[100:103], v[84:87], v[28:31]
    ds_read_b128 v[60:63], v4 offset:33792
    ds_read_b128 v[64:67], v5 offset:46080
    v_mfma_f32_16x16x32_bf16 v[32:35], v[104:107], v[84:87], v[32:35]
    ds_read_b128 v[68:71], v5 offset:47104
    ds_read_b128 v[72:75], v5 offset:48128
    v_mfma_f32_16x16x32_bf16 v[16:19], v[112:115], v[108:111], v[16:19]
    ds_read_b128 v[76:79], v5 offset:49152
    ds_read_b128 v[80:83], v5 offset:50176
    v_mfma_f32_16x16x32_bf16 v[20:23], v[116:119], v[108:111], v[20:23]
    v_mfma_f32_16x16x32_bf16 v[24:27], v[120:123], v[108:111], v[24:27]
    v_mfma_f32_16x16x32_bf16 v[28:31], v[124:127], v[108:111], v[28:31]
    v_mfma_f32_16x16x32_bf16 v[32:35], v[128:131], v[108:111], v[32:35]
    s_sub_u32 s43, s43, 1
    s_cmp_lg_u32 s43, 0
    s_cbranch_scc1 sequential_preLN__sliding_block__mixer_gmlp__prompt_kernel_c6loop
    s_waitcnt lgkmcnt(0)
    v_mfma_f32_16x16x32_bf16 v[16:19], v[40:43], v[36:39], v[16:19]
    ds_read_b128 v[84:87], v4 offset:34816
    ds_read_b128 v[88:91], v5 offset:51200
    v_mfma_f32_16x16x32_bf16 v[20:23], v[44:47], v[36:39], v[20:23]
    ds_read_b128 v[92:95], v5 offset:52224
    ds_read_b128 v[96:99], v5 offset:53248
    v_mfma_f32_16x16x32_bf16 v[24:27], v[48:51], v[36:39], v[24:27]
    ds_read_b128 v[100:103], v5 offset:54272
    ds_read_b128 v[104:107], v5 offset:55296
    v_mfma_f32_16x16x32_bf16 v[28:31], v[52:55], v[36:39], v[28:31]
    ds_read_b128 v[108:111], v4 offset:35840
    ds_read_b128 v[112:115], v5 offset:56320
    v_mfma_f32_16x16x32_bf16 v[32:35], v[56:59], v[36:39], v[32:35]
    ds_read_b128 v[116:119], v5 offset:57344
    ds_read_b128 v[120:123], v5 offset:58368
    v_mfma_f32_16x16x32_bf16 v[16:19], v[64:67], v[60:63], v[16:19]
    ds_read_b128 v[124:127], v5 offset:59392
    ds_read_b128 v[128:131], v5 offset:60416
    v_mfma_f32_16x16x32_bf16 v[20:23], v[68:71], v[60:63], v[20:23]
    v_mfma_f32_16x16x32_bf16 v[24:27], v[72:75], v[60:63], v[24:27]
    v_mfma_f32_16x16x32_bf16 v[28:31], v[76:79], v[60:63], v[28:31]
    v_mfma_f32_16x16x32_bf16 v[32:35], v[80:83], v[60:63], v[32:35]
    s_waitcnt lgkmcnt(0)
    s_barrier
    v_mfma_f32_16x16x32_bf16 v[16:19], v[88:91], v[84:87], v[16:19]
    ds_read_b128 v[36:39], v4 offset:49152
    ds_read_b128 v[40:43], v6 offset:0
    v_mfma_f32_16x16x32_bf16 v[20:23], v[92:95], v[84:87], v[20:23]
    ds_read_b128 v[44:47], v6 offset:1024
    ds_read_b128 v[48:51], v6 offset:2048
    v_mfma_f32_16x16x32_bf16 v[24:27], v[96:99], v[84:87], v[24:27]
    ds_read_b128 v[52:55], v6 offset:3072
    ds_read_b128 v[56:59], v6 offset:4096
    v_mfma_f32_16x16x32_bf16 v[28:31], v[100:103], v[84:87], v[28:31]
    ds_read_b128 v[60:63], v4 offset:50176
    ds_read_b128 v[64:67], v6 offset:5120
    v_mfma_f32_16x16x32_bf16 v[32:35], v[104:107], v[84:87], v[32:35]
    ds_read_b128 v[68:71], v6 offset:6144
    ds_read_b128 v[72:75], v6 offset:7168
    v_mfma_f32_16x16x32_bf16 v[16:19], v[112:115], v[108:111], v[16:19]
    ds_read_b128 v[76:79], v6 offset:8192
    ds_read_b128 v[80:83], v6 offset:9216
    v_mfma_f32_16x16x32_bf16 v[20:23], v[116:119], v[108:111], v[20:23]
    v_mfma_f32_16x16x32_bf16 v[24:27], v[120:123], v[108:111], v[24:27]
    v_mfma_f32_16x16x32_bf16 v[28:31], v[124:127], v[108:111], v[28:31]
    v_mfma_f32_16x16x32_bf16 v[32:35], v[128:131], v[108:111], v[32:35]
    s_waitcnt lgkmcnt(0)
    v_mfma_f32_16x16x32_bf16 v[16:19], v[40:43], v[36:39], v[16:19]
    ds_read_b128 v[84:87], v4 offset:51200
    ds_read_b128 v[88:91], v6 offset:10240
    v_mfma_f32_16x16x32_bf16 v[20:23], v[44:47], v[36:39], v[20:23]
    ds_read_b128 v[92:95], v6 offset:11264
    ds_read_b128 v[96:99], v6 offset:12288
    v_mfma_f32_16x16x32_bf16 v[24:27], v[48:51], v[36:39], v[24:27]
    ds_read_b128 v[100:103], v6 offset:13312
    ds_read_b128 v[104:107], v6 offset:14336
    v_mfma_f32_16x16x32_bf16 v[28:31], v[52:55], v[36:39], v[28:31]
    ds_read_b128 v[108:111], v4 offset:52224
    ds_read_b128 v[112:115], v6 offset:15360
    v_mfma_f32_16x16x32_bf16 v[32:35], v[56:59], v[36:39], v[32:35]
    ds_read_b128 v[116:119], v6 offset:16384
    ds_read_b128 v[120:123], v6 offset:17408
    v_mfma_f32_16x16x32_bf16 v[16:19], v[64:67], v[60:63], v[16:19]
    ds_read_b128 v[124:127], v6 offset:18432
    ds_read_b128 v[128:131], v6 offset:19456
    v_mfma_f32_16x16x32_bf16 v[20:23], v[68:71], v[60:63], v[20:23]
    v_mfma_f32_16x16x32_bf16 v[24:27], v[72:75], v[60:63], v[24:27]
    v_mfma_f32_16x16x32_bf16 v[28:31], v[76:79], v[60:63], v[28:31]
    v_mfma_f32_16x16x32_bf16 v[32:35], v[80:83], v[60:63], v[32:35]
    s_waitcnt lgkmcnt(0)
    s_barrier
    v_mfma_f32_16x16x32_bf16 v[16:19], v[88:91], v[84:87], v[16:19]
    ds_read_b128 v[36:39], v4 offset:0
    ds_read_b128 v[40:43], v5 offset:0
    v_mfma_f32_16x16x32_bf16 v[20:23], v[92:95], v[84:87], v[20:23]
    ds_read_b128 v[44:47], v5 offset:1024
    ds_read_b128 v[48:51], v5 offset:2048
    v_mfma_f32_16x16x32_bf16 v[24:27], v[96:99], v[84:87], v[24:27]
    ds_read_b128 v[52:55], v5 offset:3072
    ds_read_b128 v[56:59], v5 offset:4096
    v_mfma_f32_16x16x32_bf16 v[28:31], v[100:103], v[84:87], v[28:31]
    ds_read_b128 v[60:63], v4 offset:1024
    ds_read_b128 v[64:67], v5 offset:5120
    v_mfma_f32_16x16x32_bf16 v[32:35], v[104:107], v[84:87], v[32:35]
    ds_read_b128 v[68:71], v5 offset:6144
    ds_read_b128 v[72:75], v5 offset:7168
    v_mfma_f32_16x16x32_bf16 v[16:19], v[112:115], v[108:111], v[16:19]
    ds_read_b128 v[76:79], v5 offset:8192
    ds_read_b128 v[80:83], v5 offset:9216
    v_mfma_f32_16x16x32_bf16 v[20:23], v[116:119], v[108:111], v[20:23]
    v_mfma_f32_16x16x32_bf16 v[24:27], v[120:123], v[108:111], v[24:27]
    v_mfma_f32_16x16x32_bf16 v[28:31], v[124:127], v[108:111], v[28:31]
    v_mfma_f32_16x16x32_bf16 v[32:35], v[128:131], v[108:111], v[32:35]
    s_waitcnt lgkmcnt(0)
    v_mfma_f32_16x16x32_bf16 v[16:19], v[40:43], v[36:39], v[16:19]
    ds_read_b128 v[84:87], v4 offset:2048
    ds_read_b128 v[88:91], v5 offset:10240
    v_mfma_f32_16x16x32_bf16 v[20:23], v[44:47], v[36:39], v[20:23]
    ds_read_b128 v[92:95], v5 offset:11264
    ds_read_b128 v[96:99], v5 offset:12288
    v_mfma_f32_16x16x32_bf16 v[24:27], v[48:51], v[36:39], v[24:27]
    ds_read_b128 v[100:103], v5 offset:13312
    ds_read_b128 v[104:107], v5 offset:14336
    v_mfma_f32_16x16x32_bf16 v[28:31], v[52:55], v[36:39], v[28:31]
    ds_read_b128 v[108:111], v4 offset:3072
    ds_read_b128 v[112:115], v5 offset:15360
    v_mfma_f32_16x16x32_bf16 v[32:35], v[56:59], v[36:39], v[32:35]
    ds_read_b128 v[116:119], v5 offset:16384
    ds_read_b128 v[120:123], v5 offset:17408
    v_mfma_f32_16x16x32_bf16 v[16:19], v[64:67], v[60:63], v[16:19]
    ds_read_b128 v[124:127], v5 offset:18432
    ds_read_b128 v[128:131], v5 offset:19456
    v_mfma_f32_16x16x32_bf16 v[20:23], v[68:71], v[60:63], v[20:23]
    v_mfma_f32_16x16x32_bf16 v[24:27], v[72:75], v[60:63], v[24:27]
    v_mfma_f32_16x16x32_bf16 v[28:31], v[76:79], v[60:63], v[28:31]
    v_mfma_f32_16x16x32_bf16 v[32:35], v[80:83], v[60:63], v[32:35]
    s_waitcnt lgkmcnt(0)
    s_barrier
    v_mfma_f32_16x16x32_bf16 v[16:19], v[88:91], v[84:87], v[16:19]
    ds_read_b128 v[36:39], v4 offset:16384
    ds_read_b128 v[40:43], v5 offset:20480
    v_mfma_f32_16x16x32_bf16 v[20:23], v[92:95], v[84:87], v[20:23]
    ds_read_b128 v[44:47], v5 offset:21504
    ds_read_b128 v[48:51], v5 offset:22528
    v_mfma_f32_16x16x32_bf16 v[24:27], v[96:99], v[84:87], v[24:27]
    ds_read_b128 v[52:55], v5 offset:23552
    ds_read_b128 v[56:59], v5 offset:24576
    v_mfma_f32_16x16x32_bf16 v[28:31], v[100:103], v[84:87], v[28:31]
    ds_read_b128 v[60:63], v4 offset:17408
    ds_read_b128 v[64:67], v5 offset:25600
    v_mfma_f32_16x16x32_bf16 v[32:35], v[104:107], v[84:87], v[32:35]
    ds_read_b128 v[68:71], v5 offset:26624
    ds_read_b128 v[72:75], v5 offset:27648
    v_mfma_f32_16x16x32_bf16 v[16:19], v[112:115], v[108:111], v[16:19]
    ds_read_b128 v[76:79], v5 offset:28672
    ds_read_b128 v[80:83], v5 offset:29696
    v_mfma_f32_16x16x32_bf16 v[20:23], v[116:119], v[108:111], v[20:23]
    v_mfma_f32_16x16x32_bf16 v[24:27], v[120:123], v[108:111], v[24:27]
    v_mfma_f32_16x16x32_bf16 v[28:31], v[124:127], v[108:111], v[28:31]
    v_mfma_f32_16x16x32_bf16 v[32:35], v[128:131], v[108:111], v[32:35]
    s_waitcnt lgkmcnt(0)
    v_mfma_f32_16x16x32_bf16 v[16:19], v[40:43], v[36:39], v[16:19]
    ds_read_b128 v[84:87], v4 offset:18432
    ds_read_b128 v[88:91], v5 offset:30720
    v_mfma_f32_16x16x32_bf16 v[20:23], v[44:47], v[36:39], v[20:23]
    ds_read_b128 v[92:95], v5 offset:31744
    ds_read_b128 v[96:99], v5 offset:32768
    v_mfma_f32_16x16x32_bf16 v[24:27], v[48:51], v[36:39], v[24:27]
    ds_read_b128 v[100:103], v5 offset:33792
    ds_read_b128 v[104:107], v5 offset:34816
    v_mfma_f32_16x16x32_bf16 v[28:31], v[52:55], v[36:39], v[28:31]
    ds_read_b128 v[108:111], v4 offset:19456
    ds_read_b128 v[112:115], v5 offset:35840
    v_mfma_f32_16x16x32_bf16 v[32:35], v[56:59], v[36:39], v[32:35]
    ds_read_b128 v[116:119], v5 offset:36864
    ds_read_b128 v[120:123], v5 offset:37888
    v_mfma_f32_16x16x32_bf16 v[16:19], v[64:67], v[60:63], v[16:19]
    ds_read_b128 v[124:127], v5 offset:38912
    ds_read_b128 v[128:131], v5 offset:39936
    v_mfma_f32_16x16x32_bf16 v[20:23], v[68:71], v[60:63], v[20:23]
    v_mfma_f32_16x16x32_bf16 v[24:27], v[72:75], v[60:63], v[24:27]
    v_mfma_f32_16x16x32_bf16 v[28:31], v[76:79], v[60:63], v[28:31]
    v_mfma_f32_16x16x32_bf16 v[32:35], v[80:83], v[60:63], v[32:35]
    s_waitcnt lgkmcnt(0)
    s_barrier
    v_mfma_f32_16x16x32_bf16 v[16:19], v[88:91], v[84:87], v[16:19]
    ds_read_b64 v[36:37], v7 offset:32768
    ds_read_b64 v[38:39], v7 offset:36864
    ds_read_b128 v[40:43], v5 offset:40960
    v_mfma_f32_16x16x32_bf16 v[20:23], v[92:95], v[84:87], v[20:23]
    ds_read_b128 v[44:47], v5 offset:41984
    ds_read_b128 v[48:51], v5 offset:43008
    v_mfma_f32_16x16x32_bf16 v[24:27], v[96:99], v[84:87], v[24:27]
    ds_read_b128 v[52:55], v5 offset:44032
    ds_read_b128 v[56:59], v5 offset:45056
    v_mfma_f32_16x16x32_bf16 v[28:31], v[100:103], v[84:87], v[28:31]
    ds_read_b64 v[60:61], v7 offset:33792
    ds_read_b64 v[62:63], v7 offset:37888
    ds_read_b128 v[64:67], v5 offset:46080
    v_mfma_f32_16x16x32_bf16 v[32:35], v[104:107], v[84:87], v[32:35]
    ds_read_b128 v[68:71], v5 offset:47104
    ds_read_b128 v[72:75], v5 offset:48128
    v_mfma_f32_16x16x32_bf16 v[16:19], v[112:115], v[108:111], v[16:19]
    ds_read_b128 v[76:79], v5 offset:49152
    ds_read_b128 v[80:83], v5 offset:50176
    v_mfma_f32_16x16x32_bf16 v[20:23], v[116:119], v[108:111], v[20:23]
    v_mfma_f32_16x16x32_bf16 v[24:27], v[120:123], v[108:111], v[24:27]
    v_mfma_f32_16x16x32_bf16 v[28:31], v[124:127], v[108:111], v[28:31]
    v_mfma_f32_16x16x32_bf16 v[32:35], v[128:131], v[108:111], v[32:35]
    s_waitcnt lgkmcnt(0)
    v_mfma_f32_16x16x32_bf16 v[16:19], v[40:43], v[36:39], v[16:19]
    ds_read_b64 v[84:85], v7 offset:34816
    ds_read_b64 v[86:87], v7 offset:38912
    ds_read_b128 v[88:91], v5 offset:51200
    v_mfma_f32_16x16x32_bf16 v[20:23], v[44:47], v[36:39], v[20:23]
    ds_read_b128 v[92:95], v5 offset:52224
    ds_read_b128 v[96:99], v5 offset:53248
    v_mfma_f32_16x16x32_bf16 v[24:27], v[48:51], v[36:39], v[24:27]
    ds_read_b128 v[100:103], v5 offset:54272
    ds_read_b128 v[104:107], v5 offset:55296
    v_mfma_f32_16x16x32_bf16 v[28:31], v[52:55], v[36:39], v[28:31]
    ds_read_b64 v[108:109], v7 offset:35840
    ds_read_b64 v[110:111], v7 offset:39936
    ds_read_b128 v[112:115], v5 offset:56320
    v_mfma_f32_16x16x32_bf16 v[32:35], v[56:59], v[36:39], v[32:35]
    ds_read_b128 v[116:119], v5 offset:57344
    ds_read_b128 v[120:123], v5 offset:58368
    v_mfma_f32_16x16x32_bf16 v[16:19], v[64:67], v[60:63], v[16:19]
    ds_read_b128 v[124:127], v5 offset:59392
    ds_read_b128 v[128:131], v5 offset:60416
    v_mfma_f32_16x16x32_bf16 v[20:23], v[68:71], v[60:63], v[20:23]
    v_mfma_f32_16x16x32_bf16 v[24:27], v[72:75], v[60:63], v[24:27]
    v_mfma_f32_16x16x32_bf16 v[28:31], v[76:79], v[60:63], v[28:31]
    v_mfma_f32_16x16x32_bf16 v[32:35], v[80:83], v[60:63], v[32:35]
    s_waitcnt lgkmcnt(0)
    s_barrier
    v_mfma_f32_16x16x32_bf16 v[16:19], v[88:91], v[84:87], v[16:19]
    ds_read_b64 v[36:37], v7 offset:49152
    ds_read_b64 v[38:39], v7 offset:53248
    ds_read_b128 v[40:43], v6 offset:0
    v_mfma_f32_16x16x32_bf16 v[20:23], v[92:95], v[84:87], v[20:23]
    ds_read_b128 v[44:47], v6 offset:1024
    ds_read_b128 v[48:51], v6 offset:2048
    v_mfma_f32_16x16x32_bf16 v[24:27], v[96:99], v[84:87], v[24:27]
    ds_read_b128 v[52:55], v6 offset:3072
    ds_read_b128 v[56:59], v6 offset:4096
    v_mfma_f32_16x16x32_bf16 v[28:31], v[100:103], v[84:87], v[28:31]
    ds_read_b64 v[60:61], v7 offset:50176
    ds_read_b64 v[62:63], v7 offset:54272
    ds_read_b128 v[64:67], v6 offset:5120
    v_mfma_f32_16x16x32_bf16 v[32:35], v[104:107], v[84:87], v[32:35]
    ds_read_b128 v[68:71], v6 offset:6144
    ds_read_b128 v[72:75], v6 offset:7168
    v_mfma_f32_16x16x32_bf16 v[16:19], v[112:115], v[108:111], v[16:19]
    ds_read_b128 v[76:79], v6 offset:8192
    ds_read_b128 v[80:83], v6 offset:9216
    v_mfma_f32_16x16x32_bf16 v[20:23], v[116:119], v[108:111], v[20:23]
    v_mfma_f32_16x16x32_bf16 v[24:27], v[120:123], v[108:111], v[24:27]
    v_mfma_f32_16x16x32_bf16 v[28:31], v[124:127], v[108:111], v[28:31]
    v_mfma_f32_16x16x32_bf16 v[32:35], v[128:131], v[108:111], v[32:35]
    s_waitcnt lgkmcnt(0)
    v_mfma_f32_16x16x32_bf16 v[16:19], v[40:43], v[36:39], v[16:19]
    ds_read_b64 v[84:85], v7 offset:51200
    ds_read_b64 v[86:87], v7 offset:55296
    ds_read_b128 v[88:91], v6 offset:10240
    v_mfma_f32_16x16x32_bf16 v[20:23], v[44:47], v[36:39], v[20:23]
    ds_read_b128 v[92:95], v6 offset:11264
    ds_read_b128 v[96:99], v6 offset:12288
    v_mfma_f32_16x16x32_bf16 v[24:27], v[48:51], v[36:39], v[24:27]
    ds_read_b128 v[100:103], v6 offset:13312
    ds_read_b128 v[104:107], v6 offset:14336
    v_mfma_f32_16x16x32_bf16 v[28:31], v[52:55], v[36:39], v[28:31]
    ds_read_b64 v[108:109], v7 offset:52224
    ds_read_b64 v[110:111], v7 offset:56320
    ds_read_b128 v[112:115], v6 offset:15360
    v_mfma_f32_16x16x32_bf16 v[32:35], v[56:59], v[36:39], v[32:35]
    ds_read_b128 v[116:119], v6 offset:16384
    ds_read_b128 v[120:123], v6 offset:17408
    v_mfma_f32_16x16x32_bf16 v[16:19], v[64:67], v[60:63], v[16:19]
    ds_read_b128 v[124:127], v6 offset:18432
    ds_read_b128 v[128:131], v6 offset:19456
    v_mfma_f32_16x16x32_bf16 v[20:23], v[68:71], v[60:63], v[20:23]
    v_mfma_f32_16x16x32_bf16 v[24:27], v[72:75], v[60:63], v[24:27]
    v_mfma_f32_16x16x32_bf16 v[28:31], v[76:79], v[60:63], v[28:31]
    v_mfma_f32_16x16x32_bf16 v[32:35], v[80:83], v[60:63], v[32:35]
    s_waitcnt lgkmcnt(0)
    v_mfma_f32_16x16x32_bf16 v[16:19], v[88:91], v[84:87], v[16:19]
    v_mfma_f32_16x16x32_bf16 v[20:23], v[92:95], v[84:87], v[20:23]
    v_mfma_f32_16x16x32_bf16 v[24:27], v[96:99], v[84:87], v[24:27]
    v_mfma_f32_16x16x32_bf16 v[28:31], v[100:103], v[84:87], v[28:31]
    v_mfma_f32_16x16x32_bf16 v[32:35], v[104:107], v[84:87], v[32:35]
    v_mfma_f32_16x16x32_bf16 v[16:19], v[112:115], v[108:111], v[16:19]
    v_mfma_f32_16x16x32_bf16 v[20:23], v[116:119], v[108:111], v[20:23]
    v_mfma_f32_16x16x32_bf16 v[24:27], v[120:123], v[108:111], v[24:27]
    v_mfma_f32_16x16x32_bf16 v[28:31], v[124:127], v[108:111], v[28:31]
    v_mfma_f32_16x16x32_bf16 v[32:35], v[128:131], v[108:111], v[32:35]
    v_lshlrev_b32_e64 v60, 16, v222
    v_and_b32 v61, 0xffff0000, v222
    v_lshlrev_b32_e64 v62, 16, v223
    v_and_b32 v63, 0xffff0000, v223
    v_lshlrev_b32_e64 v64, 16, v224
    v_and_b32 v65, 0xffff0000, v224
    v_lshlrev_b32_e64 v66, 16, v225
    v_and_b32 v67, 0xffff0000, v225
    v_lshlrev_b32_e64 v68, 16, v226
    v_and_b32 v69, 0xffff0000, v226
    v_lshlrev_b32_e64 v70, 16, v227
    v_and_b32 v71, 0xffff0000, v227
    v_lshlrev_b32_e64 v72, 16, v228
    v_and_b32 v73, 0xffff0000, v228
    v_lshlrev_b32_e64 v74, 16, v229
    v_and_b32 v75, 0xffff0000, v229
    v_lshlrev_b32_e64 v76, 16, v230
    v_and_b32 v77, 0xffff0000, v230
    v_lshlrev_b32_e64 v78, 16, v231
    v_and_b32 v79, 0xffff0000, v231
    v_pk_add_f32 v[16:17], v[16:17], v[60:61]
    v_pk_add_f32 v[18:19], v[18:19], v[62:63]
    v_pk_add_f32 v[20:21], v[20:21], v[64:65]
    v_pk_add_f32 v[22:23], v[22:23], v[66:67]
    v_pk_add_f32 v[24:25], v[24:25], v[68:69]
    v_pk_add_f32 v[26:27], v[26:27], v[70:71]
    v_pk_add_f32 v[28:29], v[28:29], v[72:73]
    v_pk_add_f32 v[30:31], v[30:31], v[74:75]
    v_pk_add_f32 v[32:33], v[32:33], v[76:77]
    v_pk_add_f32 v[34:35], v[34:35], v[78:79]
    v_cvt_pk_bf16_f32 v40, v16, v17
    v_cvt_pk_bf16_f32 v41, v18, v19
    v_cvt_pk_bf16_f32 v42, v20, v21
    v_cvt_pk_bf16_f32 v43, v22, v23
    v_cvt_pk_bf16_f32 v44, v24, v25
    v_cvt_pk_bf16_f32 v45, v26, v27
    v_cvt_pk_bf16_f32 v46, v28, v29
    v_cvt_pk_bf16_f32 v47, v30, v31
    v_cvt_pk_bf16_f32 v48, v32, v33
    v_cvt_pk_bf16_f32 v49, v34, v35
    v_permlane16_swap_b32 v40, v42
    v_permlane16_swap_b32 v41, v43
    v_permlane16_swap_b32 v44, v46
    v_permlane16_swap_b32 v45, v47
    buffer_store_dwordx4 v[40:43], v232, s[8:11], s14 offen
    buffer_store_dwordx4 v[44:47], v232, s[8:11], s14 offen offset:64
    buffer_store_dwordx2 v[48:49], v233, s[8:11], s14 offen offset:128
    s_endpgm
sequential_preLN__sliding_block__mixer_gmlp__prompt_kernel_A:
    ds_read_b64 v[140:141], v14 offset:0
    ds_read_b64 v[142:143], v14 offset:32
    ds_read_b64 v[144:145], v14 offset:64
    ds_read_b64 v[146:147], v14 offset:96
    ds_read_b64 v[148:149], v14 offset:128
    v_cmp_gt_u32 vcc, 32, v1
    s_mul_i32 s46, s45, 18432
    s_add_u32 s46, s46, 11534336
    s_lshl_b32 s38, s25, 8
    s_add_u32 s47, s46, s38
    s_add_u32 s47, s47, 16384
    s_lshl_b32 s38, s25, 11
    s_add_u32 s46, s46, s38
    s_lshl_b32 s42, s45, 10
    s_lshl_b32 s39, s25, 7
    s_add_u32 s42, s42, s39
    s_add_u32 s42, s42, 14680064
    s_lshl_b32 s43, s24, 3
    s_add_u32 s43, s43, s25
    s_lshl_b32 s43, s43, 7
    s_add_u32 s43, s43, 15499264
    s_waitcnt lgkmcnt(0)
    v_lshlrev_b32 v60, 16, v140
    v_and_b32 v61, 0xffff0000, v140
    v_lshlrev_b32_e64 v62, 16, v141
    v_and_b32 v63, 0xffff0000, v141
    v_lshlrev_b32_e64 v64, 16, v142
    v_and_b32 v65, 0xffff0000, v142
    v_lshlrev_b32_e64 v66, 16, v143
    v_and_b32 v67, 0xffff0000, v143
    v_lshlrev_b32_e64 v68, 16, v144
    v_and_b32 v69, 0xffff0000, v144
    v_lshlrev_b32_e64 v70, 16, v145
    v_and_b32 v71, 0xffff0000, v145
    v_lshlrev_b32_e64 v72, 16, v146
    v_and_b32 v73, 0xffff0000, v146
    v_lshlrev_b32_e64 v74, 16, v147
    v_and_b32 v75, 0xffff0000, v147
    v_lshlrev_b32_e64 v76, 16, v148
    v_and_b32 v77, 0xffff0000, v148
    v_lshlrev_b32_e64 v78, 16, v149
    v_and_b32 v79, 0xffff0000, v149
    v_pk_add_f32 v[16:17], v[16:17], v[60:61]
    v_pk_add_f32 v[18:19], v[18:19], v[62:63]
    v_pk_add_f32 v[20:21], v[20:21], v[64:65]
    v_pk_add_f32 v[22:23], v[22:23], v[66:67]
    v_pk_add_f32 v[24:25], v[24:25], v[68:69]
    v_pk_add_f32 v[26:27], v[26:27], v[70:71]
    v_pk_add_f32 v[28:29], v[28:29], v[72:73]
    v_pk_add_f32 v[30:31], v[30:31], v[74:75]
    v_pk_add_f32 v[32:33], v[32:33], v[76:77]
    v_pk_add_f32 v[34:35], v[34:35], v[78:79]
    s_barrier
    ds_read_b128 v[80:83], v5 offset:0
    ds_read_b128 v[84:87], v5 offset:1024
    ds_read_b128 v[88:91], v5 offset:2048
    ds_read_b128 v[92:95], v5 offset:3072
    ds_read_b128 v[96:99], v6
    v_lshlrev_b32 v9, 3, v11
    v_lshl_add_u32 v9, v12, 1, v9
    v_and_b32_e64 v10, 1, v12
    v_cmp_eq_u32 s[30:31], 0, v10
    s_nop 1
    v_cndmask_b32 v9, v15, v9, s[30:31]
    s_waitcnt lgkmcnt(0)
    v_pk_add_f32 v[16:17], v[16:17], v[80:81]
    v_pk_add_f32 v[18:19], v[18:19], v[82:83]
    v_pk_add_f32 v[20:21], v[20:21], v[84:85]
    v_pk_add_f32 v[22:23], v[22:23], v[86:87]
    v_pk_add_f32 v[24:25], v[24:25], v[88:89]
    v_pk_add_f32 v[26:27], v[26:27], v[90:91]
    v_pk_add_f32 v[28:29], v[28:29], v[92:93]
    v_pk_add_f32 v[30:31], v[30:31], v[94:95]
    v_pk_add_f32 v[32:33], v[32:33], v[96:97]
    v_pk_add_f32 v[34:35], v[34:35], v[98:99]
    v_cvt_pk_bf16_f32 v40, v16, v17
    v_cvt_pk_bf16_f32 v41, v18, v19
    v_cvt_pk_bf16_f32 v42, v20, v21
    v_cvt_pk_bf16_f32 v43, v22, v23
    v_cvt_pk_bf16_f32 v44, v24, v25
    v_cvt_pk_bf16_f32 v45, v26, v27
    v_cvt_pk_bf16_f32 v46, v28, v29
    v_cvt_pk_bf16_f32 v47, v30, v31
    v_cvt_pk_bf16_f32 v48, v32, v33
    v_cvt_pk_bf16_f32 v49, v34, v35
    buffer_store_dwordx4 v[40:43], v3, s[16:19], s46 offen sc1
    buffer_store_dwordx4 v[44:47], v3, s[16:19], s46 offen offset:1024 sc1
    buffer_store_dwordx2 v[48:49], v7, s[16:19], s47 offen sc1
    v_cndmask_b32 v50, 0, v48, vcc
    v_cndmask_b32 v51, 0, v49, vcc
    v_lshlrev_b32_e64 v60, 16, v40
    v_and_b32 v61, 0xffff0000, v40
    v_lshlrev_b32_e64 v62, 16, v41
    v_and_b32 v63, 0xffff0000, v41
    v_lshlrev_b32_e64 v64, 16, v42
    v_and_b32 v65, 0xffff0000, v42
    v_lshlrev_b32_e64 v66, 16, v43
    v_and_b32 v67, 0xffff0000, v43
    v_lshlrev_b32_e64 v68, 16, v44
    v_and_b32 v69, 0xffff0000, v44
    v_lshlrev_b32_e64 v70, 16, v45
    v_and_b32 v71, 0xffff0000, v45
    v_lshlrev_b32_e64 v72, 16, v46
    v_and_b32 v73, 0xffff0000, v46
    v_lshlrev_b32_e64 v74, 16, v47
    v_and_b32 v75, 0xffff0000, v47
    v_lshlrev_b32_e64 v76, 16, v50
    v_and_b32 v77, 0xffff0000, v50
    v_lshlrev_b32_e64 v78, 16, v51
    v_and_b32 v79, 0xffff0000, v51
    v_pk_add_f32 v[16:17], v[60:61], v[62:63]
    v_pk_mul_f32 v[18:19], v[60:61], v[60:61]
    v_pk_fma_f32 v[18:19], v[62:63], v[62:63], v[18:19]
    v_pk_add_f32 v[16:17], v[16:17], v[64:65]
    v_pk_fma_f32 v[18:19], v[64:65], v[64:65], v[18:19]
    v_pk_add_f32 v[16:17], v[16:17], v[66:67]
    v_pk_fma_f32 v[18:19], v[66:67], v[66:67], v[18:19]
    v_pk_add_f32 v[16:17], v[16:17], v[68:69]
    v_pk_fma_f32 v[18:19], v[68:69], v[68:69], v[18:19]
    v_pk_add_f32 v[16:17], v[16:17], v[70:71]
    v_pk_fma_f32 v[18:19], v[70:71], v[70:71], v[18:19]
    v_pk_add_f32 v[16:17], v[16:17], v[72:73]
    v_pk_fma_f32 v[18:19], v[72:73], v[72:73], v[18:19]
    v_pk_add_f32 v[16:17], v[16:17], v[74:75]
    v_pk_fma_f32 v[18:19], v[74:75], v[74:75], v[18:19]
    v_pk_add_f32 v[16:17], v[16:17], v[76:77]
    v_pk_fma_f32 v[18:19], v[76:77], v[76:77], v[18:19]
    v_pk_add_f32 v[16:17], v[16:17], v[78:79]
    v_pk_fma_f32 v[18:19], v[78:79], v[78:79], v[18:19]
    v_add_f32 v16, v16, v17
    v_add_f32 v18, v18, v19
    s_nop 1
    v_permlane32_swap_b32 v16, v18
    v_add_f32 v16, v16, v18
    v_mov_b32 v18, v16
    s_nop 1
    v_permlane16_swap_b32 v16, v18
    v_add_f32_e64 v16, v16, v18
    buffer_store_dword v16, v9, s[16:19], s42 offen sc1
    s_barrier
    v_mov_b32 v9, 147492
    v_mov_b32 v10, 1
    v_mov_b32_e64 v8, 0
    s_waitcnt vmcnt(0)
    s_mov_b64 exec, 1
    ds_add_rtn_u32 v10, v9, v10
    s_waitcnt lgkmcnt(0)
    v_cmp_eq_u32 vcc, 3, v10
    s_nop 0
    s_and_b64 exec, exec, vcc
    buffer_store_dword v8, v8, s[16:19], s43 offen sc1
    s_mov_b64 exec, -1
    s_and_b32 s38, s2, 1
    s_lshl_b32 s38, s38, 3
    s_bfe_u32 s39, s2, 0x30003
    s_add_u32 s21, s38, s39
    s_bfe_u32 s38, s2, 0x20001
    s_lshl_b32 s38, s38, 2
    s_lshr_b32 s39, s2, 6
    s_add_u32 s22, s38, s39
    s_lshl_b32 s31, s23, 12
    s_add_u32 s32, s31, 65536
    s_and_b32 s39, s23, 1
    s_lshl_b32 s39, s39, 10
    s_add_u32 s33, s39, 81920
    s_cmp_lt_u32 s23, 2
    s_cselect_b64 s[34:35], -1, 0
    s_cselect_b64 s[36:37], 0, -1
    s_mov_b32 s46, 3184710632
    s_mov_b32 s47, 3222493025
    v_lshlrev_b32 v3, 4, v1
    s_lshl_b32 s48, s21, 2
    s_add_u32 s48, s48, s23
    s_mul_i32 s48, s48, 36864
    s_add_u32 s48, s48, 11534336
    s_mul_i32 s38, s22, 165888
    s_add_u32 s38, s38, 48234496
    s_add_u32 s49, s38, s31
    s_add_u32 s53, s38, s39
    v_cmp_eq_u32_e64 vcc, 0, v248
    s_mov_b32 s52, 0x10000
    s_nop 3
    s_cbranch_vccnz sequential_preLN__sliding_block__mixer_gmlp__prompt_kernel_g2A
sequential_preLN__sliding_block__mixer_gmlp__prompt_kernel_g2A_ok:
    v_and_b32_e64 v8, 1, v1
    v_bfe_u32 v9, v1, 3, 1
    v_lshl_add_u32 v12, v9, 4, v8
    v_lshrrev_b32_e64 v9, 4, v1
    v_lshl_add_u32 v12, v9, 2, v12
    v_bfe_u32 v9, v1, 2, 1
    v_lshl_add_u32 v12, v9, 1, v12
    v_lshlrev_b32 v12, 3, v12
    v_and_b32 v9, 2, v1
    v_cmp_eq_u32 vcc, 0, v9
    v_mov_b32 v9, 1073741824
    s_nop 0
    v_cndmask_b32 v12, v9, v12, vcc
    v_cmp_eq_u32 vcc, 1, v8
    s_lshl_b32 s42, s21, 14
    s_lshl_b32 s38, s23, 8
    s_add_u32 s42, s42, s38
    s_add_u32 s42, s42, 15204352
    s_lshl_b32 s43, s22, 10
    s_add_u32 s43, s43, s42
    v_and_b32 v7, 31, v1
    v_lshlrev_b32 v11, 3, v7
    v_lshrrev_b32_e64 v9, 5, v1
    v_lshl_add_u32 v11, v9, 10, v11
    s_add_u32 s38, s38, 141568
    v_lshl_add_u32 v7, v7, 2, s38
    v_add_u32 v5, 65536, v3
    v_add_u32 v6, 55296, v5
    v_add_u32 v4, s31, v3
    s_lshl_b32 s38, s23, 8
    s_add_u32 s39, s38, 139264
    v_lshrrev_b32_e64 v8, 4, v1
    v_lshl_add_u32 v14, v8, 4, s39
    s_add_u32 s39, s38, 141568
    v_lshl_add_u32 v15, v8, 4, s39
    v_and_b32 v13, 15, v1
    v_lshlrev_b32 v13, 2, v13
    v_add_u32 v13, 140864, v13
    s_lshl_b32 s38, s21, 2
    s_add_u32 s38, s38, s23
    s_lshl_b32 s38, s38, 11
    s_add_u32 s38, s38, 14680064
    s_mov_b32 s44, s38
    s_mul_i32 s38, s22, 576
    s_mul_i32 s39, s23, 288
    s_add_u32 s38, s38, s39
    s_cmp_ge_u32 s23, 2
    s_cselect_b32 s54, 8640, 0
    s_add_u32 s38, s38, s54
    s_add_u32 s38, s38, 14942208
    s_add_u32 s54, s38, 18432
    v_min_u32 v8, 35, v1
    v_lshlrev_b32_e64 v8, 3, v8
    buffer_load_dwordx2 v[220:221], v8, s[16:19], s38 offen sc1
    buffer_load_dwordx2 v[222:223], v8, s[16:19], s54 offen sc1
    s_add_u32 s39, s39, 140288
    v_add_u32 v224, s39, v8
    s_lshl_b32 s38, s23, 8
    s_add_u32 s38, s38, 139264
    v_bfe_u32 v8, v1, 4, 1
    v_lshlrev_b32 v8, 6, v8
    v_and_b32 v9, 7, v1
    v_lshl_add_u32 v8, v9, 3, v8
    v_add_u32_e64 v225, s38, v8
    s_mov_b32 s54, 987991609
    s_mov_b32 s55, 925353388
    s_barrier
    ds_read_b128 v[88:91], v4 offset:0
    ds_read_b128 v[92:95], v4 offset:2048
    ds_read_b128 v[96:99], v5 offset:0
    ds_read_b128 v[100:103], v5 offset:1024
    ds_read_b128 v[104:107], v5 offset:2048
    ds_read_b128 v[108:111], v5 offset:3072
    ds_read_b128 v[112:115], v5 offset:4096
    ds_read_b128 v[116:119], v5 offset:5120
    ds_read_b128 v[120:123], v5 offset:6144
    ds_read_b128 v[124:127], v5 offset:7168
    ds_read_b128 v[128:131], v5 offset:8192
    buffer_load_dwordx4 v[212:215], v3, s[16:19], s44 offen offset:0 sc1
    buffer_load_dwordx4 v[216:219], v3, s[16:19], s44 offen offset:1024 sc1
    s_waitcnt lgkmcnt(0)
    v_mfma_f32_16x16x32_bf16 v[16:19], v[88:91], v[96:99], 0
    ds_read_b128 v[132:135], v4 offset:1024
    v_mfma_f32_16x16x32_bf16 v[52:55], v[92:95], v[96:99], 0
    ds_read_b128 v[136:139], v4 offset:3072
    v_mfma_f32_16x16x32_bf16 v[20:23], v[88:91], v[100:103], 0
    ds_read_b128 v[140:143], v5 offset:9216
    v_mfma_f32_16x16x32_bf16 v[56:59], v[92:95], v[100:103], 0
    ds_read_b128 v[144:147], v5 offset:10240
    v_mfma_f32_16x16x32_bf16 v[24:27], v[88:91], v[104:107], 0
    ds_read_b128 v[148:151], v5 offset:11264
    v_mfma_f32_16x16x32_bf16 v[60:63], v[92:95], v[104:107], 0
    ds_read_b128 v[152:155], v5 offset:12288
    v_mfma_f32_16x16x32_bf16 v[28:31], v[88:91], v[108:111], 0
    ds_read_b128 v[156:159], v5 offset:13312
    v_mfma_f32_16x16x32_bf16 v[64:67], v[92:95], v[108:111], 0
    ds_read_b128 v[160:163], v5 offset:14336
    v_mfma_f32_16x16x32_bf16 v[32:35], v[88:91], v[112:115], 0
    ds_read_b128 v[164:167], v5 offset:15360
    v_mfma_f32_16x16x32_bf16 v[68:71], v[92:95], v[112:115], 0
    ds_read_b128 v[168:171], v5 offset:16384
    v_mfma_f32_16x16x32_bf16 v[36:39], v[88:91], v[116:119], 0
    ds_read_b128 v[172:175], v5 offset:17408
    v_mfma_f32_16x16x32_bf16 v[72:75], v[92:95], v[116:119], 0
    v_mfma_f32_16x16x32_bf16 v[40:43], v[88:91], v[120:123], 0
    v_mfma_f32_16x16x32_bf16 v[76:79], v[92:95], v[120:123], 0
    v_mfma_f32_16x16x32_bf16 v[44:47], v[88:91], v[124:127], 0
    v_mfma_f32_16x16x32_bf16 v[80:83], v[92:95], v[124:127], 0
    v_mfma_f32_16x16x32_bf16 v[48:51], v[88:91], v[128:131], 0
    v_mfma_f32_16x16x32_bf16 v[84:87], v[92:95], v[128:131], 0
    s_waitcnt lgkmcnt(0)
    s_barrier
    v_mfma_f32_16x16x32_bf16 v[16:19], v[132:135], v[140:143], v[16:19]
    ds_read_b128 v[88:91], v4 offset:16384
    v_mfma_f32_16x16x32_bf16 v[52:55], v[136:139], v[140:143], v[52:55]
    ds_read_b128 v[92:95], v4 offset:18432
    v_mfma_f32_16x16x32_bf16 v[20:23], v[132:135], v[144:147], v[20:23]
    ds_read_b128 v[96:99], v5 offset:18432
    v_mfma_f32_16x16x32_bf16 v[56:59], v[136:139], v[144:147], v[56:59]
    ds_read_b128 v[100:103], v5 offset:19456
    v_mfma_f32_16x16x32_bf16 v[24:27], v[132:135], v[148:151], v[24:27]
    ds_read_b128 v[104:107], v5 offset:20480
    v_mfma_f32_16x16x32_bf16 v[60:63], v[136:139], v[148:151], v[60:63]
    ds_read_b128 v[108:111], v5 offset:21504
    v_mfma_f32_16x16x32_bf16 v[28:31], v[132:135], v[152:155], v[28:31]
    ds_read_b128 v[112:115], v5 offset:22528
    v_mfma_f32_16x16x32_bf16 v[64:67], v[136:139], v[152:155], v[64:67]
    ds_read_b128 v[116:119], v5 offset:23552
    v_mfma_f32_16x16x32_bf16 v[32:35], v[132:135], v[156:159], v[32:35]
    ds_read_b128 v[120:123], v5 offset:24576
    v_mfma_f32_16x16x32_bf16 v[68:71], v[136:139], v[156:159], v[68:71]
    ds_read_b128 v[124:127], v5 offset:25600
    v_mfma_f32_16x16x32_bf16 v[36:39], v[132:135], v[160:163], v[36:39]
    ds_read_b128 v[128:131], v5 offset:26624
    v_mfma_f32_16x16x32_bf16 v[72:75], v[136:139], v[160:163], v[72:75]
    v_mfma_f32_16x16x32_bf16 v[40:43], v[132:135], v[164:167], v[40:43]
    v_mfma_f32_16x16x32_bf16 v[76:79], v[136:139], v[164:167], v[76:79]
    v_mfma_f32_16x16x32_bf16 v[44:47], v[132:135], v[168:171], v[44:47]
    v_mfma_f32_16x16x32_bf16 v[80:83], v[136:139], v[168:171], v[80:83]
    v_mfma_f32_16x16x32_bf16 v[48:51], v[132:135], v[172:175], v[48:51]
    v_mfma_f32_16x16x32_bf16 v[84:87], v[136:139], v[172:175], v[84:87]
    s_waitcnt lgkmcnt(0)
    v_mfma_f32_16x16x32_bf16 v[16:19], v[88:91], v[96:99], v[16:19]
    ds_read_b128 v[132:135], v4 offset:17408
    v_mfma_f32_16x16x32_bf16 v[52:55], v[92:95], v[96:99], v[52:55]
    ds_read_b128 v[136:139], v4 offset:19456
    v_mfma_f32_16x16x32_bf16 v[20:23], v[88:91], v[100:103], v[20:23]
    ds_read_b128 v[140:143], v5 offset:27648
    v_mfma_f32_16x16x32_bf16 v[56:59], v[92:95], v[100:103], v[56:59]
    ds_read_b128 v[144:147], v5 offset:28672
    v_mfma_f32_16x16x32_bf16 v[24:27], v[88:91], v[104:107], v[24:27]
    ds_read_b128 v[148:151], v5 offset:29696
    v_mfma_f32_16x16x32_bf16 v[60:63], v[92:95], v[104:107], v[60:63]
    ds_read_b128 v[152:155], v5 offset:30720
    v_mfma_f32_16x16x32_bf16 v[28:31], v[88:91], v[108:111], v[28:31]
    ds_read_b128 v[156:159], v5 offset:31744
    v_mfma_f32_16x16x32_bf16 v[64:67], v[92:95], v[108:111], v[64:67]
    ds_read_b128 v[160:163], v5 offset:32768
    v_mfma_f32_16x16x32_bf16 v[32:35], v[88:91], v[112:115], v[32:35]
    ds_read_b128 v[164:167], v5 offset:33792
    v_mfma_f32_16x16x32_bf16 v[68:71], v[92:95], v[112:115], v[68:71]
    ds_read_b128 v[168:171], v5 offset:34816
    v_mfma_f32_16x16x32_bf16 v[36:39], v[88:91], v[116:119], v[36:39]
    ds_read_b128 v[172:175], v5 offset:35840
    v_mfma_f32_16x16x32_bf16 v[72:75], v[92:95], v[116:119], v[72:75]
    v_mfma_f32_16x16x32_bf16 v[40:43], v[88:91], v[120:123], v[40:43]
    v_mfma_f32_16x16x32_bf16 v[76:79], v[92:95], v[120:123], v[76:79]
    v_mfma_f32_16x16x32_bf16 v[44:47], v[88:91], v[124:127], v[44:47]
    v_mfma_f32_16x16x32_bf16 v[80:83], v[92:95], v[124:127], v[80:83]
    v_mfma_f32_16x16x32_bf16 v[48:51], v[88:91], v[128:131], v[48:51]
    v_mfma_f32_16x16x32_bf16 v[84:87], v[92:95], v[128:131], v[84:87]
    s_waitcnt lgkmcnt(0)
    s_barrier
    v_mfma_f32_16x16x32_bf16 v[16:19], v[132:135], v[140:143], v[16:19]
    ds_read_b128 v[88:91], v4 offset:32768
    v_mfma_f32_16x16x32_bf16 v[52:55], v[136:139], v[140:143], v[52:55]
    ds_read_b128 v[92:95], v4 offset:34816
    v_mfma_f32_16x16x32_bf16 v[20:23], v[132:135], v[144:147], v[20:23]
    ds_read_b128 v[96:99], v5 offset:36864
    v_mfma_f32_16x16x32_bf16 v[56:59], v[136:139], v[144:147], v[56:59]
    ds_read_b128 v[100:103], v5 offset:37888
    v_mfma_f32_16x16x32_bf16 v[24:27], v[132:135], v[148:151], v[24:27]
    ds_read_b128 v[104:107], v5 offset:38912
    v_mfma_f32_16x16x32_bf16 v[60:63], v[136:139], v[148:151], v[60:63]
    ds_read_b128 v[108:111], v5 offset:39936
    v_mfma_f32_16x16x32_bf16 v[28:31], v[132:135], v[152:155], v[28:31]
    ds_read_b128 v[112:115], v5 offset:40960
    v_mfma_f32_16x16x32_bf16 v[64:67], v[136:139], v[152:155], v[64:67]
    ds_read_b128 v[116:119], v5 offset:41984
    v_mfma_f32_16x16x32_bf16 v[32:35], v[132:135], v[156:159], v[32:35]
    ds_read_b128 v[120:123], v5 offset:43008
    v_mfma_f32_16x16x32_bf16 v[68:71], v[136:139], v[156:159], v[68:71]
    ds_read_b128 v[124:127], v5 offset:44032
    v_mfma_f32_16x16x32_bf16 v[36:39], v[132:135], v[160:163], v[36:39]
    ds_read_b128 v[128:131], v5 offset:45056
    v_mfma_f32_16x16x32_bf16 v[72:75], v[136:139], v[160:163], v[72:75]
    v_mfma_f32_16x16x32_bf16 v[40:43], v[132:135], v[164:167], v[40:43]
    v_mfma_f32_16x16x32_bf16 v[76:79], v[136:139], v[164:167], v[76:79]
    v_mfma_f32_16x16x32_bf16 v[44:47], v[132:135], v[168:171], v[44:47]
    v_mfma_f32_16x16x32_bf16 v[80:83], v[136:139], v[168:171], v[80:83]
    v_mfma_f32_16x16x32_bf16 v[48:51], v[132:135], v[172:175], v[48:51]
    v_mfma_f32_16x16x32_bf16 v[84:87], v[136:139], v[172:175], v[84:87]
    s_waitcnt lgkmcnt(0)
    v_mfma_f32_16x16x32_bf16 v[16:19], v[88:91], v[96:99], v[16:19]
    ds_read_b128 v[132:135], v4 offset:33792
    s_waitcnt vmcnt(0)
    v_mfma_f32_16x16x32_bf16 v[52:55], v[92:95], v[96:99], v[52:55]
    ds_read_b128 v[136:139], v4 offset:35840
    v_add_f32_dpp v212, v212, v212 row_ror:8 row_mask:0xf bank_mask:0xf
    v_mfma_f32_16x16x32_bf16 v[20:23], v[88:91], v[100:103], v[20:23]
    ds_read_b128 v[140:143], v5 offset:46080
    v_mfma_f32_16x16x32_bf16 v[56:59], v[92:95], v[100:103], v[56:59]
    ds_read_b128 v[144:147], v5 offset:47104
    v_add_f32_dpp v213, v213, v213 row_ror:8 row_mask:0xf bank_mask:0xf
    v_mfma_f32_16x16x32_bf16 v[24:27], v[88:91], v[104:107], v[24:27]
    ds_read_b128 v[148:151], v5 offset:48128
    v_add_f32_dpp v214, v214, v214 row_ror:8 row_mask:0xf bank_mask:0xf
    v_mfma_f32_16x16x32_bf16 v[60:63], v[92:95], v[104:107], v[60:63]
    ds_read_b128 v[152:155], v5 offset:49152
    v_mfma_f32_16x16x32_bf16 v[28:31], v[88:91], v[108:111], v[28:31]
    ds_read_b128 v[156:159], v5 offset:50176
    v_add_f32_dpp v215, v215, v215 row_ror:8 row_mask:0xf bank_mask:0xf
    v_mfma_f32_16x16x32_bf16 v[64:67], v[92:95], v[108:111], v[64:67]
    ds_read_b128 v[160:163], v5 offset:51200
    v_add_f32_dpp v216, v216, v216 row_ror:8 row_mask:0xf bank_mask:0xf
    v_mfma_f32_16x16x32_bf16 v[32:35], v[88:91], v[112:115], v[32:35]
    ds_read_b128 v[164:167], v5 offset:52224
    v_mfma_f32_16x16x32_bf16 v[68:71], v[92:95], v[112:115], v[68:71]
    ds_read_b128 v[168:171], v5 offset:53248
    v_add_f32_dpp v217, v217, v217 row_ror:8 row_mask:0xf bank_mask:0xf
    v_mfma_f32_16x16x32_bf16 v[36:39], v[88:91], v[116:119], v[36:39]
    ds_read_b128 v[172:175], v5 offset:54272
    v_add_f32_dpp v218, v218, v218 row_ror:8 row_mask:0xf bank_mask:0xf
    v_mfma_f32_16x16x32_bf16 v[72:75], v[92:95], v[116:119], v[72:75]
    v_mfma_f32_16x16x32_bf16 v[40:43], v[88:91], v[120:123], v[40:43]
    v_add_f32_dpp v219, v219, v219 row_ror:8 row_mask:0xf bank_mask:0xf
    v_mfma_f32_16x16x32_bf16 v[76:79], v[92:95], v[120:123], v[76:79]
    v_add_f32 v220, v220, v222
    v_mfma_f32_16x16x32_bf16 v[44:47], v[88:91], v[124:127], v[44:47]
    v_mfma_f32_16x16x32_bf16 v[80:83], v[92:95], v[124:127], v[80:83]
    v_add_f32_e64 v221, v221, v223
    v_mfma_f32_16x16x32_bf16 v[48:51], v[88:91], v[128:131], v[48:51]
    v_permlane16_swap_b32 v212, v216
    v_mfma_f32_16x16x32_bf16 v[84:87], v[92:95], v[128:131], v[84:87]
    s_waitcnt lgkmcnt(0)
    s_barrier
    v_mfma_f32_16x16x32_bf16 v[16:19], v[132:135], v[140:143], v[16:19]
    ds_read_b128 v[88:91], v4 offset:49152
    v_permlane16_swap_b32 v213, v217
    v_mfma_f32_16x16x32_bf16 v[52:55], v[136:139], v[140:143], v[52:55]
    ds_read_b128 v[92:95], v4 offset:51200
    v_permlane16_swap_b32 v214, v218
    v_mfma_f32_16x16x32_bf16 v[20:23], v[132:135], v[144:147], v[20:23]
    ds_read_b128 v[96:99], v6 offset:0
    v_mfma_f32_16x16x32_bf16 v[56:59], v[136:139], v[144:147], v[56:59]
    ds_read_b128 v[100:103], v6 offset:1024
    v_permlane16_swap_b32 v215, v219
    v_mfma_f32_16x16x32_bf16 v[24:27], v[132:135], v[148:151], v[24:27]
    ds_read_b128 v[104:107], v6 offset:2048
    ds_write_b64 v224, v[220:221]
    v_mfma_f32_16x16x32_bf16 v[60:63], v[136:139], v[148:151], v[60:63]
    ds_read_b128 v[108:111], v6 offset:3072
    v_mfma_f32_16x16x32_bf16 v[28:31], v[132:135], v[152:155], v[28:31]
    ds_read_b128 v[112:115], v6 offset:4096
    v_add_f32_e64 v212, v212, v216
    v_mfma_f32_16x16x32_bf16 v[64:67], v[136:139], v[152:155], v[64:67]
    ds_read_b128 v[116:119], v6 offset:5120
    v_add_f32_e64 v213, v213, v217
    v_mfma_f32_16x16x32_bf16 v[32:35], v[132:135], v[156:159], v[32:35]
    ds_read_b128 v[120:123], v6 offset:6144
    v_mfma_f32_16x16x32_bf16 v[68:71], v[136:139], v[156:159], v[68:71]
    ds_read_b128 v[124:127], v6 offset:7168
    v_add_f32_e64 v214, v214, v218
    v_mfma_f32_16x16x32_bf16 v[36:39], v[132:135], v[160:163], v[36:39]
    ds_read_b128 v[128:131], v6 offset:8192
    v_add_f32_e64 v215, v215, v219
    v_mfma_f32_16x16x32_bf16 v[72:75], v[136:139], v[160:163], v[72:75]
    v_mfma_f32_16x16x32_bf16 v[40:43], v[132:135], v[164:167], v[40:43]
    v_mov_b32_e64 v216, v212
    v_mfma_f32_16x16x32_bf16 v[76:79], v[136:139], v[164:167], v[76:79]
    v_mov_b32_e64 v217, v213
    v_mfma_f32_16x16x32_bf16 v[44:47], v[132:135], v[168:171], v[44:47]
    v_mfma_f32_16x16x32_bf16 v[80:83], v[136:139], v[168:171], v[80:83]
    v_mov_b32_e64 v218, v214
    v_mfma_f32_16x16x32_bf16 v[48:51], v[132:135], v[172:175], v[48:51]
    v_mov_b32_e64 v219, v215
    v_mfma_f32_16x16x32_bf16 v[84:87], v[136:139], v[172:175], v[84:87]
    s_waitcnt lgkmcnt(0)
    v_mfma_f32_16x16x32_bf16 v[16:19], v[88:91], v[96:99], v[16:19]
    ds_read_b128 v[132:135], v4 offset:50176
    v_permlane32_swap_b32 v212, v216
    v_mfma_f32_16x16x32_bf16 v[52:55], v[92:95], v[96:99], v[52:55]
    ds_read_b128 v[136:139], v4 offset:52224
    v_permlane32_swap_b32 v213, v217
    v_mfma_f32_16x16x32_bf16 v[20:23], v[88:91], v[100:103], v[20:23]
    ds_read_b128 v[140:143], v6 offset:9216
    v_mfma_f32_16x16x32_bf16 v[56:59], v[92:95], v[100:103], v[56:59]
    ds_read_b128 v[144:147], v6 offset:10240
    v_permlane32_swap_b32 v214, v218
    v_mfma_f32_16x16x32_bf16 v[24:27], v[88:91], v[104:107], v[24:27]
    ds_read_b128 v[148:151], v6 offset:11264
    v_permlane32_swap_b32 v215, v219
    v_mfma_f32_16x16x32_bf16 v[60:63], v[92:95], v[104:107], v[60:63]
    ds_read_b128 v[152:155], v6 offset:12288
    v_mfma_f32_16x16x32_bf16 v[28:31], v[88:91], v[108:111], v[28:31]
    ds_read_b128 v[156:159], v6 offset:13312
    v_add_f32 v212, v212, v216
    v_mfma_f32_16x16x32_bf16 v[64:67], v[92:95], v[108:111], v[64:67]
    ds_read_b128 v[160:163], v6 offset:14336
    v_add_f32_e64 v213, v213, v217
    v_mfma_f32_16x16x32_bf16 v[32:35], v[88:91], v[112:115], v[32:35]
    ds_read_b128 v[164:167], v6 offset:15360
    v_mfma_f32_16x16x32_bf16 v[68:71], v[92:95], v[112:115], v[68:71]
    ds_read_b128 v[168:171], v6 offset:16384
    v_add_f32_e64 v214, v214, v218
    v_mfma_f32_16x16x32_bf16 v[36:39], v[88:91], v[116:119], v[36:39]
    ds_read_b128 v[172:175], v6 offset:17408
    v_add_f32_e64 v215, v215, v219
    v_mfma_f32_16x16x32_bf16 v[72:75], v[92:95], v[116:119], v[72:75]
    v_mfma_f32_16x16x32_bf16 v[40:43], v[88:91], v[120:123], v[40:43]
    v_mul_f32_e64 v218, s54, v212
    v_mfma_f32_16x16x32_bf16 v[76:79], v[92:95], v[120:123], v[76:79]
    v_mul_f32_e64 v219, s54, v214
    v_mfma_f32_16x16x32_bf16 v[44:47], v[88:91], v[124:127], v[44:47]
    v_mfma_f32_16x16x32_bf16 v[80:83], v[92:95], v[124:127], v[80:83]
    v_mul_f32_e64 v216, s54, v213
    v_mfma_f32_16x16x32_bf16 v[48:51], v[88:91], v[128:131], v[48:51]
    v_mul_f32_e64 v217, s54, v215
    v_mfma_f32_16x16x32_bf16 v[84:87], v[92:95], v[128:131], v[84:87]
    s_waitcnt lgkmcnt(0)
    s_barrier
    v_mfma_f32_16x16x32_bf16 v[16:19], v[132:135], v[140:143], v[16:19]
    ds_read_b128 v[88:91], v4 offset:0
    v_fma_f32 v216, -v218, v218, v216
    v_mfma_f32_16x16x32_bf16 v[52:55], v[136:139], v[140:143], v[52:55]
    ds_read_b128 v[92:95], v4 offset:2048
    v_fma_f32 v217, -v219, v219, v217
    v_mfma_f32_16x16x32_bf16 v[20:23], v[132:135], v[144:147], v[20:23]
    ds_read_b128 v[96:99], v5 offset:0
    v_mfma_f32_16x16x32_bf16 v[56:59], v[136:139], v[144:147], v[56:59]
    ds_read_b128 v[100:103], v5 offset:1024
    v_max_f32_e64 v216, 0, v216
    v_mfma_f32_16x16x32_bf16 v[24:27], v[132:135], v[148:151], v[24:27]
    ds_read_b128 v[104:107], v5 offset:2048
    v_max_f32_e64 v217, 0, v217
    v_mfma_f32_16x16x32_bf16 v[60:63], v[136:139], v[148:151], v[60:63]
    ds_read_b128 v[108:111], v5 offset:3072
    v_mfma_f32_16x16x32_bf16 v[28:31], v[132:135], v[152:155], v[28:31]
    ds_read_b128 v[112:115], v5 offset:4096
    v_add_f32_e64 v216, s55, v216
    v_mfma_f32_16x16x32_bf16 v[64:67], v[136:139], v[152:155], v[64:67]
    ds_read_b128 v[116:119], v5 offset:5120
    v_add_f32_e64 v217, s55, v217
    v_mfma_f32_16x16x32_bf16 v[32:35], v[132:135], v[156:159], v[32:35]
    ds_read_b128 v[120:123], v5 offset:6144
    v_mfma_f32_16x16x32_bf16 v[68:71], v[136:139], v[156:159], v[68:71]
    ds_read_b128 v[124:127], v5 offset:7168
    v_rsq_f32_e64 v216, v216
    v_mfma_f32_16x16x32_bf16 v[36:39], v[132:135], v[160:163], v[36:39]
    ds_read_b128 v[128:131], v5 offset:8192
    v_rsq_f32_e64 v217, v217
    v_mfma_f32_16x16x32_bf16 v[72:75], v[136:139], v[160:163], v[72:75]
    v_mfma_f32_16x16x32_bf16 v[40:43], v[132:135], v[164:167], v[40:43]
    v_sub_f32_e64 v218, 0, v218
    v_mfma_f32_16x16x32_bf16 v[76:79], v[136:139], v[164:167], v[76:79]
    v_sub_f32_e64 v219, 0, v219
    v_mfma_f32_16x16x32_bf16 v[44:47], v[132:135], v[168:171], v[44:47]
    v_mfma_f32_16x16x32_bf16 v[80:83], v[136:139], v[168:171], v[80:83]
    ds_write_b64 v225, v[216:217]
    v_mfma_f32_16x16x32_bf16 v[48:51], v[132:135], v[172:175], v[48:51]
    ds_write_b64 v225, v[218:219] offset:128
    v_mfma_f32_16x16x32_bf16 v[84:87], v[136:139], v[172:175], v[84:87]
    s_waitcnt lgkmcnt(0)
    v_mfma_f32_16x16x32_bf16 v[16:19], v[88:91], v[96:99], v[16:19]
    ds_read_b128 v[132:135], v4 offset:1024
    v_mfma_f32_16x16x32_bf16 v[52:55], v[92:95], v[96:99], v[52:55]
    ds_read_b128 v[136:139], v4 offset:3072
    v_mfma_f32_16x16x32_bf16 v[20:23], v[88:91], v[100:103], v[20:23]
    ds_read_b128 v[140:143], v5 offset:9216
    v_mfma_f32_16x16x32_bf16 v[56:59], v[92:95], v[100:103], v[56:59]
    ds_read_b128 v[144:147], v5 offset:10240
    v_mfma_f32_16x16x32_bf16 v[24:27], v[88:91], v[104:107], v[24:27]
    ds_read_b128 v[148:151], v5 offset:11264
    v_mfma_f32_16x16x32_bf16 v[60:63], v[92:95], v[104:107], v[60:63]
    ds_read_b128 v[152:155], v5 offset:12288
    v_mfma_f32_16x16x32_bf16 v[28:31], v[88:91], v[108:111], v[28:31]
    ds_read_b128 v[156:159], v5 offset:13312
    v_mfma_f32_16x16x32_bf16 v[64:67], v[92:95], v[108:111], v[64:67]
    ds_read_b128 v[160:163], v5 offset:14336
    v_mfma_f32_16x16x32_bf16 v[32:35], v[88:91], v[112:115], v[32:35]
    ds_read_b128 v[164:167], v5 offset:15360
    v_mfma_f32_16x16x32_bf16 v[68:71], v[92:95], v[112:115], v[68:71]
    ds_read_b128 v[168:171], v5 offset:16384
    v_mfma_f32_16x16x32_bf16 v[36:39], v[88:91], v[116:119], v[36:39]
    ds_read_b128 v[172:175], v5 offset:17408
    v_mfma_f32_16x16x32_bf16 v[72:75], v[92:95], v[116:119], v[72:75]
    v_mfma_f32_16x16x32_bf16 v[40:43], v[88:91], v[120:123], v[40:43]
    v_mfma_f32_16x16x32_bf16 v[76:79], v[92:95], v[120:123], v[76:79]
    v_mfma_f32_16x16x32_bf16 v[44:47], v[88:91], v[124:127], v[44:47]
    v_mfma_f32_16x16x32_bf16 v[80:83], v[92:95], v[124:127], v[80:83]
    v_mfma_f32_16x16x32_bf16 v[48:51], v[88:91], v[128:131], v[48:51]
    v_mfma_f32_16x16x32_bf16 v[84:87], v[92:95], v[128:131], v[84:87]
    s_waitcnt lgkmcnt(0)
    s_barrier
    v_mfma_f32_16x16x32_bf16 v[16:19], v[132:135], v[140:143], v[16:19]
    ds_read_b128 v[88:91], v4 offset:16384
    v_mfma_f32_16x16x32_bf16 v[52:55], v[136:139], v[140:143], v[52:55]
    ds_read_b128 v[92:95], v4 offset:18432
    v_mfma_f32_16x16x32_bf16 v[20:23], v[132:135], v[144:147], v[20:23]
    ds_read_b128 v[96:99], v5 offset:18432
    v_mfma_f32_16x16x32_bf16 v[56:59], v[136:139], v[144:147], v[56:59]
    ds_read_b128 v[100:103], v5 offset:19456
    v_mfma_f32_16x16x32_bf16 v[24:27], v[132:135], v[148:151], v[24:27]
    ds_read_b128 v[104:107], v5 offset:20480
    v_mfma_f32_16x16x32_bf16 v[60:63], v[136:139], v[148:151], v[60:63]
    ds_read_b128 v[108:111], v5 offset:21504
    v_mfma_f32_16x16x32_bf16 v[28:31], v[132:135], v[152:155], v[28:31]
    ds_read_b128 v[112:115], v5 offset:22528
    v_mfma_f32_16x16x32_bf16 v[64:67], v[136:139], v[152:155], v[64:67]
    ds_read_b128 v[116:119], v5 offset:23552
    v_mfma_f32_16x16x32_bf16 v[32:35], v[132:135], v[156:159], v[32:35]
    ds_read_b128 v[120:123], v5 offset:24576
    v_mfma_f32_16x16x32_bf16 v[68:71], v[136:139], v[156:159], v[68:71]
    ds_read_b128 v[124:127], v5 offset:25600
    v_mfma_f32_16x16x32_bf16 v[36:39], v[132:135], v[160:163], v[36:39]
    ds_read_b128 v[128:131], v5 offset:26624
    v_mfma_f32_16x16x32_bf16 v[72:75], v[136:139], v[160:163], v[72:75]
    v_mfma_f32_16x16x32_bf16 v[40:43], v[132:135], v[164:167], v[40:43]
    v_mfma_f32_16x16x32_bf16 v[76:79], v[136:139], v[164:167], v[76:79]
    v_mfma_f32_16x16x32_bf16 v[44:47], v[132:135], v[168:171], v[44:47]
    v_mfma_f32_16x16x32_bf16 v[80:83], v[136:139], v[168:171], v[80:83]
    v_mfma_f32_16x16x32_bf16 v[48:51], v[132:135], v[172:175], v[48:51]
    v_mfma_f32_16x16x32_bf16 v[84:87], v[136:139], v[172:175], v[84:87]
    s_waitcnt lgkmcnt(0)
    v_mfma_f32_16x16x32_bf16 v[16:19], v[88:91], v[96:99], v[16:19]
    ds_read_b128 v[132:135], v4 offset:17408
    v_mfma_f32_16x16x32_bf16 v[52:55], v[92:95], v[96:99], v[52:55]
    ds_read_b128 v[136:139], v4 offset:19456
    v_mfma_f32_16x16x32_bf16 v[20:23], v[88:91], v[100:103], v[20:23]
    ds_read_b128 v[140:143], v5 offset:27648
    v_mfma_f32_16x16x32_bf16 v[56:59], v[92:95], v[100:103], v[56:59]
    ds_read_b128 v[144:147], v5 offset:28672
    v_mfma_f32_16x16x32_bf16 v[24:27], v[88:91], v[104:107], v[24:27]
    ds_read_b128 v[148:151], v5 offset:29696
    v_mfma_f32_16x16x32_bf16 v[60:63], v[92:95], v[104:107], v[60:63]
    ds_read_b128 v[152:155], v5 offset:30720
    v_mfma_f32_16x16x32_bf16 v[28:31], v[88:91], v[108:111], v[28:31]
    ds_read_b128 v[156:159], v5 offset:31744
    v_mfma_f32_16x16x32_bf16 v[64:67], v[92:95], v[108:111], v[64:67]
    ds_read_b128 v[160:163], v5 offset:32768
    v_mfma_f32_16x16x32_bf16 v[32:35], v[88:91], v[112:115], v[32:35]
    ds_read_b128 v[164:167], v5 offset:33792
    v_mfma_f32_16x16x32_bf16 v[68:71], v[92:95], v[112:115], v[68:71]
    ds_read_b128 v[168:171], v5 offset:34816
    v_mfma_f32_16x16x32_bf16 v[36:39], v[88:91], v[116:119], v[36:39]
    ds_read_b128 v[172:175], v5 offset:35840
    v_mfma_f32_16x16x32_bf16 v[72:75], v[92:95], v[116:119], v[72:75]
    v_mfma_f32_16x16x32_bf16 v[40:43], v[88:91], v[120:123], v[40:43]
    v_mfma_f32_16x16x32_bf16 v[76:79], v[92:95], v[120:123], v[76:79]
    v_mfma_f32_16x16x32_bf16 v[44:47], v[88:91], v[124:127], v[44:47]
    v_mfma_f32_16x16x32_bf16 v[80:83], v[92:95], v[124:127], v[80:83]
    v_mfma_f32_16x16x32_bf16 v[48:51], v[88:91], v[128:131], v[48:51]
    v_mfma_f32_16x16x32_bf16 v[84:87], v[92:95], v[128:131], v[84:87]
    s_waitcnt lgkmcnt(0)
    s_barrier
    v_mfma_f32_16x16x32_bf16 v[16:19], v[132:135], v[140:143], v[16:19]
    ds_read_b128 v[88:91], v4 offset:32768
    v_mfma_f32_16x16x32_bf16 v[52:55], v[136:139], v[140:143], v[52:55]
    ds_read_b128 v[92:95], v4 offset:34816
    v_mfma_f32_16x16x32_bf16 v[20:23], v[132:135], v[144:147], v[20:23]
    ds_read_b128 v[96:99], v5 offset:36864
    v_mfma_f32_16x16x32_bf16 v[56:59], v[136:139], v[144:147], v[56:59]
    ds_read_b128 v[100:103], v5 offset:37888
    v_mfma_f32_16x16x32_bf16 v[24:27], v[132:135], v[148:151], v[24:27]
    ds_read_b128 v[104:107], v5 offset:38912
    v_mfma_f32_16x16x32_bf16 v[60:63], v[136:139], v[148:151], v[60:63]
    ds_read_b128 v[108:111], v5 offset:39936
    v_mfma_f32_16x16x32_bf16 v[28:31], v[132:135], v[152:155], v[28:31]
    ds_read_b128 v[112:115], v5 offset:40960
    v_mfma_f32_16x16x32_bf16 v[64:67], v[136:139], v[152:155], v[64:67]
    ds_read_b128 v[116:119], v5 offset:41984
    v_mfma_f32_16x16x32_bf16 v[32:35], v[132:135], v[156:159], v[32:35]
    ds_read_b128 v[120:123], v5 offset:43008
    v_mfma_f32_16x16x32_bf16 v[68:71], v[136:139], v[156:159], v[68:71]
    ds_read_b128 v[124:127], v5 offset:44032
    v_mfma_f32_16x16x32_bf16 v[36:39], v[132:135], v[160:163], v[36:39]
    ds_read_b128 v[128:131], v5 offset:45056
    v_mfma_f32_16x16x32_bf16 v[72:75], v[136:139], v[160:163], v[72:75]
    v_mfma_f32_16x16x32_bf16 v[40:43], v[132:135], v[164:167], v[40:43]
    v_mfma_f32_16x16x32_bf16 v[76:79], v[136:139], v[164:167], v[76:79]
    v_mfma_f32_16x16x32_bf16 v[44:47], v[132:135], v[168:171], v[44:47]
    v_mfma_f32_16x16x32_bf16 v[80:83], v[136:139], v[168:171], v[80:83]
    v_mfma_f32_16x16x32_bf16 v[48:51], v[132:135], v[172:175], v[48:51]
    v_mfma_f32_16x16x32_bf16 v[84:87], v[136:139], v[172:175], v[84:87]
    s_waitcnt lgkmcnt(0)
    v_mfma_f32_16x16x32_bf16 v[16:19], v[88:91], v[96:99], v[16:19]
    ds_read_b128 v[132:135], v4 offset:33792
    v_mfma_f32_16x16x32_bf16 v[52:55], v[92:95], v[96:99], v[52:55]
    ds_read_b128 v[136:139], v4 offset:35840
    v_mfma_f32_16x16x32_bf16 v[20:23], v[88:91], v[100:103], v[20:23]
    ds_read_b128 v[140:143], v5 offset:46080
    v_mfma_f32_16x16x32_bf16 v[56:59], v[92:95], v[100:103], v[56:59]
    ds_read_b128 v[144:147], v5 offset:47104
    v_mfma_f32_16x16x32_bf16 v[24:27], v[88:91], v[104:107], v[24:27]
    ds_read_b128 v[148:151], v5 offset:48128
    v_mfma_f32_16x16x32_bf16 v[60:63], v[92:95], v[104:107], v[60:63]
    ds_read_b128 v[152:155], v5 offset:49152
    v_mfma_f32_16x16x32_bf16 v[28:31], v[88:91], v[108:111], v[28:31]
    ds_read_b128 v[156:159], v5 offset:50176
    v_mfma_f32_16x16x32_bf16 v[64:67], v[92:95], v[108:111], v[64:67]
    ds_read_b128 v[160:163], v5 offset:51200
    v_mfma_f32_16x16x32_bf16 v[32:35], v[88:91], v[112:115], v[32:35]
    ds_read_b128 v[164:167], v5 offset:52224
    v_mfma_f32_16x16x32_bf16 v[68:71], v[92:95], v[112:115], v[68:71]
    ds_read_b128 v[168:171], v5 offset:53248
    v_mfma_f32_16x16x32_bf16 v[36:39], v[88:91], v[116:119], v[36:39]
    ds_read_b128 v[172:175], v5 offset:54272
    v_mfma_f32_16x16x32_bf16 v[72:75], v[92:95], v[116:119], v[72:75]
    v_mfma_f32_16x16x32_bf16 v[40:43], v[88:91], v[120:123], v[40:43]
    v_mfma_f32_16x16x32_bf16 v[76:79], v[92:95], v[120:123], v[76:79]
    v_mfma_f32_16x16x32_bf16 v[44:47], v[88:91], v[124:127], v[44:47]
    v_mfma_f32_16x16x32_bf16 v[80:83], v[92:95], v[124:127], v[80:83]
    v_mfma_f32_16x16x32_bf16 v[48:51], v[88:91], v[128:131], v[48:51]
    v_mfma_f32_16x16x32_bf16 v[84:87], v[92:95], v[128:131], v[84:87]
    s_waitcnt lgkmcnt(0)
    s_barrier
    v_mfma_f32_16x16x32_bf16 v[16:19], v[132:135], v[140:143], v[16:19]
    ds_read_b128 v[88:91], v4 offset:49152
    v_mfma_f32_16x16x32_bf16 v[52:55], v[136:139], v[140:143], v[52:55]
    ds_read_b128 v[92:95], v4 offset:51200
    v_mfma_f32_16x16x32_bf16 v[20:23], v[132:135], v[144:147], v[20:23]
    ds_read_b128 v[96:99], v6 offset:0
    v_mfma_f32_16x16x32_bf16 v[56:59], v[136:139], v[144:147], v[56:59]
    ds_read_b128 v[100:103], v6 offset:1024
    v_mfma_f32_16x16x32_bf16 v[24:27], v[132:135], v[148:151], v[24:27]
    ds_read_b128 v[104:107], v6 offset:2048
    v_mfma_f32_16x16x32_bf16 v[60:63], v[136:139], v[148:151], v[60:63]
    ds_read_b128 v[108:111], v6 offset:3072
    v_mfma_f32_16x16x32_bf16 v[28:31], v[132:135], v[152:155], v[28:31]
    ds_read_b128 v[112:115], v6 offset:4096
    v_mfma_f32_16x16x32_bf16 v[64:67], v[136:139], v[152:155], v[64:67]
    ds_read_b128 v[116:119], v6 offset:5120
    v_mfma_f32_16x16x32_bf16 v[32:35], v[132:135], v[156:159], v[32:35]
    ds_read_b128 v[120:123], v6 offset:6144
    v_mfma_f32_16x16x32_bf16 v[68:71], v[136:139], v[156:159], v[68:71]
    ds_read_b128 v[124:127], v6 offset:7168
    v_mfma_f32_16x16x32_bf16 v[36:39], v[132:135], v[160:163], v[36:39]
    ds_read_b128 v[128:131], v6 offset:8192
    v_mfma_f32_16x16x32_bf16 v[72:75], v[136:139], v[160:163], v[72:75]
    v_mfma_f32_16x16x32_bf16 v[40:43], v[132:135], v[164:167], v[40:43]
    v_mfma_f32_16x16x32_bf16 v[76:79], v[136:139], v[164:167], v[76:79]
    v_mfma_f32_16x16x32_bf16 v[44:47], v[132:135], v[168:171], v[44:47]
    v_mfma_f32_16x16x32_bf16 v[80:83], v[136:139], v[168:171], v[80:83]
    v_mfma_f32_16x16x32_bf16 v[48:51], v[132:135], v[172:175], v[48:51]
    v_mfma_f32_16x16x32_bf16 v[84:87], v[136:139], v[172:175], v[84:87]
    s_waitcnt lgkmcnt(0)
    v_mfma_f32_16x16x32_bf16 v[16:19], v[88:91], v[96:99], v[16:19]
    ds_read_b128 v[132:135], v4 offset:50176
    v_mfma_f32_16x16x32_bf16 v[52:55], v[92:95], v[96:99], v[52:55]
    ds_read_b128 v[136:139], v4 offset:52224
    v_mfma_f32_16x16x32_bf16 v[20:23], v[88:91], v[100:103], v[20:23]
    ds_read_b128 v[140:143], v6 offset:9216
    v_mfma_f32_16x16x32_bf16 v[56:59], v[92:95], v[100:103], v[56:59]
    ds_read_b128 v[144:147], v6 offset:10240
    v_mfma_f32_16x16x32_bf16 v[24:27], v[88:91], v[104:107], v[24:27]
    ds_read_b128 v[148:151], v6 offset:11264
    v_mfma_f32_16x16x32_bf16 v[60:63], v[92:95], v[104:107], v[60:63]
    ds_read_b128 v[152:155], v6 offset:12288
    v_mfma_f32_16x16x32_bf16 v[28:31], v[88:91], v[108:111], v[28:31]
    ds_read_b128 v[156:159], v6 offset:13312
    v_mfma_f32_16x16x32_bf16 v[64:67], v[92:95], v[108:111], v[64:67]
    ds_read_b128 v[160:163], v6 offset:14336
    v_mfma_f32_16x16x32_bf16 v[32:35], v[88:91], v[112:115], v[32:35]
    ds_read_b128 v[164:167], v6 offset:15360
    v_mfma_f32_16x16x32_bf16 v[68:71], v[92:95], v[112:115], v[68:71]
    ds_read_b128 v[168:171], v6 offset:16384
    v_mfma_f32_16x16x32_bf16 v[36:39], v[88:91], v[116:119], v[36:39]
    ds_read_b128 v[172:175], v6 offset:17408
    v_mfma_f32_16x16x32_bf16 v[72:75], v[92:95], v[116:119], v[72:75]
    v_mfma_f32_16x16x32_bf16 v[40:43], v[88:91], v[120:123], v[40:43]
    v_mfma_f32_16x16x32_bf16 v[76:79], v[92:95], v[120:123], v[76:79]
    v_mfma_f32_16x16x32_bf16 v[44:47], v[88:91], v[124:127], v[44:47]
    v_mfma_f32_16x16x32_bf16 v[80:83], v[92:95], v[124:127], v[80:83]
    v_mfma_f32_16x16x32_bf16 v[48:51], v[88:91], v[128:131], v[48:51]
    v_mfma_f32_16x16x32_bf16 v[84:87], v[92:95], v[128:131], v[84:87]
    s_waitcnt lgkmcnt(0)
    s_barrier
    v_mfma_f32_16x16x32_bf16 v[16:19], v[132:135], v[140:143], v[16:19]
    ds_read_b128 v[88:91], v4 offset:0
    v_mfma_f32_16x16x32_bf16 v[52:55], v[136:139], v[140:143], v[52:55]
    ds_read_b128 v[92:95], v4 offset:2048
    v_mfma_f32_16x16x32_bf16 v[20:23], v[132:135], v[144:147], v[20:23]
    ds_read_b128 v[96:99], v5 offset:0
    v_mfma_f32_16x16x32_bf16 v[56:59], v[136:139], v[144:147], v[56:59]
    ds_read_b128 v[100:103], v5 offset:1024
    v_mfma_f32_16x16x32_bf16 v[24:27], v[132:135], v[148:151], v[24:27]
    ds_read_b128 v[104:107], v5 offset:2048
    v_mfma_f32_16x16x32_bf16 v[60:63], v[136:139], v[148:151], v[60:63]
    ds_read_b128 v[108:111], v5 offset:3072
    v_mfma_f32_16x16x32_bf16 v[28:31], v[132:135], v[152:155], v[28:31]
    ds_read_b128 v[112:115], v5 offset:4096
    v_mfma_f32_16x16x32_bf16 v[64:67], v[136:139], v[152:155], v[64:67]
    ds_read_b128 v[116:119], v5 offset:5120
    v_mfma_f32_16x16x32_bf16 v[32:35], v[132:135], v[156:159], v[32:35]
    ds_read_b128 v[120:123], v5 offset:6144
    v_mfma_f32_16x16x32_bf16 v[68:71], v[136:139], v[156:159], v[68:71]
    ds_read_b128 v[124:127], v5 offset:7168
    v_mfma_f32_16x16x32_bf16 v[36:39], v[132:135], v[160:163], v[36:39]
    ds_read_b128 v[128:131], v5 offset:8192
    v_mfma_f32_16x16x32_bf16 v[72:75], v[136:139], v[160:163], v[72:75]
    v_mfma_f32_16x16x32_bf16 v[40:43], v[132:135], v[164:167], v[40:43]
    v_mfma_f32_16x16x32_bf16 v[76:79], v[136:139], v[164:167], v[76:79]
    v_mfma_f32_16x16x32_bf16 v[44:47], v[132:135], v[168:171], v[44:47]
    v_mfma_f32_16x16x32_bf16 v[80:83], v[136:139], v[168:171], v[80:83]
    v_mfma_f32_16x16x32_bf16 v[48:51], v[132:135], v[172:175], v[48:51]
    v_mfma_f32_16x16x32_bf16 v[84:87], v[136:139], v[172:175], v[84:87]
    s_waitcnt lgkmcnt(0)
    v_mfma_f32_16x16x32_bf16 v[16:19], v[88:91], v[96:99], v[16:19]
    ds_read_b128 v[132:135], v4 offset:1024
    v_mfma_f32_16x16x32_bf16 v[52:55], v[92:95], v[96:99], v[52:55]
    ds_read_b128 v[136:139], v4 offset:3072
    v_mfma_f32_16x16x32_bf16 v[20:23], v[88:91], v[100:103], v[20:23]
    ds_read_b128 v[140:143], v5 offset:9216
    v_mfma_f32_16x16x32_bf16 v[56:59], v[92:95], v[100:103], v[56:59]
    ds_read_b128 v[144:147], v5 offset:10240
    v_mfma_f32_16x16x32_bf16 v[24:27], v[88:91], v[104:107], v[24:27]
    ds_read_b128 v[148:151], v5 offset:11264
    v_mfma_f32_16x16x32_bf16 v[60:63], v[92:95], v[104:107], v[60:63]
    ds_read_b128 v[152:155], v5 offset:12288
    v_mfma_f32_16x16x32_bf16 v[28:31], v[88:91], v[108:111], v[28:31]
    ds_read_b128 v[156:159], v5 offset:13312
    v_mfma_f32_16x16x32_bf16 v[64:67], v[92:95], v[108:111], v[64:67]
    ds_read_b128 v[160:163], v5 offset:14336
    v_mfma_f32_16x16x32_bf16 v[32:35], v[88:91], v[112:115], v[32:35]
    ds_read_b128 v[164:167], v5 offset:15360
    v_mfma_f32_16x16x32_bf16 v[68:71], v[92:95], v[112:115], v[68:71]
    ds_read_b128 v[168:171], v5 offset:16384
    v_mfma_f32_16x16x32_bf16 v[36:39], v[88:91], v[116:119], v[36:39]
    ds_read_b128 v[172:175], v5 offset:17408
    v_mfma_f32_16x16x32_bf16 v[72:75], v[92:95], v[116:119], v[72:75]
    v_mfma_f32_16x16x32_bf16 v[40:43], v[88:91], v[120:123], v[40:43]
    v_mfma_f32_16x16x32_bf16 v[76:79], v[92:95], v[120:123], v[76:79]
    v_mfma_f32_16x16x32_bf16 v[44:47], v[88:91], v[124:127], v[44:47]
    v_mfma_f32_16x16x32_bf16 v[80:83], v[92:95], v[124:127], v[80:83]
    v_mfma_f32_16x16x32_bf16 v[48:51], v[88:91], v[128:131], v[48:51]
    v_mfma_f32_16x16x32_bf16 v[84:87], v[92:95], v[128:131], v[84:87]
    s_waitcnt lgkmcnt(0)
    s_barrier
    v_mfma_f32_16x16x32_bf16 v[16:19], v[132:135], v[140:143], v[16:19]
    ds_read_b128 v[176:179], v14 offset:0
    v_mfma_f32_16x16x32_bf16 v[52:55], v[136:139], v[140:143], v[52:55]
    ds_read_b128 v[184:187], v14 offset:128
    v_mfma_f32_16x16x32_bf16 v[20:23], v[132:135], v[144:147], v[20:23]
    ds_read_b128 v[180:183], v14 offset:64
    v_mfma_f32_16x16x32_bf16 v[56:59], v[136:139], v[144:147], v[56:59]
    v_mfma_f32_16x16x32_bf16 v[24:27], v[132:135], v[148:151], v[24:27]
    ds_read_b128 v[188:191], v14 offset:192
    v_mfma_f32_16x16x32_bf16 v[60:63], v[136:139], v[148:151], v[60:63]
    ds_read_b32 v192, v13 offset:0
    v_mfma_f32_16x16x32_bf16 v[28:31], v[132:135], v[152:155], v[28:31]
    ds_read_b32 v193, v13 offset:64
    v_mfma_f32_16x16x32_bf16 v[64:67], v[136:139], v[152:155], v[64:67]
    v_mfma_f32_16x16x32_bf16 v[32:35], v[132:135], v[156:159], v[32:35]
    ds_read_b32 v194, v13 offset:128
    v_mfma_f32_16x16x32_bf16 v[68:71], v[136:139], v[156:159], v[68:71]
    ds_read_b32 v195, v13 offset:192
    v_mfma_f32_16x16x32_bf16 v[36:39], v[132:135], v[160:163], v[36:39]
    v_mfma_f32_16x16x32_bf16 v[72:75], v[136:139], v[160:163], v[72:75]
    ds_read_b32 v196, v13 offset:256
    v_mfma_f32_16x16x32_bf16 v[40:43], v[132:135], v[164:167], v[40:43]
    ds_read_b32 v197, v13 offset:320
    v_mfma_f32_16x16x32_bf16 v[76:79], v[136:139], v[164:167], v[76:79]
    ds_read_b32 v198, v13 offset:384
    v_mfma_f32_16x16x32_bf16 v[44:47], v[132:135], v[168:171], v[44:47]
    v_mfma_f32_16x16x32_bf16 v[80:83], v[136:139], v[168:171], v[80:83]
    ds_read_b32 v199, v13 offset:448
    v_mfma_f32_16x16x32_bf16 v[48:51], v[132:135], v[172:175], v[48:51]
    ds_read_b32 v200, v13 offset:512
    v_mfma_f32_16x16x32_bf16 v[84:87], v[136:139], v[172:175], v[84:87]
    s_waitcnt lgkmcnt(0)
    v_pk_fma_f32 v[16:17], v[184:185], v[192:193], v[16:17] op_sel:[0,0,0] op_sel_hi:[1,0,1]
    v_pk_fma_f32 v[52:53], v[188:189], v[192:193], v[52:53] op_sel:[0,0,0] op_sel_hi:[1,0,1]
    v_pk_fma_f32 v[18:19], v[186:187], v[192:193], v[18:19] op_sel:[0,0,0] op_sel_hi:[1,0,1]
    v_pk_fma_f32 v[54:55], v[190:191], v[192:193], v[54:55] op_sel:[0,0,0] op_sel_hi:[1,0,1]
    v_pk_mul_f32 v[16:17], v[16:17], v[176:177]
    v_pk_mul_f32 v[52:53], v[52:53], v[180:181]
    v_pk_mul_f32 v[18:19], v[18:19], v[178:179]
    v_pk_mul_f32 v[54:55], v[54:55], v[182:183]
    v_pk_mul_f32 v[204:205], v[16:17], v[16:17]
    v_pk_mul_f32 v[208:209], v[52:53], v[52:53]
    v_pk_mul_f32 v[206:207], v[18:19], v[18:19]
    v_pk_mul_f32 v[210:211], v[54:55], v[54:55]
    v_pk_fma_f32 v[204:205], v[204:205], s[46:47], s[46:47] op_sel:[0,0,1] op_sel_hi:[1,0,1]
    v_pk_fma_f32 v[208:209], v[208:209], s[46:47], s[46:47] op_sel:[0,0,1] op_sel_hi:[1,0,1]
    v_pk_fma_f32 v[206:207], v[206:207], s[46:47], s[46:47] op_sel:[0,0,1] op_sel_hi:[1,0,1]
    v_pk_fma_f32 v[210:211], v[210:211], s[46:47], s[46:47] op_sel:[0,0,1] op_sel_hi:[1,0,1]
    v_pk_mul_f32 v[204:205], v[204:205], v[16:17]
    v_pk_mul_f32 v[208:209], v[208:209], v[52:53]
    v_pk_mul_f32 v[206:207], v[206:207], v[18:19]
    v_pk_mul_f32 v[210:211], v[210:211], v[54:55]
    v_exp_f32 v204, v204
    v_exp_f32 v208, v208
    v_exp_f32 v205, v205
    v_exp_f32 v209, v209
    v_exp_f32 v206, v206
    v_exp_f32 v210, v210
    v_exp_f32 v207, v207
    v_exp_f32 v211, v211
    v_pk_add_f32 v[204:205], v[204:205], 1.0 op_sel_hi:[1,0]
    v_pk_add_f32 v[208:209], v[208:209], 1.0 op_sel_hi:[1,0]
    v_pk_add_f32 v[206:207], v[206:207], 1.0 op_sel_hi:[1,0]
    v_pk_add_f32 v[210:211], v[210:211], 1.0 op_sel_hi:[1,0]
    v_rcp_f32 v204, v204
    v_rcp_f32 v208, v208
    v_rcp_f32 v205, v205
    v_rcp_f32 v209, v209
    v_rcp_f32 v206, v206
    v_rcp_f32 v210, v210
    v_rcp_f32 v207, v207
    v_rcp_f32 v211, v211
    v_pk_mul_f32 v[16:17], v[16:17], v[204:205]
    v_pk_mul_f32 v[52:53], v[52:53], v[208:209]
    v_pk_mul_f32 v[18:19], v[18:19], v[206:207]
    v_pk_mul_f32 v[54:55], v[54:55], v[210:211]
    v_pk_mul_f32 v[96:97], v[16:17], v[16:17]
    v_pk_mul_f32 v[100:101], v[52:53], v[52:53]
    v_pk_mul_f32 v[98:99], v[18:19], v[18:19]
    v_pk_mul_f32 v[102:103], v[54:55], v[54:55]
    v_pk_fma_f32 v[20:21], v[184:185], v[192:193], v[20:21] op_sel:[0,1,0] op_sel_hi:[1,1,1]
    v_pk_fma_f32 v[56:57], v[188:189], v[192:193], v[56:57] op_sel:[0,1,0] op_sel_hi:[1,1,1]
    v_pk_fma_f32 v[22:23], v[186:187], v[192:193], v[22:23] op_sel:[0,1,0] op_sel_hi:[1,1,1]
    v_pk_fma_f32 v[58:59], v[190:191], v[192:193], v[58:59] op_sel:[0,1,0] op_sel_hi:[1,1,1]
    v_pk_mul_f32 v[20:21], v[20:21], v[176:177]
    v_pk_mul_f32 v[56:57], v[56:57], v[180:181]
    v_pk_mul_f32 v[22:23], v[22:23], v[178:179]
    v_pk_mul_f32 v[58:59], v[58:59], v[182:183]
    v_pk_mul_f32 v[204:205], v[20:21], v[20:21]
    v_pk_mul_f32 v[208:209], v[56:57], v[56:57]
    v_pk_mul_f32 v[206:207], v[22:23], v[22:23]
    v_pk_mul_f32 v[210:211], v[58:59], v[58:59]
    v_pk_fma_f32 v[204:205], v[204:205], s[46:47], s[46:47] op_sel:[0,0,1] op_sel_hi:[1,0,1]
    v_pk_fma_f32 v[208:209], v[208:209], s[46:47], s[46:47] op_sel:[0,0,1] op_sel_hi:[1,0,1]
    v_pk_fma_f32 v[206:207], v[206:207], s[46:47], s[46:47] op_sel:[0,0,1] op_sel_hi:[1,0,1]
    v_pk_fma_f32 v[210:211], v[210:211], s[46:47], s[46:47] op_sel:[0,0,1] op_sel_hi:[1,0,1]
    v_pk_mul_f32 v[204:205], v[204:205], v[20:21]
    v_pk_mul_f32 v[208:209], v[208:209], v[56:57]
    v_pk_mul_f32 v[206:207], v[206:207], v[22:23]
    v_pk_mul_f32 v[210:211], v[210:211], v[58:59]
    v_exp_f32 v204, v204
    v_exp_f32 v208, v208
    v_exp_f32 v205, v205
    v_exp_f32 v209, v209
    v_exp_f32 v206, v206
    v_exp_f32 v210, v210
    v_exp_f32 v207, v207
    v_exp_f32 v211, v211
    v_pk_add_f32 v[204:205], v[204:205], 1.0 op_sel_hi:[1,0]
    v_pk_add_f32 v[208:209], v[208:209], 1.0 op_sel_hi:[1,0]
    v_pk_add_f32 v[206:207], v[206:207], 1.0 op_sel_hi:[1,0]
    v_pk_add_f32 v[210:211], v[210:211], 1.0 op_sel_hi:[1,0]
    v_rcp_f32 v204, v204
    v_rcp_f32 v208, v208
    v_rcp_f32 v205, v205
    v_rcp_f32 v209, v209
    v_rcp_f32 v206, v206
    v_rcp_f32 v210, v210
    v_rcp_f32 v207, v207
    v_rcp_f32 v211, v211
    v_pk_mul_f32 v[20:21], v[20:21], v[204:205]
    v_pk_mul_f32 v[56:57], v[56:57], v[208:209]
    v_pk_mul_f32 v[22:23], v[22:23], v[206:207]
    v_pk_mul_f32 v[58:59], v[58:59], v[210:211]
    v_pk_fma_f32 v[96:97], v[20:21], v[20:21], v[96:97]
    v_pk_fma_f32 v[100:101], v[56:57], v[56:57], v[100:101]
    v_pk_add_f32 v[88:89], v[20:21], v[16:17]
    v_pk_add_f32 v[92:93], v[56:57], v[52:53]
    v_pk_fma_f32 v[98:99], v[22:23], v[22:23], v[98:99]
    v_pk_fma_f32 v[102:103], v[58:59], v[58:59], v[102:103]
    v_pk_add_f32 v[90:91], v[22:23], v[18:19]
    v_pk_add_f32 v[94:95], v[58:59], v[54:55]
    v_pk_fma_f32 v[24:25], v[184:185], v[194:195], v[24:25] op_sel:[0,0,0] op_sel_hi:[1,0,1]
    v_pk_fma_f32 v[60:61], v[188:189], v[194:195], v[60:61] op_sel:[0,0,0] op_sel_hi:[1,0,1]
    v_pk_fma_f32 v[26:27], v[186:187], v[194:195], v[26:27] op_sel:[0,0,0] op_sel_hi:[1,0,1]
    v_pk_fma_f32 v[62:63], v[190:191], v[194:195], v[62:63] op_sel:[0,0,0] op_sel_hi:[1,0,1]
    v_pk_mul_f32 v[24:25], v[24:25], v[176:177]
    v_pk_mul_f32 v[60:61], v[60:61], v[180:181]
    v_pk_mul_f32 v[26:27], v[26:27], v[178:179]
    v_pk_mul_f32 v[62:63], v[62:63], v[182:183]
    v_pk_mul_f32 v[204:205], v[24:25], v[24:25]
    v_pk_mul_f32 v[208:209], v[60:61], v[60:61]
    v_pk_mul_f32 v[206:207], v[26:27], v[26:27]
    v_pk_mul_f32 v[210:211], v[62:63], v[62:63]
    v_pk_fma_f32 v[204:205], v[204:205], s[46:47], s[46:47] op_sel:[0,0,1] op_sel_hi:[1,0,1]
    v_pk_fma_f32 v[208:209], v[208:209], s[46:47], s[46:47] op_sel:[0,0,1] op_sel_hi:[1,0,1]
    v_pk_fma_f32 v[206:207], v[206:207], s[46:47], s[46:47] op_sel:[0,0,1] op_sel_hi:[1,0,1]
    v_pk_fma_f32 v[210:211], v[210:211], s[46:47], s[46:47] op_sel:[0,0,1] op_sel_hi:[1,0,1]
    v_pk_mul_f32 v[204:205], v[204:205], v[24:25]
    v_pk_mul_f32 v[208:209], v[208:209], v[60:61]
    v_pk_mul_f32 v[206:207], v[206:207], v[26:27]
    v_pk_mul_f32 v[210:211], v[210:211], v[62:63]
    v_exp_f32 v204, v204
    v_exp_f32 v208, v208
    v_exp_f32 v205, v205
    v_exp_f32 v209, v209
    v_exp_f32 v206, v206
    v_exp_f32 v210, v210
    v_exp_f32 v207, v207
    v_exp_f32 v211, v211
    v_pk_add_f32 v[204:205], v[204:205], 1.0 op_sel_hi:[1,0]
    v_pk_add_f32 v[208:209], v[208:209], 1.0 op_sel_hi:[1,0]
    v_pk_add_f32 v[206:207], v[206:207], 1.0 op_sel_hi:[1,0]
    v_pk_add_f32 v[210:211], v[210:211], 1.0 op_sel_hi:[1,0]
    v_rcp_f32 v204, v204
    v_rcp_f32 v208, v208
    v_rcp_f32 v205, v205
    v_rcp_f32 v209, v209
    v_rcp_f32 v206, v206
    v_rcp_f32 v210, v210
    v_rcp_f32 v207, v207
    v_rcp_f32 v211, v211
    v_pk_mul_f32 v[24:25], v[24:25], v[204:205]
    v_pk_mul_f32 v[60:61], v[60:61], v[208:209]
    v_pk_mul_f32 v[26:27], v[26:27], v[206:207]
    v_pk_mul_f32 v[62:63], v[62:63], v[210:211]
    v_pk_fma_f32 v[96:97], v[24:25], v[24:25], v[96:97]
    v_pk_fma_f32 v[100:101], v[60:61], v[60:61], v[100:101]
    v_pk_add_f32 v[88:89], v[88:89], v[24:25]
    v_pk_add_f32 v[92:93], v[92:93], v[60:61]
    v_pk_fma_f32 v[98:99], v[26:27], v[26:27], v[98:99]
    v_pk_fma_f32 v[102:103], v[62:63], v[62:63], v[102:103]
    v_pk_add_f32 v[90:91], v[90:91], v[26:27]
    v_pk_add_f32 v[94:95], v[94:95], v[62:63]
    v_pk_fma_f32 v[28:29], v[184:185], v[194:195], v[28:29] op_sel:[0,1,0] op_sel_hi:[1,1,1]
    v_pk_fma_f32 v[64:65], v[188:189], v[194:195], v[64:65] op_sel:[0,1,0] op_sel_hi:[1,1,1]
    v_pk_fma_f32 v[30:31], v[186:187], v[194:195], v[30:31] op_sel:[0,1,0] op_sel_hi:[1,1,1]
    v_pk_fma_f32 v[66:67], v[190:191], v[194:195], v[66:67] op_sel:[0,1,0] op_sel_hi:[1,1,1]
    v_pk_mul_f32 v[28:29], v[28:29], v[176:177]
    v_pk_mul_f32 v[64:65], v[64:65], v[180:181]
    v_pk_mul_f32 v[30:31], v[30:31], v[178:179]
    v_pk_mul_f32 v[66:67], v[66:67], v[182:183]
    v_pk_mul_f32 v[204:205], v[28:29], v[28:29]
    v_pk_mul_f32 v[208:209], v[64:65], v[64:65]
    v_pk_mul_f32 v[206:207], v[30:31], v[30:31]
    v_pk_mul_f32 v[210:211], v[66:67], v[66:67]
    v_pk_fma_f32 v[204:205], v[204:205], s[46:47], s[46:47] op_sel:[0,0,1] op_sel_hi:[1,0,1]
    v_pk_fma_f32 v[208:209], v[208:209], s[46:47], s[46:47] op_sel:[0,0,1] op_sel_hi:[1,0,1]
    v_pk_fma_f32 v[206:207], v[206:207], s[46:47], s[46:47] op_sel:[0,0,1] op_sel_hi:[1,0,1]
    v_pk_fma_f32 v[210:211], v[210:211], s[46:47], s[46:47] op_sel:[0,0,1] op_sel_hi:[1,0,1]
    v_pk_mul_f32 v[204:205], v[204:205], v[28:29]
    v_pk_mul_f32 v[208:209], v[208:209], v[64:65]
    v_pk_mul_f32 v[206:207], v[206:207], v[30:31]
    v_pk_mul_f32 v[210:211], v[210:211], v[66:67]
    v_exp_f32 v204, v204
    v_exp_f32 v208, v208
    v_exp_f32 v205, v205
    v_exp_f32 v209, v209
    v_exp_f32 v206, v206
    v_exp_f32 v210, v210
    v_exp_f32 v207, v207
    v_exp_f32 v211, v211
    v_pk_add_f32 v[204:205], v[204:205], 1.0 op_sel_hi:[1,0]
    v_pk_add_f32 v[208:209], v[208:209], 1.0 op_sel_hi:[1,0]
    v_pk_add_f32 v[206:207], v[206:207], 1.0 op_sel_hi:[1,0]
    v_pk_add_f32 v[210:211], v[210:211], 1.0 op_sel_hi:[1,0]
    v_rcp_f32 v204, v204
    v_rcp_f32 v208, v208
    v_rcp_f32 v205, v205
    v_rcp_f32 v209, v209
    v_rcp_f32 v206, v206
    v_rcp_f32 v210, v210
    v_rcp_f32 v207, v207
    v_rcp_f32 v211, v211
    v_pk_mul_f32 v[28:29], v[28:29], v[204:205]
    v_pk_mul_f32 v[64:65], v[64:65], v[208:209]
    v_pk_mul_f32 v[30:31], v[30:31], v[206:207]
    v_pk_mul_f32 v[66:67], v[66:67], v[210:211]
    v_pk_fma_f32 v[96:97], v[28:29], v[28:29], v[96:97]
    v_pk_fma_f32 v[100:101], v[64:65], v[64:65], v[100:101]
    v_pk_add_f32 v[88:89], v[88:89], v[28:29]
    v_pk_add_f32 v[92:93], v[92:93], v[64:65]
    v_pk_fma_f32 v[98:99], v[30:31], v[30:31], v[98:99]
    v_pk_fma_f32 v[102:103], v[66:67], v[66:67], v[102:103]
    v_pk_add_f32 v[90:91], v[90:91], v[30:31]
    v_pk_add_f32 v[94:95], v[94:95], v[66:67]
    v_pk_fma_f32 v[32:33], v[184:185], v[196:197], v[32:33] op_sel:[0,0,0] op_sel_hi:[1,0,1]
    v_pk_fma_f32 v[68:69], v[188:189], v[196:197], v[68:69] op_sel:[0,0,0] op_sel_hi:[1,0,1]
    v_pk_fma_f32 v[34:35], v[186:187], v[196:197], v[34:35] op_sel:[0,0,0] op_sel_hi:[1,0,1]
    v_pk_fma_f32 v[70:71], v[190:191], v[196:197], v[70:71] op_sel:[0,0,0] op_sel_hi:[1,0,1]
    v_pk_mul_f32 v[32:33], v[32:33], v[176:177]
    v_pk_mul_f32 v[68:69], v[68:69], v[180:181]
    v_pk_mul_f32 v[34:35], v[34:35], v[178:179]
    v_pk_mul_f32 v[70:71], v[70:71], v[182:183]
    v_pk_mul_f32 v[204:205], v[32:33], v[32:33]
    v_pk_mul_f32 v[208:209], v[68:69], v[68:69]
    v_pk_mul_f32 v[206:207], v[34:35], v[34:35]
    v_pk_mul_f32 v[210:211], v[70:71], v[70:71]
    v_pk_fma_f32 v[204:205], v[204:205], s[46:47], s[46:47] op_sel:[0,0,1] op_sel_hi:[1,0,1]
    v_pk_fma_f32 v[208:209], v[208:209], s[46:47], s[46:47] op_sel:[0,0,1] op_sel_hi:[1,0,1]
    v_pk_fma_f32 v[206:207], v[206:207], s[46:47], s[46:47] op_sel:[0,0,1] op_sel_hi:[1,0,1]
    v_pk_fma_f32 v[210:211], v[210:211], s[46:47], s[46:47] op_sel:[0,0,1] op_sel_hi:[1,0,1]
    v_pk_mul_f32 v[204:205], v[204:205], v[32:33]
    v_pk_mul_f32 v[208:209], v[208:209], v[68:69]
    v_pk_mul_f32 v[206:207], v[206:207], v[34:35]
    v_pk_mul_f32 v[210:211], v[210:211], v[70:71]
    v_exp_f32 v204, v204
    v_exp_f32 v208, v208
    v_exp_f32 v205, v205
    v_exp_f32 v209, v209
    v_exp_f32 v206, v206
    v_exp_f32 v210, v210
    v_exp_f32 v207, v207
    v_exp_f32 v211, v211
    v_pk_add_f32 v[204:205], v[204:205], 1.0 op_sel_hi:[1,0]
    v_pk_add_f32 v[208:209], v[208:209], 1.0 op_sel_hi:[1,0]
    v_pk_add_f32 v[206:207], v[206:207], 1.0 op_sel_hi:[1,0]
    v_pk_add_f32 v[210:211], v[210:211], 1.0 op_sel_hi:[1,0]
    v_rcp_f32 v204, v204
    v_rcp_f32 v208, v208
    v_rcp_f32 v205, v205
    v_rcp_f32 v209, v209
    v_rcp_f32 v206, v206
    v_rcp_f32 v210, v210
    v_rcp_f32 v207, v207
    v_rcp_f32 v211, v211
    v_pk_mul_f32 v[32:33], v[32:33], v[204:205]
    v_pk_mul_f32 v[68:69], v[68:69], v[208:209]
    v_pk_mul_f32 v[34:35], v[34:35], v[206:207]
    v_pk_mul_f32 v[70:71], v[70:71], v[210:211]
    v_pk_fma_f32 v[96:97], v[32:33], v[32:33], v[96:97]
    v_pk_fma_f32 v[100:101], v[68:69], v[68:69], v[100:101]
    v_pk_add_f32 v[88:89], v[88:89], v[32:33]
    v_pk_add_f32 v[92:93], v[92:93], v[68:69]
    v_pk_fma_f32 v[98:99], v[34:35], v[34:35], v[98:99]
    v_pk_fma_f32 v[102:103], v[70:71], v[70:71], v[102:103]
    v_pk_add_f32 v[90:91], v[90:91], v[34:35]
    v_pk_add_f32 v[94:95], v[94:95], v[70:71]
    v_pk_fma_f32 v[36:37], v[184:185], v[196:197], v[36:37] op_sel:[0,1,0] op_sel_hi:[1,1,1]
    v_pk_fma_f32 v[72:73], v[188:189], v[196:197], v[72:73] op_sel:[0,1,0] op_sel_hi:[1,1,1]
    v_pk_fma_f32 v[38:39], v[186:187], v[196:197], v[38:39] op_sel:[0,1,0] op_sel_hi:[1,1,1]
    v_pk_fma_f32 v[74:75], v[190:191], v[196:197], v[74:75] op_sel:[0,1,0] op_sel_hi:[1,1,1]
    v_pk_mul_f32 v[36:37], v[36:37], v[176:177]
    v_pk_mul_f32 v[72:73], v[72:73], v[180:181]
    v_pk_mul_f32 v[38:39], v[38:39], v[178:179]
    v_pk_mul_f32 v[74:75], v[74:75], v[182:183]
    v_pk_mul_f32 v[204:205], v[36:37], v[36:37]
    v_pk_mul_f32 v[208:209], v[72:73], v[72:73]
    v_pk_mul_f32 v[206:207], v[38:39], v[38:39]
    v_pk_mul_f32 v[210:211], v[74:75], v[74:75]
    v_pk_fma_f32 v[204:205], v[204:205], s[46:47], s[46:47] op_sel:[0,0,1] op_sel_hi:[1,0,1]
    v_pk_fma_f32 v[208:209], v[208:209], s[46:47], s[46:47] op_sel:[0,0,1] op_sel_hi:[1,0,1]
    v_pk_fma_f32 v[206:207], v[206:207], s[46:47], s[46:47] op_sel:[0,0,1] op_sel_hi:[1,0,1]
    v_pk_fma_f32 v[210:211], v[210:211], s[46:47], s[46:47] op_sel:[0,0,1] op_sel_hi:[1,0,1]
    v_pk_mul_f32 v[204:205], v[204:205], v[36:37]
    v_pk_mul_f32 v[208:209], v[208:209], v[72:73]
    v_pk_mul_f32 v[206:207], v[206:207], v[38:39]
    v_pk_mul_f32 v[210:211], v[210:211], v[74:75]
    v_exp_f32 v204, v204
    v_exp_f32 v208, v208
    v_exp_f32 v205, v205
    v_exp_f32 v209, v209
    v_exp_f32 v206, v206
    v_exp_f32 v210, v210
    v_exp_f32 v207, v207
    v_exp_f32 v211, v211
    v_pk_add_f32 v[204:205], v[204:205], 1.0 op_sel_hi:[1,0]
    v_pk_add_f32 v[208:209], v[208:209], 1.0 op_sel_hi:[1,0]
    v_pk_add_f32 v[206:207], v[206:207], 1.0 op_sel_hi:[1,0]
    v_pk_add_f32 v[210:211], v[210:211], 1.0 op_sel_hi:[1,0]
    v_rcp_f32 v204, v204
    v_rcp_f32 v208, v208
    v_rcp_f32 v205, v205
    v_rcp_f32 v209, v209
    v_rcp_f32 v206, v206
    v_rcp_f32 v210, v210
    v_rcp_f32 v207, v207
    v_rcp_f32 v211, v211
    v_pk_mul_f32 v[36:37], v[36:37], v[204:205]
    v_pk_mul_f32 v[72:73], v[72:73], v[208:209]
    v_pk_mul_f32 v[38:39], v[38:39], v[206:207]
    v_pk_mul_f32 v[74:75], v[74:75], v[210:211]
    v_pk_fma_f32 v[96:97], v[36:37], v[36:37], v[96:97]
    v_pk_fma_f32 v[100:101], v[72:73], v[72:73], v[100:101]
    v_pk_add_f32 v[88:89], v[88:89], v[36:37]
    v_pk_add_f32 v[92:93], v[92:93], v[72:73]
    v_pk_fma_f32 v[98:99], v[38:39], v[38:39], v[98:99]
    v_pk_fma_f32 v[102:103], v[74:75], v[74:75], v[102:103]
    v_pk_add_f32 v[90:91], v[90:91], v[38:39]
    v_pk_add_f32 v[94:95], v[94:95], v[74:75]
    v_pk_fma_f32 v[40:41], v[184:185], v[198:199], v[40:41] op_sel:[0,0,0] op_sel_hi:[1,0,1]
    v_pk_fma_f32 v[76:77], v[188:189], v[198:199], v[76:77] op_sel:[0,0,0] op_sel_hi:[1,0,1]
    v_pk_fma_f32 v[42:43], v[186:187], v[198:199], v[42:43] op_sel:[0,0,0] op_sel_hi:[1,0,1]
    v_pk_fma_f32 v[78:79], v[190:191], v[198:199], v[78:79] op_sel:[0,0,0] op_sel_hi:[1,0,1]
    v_pk_mul_f32 v[40:41], v[40:41], v[176:177]
    v_pk_mul_f32 v[76:77], v[76:77], v[180:181]
    v_pk_mul_f32 v[42:43], v[42:43], v[178:179]
    v_pk_mul_f32 v[78:79], v[78:79], v[182:183]
    v_pk_mul_f32 v[204:205], v[40:41], v[40:41]
    v_pk_mul_f32 v[208:209], v[76:77], v[76:77]
    v_pk_mul_f32 v[206:207], v[42:43], v[42:43]
    v_pk_mul_f32 v[210:211], v[78:79], v[78:79]
    v_pk_fma_f32 v[204:205], v[204:205], s[46:47], s[46:47] op_sel:[0,0,1] op_sel_hi:[1,0,1]
    v_pk_fma_f32 v[208:209], v[208:209], s[46:47], s[46:47] op_sel:[0,0,1] op_sel_hi:[1,0,1]
    v_pk_fma_f32 v[206:207], v[206:207], s[46:47], s[46:47] op_sel:[0,0,1] op_sel_hi:[1,0,1]
    v_pk_fma_f32 v[210:211], v[210:211], s[46:47], s[46:47] op_sel:[0,0,1] op_sel_hi:[1,0,1]
    v_pk_mul_f32 v[204:205], v[204:205], v[40:41]
    v_pk_mul_f32 v[208:209], v[208:209], v[76:77]
    v_pk_mul_f32 v[206:207], v[206:207], v[42:43]
    v_pk_mul_f32 v[210:211], v[210:211], v[78:79]
    v_exp_f32 v204, v204
    v_exp_f32 v208, v208
    v_exp_f32 v205, v205
    v_exp_f32 v209, v209
    v_exp_f32 v206, v206
    v_exp_f32 v210, v210
    v_exp_f32 v207, v207
    v_exp_f32 v211, v211
    v_pk_add_f32 v[204:205], v[204:205], 1.0 op_sel_hi:[1,0]
    v_pk_add_f32 v[208:209], v[208:209], 1.0 op_sel_hi:[1,0]
    v_pk_add_f32 v[206:207], v[206:207], 1.0 op_sel_hi:[1,0]
    v_pk_add_f32 v[210:211], v[210:211], 1.0 op_sel_hi:[1,0]
    v_rcp_f32 v204, v204
    v_rcp_f32 v208, v208
    v_rcp_f32 v205, v205
    v_rcp_f32 v209, v209
    v_rcp_f32 v206, v206
    v_rcp_f32 v210, v210
    v_rcp_f32 v207, v207
    v_rcp_f32 v211, v211
    v_pk_mul_f32 v[40:41], v[40:41], v[204:205]
    v_pk_mul_f32 v[76:77], v[76:77], v[208:209]
    v_pk_mul_f32 v[42:43], v[42:43], v[206:207]
    v_pk_mul_f32 v[78:79], v[78:79], v[210:211]
    v_pk_fma_f32 v[96:97], v[40:41], v[40:41], v[96:97]
    v_pk_fma_f32 v[100:101], v[76:77], v[76:77], v[100:101]
    v_pk_add_f32 v[88:89], v[88:89], v[40:41]
    v_pk_add_f32 v[92:93], v[92:93], v[76:77]
    v_pk_fma_f32 v[98:99], v[42:43], v[42:43], v[98:99]
    v_pk_fma_f32 v[102:103], v[78:79], v[78:79], v[102:103]
    v_pk_add_f32 v[90:91], v[90:91], v[42:43]
    v_pk_add_f32 v[94:95], v[94:95], v[78:79]
    v_pk_fma_f32 v[44:45], v[184:185], v[198:199], v[44:45] op_sel:[0,1,0] op_sel_hi:[1,1,1]
    v_pk_fma_f32 v[80:81], v[188:189], v[198:199], v[80:81] op_sel:[0,1,0] op_sel_hi:[1,1,1]
    v_pk_fma_f32 v[46:47], v[186:187], v[198:199], v[46:47] op_sel:[0,1,0] op_sel_hi:[1,1,1]
    v_pk_fma_f32 v[82:83], v[190:191], v[198:199], v[82:83] op_sel:[0,1,0] op_sel_hi:[1,1,1]
    v_pk_mul_f32 v[44:45], v[44:45], v[176:177]
    v_pk_mul_f32 v[80:81], v[80:81], v[180:181]
    v_pk_mul_f32 v[46:47], v[46:47], v[178:179]
    v_pk_mul_f32 v[82:83], v[82:83], v[182:183]
    v_pk_mul_f32 v[204:205], v[44:45], v[44:45]
    v_pk_mul_f32 v[208:209], v[80:81], v[80:81]
    v_pk_mul_f32 v[206:207], v[46:47], v[46:47]
    v_pk_mul_f32 v[210:211], v[82:83], v[82:83]
    v_pk_fma_f32 v[204:205], v[204:205], s[46:47], s[46:47] op_sel:[0,0,1] op_sel_hi:[1,0,1]
    v_pk_fma_f32 v[208:209], v[208:209], s[46:47], s[46:47] op_sel:[0,0,1] op_sel_hi:[1,0,1]
    v_pk_fma_f32 v[206:207], v[206:207], s[46:47], s[46:47] op_sel:[0,0,1] op_sel_hi:[1,0,1]
    v_pk_fma_f32 v[210:211], v[210:211], s[46:47], s[46:47] op_sel:[0,0,1] op_sel_hi:[1,0,1]
    v_pk_mul_f32 v[204:205], v[204:205], v[44:45]
    v_pk_mul_f32 v[208:209], v[208:209], v[80:81]
    v_pk_mul_f32 v[206:207], v[206:207], v[46:47]
    v_pk_mul_f32 v[210:211], v[210:211], v[82:83]
    v_exp_f32 v204, v204
    v_exp_f32 v208, v208
    v_exp_f32 v205, v205
    v_exp_f32 v209, v209
    v_exp_f32 v206, v206
    v_exp_f32 v210, v210
    v_exp_f32 v207, v207
    v_exp_f32 v211, v211
    v_pk_add_f32 v[204:205], v[204:205], 1.0 op_sel_hi:[1,0]
    v_pk_add_f32 v[208:209], v[208:209], 1.0 op_sel_hi:[1,0]
    v_pk_add_f32 v[206:207], v[206:207], 1.0 op_sel_hi:[1,0]
    v_pk_add_f32 v[210:211], v[210:211], 1.0 op_sel_hi:[1,0]
    v_rcp_f32 v204, v204
    v_rcp_f32 v208, v208
    v_rcp_f32 v205, v205
    v_rcp_f32 v209, v209
    v_rcp_f32 v206, v206
    v_rcp_f32 v210, v210
    v_rcp_f32 v207, v207
    v_rcp_f32 v211, v211
    v_pk_mul_f32 v[44:45], v[44:45], v[204:205]
    v_pk_mul_f32 v[80:81], v[80:81], v[208:209]
    v_pk_mul_f32 v[46:47], v[46:47], v[206:207]
    v_pk_mul_f32 v[82:83], v[82:83], v[210:211]
    v_pk_fma_f32 v[96:97], v[44:45], v[44:45], v[96:97]
    v_pk_fma_f32 v[100:101], v[80:81], v[80:81], v[100:101]
    v_pk_add_f32 v[88:89], v[88:89], v[44:45]
    v_pk_add_f32 v[92:93], v[92:93], v[80:81]
    v_pk_fma_f32 v[98:99], v[46:47], v[46:47], v[98:99]
    v_pk_fma_f32 v[102:103], v[82:83], v[82:83], v[102:103]
    v_pk_add_f32 v[90:91], v[90:91], v[46:47]
    v_pk_add_f32 v[94:95], v[94:95], v[82:83]
    v_pk_fma_f32 v[48:49], v[184:185], v[200:201], v[48:49] op_sel:[0,0,0] op_sel_hi:[1,0,1]
    v_pk_fma_f32 v[84:85], v[188:189], v[200:201], v[84:85] op_sel:[0,0,0] op_sel_hi:[1,0,1]
    v_pk_fma_f32 v[50:51], v[186:187], v[200:201], v[50:51] op_sel:[0,0,0] op_sel_hi:[1,0,1]
    v_pk_fma_f32 v[86:87], v[190:191], v[200:201], v[86:87] op_sel:[0,0,0] op_sel_hi:[1,0,1]
    v_pk_mul_f32 v[48:49], v[48:49], v[176:177]
    v_pk_mul_f32 v[84:85], v[84:85], v[180:181]
    v_pk_mul_f32 v[50:51], v[50:51], v[178:179]
    v_pk_mul_f32 v[86:87], v[86:87], v[182:183]
    v_pk_mul_f32 v[204:205], v[48:49], v[48:49]
    v_pk_mul_f32 v[208:209], v[84:85], v[84:85]
    v_pk_mul_f32 v[206:207], v[50:51], v[50:51]
    v_pk_mul_f32 v[210:211], v[86:87], v[86:87]
    v_pk_fma_f32 v[204:205], v[204:205], s[46:47], s[46:47] op_sel:[0,0,1] op_sel_hi:[1,0,1]
    v_pk_fma_f32 v[208:209], v[208:209], s[46:47], s[46:47] op_sel:[0,0,1] op_sel_hi:[1,0,1]
    v_pk_fma_f32 v[206:207], v[206:207], s[46:47], s[46:47] op_sel:[0,0,1] op_sel_hi:[1,0,1]
    v_pk_fma_f32 v[210:211], v[210:211], s[46:47], s[46:47] op_sel:[0,0,1] op_sel_hi:[1,0,1]
    v_pk_mul_f32 v[204:205], v[204:205], v[48:49]
    v_pk_mul_f32 v[208:209], v[208:209], v[84:85]
    v_pk_mul_f32 v[206:207], v[206:207], v[50:51]
    v_pk_mul_f32 v[210:211], v[210:211], v[86:87]
    v_exp_f32 v204, v204
    v_exp_f32 v208, v208
    v_exp_f32 v205, v205
    v_exp_f32 v209, v209
    v_exp_f32 v206, v206
    v_exp_f32 v210, v210
    v_exp_f32 v207, v207
    v_exp_f32 v211, v211
    v_pk_add_f32 v[204:205], v[204:205], 1.0 op_sel_hi:[1,0]
    v_pk_add_f32 v[208:209], v[208:209], 1.0 op_sel_hi:[1,0]
    v_pk_add_f32 v[206:207], v[206:207], 1.0 op_sel_hi:[1,0]
    v_pk_add_f32 v[210:211], v[210:211], 1.0 op_sel_hi:[1,0]
    v_rcp_f32 v204, v204
    v_rcp_f32 v208, v208
    v_rcp_f32 v205, v205
    v_rcp_f32 v209, v209
    v_rcp_f32 v206, v206
    v_rcp_f32 v210, v210
    v_rcp_f32 v207, v207
    v_rcp_f32 v211, v211
    v_pk_mul_f32 v[48:49], v[48:49], v[204:205]
    v_pk_mul_f32 v[84:85], v[84:85], v[208:209]
    v_pk_mul_f32 v[50:51], v[50:51], v[206:207]
    v_pk_mul_f32 v[86:87], v[86:87], v[210:211]
    v_pk_fma_f32 v[96:97], v[48:49], v[48:49], v[96:97]
    v_pk_fma_f32 v[100:101], v[84:85], v[84:85], v[100:101]
    v_pk_add_f32 v[88:89], v[88:89], v[48:49]
    v_pk_add_f32 v[92:93], v[92:93], v[84:85]
    v_pk_fma_f32 v[98:99], v[50:51], v[50:51], v[98:99]
    v_pk_fma_f32 v[102:103], v[86:87], v[86:87], v[102:103]
    v_pk_add_f32 v[90:91], v[90:91], v[50:51]
    v_pk_add_f32 v[94:95], v[94:95], v[86:87]
    v_add_f32_dpp v104, v88, v88 row_ror:8 row_mask:0xf bank_mask:0x3
    v_add_f32_dpp v105, v89, v89 row_ror:8 row_mask:0xf bank_mask:0x3
    v_add_f32_dpp v106, v90, v90 row_ror:8 row_mask:0xf bank_mask:0x3
    v_add_f32_dpp v107, v91, v91 row_ror:8 row_mask:0xf bank_mask:0x3
    v_add_f32_dpp v104, v92, v92 row_ror:8 row_mask:0xf bank_mask:0xc
    v_add_f32_dpp v105, v93, v93 row_ror:8 row_mask:0xf bank_mask:0xc
    v_add_f32_dpp v106, v94, v94 row_ror:8 row_mask:0xf bank_mask:0xc
    v_add_f32_dpp v107, v95, v95 row_ror:8 row_mask:0xf bank_mask:0xc
    v_add_f32_dpp v108, v96, v96 row_ror:8 row_mask:0xf bank_mask:0x3
    v_add_f32_dpp v109, v97, v97 row_ror:8 row_mask:0xf bank_mask:0x3
    v_add_f32_dpp v110, v98, v98 row_ror:8 row_mask:0xf bank_mask:0x3
    v_add_f32_dpp v111, v99, v99 row_ror:8 row_mask:0xf bank_mask:0x3
    v_add_f32_dpp v108, v100, v100 row_ror:8 row_mask:0xf bank_mask:0xc
    v_add_f32_dpp v109, v101, v101 row_ror:8 row_mask:0xf bank_mask:0xc
    v_add_f32_dpp v110, v102, v102 row_ror:8 row_mask:0xf bank_mask:0xc
    v_add_f32_dpp v111, v103, v103 row_ror:8 row_mask:0xf bank_mask:0xc
    v_add_f32_dpp v112, v104, v104 row_shl:4 row_mask:0xf bank_mask:0x5
    v_add_f32_dpp v113, v105, v105 row_shl:4 row_mask:0xf bank_mask:0x5
    v_add_f32_dpp v114, v108, v108 row_shl:4 row_mask:0xf bank_mask:0x5
    v_add_f32_dpp v115, v109, v109 row_shl:4 row_mask:0xf bank_mask:0x5
    v_add_f32_dpp v112, v106, v106 row_shr:4 row_mask:0xf bank_mask:0xa
    v_add_f32_dpp v113, v107, v107 row_shr:4 row_mask:0xf bank_mask:0xa
    v_add_f32_dpp v114, v110, v110 row_shr:4 row_mask:0xf bank_mask:0xa
    v_add_f32_dpp v115, v111, v111 row_shr:4 row_mask:0xf bank_mask:0xa
    v_add_f32_dpp v112, v112, v112 quad_perm:[1,0,3,2] row_mask:0xf bank_mask:0xf
    v_add_f32_dpp v113, v113, v113 quad_perm:[1,0,3,2] row_mask:0xf bank_mask:0xf
    v_add_f32_dpp v114, v114, v114 quad_perm:[1,0,3,2] row_mask:0xf bank_mask:0xf
    v_add_f32_dpp v115, v115, v115 quad_perm:[1,0,3,2] row_mask:0xf bank_mask:0xf
    v_add_f32_dpp v112, v112, v112 quad_perm:[2,3,0,1] row_mask:0xf bank_mask:0xf
    v_add_f32_dpp v113, v113, v113 quad_perm:[2,3,0,1] row_mask:0xf bank_mask:0xf
    v_add_f32_dpp v114, v114, v114 quad_perm:[2,3,0,1] row_mask:0xf bank_mask:0xf
    v_add_f32_dpp v115, v115, v115 quad_perm:[2,3,0,1] row_mask:0xf bank_mask:0xf
    v_cndmask_b32 v104, v112, v113, vcc
    v_cndmask_b32 v105, v114, v115, vcc
    v_and_b32 v105, 0x7fffffff, v105
    buffer_store_dwordx2 v[104:105], v12, s[16:19], s43 offen sc1
    s_add_u32 s43, s42, 4096
    s_add_u32 s50, s42, 8192
    s_add_u32 s51, s42, 12288
    s_barrier
    s_add_u32 s28, s48, 8192
    s_add_u32 s29, s48, 24576
    s_add_u32 m0, s31, 16384
    s_nop 0
    buffer_load_dwordx4 v3, s[16:19], s28 offen offset:0 sc1 lds
    buffer_load_dwordx4 v3, s[16:19], s28 offen offset:1024 sc1 lds
    buffer_load_dwordx4 v3, s[16:19], s29 offen offset:2048 sc1 lds
    buffer_load_dwordx4 v3, s[16:19], s29 offen offset:3072 sc1 lds
    s_add_u32 s30, s49, 73728
    s_add_u32 m0, s32, 18432
    s_add_u32 s28, s53, 90112
    buffer_load_dwordx4 v3, s[16:19], s30 offen offset:0 sc1 lds
    buffer_load_dwordx4 v3, s[16:19], s30 offen offset:1024 sc1 lds
    buffer_load_dwordx4 v3, s[16:19], s30 offen offset:2048 sc1 lds
    buffer_load_dwordx4 v3, s[16:19], s30 offen offset:3072 sc1 lds
    s_add_u32 m0, s33, 18432
    s_mov_b64 exec, s[36:37]
    buffer_load_dwordx4 v3, s[16:19], s28 offen sc1 lds
    s_mov_b64 exec, -1
    s_barrier
    s_add_u32 s28, s48, 10240
    s_add_u32 s29, s48, 26624
    s_add_u32 m0, s31, 32768
    s_nop 0
    buffer_load_dwordx4 v3, s[16:19], s28 offen offset:0 sc1 lds
    buffer_load_dwordx4 v3, s[16:19], s28 offen offset:1024 sc1 lds
    buffer_load_dwordx4 v3, s[16:19], s29 offen offset:2048 sc1 lds
    buffer_load_dwordx4 v3, s[16:19], s29 offen offset:3072 sc1 lds
    s_add_u32 s30, s49, 92160
    s_add_u32 m0, s32, 36864
    s_add_u32 s28, s53, 108544
    buffer_load_dwordx4 v3, s[16:19], s30 offen offset:0 sc1 lds
    buffer_load_dwordx4 v3, s[16:19], s30 offen offset:1024 sc1 lds
    buffer_load_dwordx4 v3, s[16:19], s30 offen offset:2048 sc1 lds
    buffer_load_dwordx4 v3, s[16:19], s30 offen offset:3072 sc1 lds
    s_add_u32 m0, s33, 36864
    s_mov_b64 exec, s[34:35]
    buffer_load_dwordx4 v3, s[16:19], s28 offen sc1 lds
    s_mov_b64 exec, -1
    s_barrier
    buffer_load_dwordx2 v[104:105], v11, s[16:19], s42 offen offset:0 sc1
    buffer_load_dwordx2 v[106:107], v11, s[16:19], s42 offen offset:2048 sc1
    buffer_load_dwordx2 v[108:109], v11, s[16:19], s43 offen offset:0 sc1
    buffer_load_dwordx2 v[110:111], v11, s[16:19], s43 offen offset:2048 sc1
    buffer_load_dwordx2 v[112:113], v11, s[16:19], s50 offen offset:0 sc1
    buffer_load_dwordx2 v[114:115], v11, s[16:19], s50 offen offset:2048 sc1
    buffer_load_dwordx2 v[116:117], v11, s[16:19], s51 offen offset:0 sc1
    buffer_load_dwordx2 v[118:119], v11, s[16:19], s51 offen offset:2048 sc1
    s_add_u32 s28, s48, 12288
    s_add_u32 s29, s48, 28672
    s_add_u32 m0, s31, 49152
    s_nop 0
    buffer_load_dwordx4 v3, s[16:19], s28 offen offset:0 sc1 lds
    buffer_load_dwordx4 v3, s[16:19], s28 offen offset:1024 sc1 lds
    buffer_load_dwordx4 v3, s[16:19], s29 offen offset:2048 sc1 lds
    buffer_load_dwordx4 v3, s[16:19], s29 offen offset:3072 sc1 lds
    s_add_u32 s30, s49, 110592
    s_add_u32 m0, s32, 55296
    s_add_u32 s28, s53, 126976
    buffer_load_dwordx4 v3, s[16:19], s30 offen offset:0 sc1 lds
    buffer_load_dwordx4 v3, s[16:19], s30 offen offset:1024 sc1 lds
    buffer_load_dwordx4 v3, s[16:19], s30 offen offset:2048 sc1 lds
    buffer_load_dwordx4 v3, s[16:19], s30 offen offset:3072 sc1 lds
    s_add_u32 m0, s33, 55296
    s_mov_b64 exec, s[36:37]
    buffer_load_dwordx4 v3, s[16:19], s28 offen sc1 lds
    s_mov_b64 exec, -1
    s_waitcnt vmcnt(25)
    s_barrier
    s_mov_b32 s52, 0x20000
    s_waitcnt vmcnt(8)
    v_max3_u32 v9, v105, v107, v109
    v_max3_u32 v9, v9, v111, v113
    v_max3_u32 v9, v9, v115, v117
    v_max_u32 v9, v9, v119
    v_cmp_eq_u32_e64 vcc, -1, v9
    s_nop 4
    s_cbranch_vccnz sequential_preLN__sliding_block__mixer_gmlp__prompt_kernel_zpoll
sequential_preLN__sliding_block__mixer_gmlp__prompt_kernel_zpoll_ok:
    s_add_u32 s28, s48, 14336
    s_add_u32 s29, s48, 30720
    s_add_u32 m0, s31, 0
    s_nop 0
    buffer_load_dwordx4 v3, s[16:19], s28 offen offset:0 sc1 lds
    v_add_f32 v104, v104, v106
    v_add_f32 v105, v105, v107
    v_add_f32 v108, v108, v110
    v_add_f32 v109, v109, v111
    v_add_f32 v112, v112, v114
    v_add_f32 v113, v113, v115
    v_add_f32 v116, v116, v118
    v_add_f32 v117, v117, v119
    v_add_f32 v104, v104, v108
    v_add_f32 v105, v105, v109
    v_add_f32 v112, v112, v116
    v_add_f32 v113, v113, v117
    v_add_f32 v104, v104, v112
    v_add_f32 v105, v105, v113
    v_mov_b32 v106, v104
    v_mov_b32_e64 v107, v105
    s_nop 0
    v_permlane32_swap_b32 v106, v104
    v_permlane32_swap_b32 v107, v105
    buffer_load_dwordx4 v3, s[16:19], s28 offen offset:1024 sc1 lds
    v_add_f32 v104, v104, v106
    v_add_f32 v105, v105, v107
    s_mov_b32 s38, 971214393
    v_mul_f32 v10, s38, v104
    v_mul_f32 v9, s38, v105
    v_fma_f32 v9, -v10, v10, v9
    v_max_f32_e64 v9, 0, v9
    v_add_f32 v9, 925353388, v9
    v_rsq_f32 v9, v9
    s_nop 0
    v_mul_f32 v10, v10, v9
    v_sub_f32 v10, 0, v10
    ds_write_b32 v7, v9
    ds_write_b32 v7, v10 offset:128
    ds_read_b128 v[176:179], v15 offset:0
    ds_read_b128 v[184:187], v15 offset:128
    ds_read_b128 v[180:183], v15 offset:64
    ds_read_b128 v[188:191], v15 offset:192
    s_lshl_b32 s42, s22, 6
    buffer_load_dwordx4 v3, s[16:19], s29 offen offset:2048 sc1 lds
    s_lshl_b32 s38, s21, 2
    s_add_u32 s42, s42, s38
    s_add_u32 s42, s42, s23
    s_lshl_b32 s43, s22, 4
    s_add_u32 s43, s43, s21
    s_lshl_b32 s43, s43, 7
    s_add_u32 s43, s43, 15532032
    s_mul_i32 s42, s42, 9216
    s_add_u32 s42, s42, 16777216
    s_waitcnt lgkmcnt(0)
    v_pk_fma_f32 v[16:17], v[16:17], v[176:177], v[184:185]
    v_pk_fma_f32 v[18:19], v[18:19], v[178:179], v[186:187]
    v_pk_fma_f32 v[52:53], v[52:53], v[180:181], v[188:189]
    v_pk_fma_f32 v[54:55], v[54:55], v[182:183], v[190:191]
    v_pk_fma_f32 v[20:21], v[20:21], v[176:177], v[184:185]
    v_pk_fma_f32 v[22:23], v[22:23], v[178:179], v[186:187]
    v_pk_fma_f32 v[56:57], v[56:57], v[180:181], v[188:189]
    v_pk_fma_f32 v[58:59], v[58:59], v[182:183], v[190:191]
    buffer_load_dwordx4 v3, s[16:19], s29 offen offset:3072 sc1 lds
    v_pk_fma_f32 v[24:25], v[24:25], v[176:177], v[184:185]
    v_pk_fma_f32 v[26:27], v[26:27], v[178:179], v[186:187]
    v_pk_fma_f32 v[60:61], v[60:61], v[180:181], v[188:189]
    v_pk_fma_f32 v[62:63], v[62:63], v[182:183], v[190:191]
    v_pk_fma_f32 v[28:29], v[28:29], v[176:177], v[184:185]
    v_pk_fma_f32 v[30:31], v[30:31], v[178:179], v[186:187]
    v_pk_fma_f32 v[64:65], v[64:65], v[180:181], v[188:189]
    v_pk_fma_f32 v[66:67], v[66:67], v[182:183], v[190:191]
    v_pk_fma_f32 v[32:33], v[32:33], v[176:177], v[184:185]
    v_pk_fma_f32 v[34:35], v[34:35], v[178:179], v[186:187]
    v_pk_fma_f32 v[68:69], v[68:69], v[180:181], v[188:189]
    v_pk_fma_f32 v[70:71], v[70:71], v[182:183], v[190:191]
    v_pk_fma_f32 v[36:37], v[36:37], v[176:177], v[184:185]
    v_pk_fma_f32 v[38:39], v[38:39], v[178:179], v[186:187]
    v_pk_fma_f32 v[72:73], v[72:73], v[180:181], v[188:189]
    v_pk_fma_f32 v[74:75], v[74:75], v[182:183], v[190:191]
    v_pk_fma_f32 v[40:41], v[40:41], v[176:177], v[184:185]
    v_pk_fma_f32 v[42:43], v[42:43], v[178:179], v[186:187]
    s_add_u32 s30, s49, 129024
    s_add_u32 m0, s32, 0
    s_add_u32 s28, s53, 145408
    buffer_load_dwordx4 v3, s[16:19], s30 offen offset:0 sc1 lds
    s_nop 0
    v_pk_fma_f32 v[76:77], v[76:77], v[180:181], v[188:189]
    v_pk_fma_f32 v[78:79], v[78:79], v[182:183], v[190:191]
    v_pk_fma_f32 v[44:45], v[44:45], v[176:177], v[184:185]
    v_pk_fma_f32 v[46:47], v[46:47], v[178:179], v[186:187]
    v_pk_fma_f32 v[80:81], v[80:81], v[180:181], v[188:189]
    v_pk_fma_f32 v[82:83], v[82:83], v[182:183], v[190:191]
    v_pk_fma_f32 v[48:49], v[48:49], v[176:177], v[184:185]
    v_pk_fma_f32 v[50:51], v[50:51], v[178:179], v[186:187]
    v_pk_fma_f32 v[84:85], v[84:85], v[180:181], v[188:189]
    v_pk_fma_f32 v[86:87], v[86:87], v[182:183], v[190:191]
    v_cvt_pk_bf16_f32 v128, v16, v17
    v_cvt_pk_bf16_f32 v129, v18, v19
    v_cvt_pk_bf16_f32 v130, v52, v53
    v_cvt_pk_bf16_f32 v131, v54, v55
    v_cvt_pk_bf16_f32 v132, v20, v21
    v_cvt_pk_bf16_f32 v133, v22, v23
    v_cvt_pk_bf16_f32 v134, v56, v57
    v_cvt_pk_bf16_f32 v135, v58, v59
    buffer_load_dwordx4 v3, s[16:19], s30 offen offset:1024 sc1 lds
    v_cvt_pk_bf16_f32 v136, v24, v25
    v_cvt_pk_bf16_f32 v137, v26, v27
    v_cvt_pk_bf16_f32 v138, v60, v61
    v_cvt_pk_bf16_f32 v139, v62, v63
    v_cvt_pk_bf16_f32 v140, v28, v29
    v_cvt_pk_bf16_f32 v141, v30, v31
    v_cvt_pk_bf16_f32 v142, v64, v65
    v_cvt_pk_bf16_f32 v143, v66, v67
    v_cvt_pk_bf16_f32 v144, v32, v33
    v_cvt_pk_bf16_f32 v145, v34, v35
    v_cvt_pk_bf16_f32 v146, v68, v69
    v_cvt_pk_bf16_f32 v147, v70, v71
    v_cvt_pk_bf16_f32 v148, v36, v37
    v_cvt_pk_bf16_f32 v149, v38, v39
    v_cvt_pk_bf16_f32 v150, v72, v73
    v_cvt_pk_bf16_f32 v151, v74, v75
    v_cvt_pk_bf16_f32 v152, v40, v41
    v_cvt_pk_bf16_f32 v153, v42, v43
    buffer_load_dwordx4 v3, s[16:19], s30 offen offset:2048 sc1 lds
    v_cvt_pk_bf16_f32 v154, v76, v77
    v_cvt_pk_bf16_f32 v155, v78, v79
    v_cvt_pk_bf16_f32 v156, v44, v45
    v_cvt_pk_bf16_f32 v157, v46, v47
    v_cvt_pk_bf16_f32 v158, v80, v81
    v_cvt_pk_bf16_f32 v159, v82, v83
    v_cvt_pk_bf16_f32 v160, v48, v49
    v_cvt_pk_bf16_f32 v161, v50, v51
    v_cvt_pk_bf16_f32 v162, v84, v85
    v_cvt_pk_bf16_f32 v163, v86, v87
    v_permlane32_swap_b32 v128, v130
    v_permlane32_swap_b32 v129, v131
    v_permlane32_swap_b32 v132, v134
    v_permlane32_swap_b32 v133, v135
    v_permlane32_swap_b32 v136, v138
    v_permlane32_swap_b32 v137, v139
    v_permlane32_swap_b32 v140, v142
    v_permlane32_swap_b32 v141, v143
    buffer_load_dwordx4 v3, s[16:19], s30 offen offset:3072 sc1 lds
    v_permlane32_swap_b32 v144, v146
    v_permlane32_swap_b32 v145, v147
    v_permlane32_swap_b32 v148, v150
    v_permlane32_swap_b32 v149, v151
    v_permlane32_swap_b32 v152, v154
    v_permlane32_swap_b32 v153, v155
    v_permlane32_swap_b32 v156, v158
    v_permlane32_swap_b32 v157, v159
    v_permlane32_swap_b32 v160, v162
    v_permlane32_swap_b32 v161, v163
    v_permlane16_swap_b32 v128, v130
    v_permlane16_swap_b32 v129, v131
    v_permlane16_swap_b32 v132, v134
    v_permlane16_swap_b32 v133, v135
    v_permlane16_swap_b32 v136, v138
    v_permlane16_swap_b32 v137, v139
    v_permlane16_swap_b32 v140, v142
    v_permlane16_swap_b32 v141, v143
    s_add_u32 m0, s33, 0
    s_mov_b64 exec, s[34:35]
    buffer_load_dwordx4 v3, s[16:19], s28 offen sc1 lds
    s_mov_b64 exec, -1
    v_permlane16_swap_b32 v144, v146
    v_permlane16_swap_b32 v145, v147
    v_permlane16_swap_b32 v148, v150
    v_permlane16_swap_b32 v149, v151
    v_permlane16_swap_b32 v152, v154
    v_permlane16_swap_b32 v153, v155
    v_permlane16_swap_b32 v156, v158
    v_permlane16_swap_b32 v157, v159
    v_permlane16_swap_b32 v160, v162
    v_permlane16_swap_b32 v161, v163
    buffer_store_dwordx4 v[128:131], v3, s[16:19], s42 offen offset:0 sc1
    buffer_store_dwordx4 v[132:135], v3, s[16:19], s42 offen offset:1024 sc1
    buffer_store_dwordx4 v[136:139], v3, s[16:19], s42 offen offset:2048 sc1
    buffer_store_dwordx4 v[140:143], v3, s[16:19], s42 offen offset:3072 sc1
    s_add_u32 s42, s42, 4096
    buffer_store_dwordx4 v[144:147], v3, s[16:19], s42 offen offset:0 sc1
    buffer_store_dwordx4 v[148:151], v3, s[16:19], s42 offen offset:1024 sc1
    buffer_store_dwordx4 v[152:155], v3, s[16:19], s42 offen offset:2048 sc1
    buffer_store_dwordx4 v[156:159], v3, s[16:19], s42 offen offset:3072 sc1
    s_add_u32 s42, s42, 4096
    buffer_store_dwordx4 v[160:163], v3, s[16:19], s42 offen offset:0 sc1
    s_waitcnt vmcnt(34)
    s_barrier
    s_add_u32 s28, s48, 16384
    s_add_u32 s29, s48, 32768
    s_add_u32 m0, s31, 16384
    s_nop 0
    buffer_load_dwordx4 v3, s[16:19], s28 offen offset:0 sc1 lds
    buffer_load_dwordx4 v3, s[16:19], s28 offen offset:1024 sc1 lds
    buffer_load_dwordx4 v3, s[16:19], s29 offen offset:2048 sc1 lds
    buffer_load_dwordx4 v3, s[16:19], s29 offen offset:3072 sc1 lds
    s_add_u32 s30, s49, 147456
    s_add_u32 m0, s32, 18432
    s_add_u32 s28, s53, 163840
    buffer_load_dwordx4 v3, s[16:19], s30 offen offset:0 sc1 lds
    buffer_load_dwordx4 v3, s[16:19], s30 offen offset:1024 sc1 lds
    buffer_load_dwordx4 v3, s[16:19], s30 offen offset:2048 sc1 lds
    buffer_load_dwordx4 v3, s[16:19], s30 offen offset:3072 sc1 lds
    s_add_u32 m0, s33, 18432
    s_mov_b64 exec, s[36:37]
    buffer_load_dwordx4 v3, s[16:19], s28 offen sc1 lds
    s_mov_b64 exec, -1
    s_waitcnt vmcnt(26)
    s_barrier
    s_waitcnt vmcnt(17)
    s_barrier
    v_mov_b32 v9, 147488
    v_mov_b32 v10, 1
    v_mov_b32 v8, 0
    s_waitcnt vmcnt(8)
    s_mov_b64 exec, 1
    ds_add_rtn_u32 v10, v9, v10
    s_waitcnt lgkmcnt(0)
    v_cmp_eq_u32 vcc, 3, v10
    s_nop 0
    s_and_b64 exec, exec, vcc
    buffer_store_dword v8, v8, s[16:19], s43 offen sc1
    s_mov_b64 exec, -1
    s_waitcnt vmcnt(0)
    s_barrier
    s_mov_b32 s55, s43
    v_lshrrev_b32_e64 v11, 3, v1
    v_mul_u32_u24 v12, 4096, v11
    v_and_b32 v13, 7, v1
    v_lshrrev_b32 v14, 4, v1
    v_xor_b32_e64 v13, v13, v14
    v_lshl_add_u32 v4, v13, 4, v12
    v_xor_b32_e64 v13, 4, v13
    v_lshl_add_u32 v5, v13, 4, v12
    v_add_u32 v5, 32768, v5
    v_subrev_u32 v5, 1024, v5
    v_and_b32 v6, 15, v1
    v_lshlrev_b32_e64 v6, 7, v6
    s_lshl_b32 s38, s21, 19
    s_lshl_b32 s39, s23, 17
    s_add_u32 s28, s38, s39
    s_add_u32 s29, s28, 63488
    s_mul_i32 s38, s22, 589824
    s_add_u32 s38, s38, 16777216
    s_add_u32 s30, s38, s31
    s_and_b32 s39, s23, 1
    s_lshl_b32 s39, s39, 10
    s_add_u32 s44, s38, s39
    s_add_u32 s44, s44, 16384
    s_add_u32 s45, s21, s22
    s_and_b32 s45, s45, 3
    s_mov_b32 s46, 512
    s_mov_b32 s47, 73728
    s_lshl_b32 s42, s22, 11
    s_add_u32 s42, s42, 15532032
    s_mov_b32 s8, s4
    s_mov_b32 s9, s5
    s_mov_b32 s10, 8388608
    s_mov_b32 s11, 0x20000
    s_cmp_eq_u32 s45, 0
    s_cselect_b32 s38, s46, 0
    s_add_u32 s48, s28, s38
    s_add_u32 s49, s29, s38
    s_add_u32 m0, s31, 32768
    s_add_u32 s28, s28, 128
    buffer_load_dwordx4 v4, s[8:11], s48 offen offset:0 lds
    buffer_load_dwordx4 v5, s[8:11], s48 offen offset:1024 lds
    buffer_load_dwordx4 v4, s[8:11], s49 offen offset:2048 lds
    buffer_load_dwordx4 v5, s[8:11], s49 offen offset:3072 lds
    s_add_u32 s29, s29, 128
    s_mov_b32 s52, 0x20000
    v_mov_b32 v9, 147456
    s_cmp_lg_u32 s23, 0
    s_cbranch_scc1 sequential_preLN__sliding_block__mixer_gmlp__prompt_kernel_f4poll_l
    v_mov_b32 v8, 147488
sequential_preLN__sliding_block__mixer_gmlp__prompt_kernel_f4poll_a:
    ds_read_b32 v10, v8
    s_waitcnt lgkmcnt(0)
    v_cmp_gt_u32_e64 vcc, 4, v10
    s_sub_u32 s52, s52, 1
    s_nop 3
    s_cbranch_vccnz sequential_preLN__sliding_block__mixer_gmlp__prompt_kernel_f4poll_ar
sequential_preLN__sliding_block__mixer_gmlp__prompt_kernel_f4poll_ad:
    s_sleep 6
sequential_preLN__sliding_block__mixer_gmlp__prompt_kernel_f4poll_g:
    buffer_load_dword v10, v6, s[16:19], s42 offen sc1
    s_waitcnt vmcnt(0)
    v_cmp_eq_u32 vcc, -1, v10
    s_sub_u32 s52, s52, 1
    s_nop 3
    s_cbranch_vccnz sequential_preLN__sliding_block__mixer_gmlp__prompt_kernel_f4poll_gr
sequential_preLN__sliding_block__mixer_gmlp__prompt_kernel_f4poll_gd:
    v_mov_b32 v10, 1
    ds_write_b32 v9, v10
sequential_preLN__sliding_block__mixer_gmlp__prompt_kernel_f4poll_ok:
    s_cmp_eq_u32 s45, 0
    s_cselect_b32 s39, s47, 0
    s_add_u32 s50, s30, s39
    s_add_u32 s51, s44, s39
    s_add_u32 m0, s32, 36864
    s_add_u32 s30, s30, 18432
    buffer_load_dwordx4 v3, s[16:19], s50 offen offset:0 sc1 lds
    buffer_load_dwordx4 v3, s[16:19], s50 offen offset:1024 sc1 lds
    buffer_load_dwordx4 v3, s[16:19], s50 offen offset:2048 sc1 lds
    buffer_load_dwordx4 v3, s[16:19], s50 offen offset:3072 sc1 lds
    s_add_u32 m0, s33, 36864
    s_mov_b64 exec, s[34:35]
    buffer_load_dwordx4 v3, s[16:19], s51 offen sc1 lds
    s_mov_b64 exec, -1
    s_add_u32 s44, s44, 18432
    s_cmp_eq_u32 s45, 1
    s_cselect_b32 s38, s46, 0
    s_add_u32 s48, s28, s38
    s_add_u32 s49, s29, s38
    s_add_u32 m0, s31, 49152
    s_add_u32 s28, s28, 128
    buffer_load_dwordx4 v4, s[8:11], s48 offen offset:0 lds
    buffer_load_dwordx4 v5, s[8:11], s48 offen offset:1024 lds
    buffer_load_dwordx4 v4, s[8:11], s49 offen offset:2048 lds
    buffer_load_dwordx4 v5, s[8:11], s49 offen offset:3072 lds
    s_add_u32 s29, s29, 128
    s_cmp_eq_u32 s45, 1
    s_cselect_b32 s39, s47, 0
    s_add_u32 s50, s30, s39
    s_add_u32 s51, s44, s39
    s_add_u32 m0, s32, 55296
    s_add_u32 s30, s30, 18432
    buffer_load_dwordx4 v3, s[16:19], s50 offen offset:0 sc1 lds
    buffer_load_dwordx4 v3, s[16:19], s50 offen offset:1024 sc1 lds
    buffer_load_dwordx4 v3, s[16:19], s50 offen offset:2048 sc1 lds
    buffer_load_dwordx4 v3, s[16:19], s50 offen offset:3072 sc1 lds
    s_add_u32 m0, s33, 55296
    s_mov_b64 exec, s[36:37]
    buffer_load_dwordx4 v3, s[16:19], s51 offen sc1 lds
    s_mov_b64 exec, -1
    s_add_u32 s44, s44, 18432
    s_cmp_eq_u32 s45, 2
    s_cselect_b32 s38, s46, 0
    s_add_u32 s48, s28, s38
    s_add_u32 s49, s29, s38
    s_add_u32 m0, s31, 0
    s_add_u32 s28, s28, 128
    buffer_load_dwordx4 v4, s[8:11], s48 offen offset:0 lds
    buffer_load_dwordx4 v5, s[8:11], s48 offen offset:1024 lds
    buffer_load_dwordx4 v4, s[8:11], s49 offen offset:2048 lds
    buffer_load_dwordx4 v5, s[8:11], s49 offen offset:3072 lds
    s_add_u32 s29, s29, 128
    s_cmp_eq_u32 s45, 2
    s_cselect_b32 s39, s47, 0
    s_add_u32 s50, s30, s39
    s_add_u32 s51, s44, s39
    s_add_u32 m0, s32, 0
    s_add_u32 s30, s30, 18432
    buffer_load_dwordx4 v3, s[16:19], s50 offen offset:0 sc1 lds
    buffer_load_dwordx4 v3, s[16:19], s50 offen offset:1024 sc1 lds
    buffer_load_dwordx4 v3, s[16:19], s50 offen offset:2048 sc1 lds
    buffer_load_dwordx4 v3, s[16:19], s50 offen offset:3072 sc1 lds
    s_add_u32 m0, s33, 0
    s_mov_b64 exec, s[34:35]
    buffer_load_dwordx4 v3, s[16:19], s51 offen sc1 lds
    s_mov_b64 exec, -1
    s_add_u32 s44, s44, 18432
    s_waitcnt vmcnt(17)
    s_barrier
    s_cmp_eq_u32 s45, 3
    s_cselect_b32 s38, s46, 0
    s_add_u32 s48, s28, s38
    s_add_u32 s49, s29, s38
    s_add_u32 m0, s31, 16384
    s_add_u32 s28, s28, 128
    buffer_load_dwordx4 v4, s[8:11], s48 offen offset:0 lds
    buffer_load_dwordx4 v5, s[8:11], s48 offen offset:1024 lds
    buffer_load_dwordx4 v4, s[8:11], s49 offen offset:2048 lds
    buffer_load_dwordx4 v5, s[8:11], s49 offen offset:3072 lds
    s_add_u32 s29, s29, 128
    s_cmp_eq_u32 s45, 3
    s_cselect_b32 s39, s47, 0
    s_add_u32 s50, s30, s39
    s_add_u32 s51, s44, s39
    s_add_u32 m0, s32, 18432
    s_add_u32 s30, s30, 18432
    buffer_load_dwordx4 v3, s[16:19], s50 offen offset:0 sc1 lds
    buffer_load_dwordx4 v3, s[16:19], s50 offen offset:1024 sc1 lds
    buffer_load_dwordx4 v3, s[16:19], s50 offen offset:2048 sc1 lds
    buffer_load_dwordx4 v3, s[16:19], s50 offen offset:3072 sc1 lds
    s_add_u32 m0, s33, 18432
    s_mov_b64 exec, s[36:37]
    buffer_load_dwordx4 v3, s[16:19], s51 offen sc1 lds
    s_mov_b64 exec, -1
    s_add_u32 s44, s44, 18432
    s_waitcnt vmcnt(17)
    s_barrier
    s_cmp_eq_u32 s45, 0
    s_cselect_b32 s38, s46, 0
    s_add_u32 s48, s28, s38
    s_add_u32 s49, s29, s38
    s_add_u32 m0, s31, 32768
    s_add_u32 s28, s28, 128
    buffer_load_dwordx4 v4, s[8:11], s48 offen offset:0 lds
    buffer_load_dwordx4 v5, s[8:11], s48 offen offset:1024 lds
    buffer_load_dwordx4 v4, s[8:11], s49 offen offset:2048 lds
    buffer_load_dwordx4 v5, s[8:11], s49 offen offset:3072 lds
    s_add_u32 s29, s29, 128
    s_cmp_eq_u32 s45, 0
    s_cselect_b32 s39, s47, 0
    s_add_u32 s50, s30, s39
    s_add_u32 s51, s44, s39
    s_add_u32 m0, s32, 36864
    s_add_u32 s30, s30, 18432
    buffer_load_dwordx4 v3, s[16:19], s50 offen offset:0 sc1 lds
    buffer_load_dwordx4 v3, s[16:19], s50 offen offset:1024 sc1 lds
    buffer_load_dwordx4 v3, s[16:19], s50 offen offset:2048 sc1 lds
    buffer_load_dwordx4 v3, s[16:19], s50 offen offset:3072 sc1 lds
    s_add_u32 m0, s33, 36864
    s_mov_b64 exec, s[34:35]
    buffer_load_dwordx4 v3, s[16:19], s51 offen sc1 lds
    s_mov_b64 exec, -1
    s_add_u32 s44, s44, 18432
    s_waitcnt vmcnt(17)
    s_barrier
    s_cmp_eq_u32 s45, 1
    s_cselect_b32 s38, s46, 0
    s_add_u32 s48, s28, s38
    s_add_u32 s49, s29, s38
    s_add_u32 m0, s31, 49152
    s_add_u32 s28, s28, 128
    buffer_load_dwordx4 v4, s[8:11], s48 offen offset:0 lds
    buffer_load_dwordx4 v5, s[8:11], s48 offen offset:1024 lds
    buffer_load_dwordx4 v4, s[8:11], s49 offen offset:2048 lds
    buffer_load_dwordx4 v5, s[8:11], s49 offen offset:3072 lds
    s_add_u32 s29, s29, 128
    s_cmp_eq_u32 s45, 1
    s_cselect_b32 s39, s47, 0
    s_add_u32 s50, s30, s39
    s_add_u32 s51, s44, s39
    s_add_u32 m0, s32, 55296
    s_add_u32 s30, s30, 18432
    buffer_load_dwordx4 v3, s[16:19], s50 offen offset:0 sc1 lds
    buffer_load_dwordx4 v3, s[16:19], s50 offen offset:1024 sc1 lds
    buffer_load_dwordx4 v3, s[16:19], s50 offen offset:2048 sc1 lds
    buffer_load_dwordx4 v3, s[16:19], s50 offen offset:3072 sc1 lds
    s_add_u32 m0, s33, 55296
    s_mov_b64 exec, s[36:37]
    buffer_load_dwordx4 v3, s[16:19], s51 offen sc1 lds
    s_mov_b64 exec, -1
    s_add_u32 s44, s44, 18432
    s_waitcnt vmcnt(17)
    s_barrier
    s_cmp_eq_u32 s45, 2
    s_cselect_b32 s38, s46, 0
    s_add_u32 s48, s28, s38
    s_add_u32 s49, s29, s38
    s_add_u32 m0, s31, 0
    s_add_u32 s28, s28, 128
    buffer_load_dwordx4 v4, s[8:11], s48 offen offset:0 lds
    buffer_load_dwordx4 v5, s[8:11], s48 offen offset:1024 lds
    buffer_load_dwordx4 v4, s[8:11], s49 offen offset:2048 lds
    buffer_load_dwordx4 v5, s[8:11], s49 offen offset:3072 lds
    s_add_u32 s29, s29, 128
    s_cmp_eq_u32 s45, 2
    s_cselect_b32 s39, s47, 0
    s_add_u32 s50, s30, s39
    s_add_u32 s51, s44, s39
    s_add_u32 m0, s32, 0
    s_add_u32 s30, s30, 18432
    buffer_load_dwordx4 v3, s[16:19], s50 offen offset:0 sc1 lds
    buffer_load_dwordx4 v3, s[16:19], s50 offen offset:1024 sc1 lds
    buffer_load_dwordx4 v3, s[16:19], s50 offen offset:2048 sc1 lds
    buffer_load_dwordx4 v3, s[16:19], s50 offen offset:3072 sc1 lds
    s_add_u32 m0, s33, 0
    s_mov_b64 exec, s[34:35]
    buffer_load_dwordx4 v3, s[16:19], s51 offen sc1 lds
    s_mov_b64 exec, -1
    s_add_u32 s44, s44, 18432
    s_waitcnt vmcnt(17)
    s_barrier
    s_cmp_eq_u32 s45, 3
    s_cselect_b32 s38, s46, 0
    s_add_u32 s48, s28, s38
    s_add_u32 s49, s29, s38
    s_add_u32 m0, s31, 16384
    s_add_u32 s28, s28, 128
    buffer_load_dwordx4 v4, s[8:11], s48 offen offset:0 lds
    buffer_load_dwordx4 v5, s[8:11], s48 offen offset:1024 lds
    buffer_load_dwordx4 v4, s[8:11], s49 offen offset:2048 lds
    buffer_load_dwordx4 v5, s[8:11], s49 offen offset:3072 lds
    s_add_u32 s29, s29, 128
    s_cmp_eq_u32 s45, 3
    s_cselect_b32 s39, s47, 0
    s_add_u32 s50, s30, s39
    s_add_u32 s51, s44, s39
    s_add_u32 m0, s32, 18432
    s_add_u32 s30, s30, 18432
    buffer_load_dwordx4 v3, s[16:19], s50 offen offset:0 sc1 lds
    buffer_load_dwordx4 v3, s[16:19], s50 offen offset:1024 sc1 lds
    buffer_load_dwordx4 v3, s[16:19], s50 offen offset:2048 sc1 lds
    buffer_load_dwordx4 v3, s[16:19], s50 offen offset:3072 sc1 lds
    s_add_u32 m0, s33, 18432
    s_mov_b64 exec, s[36:37]
    buffer_load_dwordx4 v3, s[16:19], s51 offen sc1 lds
    s_mov_b64 exec, -1
    s_add_u32 s44, s44, 18432
    s_mov_b32 s43, 6
sequential_preLN__sliding_block__mixer_gmlp__prompt_kernel_l5loop:
    s_cmp_le_u32 s43, 1
    s_cselect_b32 s46, 4294963712, s46
    s_cselect_b32 s47, 4294451200, s47
    s_waitcnt vmcnt(17)
    s_barrier
    s_cmp_eq_u32 s45, 0
    s_cselect_b32 s38, s46, 0
    s_add_u32 s48, s28, s38
    s_add_u32 s49, s29, s38
    s_add_u32 m0, s31, 32768
    s_add_u32 s28, s28, 128
    buffer_load_dwordx4 v4, s[8:11], s48 offen offset:0 lds
    buffer_load_dwordx4 v5, s[8:11], s48 offen offset:1024 lds
    buffer_load_dwordx4 v4, s[8:11], s49 offen offset:2048 lds
    buffer_load_dwordx4 v5, s[8:11], s49 offen offset:3072 lds
    s_add_u32 s29, s29, 128
    s_cmp_eq_u32 s45, 0
    s_cselect_b32 s39, s47, 0
    s_add_u32 s50, s30, s39
    s_add_u32 s51, s44, s39
    s_add_u32 m0, s32, 36864
    s_add_u32 s30, s30, 18432
    buffer_load_dwordx4 v3, s[16:19], s50 offen offset:0 sc1 lds
    buffer_load_dwordx4 v3, s[16:19], s50 offen offset:1024 sc1 lds
    buffer_load_dwordx4 v3, s[16:19], s50 offen offset:2048 sc1 lds
    buffer_load_dwordx4 v3, s[16:19], s50 offen offset:3072 sc1 lds
    s_add_u32 m0, s33, 36864
    s_mov_b64 exec, s[34:35]
    buffer_load_dwordx4 v3, s[16:19], s51 offen sc1 lds
    s_mov_b64 exec, -1
    s_add_u32 s44, s44, 18432
    s_waitcnt vmcnt(17)
    s_barrier
    s_cmp_eq_u32 s45, 1
    s_cselect_b32 s38, s46, 0
    s_add_u32 s48, s28, s38
    s_add_u32 s49, s29, s38
    s_add_u32 m0, s31, 49152
    s_add_u32 s28, s28, 128
    buffer_load_dwordx4 v4, s[8:11], s48 offen offset:0 lds
    buffer_load_dwordx4 v5, s[8:11], s48 offen offset:1024 lds
    buffer_load_dwordx4 v4, s[8:11], s49 offen offset:2048 lds
    buffer_load_dwordx4 v5, s[8:11], s49 offen offset:3072 lds
    s_add_u32 s29, s29, 128
    s_cmp_eq_u32 s45, 1
    s_cselect_b32 s39, s47, 0
    s_add_u32 s50, s30, s39
    s_add_u32 s51, s44, s39
    s_add_u32 m0, s32, 55296
    s_add_u32 s30, s30, 18432
    buffer_load_dwordx4 v3, s[16:19], s50 offen offset:0 sc1 lds
    buffer_load_dwordx4 v3, s[16:19], s50 offen offset:1024 sc1 lds
    buffer_load_dwordx4 v3, s[16:19], s50 offen offset:2048 sc1 lds
    buffer_load_dwordx4 v3, s[16:19], s50 offen offset:3072 sc1 lds
    s_add_u32 m0, s33, 55296
    s_mov_b64 exec, s[36:37]
    buffer_load_dwordx4 v3, s[16:19], s51 offen sc1 lds
    s_mov_b64 exec, -1
    s_add_u32 s44, s44, 18432
    s_waitcnt vmcnt(17)
    s_barrier
    s_cmp_eq_u32 s45, 2
    s_cselect_b32 s38, s46, 0
    s_add_u32 s48, s28, s38
    s_add_u32 s49, s29, s38
    s_add_u32 m0, s31, 0
    s_add_u32 s28, s28, 128
    buffer_load_dwordx4 v4, s[8:11], s48 offen offset:0 lds
    buffer_load_dwordx4 v5, s[8:11], s48 offen offset:1024 lds
    buffer_load_dwordx4 v4, s[8:11], s49 offen offset:2048 lds
    buffer_load_dwordx4 v5, s[8:11], s49 offen offset:3072 lds
    s_add_u32 s29, s29, 128
    s_cmp_eq_u32 s45, 2
    s_cselect_b32 s39, s47, 0
    s_add_u32 s50, s30, s39
    s_add_u32 s51, s44, s39
    s_add_u32 m0, s32, 0
    s_add_u32 s30, s30, 18432
    buffer_load_dwordx4 v3, s[16:19], s50 offen offset:0 sc1 lds
    buffer_load_dwordx4 v3, s[16:19], s50 offen offset:1024 sc1 lds
    buffer_load_dwordx4 v3, s[16:19], s50 offen offset:2048 sc1 lds
    buffer_load_dwordx4 v3, s[16:19], s50 offen offset:3072 sc1 lds
    s_add_u32 m0, s33, 0
    s_mov_b64 exec, s[34:35]
    buffer_load_dwordx4 v3, s[16:19], s51 offen sc1 lds
    s_mov_b64 exec, -1
    s_add_u32 s44, s44, 18432
    s_waitcnt vmcnt(17)
    s_barrier
    s_cmp_eq_u32 s45, 3
    s_cselect_b32 s38, s46, 0
    s_add_u32 s48, s28, s38
    s_add_u32 s49, s29, s38
    s_add_u32 m0, s31, 16384
    s_add_u32 s28, s28, 128
    buffer_load_dwordx4 v4, s[8:11], s48 offen offset:0 lds
    buffer_load_dwordx4 v5, s[8:11], s48 offen offset:1024 lds
    buffer_load_dwordx4 v4, s[8:11], s49 offen offset:2048 lds
    buffer_load_dwordx4 v5, s[8:11], s49 offen offset:3072 lds
    s_add_u32 s29, s29, 128
    s_cmp_eq_u32 s45, 3
    s_cselect_b32 s39, s47, 0
    s_add_u32 s50, s30, s39
    s_add_u32 s51, s44, s39
    s_add_u32 m0, s32, 18432
    s_add_u32 s30, s30, 18432
    buffer_load_dwordx4 v3, s[16:19], s50 offen offset:0 sc1 lds
    buffer_load_dwordx4 v3, s[16:19], s50 offen offset:1024 sc1 lds
    buffer_load_dwordx4 v3, s[16:19], s50 offen offset:2048 sc1 lds
    buffer_load_dwordx4 v3, s[16:19], s50 offen offset:3072 sc1 lds
    s_add_u32 m0, s33, 18432
    s_mov_b64 exec, s[36:37]
    buffer_load_dwordx4 v3, s[16:19], s51 offen sc1 lds
    s_mov_b64 exec, -1
    s_add_u32 s44, s44, 18432
    s_sub_u32 s43, s43, 1
    s_cmp_lg_u32 s43, 0
    s_cbranch_scc1 sequential_preLN__sliding_block__mixer_gmlp__prompt_kernel_l5loop
    s_and_b32 s38, s2, 3
    s_lshl_b32 s38, s38, 3
    s_bfe_u32 s39, s2, 0x30003
    s_add_u32 s24, s38, s39
    s_bfe_u32 s38, s2, 0x10002
    s_lshl_b32 s38, s38, 2
    s_lshr_b32 s39, s2, 6
    s_add_u32 s25, s38, s39
    s_mul_i32 s38, s25, 368640
    s_add_u32 s38, s38, 55574528
    s_mul_i32 s12, s23, 5120
    s_add_u32 s26, s38, s12
    s_add_u32 s27, s26, 4096
    s_add_u32 s12, s12, 65536
    s_lshl_b32 s13, s24, 2
    s_add_u32 s13, s13, s23
    s_lshr_b32 s15, s13, 1
    s_lshl_b32 s13, s13, 16
    s_add_u32 s13, s13, 0
    s_lshl_b32 s15, s15, 4
    s_and_b32 s38, s23, 1
    s_add_u32 s15, s15, s38
    s_lshl_b32 s15, s15, 10
    s_add_u32 s15, s15, 8388608
    s_lshr_b32 s14, s24, 1
    s_lshl_b32 s14, s14, 11
    s_add_u32 s14, s14, 15564800
    s_cmp_eq_u32 s23, 0
    s_cselect_b64 s[54:55], -1, 0
    s_mul_i32 s38, s25, 368640
    s_and_b32 s39, s24, 7
    s_lshl_b32 s39, s39, 2
    s_add_u32 s39, s39, s23
    s_mul_i32 s39, s39, 9216
    s_add_u32 s42, s38, s39
    s_add_u32 s42, s42, 55648256
    s_waitcnt vmcnt(17)
    s_barrier
    s_mov_b32 m0, 151552
    s_nop 0
    buffer_load_dwordx4 v3, s[16:19], s42 offen offset:0 sc1 lds
    buffer_load_dwordx4 v3, s[16:19], s42 offen offset:1024 sc1 lds
    buffer_load_dwordx4 v3, s[16:19], s42 offen offset:2048 sc1 lds
    buffer_load_dwordx4 v3, s[16:19], s42 offen offset:3072 sc1 lds
    s_add_u32 s42, s42, 4096
    buffer_load_dwordx4 v3, s[16:19], s42 offen offset:0 sc1 lds
    buffer_load_dwordx4 v3, s[16:19], s42 offen offset:1024 sc1 lds
    buffer_load_dwordx4 v3, s[16:19], s42 offen offset:2048 sc1 lds
    buffer_load_dwordx4 v3, s[16:19], s42 offen offset:3072 sc1 lds
    s_add_u32 s42, s42, 4096
    buffer_load_dwordx4 v3, s[16:19], s42 offen offset:0 sc1 lds
    s_waitcnt vmcnt(17)
    s_barrier
    s_add_u32 m0, s12, 40960
    s_nop 0
    buffer_load_dwordx4 v3, s[16:19], s26 offen offset:0 sc1 lds
    buffer_load_dwordx4 v3, s[16:19], s26 offen offset:1024 sc1 lds
    buffer_load_dwordx4 v3, s[16:19], s26 offen offset:2048 sc1 lds
    buffer_load_dwordx4 v3, s[16:19], s26 offen offset:3072 sc1 lds
    s_add_u32 m0, s12, 45056
    s_add_u32 s26, s26, 20480
    buffer_load_dwordx4 v3, s[16:19], s27 offen sc1 lds
    s_add_u32 s27, s27, 20480
    s_waitcnt vmcnt(14)
    s_barrier
    s_add_u32 m0, s12, 61440
    s_nop 0
    buffer_load_dwordx4 v3, s[16:19], s26 offen offset:0 sc1 lds
    buffer_load_dwordx4 v3, s[16:19], s26 offen offset:1024 sc1 lds
    buffer_load_dwordx4 v3, s[16:19], s26 offen offset:2048 sc1 lds
    buffer_load_dwordx4 v3, s[16:19], s26 offen offset:3072 sc1 lds
    s_add_u32 m0, s12, 65536
    s_add_u32 s26, s26, 20480
    buffer_load_dwordx4 v3, s[16:19], s27 offen sc1 lds
    s_add_u32 s27, s27, 20480
    s_barrier
    s_barrier
    s_mov_b32 s52, 0x20000
    v_mov_b32 v8, 147500
sequential_preLN__sliding_block__mixer_gmlp__prompt_kernel_f5own:
    ds_read_b32 v10, v8
    s_waitcnt lgkmcnt(0)
    v_cmp_gt_u32 vcc, 4, v10
    s_sub_u32 s52, s52, 1
    s_nop 3
    s_cbranch_vccnz sequential_preLN__sliding_block__mixer_gmlp__prompt_kernel_f5own_r
sequential_preLN__sliding_block__mixer_gmlp__prompt_kernel_f5own_d:
    s_add_u32 m0, s12, 0
    s_nop 0
    buffer_load_dwordx4 v3, s[16:19], s26 offen offset:0 sc1 lds
    buffer_load_dwordx4 v3, s[16:19], s26 offen offset:1024 sc1 lds
    buffer_load_dwordx4 v3, s[16:19], s26 offen offset:2048 sc1 lds
    buffer_load_dwordx4 v3, s[16:19], s26 offen offset:3072 sc1 lds
    s_add_u32 m0, s12, 4096
    s_add_u32 s26, s26, 20480
    buffer_load_dwordx4 v3, s[16:19], s27 offen sc1 lds
    s_add_u32 s27, s27, 20480
    s_add_u32 m0, s12, 20480
    s_nop 0
    buffer_load_dwordx4 v3, s[16:19], s26 offen offset:0 sc1 lds
    buffer_load_dwordx4 v3, s[16:19], s26 offen offset:1024 sc1 lds
    buffer_load_dwordx4 v3, s[16:19], s26 offen offset:2048 sc1 lds
    buffer_load_dwordx4 v3, s[16:19], s26 offen offset:3072 sc1 lds
    s_add_u32 m0, s12, 24576
    s_add_u32 s26, s26, 20480
    buffer_load_dwordx4 v3, s[16:19], s27 offen sc1 lds
    s_add_u32 s27, s27, 20480
    s_mov_b32 s52, 0x20000
    v_mov_b32 v9, 147460
    s_cmp_lg_u32 s23, 0
    s_cbranch_scc1 sequential_preLN__sliding_block__mixer_gmlp__prompt_kernel_f5poll_l
sequential_preLN__sliding_block__mixer_gmlp__prompt_kernel_f5poll_g:
    buffer_load_dword v10, v6, s[16:19], s14 offen sc1
    s_waitcnt vmcnt(0)
    v_cmp_eq_u32 vcc, -1, v10
    s_sub_u32 s52, s52, 1
    s_nop 3
    s_cbranch_vccnz sequential_preLN__sliding_block__mixer_gmlp__prompt_kernel_f5poll_gr
sequential_preLN__sliding_block__mixer_gmlp__prompt_kernel_f5poll_gd:
    v_mov_b32_e64 v10, 1
    ds_write_b32 v9, v10
sequential_preLN__sliding_block__mixer_gmlp__prompt_kernel_f5poll_ok:
    s_add_u32 m0, s31, 32768
    s_nop 0
    buffer_load_dwordx4 v3, s[16:19], s13 offen offset:0 sc1 lds
    buffer_load_dwordx4 v3, s[16:19], s13 offen offset:1024 sc1 lds
    buffer_load_dwordx4 v3, s[16:19], s13 offen offset:2048 sc1 lds
    buffer_load_dwordx4 v3, s[16:19], s13 offen offset:3072 sc1 lds
    s_add_u32 s13, s13, 4096
    s_add_u32 m0, s31, 49152
    s_nop 0
    buffer_load_dwordx4 v3, s[16:19], s13 offen offset:0 sc1 lds
    buffer_load_dwordx4 v3, s[16:19], s13 offen offset:1024 sc1 lds
    buffer_load_dwordx4 v3, s[16:19], s13 offen offset:2048 sc1 lds
    buffer_load_dwordx4 v3, s[16:19], s13 offen offset:3072 sc1 lds
    s_add_u32 s13, s13, 4096
    s_add_u32 m0, s31, 0
    s_nop 0
    buffer_load_dwordx4 v3, s[16:19], s13 offen offset:0 sc1 lds
    buffer_load_dwordx4 v3, s[16:19], s13 offen offset:1024 sc1 lds
    buffer_load_dwordx4 v3, s[16:19], s13 offen offset:2048 sc1 lds
    buffer_load_dwordx4 v3, s[16:19], s13 offen offset:3072 sc1 lds
    s_add_u32 s13, s13, 4096
    s_waitcnt vmcnt(8)
    s_barrier
    s_add_u32 m0, s31, 16384
    s_nop 0
    buffer_load_dwordx4 v3, s[16:19], s13 offen offset:0 sc1 lds
    buffer_load_dwordx4 v3, s[16:19], s13 offen offset:1024 sc1 lds
    buffer_load_dwordx4 v3, s[16:19], s13 offen offset:2048 sc1 lds
    buffer_load_dwordx4 v3, s[16:19], s13 offen offset:3072 sc1 lds
    s_add_u32 s13, s13, 4096
    s_waitcnt vmcnt(8)
    s_barrier
    s_add_u32 s14, s14, 32768
    v_mov_b32_e64 v10, 0
    s_mov_b64 exec, s[54:55]
    buffer_load_dword v10, v6, s[16:19], s14 offen sc1
    s_mov_b64 exec, -1
    s_add_u32 m0, s12, 40960
    s_nop 0
    buffer_load_dwordx4 v3, s[16:19], s26 offen offset:0 sc1 lds
    buffer_load_dwordx4 v3, s[16:19], s26 offen offset:1024 sc1 lds
    buffer_load_dwordx4 v3, s[16:19], s26 offen offset:2048 sc1 lds
    buffer_load_dwordx4 v3, s[16:19], s26 offen offset:3072 sc1 lds
    s_add_u32 m0, s12, 45056
    s_add_u32 s26, s26, 20480
    buffer_load_dwordx4 v3, s[16:19], s27 offen sc1 lds
    s_add_u32 s27, s27, 20480
    s_mov_b32 s52, 0x20000
    s_waitcnt vmcnt(5)
    v_cmp_eq_u32 vcc, -1, v10
    s_nop 4
    s_cbranch_vccnz sequential_preLN__sliding_block__mixer_gmlp__prompt_kernel_f5b
sequential_preLN__sliding_block__mixer_gmlp__prompt_kernel_f5b_ok:
    s_waitcnt vmcnt(9)
    s_barrier
    s_add_u32 m0, s31, 32768
    s_nop 0
    buffer_load_dwordx4 v3, s[16:19], s13 offen offset:0 sc1 lds
    buffer_load_dwordx4 v3, s[16:19], s13 offen offset:1024 sc1 lds
    buffer_load_dwordx4 v3, s[16:19], s13 offen offset:2048 sc1 lds
    buffer_load_dwordx4 v3, s[16:19], s13 offen offset:3072 sc1 lds
    s_add_u32 s13, s13, 4096
    s_add_u32 m0, s31, 49152
    s_nop 0
    buffer_load_dwordx4 v3, s[16:19], s13 offen offset:0 sc1 lds
    buffer_load_dwordx4 v3, s[16:19], s13 offen offset:1024 sc1 lds
    buffer_load_dwordx4 v3, s[16:19], s13 offen offset:2048 sc1 lds
    buffer_load_dwordx4 v3, s[16:19], s13 offen offset:3072 sc1 lds
    s_add_u32 s13, s13, 4096
    s_add_u32 m0, s12, 61440
    s_nop 0
    buffer_load_dwordx4 v3, s[16:19], s26 offen offset:0 sc1 lds
    buffer_load_dwordx4 v3, s[16:19], s26 offen offset:1024 sc1 lds
    buffer_load_dwordx4 v3, s[16:19], s26 offen offset:2048 sc1 lds
    buffer_load_dwordx4 v3, s[16:19], s26 offen offset:3072 sc1 lds
    s_add_u32 m0, s12, 65536
    s_add_u32 s26, s26, 20480
    buffer_load_dwordx4 v3, s[16:19], s27 offen sc1 lds
    s_add_u32 s27, s27, 20480
    s_waitcnt vmcnt(18)
    s_barrier
    s_add_u32 m0, s31, 0
    s_nop 0
    buffer_load_dwordx4 v3, s[16:19], s13 offen offset:0 sc1 lds
    buffer_load_dwordx4 v3, s[16:19], s13 offen offset:1024 sc1 lds
    buffer_load_dwordx4 v3, s[16:19], s13 offen offset:2048 sc1 lds
    buffer_load_dwordx4 v3, s[16:19], s13 offen offset:3072 sc1 lds
    s_add_u32 s13, s13, 4096
    s_add_u32 m0, s12, 0
    s_nop 0
    buffer_load_dwordx4 v3, s[16:19], s26 offen offset:0 sc1 lds
    buffer_load_dwordx4 v3, s[16:19], s26 offen offset:1024 sc1 lds
    buffer_load_dwordx4 v3, s[16:19], s26 offen offset:2048 sc1 lds
    buffer_load_dwordx4 v3, s[16:19], s26 offen offset:3072 sc1 lds
    s_add_u32 m0, s12, 4096
    s_add_u32 s26, s26, 20480
    buffer_load_dwordx4 v3, s[16:19], s27 offen sc1 lds
    s_add_u32 s27, s27, 20480
    s_waitcnt vmcnt(18)
    s_barrier
    s_add_u32 s14, s14, 32768
    v_mov_b32_e64 v10, 0
    s_mov_b64 exec, s[54:55]
    buffer_load_dword v10, v6, s[16:19], s14 offen sc1
    s_mov_b64 exec, -1
    s_add_u32 m0, s31, 16384
    s_nop 0
    buffer_load_dwordx4 v3, s[16:19], s13 offen offset:0 sc1 lds
    buffer_load_dwordx4 v3, s[16:19], s13 offen offset:1024 sc1 lds
    buffer_load_dwordx4 v3, s[16:19], s13 offen offset:2048 sc1 lds
    buffer_load_dwordx4 v3, s[16:19], s13 offen offset:3072 sc1 lds
    s_add_u32 s13, s13, 4096
    s_add_u32 m0, s12, 20480
    s_nop 0
    buffer_load_dwordx4 v3, s[16:19], s26 offen offset:0 sc1 lds
    buffer_load_dwordx4 v3, s[16:19], s26 offen offset:1024 sc1 lds
    buffer_load_dwordx4 v3, s[16:19], s26 offen offset:2048 sc1 lds
    buffer_load_dwordx4 v3, s[16:19], s26 offen offset:3072 sc1 lds
    s_add_u32 m0, s12, 24576
    s_add_u32 s26, s26, 20480
    buffer_load_dwordx4 v3, s[16:19], s27 offen sc1 lds
    s_add_u32 s27, s27, 20480
    s_mov_b32 s52, 0x20000
    s_waitcnt vmcnt(9)
    v_cmp_eq_u32 vcc, -1, v10
    s_nop 4
    s_cbranch_vccnz sequential_preLN__sliding_block__mixer_gmlp__prompt_kernel_f5c
sequential_preLN__sliding_block__mixer_gmlp__prompt_kernel_f5c_ok:
    s_mov_b32 s43, 2
sequential_preLN__sliding_block__mixer_gmlp__prompt_kernel_l6loop:
    s_waitcnt vmcnt(18)
    s_barrier
    s_add_u32 m0, s31, 32768
    s_nop 0
    buffer_load_dwordx4 v3, s[16:19], s13 offen offset:0 sc1 lds
    buffer_load_dwordx4 v3, s[16:19], s13 offen offset:1024 sc1 lds
    buffer_load_dwordx4 v3, s[16:19], s13 offen offset:2048 sc1 lds
    buffer_load_dwordx4 v3, s[16:19], s13 offen offset:3072 sc1 lds
    s_add_u32 s13, s13, 4096
    s_add_u32 m0, s12, 40960
    s_nop 0
    buffer_load_dwordx4 v3, s[16:19], s26 offen offset:0 sc1 lds
    buffer_load_dwordx4 v3, s[16:19], s26 offen offset:1024 sc1 lds
    buffer_load_dwordx4 v3, s[16:19], s26 offen offset:2048 sc1 lds
    buffer_load_dwordx4 v3, s[16:19], s26 offen offset:3072 sc1 lds
    s_add_u32 m0, s12, 45056
    s_add_u32 s26, s26, 20480
    buffer_load_dwordx4 v3, s[16:19], s27 offen sc1 lds
    s_add_u32 s27, s27, 20480
    s_waitcnt vmcnt(18)
    s_barrier
    s_add_u32 m0, s31, 49152
    s_nop 0
    buffer_load_dwordx4 v3, s[16:19], s13 offen offset:0 sc1 lds
    buffer_load_dwordx4 v3, s[16:19], s13 offen offset:1024 sc1 lds
    buffer_load_dwordx4 v3, s[16:19], s13 offen offset:2048 sc1 lds
    buffer_load_dwordx4 v3, s[16:19], s13 offen offset:3072 sc1 lds
    s_add_u32 s13, s13, 4096
    s_add_u32 m0, s12, 61440
    s_nop 0
    buffer_load_dwordx4 v3, s[16:19], s26 offen offset:0 sc1 lds
    buffer_load_dwordx4 v3, s[16:19], s26 offen offset:1024 sc1 lds
    buffer_load_dwordx4 v3, s[16:19], s26 offen offset:2048 sc1 lds
    buffer_load_dwordx4 v3, s[16:19], s26 offen offset:3072 sc1 lds
    s_add_u32 m0, s12, 65536
    s_add_u32 s26, s26, 20480
    buffer_load_dwordx4 v3, s[16:19], s27 offen sc1 lds
    s_add_u32 s27, s27, 20480
    s_waitcnt vmcnt(18)
    s_barrier
    s_add_u32 m0, s31, 0
    s_nop 0
    buffer_load_dwordx4 v3, s[16:19], s13 offen offset:0 sc1 lds
    buffer_load_dwordx4 v3, s[16:19], s13 offen offset:1024 sc1 lds
    buffer_load_dwordx4 v3, s[16:19], s13 offen offset:2048 sc1 lds
    buffer_load_dwordx4 v3, s[16:19], s13 offen offset:3072 sc1 lds
    s_add_u32 s13, s13, 4096
    s_add_u32 m0, s12, 0
    s_nop 0
    buffer_load_dwordx4 v3, s[16:19], s26 offen offset:0 sc1 lds
    buffer_load_dwordx4 v3, s[16:19], s26 offen offset:1024 sc1 lds
    buffer_load_dwordx4 v3, s[16:19], s26 offen offset:2048 sc1 lds
    buffer_load_dwordx4 v3, s[16:19], s26 offen offset:3072 sc1 lds
    s_add_u32 m0, s12, 4096
    s_add_u32 s26, s26, 20480
    buffer_load_dwordx4 v3, s[16:19], s27 offen sc1 lds
    s_add_u32 s27, s27, 20480
    s_waitcnt vmcnt(18)
    s_barrier
    s_add_u32 m0, s31, 16384
    s_nop 0
    buffer_load_dwordx4 v3, s[16:19], s13 offen offset:0 sc1 lds
    buffer_load_dwordx4 v3, s[16:19], s13 offen offset:1024 sc1 lds
    buffer_load_dwordx4 v3, s[16:19], s13 offen offset:2048 sc1 lds
    buffer_load_dwordx4 v3, s[16:19], s13 offen offset:3072 sc1 lds
    s_add_u32 s13, s13, 4096
    s_add_u32 m0, s12, 20480
    s_nop 0
    buffer_load_dwordx4 v3, s[16:19], s26 offen offset:0 sc1 lds
    buffer_load_dwordx4 v3, s[16:19], s26 offen offset:1024 sc1 lds
    buffer_load_dwordx4 v3, s[16:19], s26 offen offset:2048 sc1 lds
    buffer_load_dwordx4 v3, s[16:19], s26 offen offset:3072 sc1 lds
    s_add_u32 m0, s12, 24576
    s_add_u32 s26, s26, 20480
    buffer_load_dwordx4 v3, s[16:19], s27 offen sc1 lds
    s_add_u32 s27, s27, 20480
    s_sub_u32 s43, s43, 1
    s_cmp_lg_u32 s43, 0
    s_cbranch_scc1 sequential_preLN__sliding_block__mixer_gmlp__prompt_kernel_l6loop
    s_waitcnt vmcnt(18)
    s_barrier
    s_add_u32 m0, s31, 32768
    s_nop 0
    buffer_load_dwordx4 v3, s[16:19], s15 offen offset:0 sc1 lds
    s_add_u32 s15, s15, 1024
    buffer_load_dwordx4 v3, s[16:19], s15 offen offset:1024 sc1 lds
    s_add_u32 s15, s15, 1024
    buffer_load_dwordx4 v3, s[16:19], s15 offen offset:2048 sc1 lds
    s_add_u32 s15, s15, 1024
    buffer_load_dwordx4 v3, s[16:19], s15 offen offset:3072 sc1 lds
    s_add_u32 s15, s15, 1024
    s_add_u32 s15, s15, 4096
    s_add_u32 m0, s12, 40960
    s_nop 0
    buffer_load_dwordx4 v3, s[16:19], s26 offen offset:0 sc1 lds
    buffer_load_dwordx4 v3, s[16:19], s26 offen offset:1024 sc1 lds
    buffer_load_dwordx4 v3, s[16:19], s26 offen offset:2048 sc1 lds
    buffer_load_dwordx4 v3, s[16:19], s26 offen offset:3072 sc1 lds
    s_add_u32 m0, s12, 45056
    s_add_u32 s26, s26, 20480
    buffer_load_dwordx4 v3, s[16:19], s27 offen sc1 lds
    s_add_u32 s27, s27, 20480
    s_waitcnt vmcnt(18)
    s_barrier
    s_add_u32 m0, s31, 49152
    s_nop 0
    buffer_load_dwordx4 v3, s[16:19], s15 offen offset:0 sc1 lds
    s_add_u32 s15, s15, 1024
    buffer_load_dwordx4 v3, s[16:19], s15 offen offset:1024 sc1 lds
    s_add_u32 s15, s15, 1024
    buffer_load_dwordx4 v3, s[16:19], s15 offen offset:2048 sc1 lds
    s_add_u32 s15, s15, 1024
    buffer_load_dwordx4 v3, s[16:19], s15 offen offset:3072 sc1 lds
    s_add_u32 s15, s15, 1024
    s_add_u32 s15, s15, 4096
    s_add_u32 m0, s12, 61440
    s_nop 0
    buffer_load_dwordx4 v3, s[16:19], s26 offen offset:0 sc1 lds
    buffer_load_dwordx4 v3, s[16:19], s26 offen offset:1024 sc1 lds
    buffer_load_dwordx4 v3, s[16:19], s26 offen offset:2048 sc1 lds
    buffer_load_dwordx4 v3, s[16:19], s26 offen offset:3072 sc1 lds
    s_add_u32 m0, s12, 65536
    s_add_u32 s26, s26, 20480
    buffer_load_dwordx4 v3, s[16:19], s27 offen sc1 lds
    s_add_u32 s27, s27, 20480
    s_waitcnt vmcnt(18)
    s_barrier
    s_waitcnt vmcnt(9)
    s_barrier
    s_waitcnt vmcnt(0)
    s_barrier
sequential_preLN__sliding_block__mixer_gmlp__prompt_kernel_end:
    s_endpgm
sequential_preLN__sliding_block__mixer_gmlp__prompt_kernel_c1poll:
    s_cmp_lg_u32 s23, 0
    s_cbranch_scc1 sequential_preLN__sliding_block__mixer_gmlp__prompt_kernel_c1poll_l
sequential_preLN__sliding_block__mixer_gmlp__prompt_kernel_c1poll_g:
    s_sleep 8
    buffer_load_dword v10, v8, s[44:47], 0 offen sc1
    s_waitcnt vmcnt(0)
    v_cmp_gt_u32_e64 vcc, 1, v10
    s_sub_u32 s52, s52, 1
    s_nop 3
    s_cbranch_vccz sequential_preLN__sliding_block__mixer_gmlp__prompt_kernel_c1poll_ok
    s_cmp_eq_u32 s52, 0
    s_cbranch_scc1 sequential_preLN__sliding_block__mixer_gmlp__prompt_kernel_c1poll_ok
    s_branch sequential_preLN__sliding_block__mixer_gmlp__prompt_kernel_c1poll_g
sequential_preLN__sliding_block__mixer_gmlp__prompt_kernel_c1poll_l:
    ds_read_b32 v10, v9
    s_waitcnt lgkmcnt(0)
    v_cmp_ne_u32 vcc, 0, v10
    s_sub_u32 s52, s52, 1
    s_nop 3
    s_cbranch_vccnz sequential_preLN__sliding_block__mixer_gmlp__prompt_kernel_c1poll_ok
    s_cmp_eq_u32 s52, 0
    s_cbranch_scc1 sequential_preLN__sliding_block__mixer_gmlp__prompt_kernel_c1poll_ok
    s_sleep 2
    s_branch sequential_preLN__sliding_block__mixer_gmlp__prompt_kernel_c1poll_l
sequential_preLN__sliding_block__mixer_gmlp__prompt_kernel_f1r:
    s_cmp_eq_u32 s42, 0
    s_cbranch_scc1 sequential_preLN__sliding_block__mixer_gmlp__prompt_kernel_f1ok
    s_sleep 3
    s_branch sequential_preLN__sliding_block__mixer_gmlp__prompt_kernel_f1g
sequential_preLN__sliding_block__mixer_gmlp__prompt_kernel_g3r:
    s_sleep 8
    buffer_load_dword v248, v249, s[24:27], 0 offen sc1
    s_waitcnt vmcnt(0)
    v_cmp_eq_u32 vcc, 0, v248
    s_sub_u32 s42, s42, 1
    s_nop 3
    s_cbranch_vccz sequential_preLN__sliding_block__mixer_gmlp__prompt_kernel_g3ok
    s_cmp_eq_u32 s42, 0
    s_cbranch_scc1 sequential_preLN__sliding_block__mixer_gmlp__prompt_kernel_g3ok
    s_branch sequential_preLN__sliding_block__mixer_gmlp__prompt_kernel_g3r
sequential_preLN__sliding_block__mixer_gmlp__prompt_kernel_f2poll:
    buffer_load_dword v10, v6, s[16:19], s42 offen sc1
    s_waitcnt vmcnt(0)
    v_cmp_eq_u32_e64 vcc, -1, v10
    s_sub_u32 s52, s52, 1
    s_nop 3
    s_cbranch_vccz sequential_preLN__sliding_block__mixer_gmlp__prompt_kernel_f2poll_ok
    s_cmp_eq_u32 s52, 0
    s_cbranch_scc1 sequential_preLN__sliding_block__mixer_gmlp__prompt_kernel_f2poll_ok
    s_sleep 2
    s_branch sequential_preLN__sliding_block__mixer_gmlp__prompt_kernel_f2poll
sequential_preLN__sliding_block__mixer_gmlp__prompt_kernel_g2B:
    s_load_dwordx2 s[12:13], s[0:1], 72
    s_mov_b32 s14, 256
    s_mov_b32 s15, 0x20000
    s_waitcnt lgkmcnt(0)
sequential_preLN__sliding_block__mixer_gmlp__prompt_kernel_g2B_l:
    s_sleep 8
    buffer_load_dword v248, v249, s[12:15], 0 offen sc1
    s_waitcnt vmcnt(0)
    v_cmp_eq_u32 vcc, 0, v248
    s_sub_u32 s52, s52, 1
    s_nop 3
    s_cbranch_vccz sequential_preLN__sliding_block__mixer_gmlp__prompt_kernel_g2B_ok
    s_cmp_eq_u32 s52, 0
    s_cbranch_scc1 sequential_preLN__sliding_block__mixer_gmlp__prompt_kernel_g2B_ok
    s_branch sequential_preLN__sliding_block__mixer_gmlp__prompt_kernel_g2B_l
sequential_preLN__sliding_block__mixer_gmlp__prompt_kernel_f3poll_ar:
    s_cmp_eq_u32 s52, 0
    s_cbranch_scc1 sequential_preLN__sliding_block__mixer_gmlp__prompt_kernel_f3poll_ad
    s_sleep 1
    s_branch sequential_preLN__sliding_block__mixer_gmlp__prompt_kernel_f3poll_a
sequential_preLN__sliding_block__mixer_gmlp__prompt_kernel_f3poll_gr:
    s_cmp_eq_u32 s52, 0
    s_cbranch_scc1 sequential_preLN__sliding_block__mixer_gmlp__prompt_kernel_f3poll_gd
    s_sleep 2
    s_branch sequential_preLN__sliding_block__mixer_gmlp__prompt_kernel_f3poll_g
sequential_preLN__sliding_block__mixer_gmlp__prompt_kernel_f3poll_l:
    ds_read_b32 v10, v9
    s_waitcnt lgkmcnt(0)
    v_cmp_ne_u32_e64 vcc, 0, v10
    s_sub_u32 s52, s52, 1
    s_nop 3
    s_cbranch_vccnz sequential_preLN__sliding_block__mixer_gmlp__prompt_kernel_f3poll_ok
    s_cmp_eq_u32 s52, 0
    s_cbranch_scc1 sequential_preLN__sliding_block__mixer_gmlp__prompt_kernel_f3poll_ok
    s_sleep 1
    s_branch sequential_preLN__sliding_block__mixer_gmlp__prompt_kernel_f3poll_l
sequential_preLN__sliding_block__mixer_gmlp__prompt_kernel_g2A:
    s_load_dwordx2 s[12:13], s[0:1], 72
    s_mov_b32 s14, 256
    s_mov_b32 s15, 0x20000
    s_waitcnt lgkmcnt(0)
sequential_preLN__sliding_block__mixer_gmlp__prompt_kernel_g2A_l:
    s_sleep 8
    buffer_load_dword v248, v249, s[12:15], 0 offen sc1
    s_waitcnt vmcnt(0)
    v_cmp_eq_u32 vcc, 0, v248
    s_sub_u32 s52, s52, 1
    s_nop 3
    s_cbranch_vccz sequential_preLN__sliding_block__mixer_gmlp__prompt_kernel_g2A_ok
    s_cmp_eq_u32 s52, 0
    s_cbranch_scc1 sequential_preLN__sliding_block__mixer_gmlp__prompt_kernel_g2A_ok
    s_branch sequential_preLN__sliding_block__mixer_gmlp__prompt_kernel_g2A_l
sequential_preLN__sliding_block__mixer_gmlp__prompt_kernel_zpoll:
    buffer_load_dwordx2 v[104:105], v11, s[16:19], s42 offen offset:0 sc1
    buffer_load_dwordx2 v[106:107], v11, s[16:19], s42 offen offset:2048 sc1
    buffer_load_dwordx2 v[108:109], v11, s[16:19], s43 offen offset:0 sc1
    buffer_load_dwordx2 v[110:111], v11, s[16:19], s43 offen offset:2048 sc1
    buffer_load_dwordx2 v[112:113], v11, s[16:19], s50 offen offset:0 sc1
    buffer_load_dwordx2 v[114:115], v11, s[16:19], s50 offen offset:2048 sc1
    buffer_load_dwordx2 v[116:117], v11, s[16:19], s51 offen offset:0 sc1
    buffer_load_dwordx2 v[118:119], v11, s[16:19], s51 offen offset:2048 sc1
    s_waitcnt vmcnt(0)
    v_max3_u32 v9, v105, v107, v109
    v_max3_u32 v9, v9, v111, v113
    v_max3_u32 v9, v9, v115, v117
    v_max_u32 v9, v9, v119
    v_cmp_eq_u32_e64 vcc, -1, v9
    s_sub_u32 s52, s52, 1
    s_nop 3
    s_cbranch_vccz sequential_preLN__sliding_block__mixer_gmlp__prompt_kernel_zpoll_ok
    s_cmp_eq_u32 s52, 0
    s_cbranch_scc1 sequential_preLN__sliding_block__mixer_gmlp__prompt_kernel_zpoll_ok
    s_branch sequential_preLN__sliding_block__mixer_gmlp__prompt_kernel_zpoll
sequential_preLN__sliding_block__mixer_gmlp__prompt_kernel_f4poll_ar:
    s_cmp_eq_u32 s52, 0
    s_cbranch_scc1 sequential_preLN__sliding_block__mixer_gmlp__prompt_kernel_f4poll_ad
    s_sleep 1
    s_branch sequential_preLN__sliding_block__mixer_gmlp__prompt_kernel_f4poll_a
sequential_preLN__sliding_block__mixer_gmlp__prompt_kernel_f4poll_gr:
    s_cmp_eq_u32 s52, 0
    s_cbranch_scc1 sequential_preLN__sliding_block__mixer_gmlp__prompt_kernel_f4poll_gd
    s_sleep 2
    s_branch sequential_preLN__sliding_block__mixer_gmlp__prompt_kernel_f4poll_g
sequential_preLN__sliding_block__mixer_gmlp__prompt_kernel_f4poll_l:
    ds_read_b32 v10, v9
    s_waitcnt lgkmcnt(0)
    v_cmp_ne_u32_e64 vcc, 0, v10
    s_sub_u32 s52, s52, 1
    s_nop 3
    s_cbranch_vccnz sequential_preLN__sliding_block__mixer_gmlp__prompt_kernel_f4poll_ok
    s_cmp_eq_u32 s52, 0
    s_cbranch_scc1 sequential_preLN__sliding_block__mixer_gmlp__prompt_kernel_f4poll_ok
    s_sleep 1
    s_branch sequential_preLN__sliding_block__mixer_gmlp__prompt_kernel_f4poll_l
sequential_preLN__sliding_block__mixer_gmlp__prompt_kernel_f5own_r:
    s_cmp_eq_u32 s52, 0
    s_cbranch_scc1 sequential_preLN__sliding_block__mixer_gmlp__prompt_kernel_f5own_d
    s_sleep 1
    s_branch sequential_preLN__sliding_block__mixer_gmlp__prompt_kernel_f5own
sequential_preLN__sliding_block__mixer_gmlp__prompt_kernel_f5poll_gr:
    s_cmp_eq_u32 s52, 0
    s_cbranch_scc1 sequential_preLN__sliding_block__mixer_gmlp__prompt_kernel_f5poll_gd
    s_sleep 2
    s_branch sequential_preLN__sliding_block__mixer_gmlp__prompt_kernel_f5poll_g
sequential_preLN__sliding_block__mixer_gmlp__prompt_kernel_f5poll_l:
    ds_read_b32 v10, v9
    s_waitcnt lgkmcnt(0)
    v_cmp_ne_u32_e64 vcc, 0, v10
    s_sub_u32 s52, s52, 1
    s_nop 3
    s_cbranch_vccnz sequential_preLN__sliding_block__mixer_gmlp__prompt_kernel_f5poll_ok
    s_cmp_eq_u32 s52, 0
    s_cbranch_scc1 sequential_preLN__sliding_block__mixer_gmlp__prompt_kernel_f5poll_ok
    s_sleep 1
    s_branch sequential_preLN__sliding_block__mixer_gmlp__prompt_kernel_f5poll_l
sequential_preLN__sliding_block__mixer_gmlp__prompt_kernel_f5b:
    buffer_load_dword v10, v6, s[16:19], s14 offen sc1
    s_waitcnt vmcnt(0)
    v_cmp_eq_u32_e64 vcc, -1, v10
    s_sub_u32 s52, s52, 1
    s_nop 3
    s_cbranch_vccz sequential_preLN__sliding_block__mixer_gmlp__prompt_kernel_f5b_ok
    s_cmp_eq_u32 s52, 0
    s_cbranch_scc1 sequential_preLN__sliding_block__mixer_gmlp__prompt_kernel_f5b_ok
    s_sleep 2
    s_branch sequential_preLN__sliding_block__mixer_gmlp__prompt_kernel_f5b
sequential_preLN__sliding_block__mixer_gmlp__prompt_kernel_f5c:
    buffer_load_dword v10, v6, s[16:19], s14 offen sc1
    s_waitcnt vmcnt(0)
    v_cmp_eq_u32 vcc, -1, v10
    s_sub_u32 s52, s52, 1
    s_nop 3
    s_cbranch_vccz sequential_preLN__sliding_block__mixer_gmlp__prompt_kernel_f5c_ok
    s_cmp_eq_u32 s52, 0
    s_cbranch_scc1 sequential_preLN__sliding_block__mixer_gmlp__prompt_kernel_f5c_ok
    s_sleep 2
    s_branch sequential_preLN__sliding_block__mixer_gmlp__prompt_kernel_f5c
sequential_preLN__sliding_block__mixer_gmlp__prompt_kernel_codeend:
    s_endpgm
.section .rodata,"a"
.p2align 6
.amdhsa_kernel sequential_preLN__sliding_block__mixer_gmlp__prompt_kernel
  .amdhsa_next_free_vgpr 255
  .amdhsa_next_free_sgpr 56
  .amdhsa_accum_offset 256
  .amdhsa_group_segment_fixed_size 0
  .amdhsa_kernarg_size 88
  .amdhsa_user_sgpr_count 2
  .amdhsa_user_sgpr_kernarg_segment_ptr 1
  .amdhsa_system_sgpr_workgroup_id_x 1
  .amdhsa_float_denorm_mode_32 3
.end_amdhsa_kernel
```
